```python
import torch

def _softmax(x, axis=-1):
    return torch.softmax(x, dim=axis)

def _gelu(x):
    return torch.nn.functional.gelu(x, approximate='tanh')

def _silu(x):
    return torch.nn.functional.silu(x)

def _sigmoid(x):
    return torch.sigmoid(x)

def _layernorm(x, axis=-1, eps=1e-05):
    m = x.mean(dim=axis, keepdim=True)
    v = x.var(dim=axis, keepdim=True, unbiased=False)
    return (x - m) / torch.sqrt(v + eps)

def _scatter_add(tgt, idx, src, axis=0):
    return tgt.clone().index_add_(axis, idx, src)

def _segment_sum(src, seg, n):
    out = torch.zeros((n,) + src.shape[1:], dtype=src.dtype)
    return out.index_add_(0, seg, src)

def _pad(x, pw):
    flat = tuple((v for pair in reversed(pw) for v in pair))
    return torch.nn.functional.pad(x, flat)
kernel_name = 'parallel_sum__memory_aug_recurrent_mem_tr__glu_gated_reglu__prompt'

def setup_inputs():

    _w = lambda a: (lambda t: t.to(torch.bfloat16) if t.is_floating_point() else t)(torch.as_tensor(a))

    def _A_setup():
        B, S, Dm = (1, 2048, 512)
        H, Dh = (32, 128)
        M, seg = (8, 32)
        seg = min(seg, S)
        S = S // seg * seg
        return {'x': _w((lambda *s: torch.randn(*s, dtype=torch.bfloat16) * 0.05)(B, S, Dm)), 'mem0': _w((lambda *s: torch.randn(*s, dtype=torch.bfloat16) * 0.2)(B, M, Dm)), 'Wq': _w((lambda *s: torch.randn(*s, dtype=torch.bfloat16) * 1.6)(Dm, H, Dh) * Dm ** (-0.5)), 'Wk': _w((lambda *s: torch.randn(*s, dtype=torch.bfloat16) * 1.6)(Dm, H, Dh) * Dm ** (-0.5)), 'Wv': _w((lambda *s: torch.randn(*s, dtype=torch.bfloat16) * 0.2)(Dm, H, Dh) * Dm ** (-0.5)), 'Wo': _w((lambda *s: torch.randn(*s, dtype=torch.bfloat16) * 0.2)(H, Dh, Dm) * (H * Dh) ** (-0.5)), 'seg_len': seg}
    _A_in = _A_setup()

    def _B_setup():
        B, S, D, F = (1, 2048, 512, 1792)
        return {'x': _w((lambda *s: torch.randn(*s, dtype=torch.bfloat16) * 0.05)(B, S, D)), 'W_gate': _w((lambda *s: torch.randn(*s, dtype=torch.bfloat16) * 0.2)(D, F) * (2.0 / D) ** 0.5), 'W_up': _w((lambda *s: torch.randn(*s, dtype=torch.bfloat16) * 0.2)(D, F) * (2.0 / D) ** 0.5), 'W_down': _w((lambda *s: torch.randn(*s, dtype=torch.bfloat16) * 0.2)(F, D) * (1.0 / F) ** 0.5)}
    _B_in = _B_setup()
    return {'A_x': _A_in['x'], 'A_mem0': _A_in['mem0'], 'A_Wq': _A_in['Wq'], 'A_Wk': _A_in['Wk'], 'A_Wv': _A_in['Wv'], 'A_Wo': _A_in['Wo'], 'A_seg_len': _A_in['seg_len'], 'B_x': _B_in['x'], 'B_W_gate': _B_in['W_gate'], 'B_W_up': _B_in['W_up'], 'B_W_down': _B_in['W_down']}

def reference(A_x, A_mem0, A_Wq, A_Wk, A_Wv, A_Wo, A_seg_len, B_x, B_W_gate, B_W_up, B_W_down):

    def _A_ref(x, mem0, Wq, Wk, Wv, Wo, seg_len):
        B, S, Dm = x.shape
        H, Dh = (Wq.shape[1], Wq.shape[2])
        M = mem0.shape[1]
        scale = Dh ** (-0.5)
        n_seg = S // seg_len
        L = M + seg_len
        idx = torch.arange(L)
        mask = (idx[:, None] < M) | (idx[:, None] >= idx[None, :])
        mem = mem0
        outs = []
        for s in range(n_seg):
            xs = x[:, s * seg_len:(s + 1) * seg_len, :].clone()
            h = torch.concatenate([mem, xs], axis=1)
            q = torch.einsum('btd,dhe->bhte', h, Wq)
            k = torch.einsum('btd,dhe->bhte', h, Wk)
            v = torch.einsum('btd,dhe->bhte', h, Wv)
            scores = torch.einsum('bhqe,bhke->bhqk', q, k) * scale
            scores = torch.where(mask[None, None], scores, -1000000000.0)
            p = _softmax(scores, axis=-1)
            o = torch.einsum('bhqk,bhke->bhqe', p, v)
            o = torch.einsum('bhte,hed->btd', o, Wo)
            mem = o[:, :M, :].clone()
            outs.append(o[:, M:, :])
        return torch.concatenate(outs, axis=1)

    def _B_ref(x, W_gate, W_up, W_down):
        gate = torch.einsum('bsd,df->bsf', x, W_gate)
        up = torch.einsum('bsd,df->bsf', x, W_up)
        gate = gate * (lambda x, dt: x.to(dt))(gate > 0, gate.dtype)
        h = gate * up
        return torch.einsum('bsf,fd->bsd', h, W_down)
    x = A_x
    xn = _layernorm(x, axis=-1)
    return x + _A_ref(xn, A_mem0, A_Wq, A_Wk, A_Wv, A_Wo, A_seg_len) + _B_ref(xn, B_W_gate, B_W_up, B_W_down)
```

```asm
; @launch grid=(256,1,1) block=(256,1,1) lds=163840
.amdgcn_target "amdgcn-amd-amdhsa--gfx950"
.text
.globl parallel_sum__memory_aug_recurrent_mem_tr__glu_gated_reglu__prompt_kernel
.p2align 8
.type parallel_sum__memory_aug_recurrent_mem_tr__glu_gated_reglu__prompt_kernel,@function
parallel_sum__memory_aug_recurrent_mem_tr__glu_gated_reglu__prompt_kernel:
    s_cmp_ge_u32 s2, 256
    s_cbranch_scc1 L_abort
    s_load_dwordx8 s[4:11], s[0:1], 0
    s_load_dwordx4 s[12:15], s[0:1], 32
    s_load_dwordx8 s[16:23], s[0:1], 64
    s_load_dwordx4 s[24:27], s[0:1], 96
    s_getreg_b32 s46, hwreg(HW_REG_XCC_ID)
    s_and_b32 s46, s46, 7
    v_lshrrev_b32 v1, 6, v0
    v_and_b32 v0, 63, v0
    v_readfirstlane_b32 s44, v1
    v_lshlrev_b32 v0, 4, v0
    s_mov_b32 s52, 0x05040100
    s_mov_b32 s53, 0x07060302
    s_mov_b32 s59, 1040356334
    s_waitcnt lgkmcnt(0)
    s_load_dwordx2 s[42:43], s[26:27], 0
    s_mov_b32 s28, s26
    s_and_b32 s29, s27, 0xffff
    s_mov_b32 s30, 268435456
    s_mov_b32 s31, 0x20000
    s_mov_b32 s50, s46
    s_and_b32 s54, s2, 7
    s_lshl_b32 s45, s54, 5
    s_lshr_b32 s56, s2, 3
    s_add_u32 s45, s45, s56
    s_mov_b32 s51, 0
L_dispatch:
    s_cmp_ge_u32 s45, 32
    s_cbranch_scc1 L_worker
    s_mov_b32 s65, s45
    s_and_b32 s54, s44, 3
    s_lshl_b32 s47, s54, 12
    s_lshl_b32 s54, s54, 6
    v_xor_b32 v49, s54, v0
    v_lshrrev_b32 v48, 8, v0
    v_mul_u32_u24 v48, 7936, v48
    v_add_u32 v48, v48, v49
    s_mov_b32 s32, s14
    s_and_b32 s33, s15, 0xffff
    s_mov_b32 s34, 4194304
    s_mov_b32 s35, 0x20000
    s_lshl_b32 s48, s65, 17
    s_add_u32 s48, s48, s47
    s_add_u32 m0, s47, 98304
    s_add_u32 s54, s48, 0
    buffer_load_dwordx4 v49, s[32:35], s54 offen offset:0 lds
    buffer_load_dwordx4 v49, s[32:35], s54 offen offset:1024 lds
    buffer_load_dwordx4 v49, s[32:35], s54 offen offset:2048 lds
    buffer_load_dwordx4 v49, s[32:35], s54 offen offset:3072 lds
    s_add_u32 m0, s47, 131072
    s_add_u32 s54, s48, 16384
    buffer_load_dwordx4 v49, s[32:35], s54 offen offset:0 lds
    buffer_load_dwordx4 v49, s[32:35], s54 offen offset:1024 lds
    buffer_load_dwordx4 v49, s[32:35], s54 offen offset:2048 lds
    buffer_load_dwordx4 v49, s[32:35], s54 offen offset:3072 lds
    s_add_u32 m0, s47, 8192
    s_add_u32 s54, s48, 32768
    buffer_load_dwordx4 v49, s[32:35], s54 offen offset:0 lds
    buffer_load_dwordx4 v49, s[32:35], s54 offen offset:1024 lds
    buffer_load_dwordx4 v49, s[32:35], s54 offen offset:2048 lds
    buffer_load_dwordx4 v49, s[32:35], s54 offen offset:3072 lds
    s_add_u32 m0, s47, 32768
    s_add_u32 s54, s48, 49152
    buffer_load_dwordx4 v49, s[32:35], s54 offen offset:0 lds
    buffer_load_dwordx4 v49, s[32:35], s54 offen offset:1024 lds
    buffer_load_dwordx4 v49, s[32:35], s54 offen offset:2048 lds
    buffer_load_dwordx4 v49, s[32:35], s54 offen offset:3072 lds
    s_waitcnt lgkmcnt(0)
    s_add_u32 s42, s42, 0x7F4A7C15
    s_addc_u32 s43, s43, 0x9E3779B9
    s_or_b32 s54, s2, s44
    s_cbranch_scc1 L_nz_1
    s_mov_b32 s55, 2048
    s_add_u32 s56, s42, s50
    s_addc_u32 s57, s43, 0
    v_mov_b32 v16, s56
    v_mov_b32 v17, s57
    s_mov_b64 exec, 1
    buffer_store_dwordx2 v[16:17], off, s[28:31], s55 sc1
    s_mov_b64 exec, -1
L_nz_1:
    s_lshl_b32 s54, s44, 5
    s_add_u32 s57, s54, s65
    v_lshrrev_b32 v24, 4, v0
    v_lshrrev_b32 v25, 4, v24
    v_and_b32 v26, 15, v24
    s_lshl_b32 s54, s57, 11
    s_add_u32 s66, s54, 262144
    s_add_u32 s67, s54, 524288
    v_and_b32 v27, 3, v24
    v_lshlrev_b32 v27, 2, v27
    v_lshl_add_u32 v27, v25, 4, v27
    s_lshl_b32 s54, s57, 6
    v_add_u32 v5, s54, v27
    v_lshrrev_b32 v27, 4, v26
    v_lshl_add_u32 v5, v27, 13, v5
    s_and_b32 s101, s65, 0
    s_lshl_b32 s101, s101, 2
    s_add_u32 s101, s101, s44
    s_lshl_b32 s101, s101, 11
    s_mov_b32 s68, 131072
    s_mov_b32 s69, 163840
    s_mov_b32 s70, 196608
    v_mov_b32 v32, -1
    v_mov_b32 v33, -1
    v_mov_b32 v34, -1
    v_mov_b32 v35, -1
    buffer_store_dwordx4 v[32:35], v0, s[28:31], s66 offen sc1
    buffer_store_dwordx4 v[32:35], v0, s[28:31], s66 offen offset:1024 sc1
    buffer_store_dwordx4 v[32:35], v0, s[28:31], s67 offen sc1
    buffer_store_dwordx4 v[32:35], v0, s[28:31], s67 offen offset:1024 sc1
    buffer_store_dword v32, v5, s[28:31], s68 offen sc1
    buffer_store_dword v32, v5, s[28:31], s69 offen sc1
    buffer_store_dword v32, v5, s[28:31], s70 offen sc1
    v_lshrrev_b32 v27, 3, v26
    v_lshl_add_u32 v27, v27, 2, v25
    v_lshlrev_b32 v27, 11, v27
    v_and_b32 v28, 7, v26
    v_lshl_add_u32 v27, v28, 3, v27
    s_lshl_b32 s54, s44, 14
    s_lshl_b32 s55, s65, 6
    s_add_u32 s54, s54, s55
    v_add_u32 v7, s54, v27
    s_lshl_b32 s54, s44, 15
    s_add_u32 s54, s54, 32768
    v_add_u32 v1, s54, v0
    s_lshl_b32 s54, s44, 11
    v_add_u32 v2, s54, v0
    s_lshl_b32 s73, s44, 12
    s_add_u32 s73, s73, 8192
    v_mov_b32 v11, v0
    v_lshrrev_b32 v27, 2, v26
    v_lshlrev_b32 v27, 7, v27
    v_lshl_add_u32 v27, v25, 5, v27
    v_and_b32 v28, 3, v26
    v_lshl_add_u32 v27, v28, 2, v27
    s_lshl_b32 s54, s44, 10
    s_add_u32 s54, s54, 24576
    v_add_u32 v3, s54, v27
    v_lshrrev_b32 v27, 2, v26
    v_and_b32 v28, 1, v26
    v_lshl_add_u32 v36, v27, 1, v28
    v_lshlrev_b32 v27, 4, v36
    v_lshl_add_u32 v27, v25, 7, v27
    v_add_u32 v4, 24576, v27
    v_and_b32 v27, 2, v26
    v_mov_b32 v10, 0x4444
    v_mov_b32 v28, 0xeeee
    v_cmp_eq_u32 vcc, 2, v27
    s_nop 1
    v_cndmask_b32 v10, v10, v28, vcc
    v_and_b32 v27, 1, v26
    v_cmp_eq_u32 vcc, 1, v27
    v_mov_b32 v28, 0x3f800000
    v_mov_b32 v29, 0x3f80
    v_cndmask_b32 v28, v29, v28, vcc
    v_lshrrev_b32 v27, 2, v26
    v_cmp_eq_u32 vcc, 0, v27
    s_nop 1
    v_cndmask_b32 v12, 0, v28, vcc
    v_cmp_eq_u32 vcc, 1, v27
    s_nop 1
    v_cndmask_b32 v13, 0, v28, vcc
    v_cmp_eq_u32 vcc, 2, v27
    s_nop 1
    v_cndmask_b32 v14, 0, v28, vcc
    v_cmp_eq_u32 vcc, 3, v27
    s_nop 1
    v_cndmask_b32 v15, 0, v28, vcc
    s_mov_b32 s36, s6
    s_and_b32 s37, s7, 0xffff
    s_mov_b32 s38, 8192
    s_mov_b32 s39, 0x20000
    v_lshlrev_b32 v27, 10, v36
    v_lshl_add_u32 v27, v25, 5, v27
    v_bfe_u32 v28, v26, 1, 1
    v_lshl_add_u32 v27, v28, 2, v27
    s_lshl_b32 s54, s44, 8
    buffer_load_dword v64, v27, s[36:39], s54 offen offset:0
    buffer_load_dword v65, v27, s[36:39], s54 offen offset:8
    buffer_load_dword v66, v27, s[36:39], s54 offen offset:16
    buffer_load_dword v67, v27, s[36:39], s54 offen offset:24
    buffer_load_dword v68, v27, s[36:39], s54 offen offset:128
    buffer_load_dword v69, v27, s[36:39], s54 offen offset:136
    buffer_load_dword v70, v27, s[36:39], s54 offen offset:144
    buffer_load_dword v71, v27, s[36:39], s54 offen offset:152
    s_lshl_b32 s74, s65, 9
    s_add_u32 s74, s74, 32768
    s_lshl_b32 s75, s65, 7
    s_add_u32 s75, s75, 12288
    s_lshl_b32 s71, s65, 13
    s_lshl_b32 s54, s44, 11
    s_add_u32 s71, s71, s54
    s_add_u32 s78, s71, 50331648
    s_add_u32 s71, s71, 33554432
    s_lshl_b32 s72, s65, 12
    s_lshl_b32 s54, s44, 10
    s_add_u32 s72, s72, s54
    s_add_u32 s72, s72, 4063232
    s_mov_b32 s79, 562036736
    s_mov_b32 s100, 1006632960
    s_mov_b32 s64, 0
    v_lshrrev_b32 v6, 1, v0
    s_waitcnt lgkmcnt(0)
    v_lshrrev_b32 v32, 8, v0
    v_bfe_u32 v33, v0, 4, 4
    v_lshlrev_b32 v33, 2, v33
    v_lshl_add_u32 v33, v32, 12, v33
    v_add_u32 v33, 32768, v33
    v_xor_b32 v50, s44, v32
    v_lshl_add_u32 v50, v50, 6, v33
    v_add_u32 v51, 0x10000, v50
    v_subrev_u32 v21, 24576, v50
    v_bfe_u32 v33, v0, 4, 4
    s_lshl_b32 s54, s44, 7
    v_lshl_add_u32 v33, v33, 3, s54
    v_lshlrev_b32 v52, 6, v32
    v_xor_b32 v33, v33, v52
    v_lshl_add_u32 v33, v32, 12, v33
    v_add_u32 v52, 32768, v33
    v_lshrrev_b32 v28, 1, v0
    v_and_b32 v29, 0xff, v28
    s_waitcnt vmcnt(27)
    s_barrier
    s_add_u32 m0, s47, 65536
    s_add_u32 s54, s48, 65536
    buffer_load_dwordx4 v49, s[32:35], s54 offen offset:0 lds
    buffer_load_dwordx4 v49, s[32:35], s54 offen offset:1024 lds
    buffer_load_dwordx4 v49, s[32:35], s54 offen offset:2048 lds
    buffer_load_dwordx4 v49, s[32:35], s54 offen offset:3072 lds
    buffer_load_dwordx2 v[16:17], off, s[28:31], 0 offset:2048 sc1
    ds_read2st64_b32 v[32:33], v51 offset0:0 offset1:4
    ds_read2st64_b32 v[34:35], v51 offset0:8 offset1:12
    ds_read2st64_b32 v[36:37], v51 offset0:1 offset1:5
    ds_read2st64_b32 v[38:39], v51 offset0:9 offset1:13
    ds_read2st64_b32 v[40:41], v51 offset0:2 offset1:6
    ds_read2st64_b32 v[42:43], v51 offset0:10 offset1:14
    ds_read2st64_b32 v[44:45], v51 offset0:3 offset1:7
    ds_read2st64_b32 v[46:47], v51 offset0:11 offset1:15
    s_waitcnt lgkmcnt(6)
    v_perm_b32 v60, v33, v32, s52
    v_accvgpr_write_b32 a0, v60
    v_perm_b32 v61, v33, v32, s53
    v_accvgpr_write_b32 a1, v61
    v_perm_b32 v62, v35, v34, s52
    v_accvgpr_write_b32 a2, v62
    v_perm_b32 v63, v35, v34, s53
    v_accvgpr_write_b32 a3, v63
    s_waitcnt lgkmcnt(4)
    v_perm_b32 v60, v37, v36, s52
    v_accvgpr_write_b32 a32, v60
    v_perm_b32 v61, v37, v36, s53
    v_accvgpr_write_b32 a33, v61
    v_perm_b32 v62, v39, v38, s52
    v_accvgpr_write_b32 a34, v62
    v_perm_b32 v63, v39, v38, s53
    v_accvgpr_write_b32 a35, v63
    s_waitcnt lgkmcnt(2)
    v_perm_b32 v60, v41, v40, s52
    v_accvgpr_write_b32 a64, v60
    v_perm_b32 v61, v41, v40, s53
    v_accvgpr_write_b32 a65, v61
    v_perm_b32 v62, v43, v42, s52
    v_accvgpr_write_b32 a66, v62
    v_perm_b32 v63, v43, v42, s53
    v_accvgpr_write_b32 a67, v63
    s_waitcnt lgkmcnt(0)
    v_perm_b32 v60, v45, v44, s52
    v_accvgpr_write_b32 a96, v60
    v_perm_b32 v61, v45, v44, s53
    v_accvgpr_write_b32 a97, v61
    v_perm_b32 v62, v47, v46, s52
    v_accvgpr_write_b32 a98, v62
    v_perm_b32 v63, v47, v46, s53
    v_accvgpr_write_b32 a99, v63
    s_waitcnt vmcnt(28)
    s_barrier
    s_add_u32 m0, s47, 98304
    s_add_u32 s54, s48, 81920
    buffer_load_dwordx4 v49, s[32:35], s54 offen offset:0 lds
    buffer_load_dwordx4 v49, s[32:35], s54 offen offset:1024 lds
    buffer_load_dwordx4 v49, s[32:35], s54 offen offset:2048 lds
    buffer_load_dwordx4 v49, s[32:35], s54 offen offset:3072 lds
    ds_read2st64_b32 v[32:33], v51 offset0:128 offset1:132
    ds_read2st64_b32 v[34:35], v51 offset0:136 offset1:140
    ds_read2st64_b32 v[36:37], v51 offset0:129 offset1:133
    ds_read2st64_b32 v[38:39], v51 offset0:137 offset1:141
    ds_read2st64_b32 v[40:41], v51 offset0:130 offset1:134
    ds_read2st64_b32 v[42:43], v51 offset0:138 offset1:142
    ds_read2st64_b32 v[44:45], v51 offset0:131 offset1:135
    ds_read2st64_b32 v[46:47], v51 offset0:139 offset1:143
    s_waitcnt lgkmcnt(6)
    v_perm_b32 v60, v33, v32, s52
    v_accvgpr_write_b32 a4, v60
    v_perm_b32 v61, v33, v32, s53
    v_accvgpr_write_b32 a5, v61
    v_perm_b32 v62, v35, v34, s52
    v_accvgpr_write_b32 a6, v62
    v_perm_b32 v63, v35, v34, s53
    v_accvgpr_write_b32 a7, v63
    s_waitcnt lgkmcnt(4)
    v_perm_b32 v60, v37, v36, s52
    v_accvgpr_write_b32 a36, v60
    v_perm_b32 v61, v37, v36, s53
    v_accvgpr_write_b32 a37, v61
    v_perm_b32 v62, v39, v38, s52
    v_accvgpr_write_b32 a38, v62
    v_perm_b32 v63, v39, v38, s53
    v_accvgpr_write_b32 a39, v63
    s_waitcnt lgkmcnt(2)
    v_perm_b32 v60, v41, v40, s52
    v_accvgpr_write_b32 a68, v60
    v_perm_b32 v61, v41, v40, s53
    v_accvgpr_write_b32 a69, v61
    v_perm_b32 v62, v43, v42, s52
    v_accvgpr_write_b32 a70, v62
    v_perm_b32 v63, v43, v42, s53
    v_accvgpr_write_b32 a71, v63
    s_waitcnt lgkmcnt(0)
    v_perm_b32 v60, v45, v44, s52
    v_accvgpr_write_b32 a100, v60
    v_perm_b32 v61, v45, v44, s53
    v_accvgpr_write_b32 a101, v61
    v_perm_b32 v62, v47, v46, s52
    v_accvgpr_write_b32 a102, v62
    v_perm_b32 v63, v47, v46, s53
    v_accvgpr_write_b32 a103, v63
    s_waitcnt vmcnt(28)
    s_barrier
    s_add_u32 m0, s47, 131072
    s_add_u32 s54, s48, 98304
    buffer_load_dwordx4 v49, s[32:35], s54 offen offset:0 lds
    buffer_load_dwordx4 v49, s[32:35], s54 offen offset:1024 lds
    buffer_load_dwordx4 v49, s[32:35], s54 offen offset:2048 lds
    buffer_load_dwordx4 v49, s[32:35], s54 offen offset:3072 lds
    ds_read2st64_b32 v[32:33], v21 offset0:0 offset1:4
    ds_read2st64_b32 v[34:35], v21 offset0:8 offset1:12
    ds_read2st64_b32 v[36:37], v21 offset0:1 offset1:5
    ds_read2st64_b32 v[38:39], v21 offset0:9 offset1:13
    ds_read2st64_b32 v[40:41], v21 offset0:2 offset1:6
    ds_read2st64_b32 v[42:43], v21 offset0:10 offset1:14
    ds_read2st64_b32 v[44:45], v21 offset0:3 offset1:7
    ds_read2st64_b32 v[46:47], v21 offset0:11 offset1:15
    s_waitcnt lgkmcnt(6)
    v_perm_b32 v60, v33, v32, s52
    v_accvgpr_write_b32 a8, v60
    v_perm_b32 v61, v33, v32, s53
    v_accvgpr_write_b32 a9, v61
    v_perm_b32 v62, v35, v34, s52
    v_accvgpr_write_b32 a10, v62
    v_perm_b32 v63, v35, v34, s53
    v_accvgpr_write_b32 a11, v63
    s_waitcnt lgkmcnt(4)
    v_perm_b32 v60, v37, v36, s52
    v_accvgpr_write_b32 a40, v60
    v_perm_b32 v61, v37, v36, s53
    v_accvgpr_write_b32 a41, v61
    v_perm_b32 v62, v39, v38, s52
    v_accvgpr_write_b32 a42, v62
    v_perm_b32 v63, v39, v38, s53
    v_accvgpr_write_b32 a43, v63
    s_waitcnt lgkmcnt(2)
    v_perm_b32 v60, v41, v40, s52
    v_accvgpr_write_b32 a72, v60
    v_perm_b32 v61, v41, v40, s53
    v_accvgpr_write_b32 a73, v61
    v_perm_b32 v62, v43, v42, s52
    v_accvgpr_write_b32 a74, v62
    v_perm_b32 v63, v43, v42, s53
    v_accvgpr_write_b32 a75, v63
    s_waitcnt lgkmcnt(0)
    v_perm_b32 v60, v45, v44, s52
    v_accvgpr_write_b32 a104, v60
    v_perm_b32 v61, v45, v44, s53
    v_accvgpr_write_b32 a105, v61
    v_perm_b32 v62, v47, v46, s52
    v_accvgpr_write_b32 a106, v62
    v_perm_b32 v63, v47, v46, s53
    v_accvgpr_write_b32 a107, v63
    s_waitcnt vmcnt(28)
    s_barrier
    s_add_u32 m0, s47, 8192
    s_add_u32 s54, s48, 114688
    buffer_load_dwordx4 v49, s[32:35], s54 offen offset:0 lds
    buffer_load_dwordx4 v49, s[32:35], s54 offen offset:1024 lds
    buffer_load_dwordx4 v49, s[32:35], s54 offen offset:2048 lds
    buffer_load_dwordx4 v49, s[32:35], s54 offen offset:3072 lds
    ds_read2st64_b32 v[32:33], v50 offset0:0 offset1:4
    ds_read2st64_b32 v[34:35], v50 offset0:8 offset1:12
    ds_read2st64_b32 v[36:37], v50 offset0:1 offset1:5
    ds_read2st64_b32 v[38:39], v50 offset0:9 offset1:13
    ds_read2st64_b32 v[40:41], v50 offset0:2 offset1:6
    ds_read2st64_b32 v[42:43], v50 offset0:10 offset1:14
    ds_read2st64_b32 v[44:45], v50 offset0:3 offset1:7
    ds_read2st64_b32 v[46:47], v50 offset0:11 offset1:15
    s_waitcnt lgkmcnt(6)
    v_perm_b32 v60, v33, v32, s52
    v_accvgpr_write_b32 a12, v60
    v_perm_b32 v61, v33, v32, s53
    v_accvgpr_write_b32 a13, v61
    v_perm_b32 v62, v35, v34, s52
    v_accvgpr_write_b32 a14, v62
    v_perm_b32 v63, v35, v34, s53
    v_accvgpr_write_b32 a15, v63
    s_waitcnt lgkmcnt(4)
    v_perm_b32 v60, v37, v36, s52
    v_accvgpr_write_b32 a44, v60
    v_perm_b32 v61, v37, v36, s53
    v_accvgpr_write_b32 a45, v61
    v_perm_b32 v62, v39, v38, s52
    v_accvgpr_write_b32 a46, v62
    v_perm_b32 v63, v39, v38, s53
    v_accvgpr_write_b32 a47, v63
    s_waitcnt lgkmcnt(2)
    v_perm_b32 v60, v41, v40, s52
    v_accvgpr_write_b32 a76, v60
    v_perm_b32 v61, v41, v40, s53
    v_accvgpr_write_b32 a77, v61
    v_perm_b32 v62, v43, v42, s52
    v_accvgpr_write_b32 a78, v62
    v_perm_b32 v63, v43, v42, s53
    v_accvgpr_write_b32 a79, v63
    s_waitcnt lgkmcnt(0)
    v_perm_b32 v60, v45, v44, s52
    v_accvgpr_write_b32 a108, v60
    v_perm_b32 v61, v45, v44, s53
    v_accvgpr_write_b32 a109, v61
    v_perm_b32 v62, v47, v46, s52
    v_accvgpr_write_b32 a110, v62
    v_perm_b32 v63, v47, v46, s53
    v_accvgpr_write_b32 a111, v63
    s_waitcnt vmcnt(13)
    s_barrier
    s_mov_b32 s32, s10
    s_and_b32 s33, s11, 0xffff
    s_mov_b32 s34, 4194304
    s_mov_b32 s35, 0x20000
    s_lshl_b32 s48, s65, 8
    s_lshl_b32 s54, s47, 4
    s_add_u32 s48, s48, s54
    s_add_u32 m0, s47, 32768
    s_add_u32 s54, s48, 0
    buffer_load_dwordx4 v48, s[32:35], s54 offen lds
    s_add_u32 m0, s47, 33792
    s_add_u32 s54, s48, 32768
    buffer_load_dwordx4 v48, s[32:35], s54 offen lds
    s_add_u32 m0, s47, 34816
    s_add_u32 s54, s48, 262144
    buffer_load_dwordx4 v48, s[32:35], s54 offen lds
    s_add_u32 m0, s47, 35840
    s_add_u32 s54, s48, 294912
    buffer_load_dwordx4 v48, s[32:35], s54 offen lds
    s_waitcnt vmcnt(16)
    s_cmp_eq_u32 s51, -1
    s_cbranch_scc1 L_plk_2
    s_mov_b32 s58, 0
    s_branch L_plc_4
L_pll_3:
    buffer_load_dwordx2 v[16:17], off, s[28:31], 0 offset:2048 sc1
    s_waitcnt vmcnt(0)
L_plc_4:
    v_readfirstlane_b32 s56, v16
    v_readfirstlane_b32 s57, v17
    s_sub_u32 s56, s56, s42
    s_subb_u32 s57, s57, s43
    s_lshr_b32 s55, s56, 3
    s_or_b32 s57, s57, s55
    s_cbranch_scc0 L_plo_5
    s_add_u32 s58, s58, 1
    s_cmp_lt_u32 s58, 1048576
    s_cbranch_scc1 L_pll_3
    s_branch L_abort
L_plo_5:
    s_mov_b32 s36, s24
    s_and_b32 s37, s25, 0xffff
    s_mov_b32 s38, 256
    s_mov_b32 s39, 0x20000
    s_cmp_eq_u32 s56, s50
    s_cselect_b32 s51, 0, 128
    s_cbranch_scc0 L_swap
    s_cmp_lg_u32 s44, 0
    s_cbranch_scc1 L_plk_2
    v_mov_b32 v16, 1
    s_mov_b64 exec, 1
    buffer_atomic_add v16, off, s[36:39], s51 sc1
    s_mov_b64 exec, -1
L_plk_2:
    ds_write_b128 v2, v[64:67]
    ds_write_b128 v2, v[68:71] offset:1024
    s_cmp_lg_u32 s44, 0
    s_cbranch_scc1 L_tr_7
    s_lshl_b32 s55, s65, 3
    s_add_u32 s55, s55, 4096
    s_add_u32 s56, s42, s46
    s_addc_u32 s57, s43, 0
    v_mov_b32 v24, s56
    v_mov_b32 v25, s57
    s_mov_b64 exec, 1
    buffer_store_dwordx2 v[24:25], off, s[28:31], s55 sc1
    s_mov_b64 exec, -1
L_tr_7:
    ds_read2st64_b32 v[32:33], v50 offset0:128 offset1:132
    ds_read2st64_b32 v[34:35], v50 offset0:136 offset1:140
    ds_read2st64_b32 v[36:37], v50 offset0:129 offset1:133
    ds_read2st64_b32 v[38:39], v50 offset0:137 offset1:141
    ds_read2st64_b32 v[40:41], v50 offset0:130 offset1:134
    ds_read2st64_b32 v[42:43], v50 offset0:138 offset1:142
    ds_read2st64_b32 v[44:45], v50 offset0:131 offset1:135
    ds_read2st64_b32 v[46:47], v50 offset0:139 offset1:143
    s_waitcnt lgkmcnt(6)
    v_perm_b32 v60, v33, v32, s52
    v_accvgpr_write_b32 a16, v60
    v_perm_b32 v61, v33, v32, s53
    v_accvgpr_write_b32 a17, v61
    v_perm_b32 v62, v35, v34, s52
    v_accvgpr_write_b32 a18, v62
    v_perm_b32 v63, v35, v34, s53
    v_accvgpr_write_b32 a19, v63
    s_waitcnt lgkmcnt(4)
    v_perm_b32 v60, v37, v36, s52
    v_accvgpr_write_b32 a48, v60
    v_perm_b32 v61, v37, v36, s53
    v_accvgpr_write_b32 a49, v61
    v_perm_b32 v62, v39, v38, s52
    v_accvgpr_write_b32 a50, v62
    v_perm_b32 v63, v39, v38, s53
    v_accvgpr_write_b32 a51, v63
    s_waitcnt lgkmcnt(2)
    v_perm_b32 v60, v41, v40, s52
    v_accvgpr_write_b32 a80, v60
    v_perm_b32 v61, v41, v40, s53
    v_accvgpr_write_b32 a81, v61
    v_perm_b32 v62, v43, v42, s52
    v_accvgpr_write_b32 a82, v62
    v_perm_b32 v63, v43, v42, s53
    v_accvgpr_write_b32 a83, v63
    s_waitcnt lgkmcnt(0)
    v_perm_b32 v60, v45, v44, s52
    v_accvgpr_write_b32 a112, v60
    v_perm_b32 v61, v45, v44, s53
    v_accvgpr_write_b32 a113, v61
    v_perm_b32 v62, v47, v46, s52
    v_accvgpr_write_b32 a114, v62
    v_perm_b32 v63, v47, v46, s53
    v_accvgpr_write_b32 a115, v63
    s_waitcnt vmcnt(12)
    s_barrier
    s_add_u32 m0, s47, 65536
    s_add_u32 s54, s48, 524288
    buffer_load_dwordx4 v48, s[32:35], s54 offen lds
    s_add_u32 m0, s47, 66560
    s_add_u32 s54, s48, 557056
    buffer_load_dwordx4 v48, s[32:35], s54 offen lds
    s_add_u32 m0, s47, 67584
    s_add_u32 s54, s48, 786432
    buffer_load_dwordx4 v48, s[32:35], s54 offen lds
    s_add_u32 m0, s47, 68608
    s_add_u32 s54, s48, 819200
    buffer_load_dwordx4 v48, s[32:35], s54 offen lds
    ds_read2st64_b32 v[32:33], v51 offset0:0 offset1:4
    ds_read2st64_b32 v[34:35], v51 offset0:8 offset1:12
    ds_read2st64_b32 v[36:37], v51 offset0:1 offset1:5
    ds_read2st64_b32 v[38:39], v51 offset0:9 offset1:13
    ds_read2st64_b32 v[40:41], v51 offset0:2 offset1:6
    ds_read2st64_b32 v[42:43], v51 offset0:10 offset1:14
    ds_read2st64_b32 v[44:45], v51 offset0:3 offset1:7
    ds_read2st64_b32 v[46:47], v51 offset0:11 offset1:15
    s_waitcnt lgkmcnt(6)
    v_perm_b32 v60, v33, v32, s52
    v_accvgpr_write_b32 a20, v60
    v_perm_b32 v61, v33, v32, s53
    v_accvgpr_write_b32 a21, v61
    v_perm_b32 v62, v35, v34, s52
    v_accvgpr_write_b32 a22, v62
    v_perm_b32 v63, v35, v34, s53
    v_accvgpr_write_b32 a23, v63
    s_waitcnt lgkmcnt(4)
    v_perm_b32 v60, v37, v36, s52
    v_accvgpr_write_b32 a52, v60
    v_perm_b32 v61, v37, v36, s53
    v_accvgpr_write_b32 a53, v61
    v_perm_b32 v62, v39, v38, s52
    v_accvgpr_write_b32 a54, v62
    v_perm_b32 v63, v39, v38, s53
    v_accvgpr_write_b32 a55, v63
    s_waitcnt lgkmcnt(2)
    v_perm_b32 v60, v41, v40, s52
    v_accvgpr_write_b32 a84, v60
    v_perm_b32 v61, v41, v40, s53
    v_accvgpr_write_b32 a85, v61
    v_perm_b32 v62, v43, v42, s52
    v_accvgpr_write_b32 a86, v62
    v_perm_b32 v63, v43, v42, s53
    v_accvgpr_write_b32 a87, v63
    s_waitcnt lgkmcnt(0)
    v_perm_b32 v60, v45, v44, s52
    v_accvgpr_write_b32 a116, v60
    v_perm_b32 v61, v45, v44, s53
    v_accvgpr_write_b32 a117, v61
    v_perm_b32 v62, v47, v46, s52
    v_accvgpr_write_b32 a118, v62
    v_perm_b32 v63, v47, v46, s53
    v_accvgpr_write_b32 a119, v63
    s_waitcnt vmcnt(12)
    s_barrier
    s_add_u32 m0, s47, 98304
    s_add_u32 s54, s48, 1048576
    buffer_load_dwordx4 v48, s[32:35], s54 offen lds
    s_add_u32 m0, s47, 99328
    s_add_u32 s54, s48, 1081344
    buffer_load_dwordx4 v48, s[32:35], s54 offen lds
    s_add_u32 m0, s47, 100352
    s_add_u32 s54, s48, 1310720
    buffer_load_dwordx4 v48, s[32:35], s54 offen lds
    s_add_u32 m0, s47, 101376
    s_add_u32 s54, s48, 1343488
    buffer_load_dwordx4 v48, s[32:35], s54 offen lds
    ds_read2st64_b32 v[32:33], v51 offset0:128 offset1:132
    ds_read2st64_b32 v[34:35], v51 offset0:136 offset1:140
    ds_read2st64_b32 v[36:37], v51 offset0:129 offset1:133
    ds_read2st64_b32 v[38:39], v51 offset0:137 offset1:141
    ds_read2st64_b32 v[40:41], v51 offset0:130 offset1:134
    ds_read2st64_b32 v[42:43], v51 offset0:138 offset1:142
    ds_read2st64_b32 v[44:45], v51 offset0:131 offset1:135
    ds_read2st64_b32 v[46:47], v51 offset0:139 offset1:143
    s_waitcnt lgkmcnt(6)
    v_perm_b32 v60, v33, v32, s52
    v_accvgpr_write_b32 a24, v60
    v_perm_b32 v61, v33, v32, s53
    v_accvgpr_write_b32 a25, v61
    v_perm_b32 v62, v35, v34, s52
    v_accvgpr_write_b32 a26, v62
    v_perm_b32 v63, v35, v34, s53
    v_accvgpr_write_b32 a27, v63
    s_waitcnt lgkmcnt(4)
    v_perm_b32 v60, v37, v36, s52
    v_accvgpr_write_b32 a56, v60
    v_perm_b32 v61, v37, v36, s53
    v_accvgpr_write_b32 a57, v61
    v_perm_b32 v62, v39, v38, s52
    v_accvgpr_write_b32 a58, v62
    v_perm_b32 v63, v39, v38, s53
    v_accvgpr_write_b32 a59, v63
    s_waitcnt lgkmcnt(2)
    v_perm_b32 v60, v41, v40, s52
    v_accvgpr_write_b32 a88, v60
    v_perm_b32 v61, v41, v40, s53
    v_accvgpr_write_b32 a89, v61
    v_perm_b32 v62, v43, v42, s52
    v_accvgpr_write_b32 a90, v62
    v_perm_b32 v63, v43, v42, s53
    v_accvgpr_write_b32 a91, v63
    s_waitcnt lgkmcnt(0)
    v_perm_b32 v60, v45, v44, s52
    v_accvgpr_write_b32 a120, v60
    v_perm_b32 v61, v45, v44, s53
    v_accvgpr_write_b32 a121, v61
    v_perm_b32 v62, v47, v46, s52
    v_accvgpr_write_b32 a122, v62
    v_perm_b32 v63, v47, v46, s53
    v_accvgpr_write_b32 a123, v63
    s_waitcnt vmcnt(12)
    s_barrier
    s_add_u32 m0, s47, 131072
    s_add_u32 s54, s48, 1572864
    buffer_load_dwordx4 v48, s[32:35], s54 offen lds
    s_add_u32 m0, s47, 132096
    s_add_u32 s54, s48, 1605632
    buffer_load_dwordx4 v48, s[32:35], s54 offen lds
    s_add_u32 m0, s47, 133120
    s_add_u32 s54, s48, 1835008
    buffer_load_dwordx4 v48, s[32:35], s54 offen lds
    s_add_u32 m0, s47, 134144
    s_add_u32 s54, s48, 1867776
    buffer_load_dwordx4 v48, s[32:35], s54 offen lds
    ds_read2st64_b32 v[32:33], v21 offset0:0 offset1:4
    ds_read2st64_b32 v[34:35], v21 offset0:8 offset1:12
    ds_read2st64_b32 v[36:37], v21 offset0:1 offset1:5
    ds_read2st64_b32 v[38:39], v21 offset0:9 offset1:13
    ds_read2st64_b32 v[40:41], v21 offset0:2 offset1:6
    ds_read2st64_b32 v[42:43], v21 offset0:10 offset1:14
    ds_read2st64_b32 v[44:45], v21 offset0:3 offset1:7
    ds_read2st64_b32 v[46:47], v21 offset0:11 offset1:15
    s_waitcnt lgkmcnt(6)
    v_perm_b32 v60, v33, v32, s52
    v_accvgpr_write_b32 a28, v60
    v_perm_b32 v61, v33, v32, s53
    v_accvgpr_write_b32 a29, v61
    v_perm_b32 v62, v35, v34, s52
    v_accvgpr_write_b32 a30, v62
    v_perm_b32 v63, v35, v34, s53
    v_accvgpr_write_b32 a31, v63
    s_waitcnt lgkmcnt(4)
    v_perm_b32 v60, v37, v36, s52
    v_accvgpr_write_b32 a60, v60
    v_perm_b32 v61, v37, v36, s53
    v_accvgpr_write_b32 a61, v61
    v_perm_b32 v62, v39, v38, s52
    v_accvgpr_write_b32 a62, v62
    v_perm_b32 v63, v39, v38, s53
    v_accvgpr_write_b32 a63, v63
    s_waitcnt lgkmcnt(2)
    v_perm_b32 v60, v41, v40, s52
    v_accvgpr_write_b32 a92, v60
    v_perm_b32 v61, v41, v40, s53
    v_accvgpr_write_b32 a93, v61
    v_perm_b32 v62, v43, v42, s52
    v_accvgpr_write_b32 a94, v62
    v_perm_b32 v63, v43, v42, s53
    v_accvgpr_write_b32 a95, v63
    s_waitcnt lgkmcnt(0)
    v_perm_b32 v60, v45, v44, s52
    v_accvgpr_write_b32 a124, v60
    v_perm_b32 v61, v45, v44, s53
    v_accvgpr_write_b32 a125, v61
    v_perm_b32 v62, v47, v46, s52
    v_accvgpr_write_b32 a126, v62
    v_perm_b32 v63, v47, v46, s53
    v_accvgpr_write_b32 a127, v63
    s_waitcnt vmcnt(12)
    s_barrier
    s_add_u32 m0, s47, 8192
    s_add_u32 s54, s48, 2097152
    buffer_load_dwordx4 v48, s[32:35], s54 offen lds
    s_add_u32 m0, s47, 9216
    s_add_u32 s54, s48, 2129920
    buffer_load_dwordx4 v48, s[32:35], s54 offen lds
    s_add_u32 m0, s47, 10240
    s_add_u32 s54, s48, 2359296
    buffer_load_dwordx4 v48, s[32:35], s54 offen lds
    s_add_u32 m0, s47, 11264
    s_add_u32 s54, s48, 2392064
    buffer_load_dwordx4 v48, s[32:35], s54 offen lds
    ds_read2st64_b32 v[32:33], v50 offset0:0 offset1:1
    ds_read2st64_b32 v[34:35], v50 offset0:2 offset1:3
    ds_read2st64_b32 v[36:37], v50 offset0:4 offset1:5
    ds_read2st64_b32 v[38:39], v50 offset0:6 offset1:7
    ds_read2st64_b32 v[40:41], v50 offset0:8 offset1:9
    ds_read2st64_b32 v[42:43], v50 offset0:10 offset1:11
    ds_read2st64_b32 v[44:45], v50 offset0:12 offset1:13
    ds_read2st64_b32 v[46:47], v50 offset0:14 offset1:15
    s_waitcnt lgkmcnt(6)
    v_perm_b32 v128, v33, v32, s52
    v_perm_b32 v52, v33, v32, s53
    v_perm_b32 v129, v35, v34, s52
    v_perm_b32 v53, v35, v34, s53
    s_waitcnt lgkmcnt(4)
    v_perm_b32 v130, v37, v36, s52
    v_perm_b32 v54, v37, v36, s53
    v_perm_b32 v131, v39, v38, s52
    v_perm_b32 v55, v39, v38, s53
    ds_write_b128 v1, v[52:55] offset:16384
    s_waitcnt lgkmcnt(3)
    v_perm_b32 v132, v41, v40, s52
    v_perm_b32 v56, v41, v40, s53
    v_perm_b32 v133, v43, v42, s52
    v_perm_b32 v57, v43, v42, s53
    s_waitcnt lgkmcnt(1)
    v_perm_b32 v134, v45, v44, s52
    v_perm_b32 v58, v45, v44, s53
    v_perm_b32 v135, v47, v46, s52
    v_perm_b32 v59, v47, v46, s53
    ds_write_b128 v1, v[56:59] offset:17408
    s_waitcnt vmcnt(12)
    s_barrier
    s_add_u32 m0, s47, 32768
    s_add_u32 s54, s48, 2621440
    buffer_load_dwordx4 v48, s[32:35], s54 offen lds
    s_add_u32 m0, s47, 33792
    s_add_u32 s54, s48, 2654208
    buffer_load_dwordx4 v48, s[32:35], s54 offen lds
    s_add_u32 m0, s47, 34816
    s_add_u32 s54, s48, 2883584
    buffer_load_dwordx4 v48, s[32:35], s54 offen lds
    s_add_u32 m0, s47, 35840
    s_add_u32 s54, s48, 2916352
    buffer_load_dwordx4 v48, s[32:35], s54 offen lds
    ds_read2st64_b32 v[32:33], v50 offset0:128 offset1:129
    ds_read2st64_b32 v[34:35], v50 offset0:130 offset1:131
    ds_read2st64_b32 v[36:37], v50 offset0:132 offset1:133
    ds_read2st64_b32 v[38:39], v50 offset0:134 offset1:135
    ds_read2st64_b32 v[40:41], v50 offset0:136 offset1:137
    ds_read2st64_b32 v[42:43], v50 offset0:138 offset1:139
    ds_read2st64_b32 v[44:45], v50 offset0:140 offset1:141
    ds_read2st64_b32 v[46:47], v50 offset0:142 offset1:143
    s_waitcnt lgkmcnt(6)
    v_perm_b32 v136, v33, v32, s52
    v_perm_b32 v52, v33, v32, s53
    v_perm_b32 v137, v35, v34, s52
    v_perm_b32 v53, v35, v34, s53
    s_waitcnt lgkmcnt(4)
    v_perm_b32 v138, v37, v36, s52
    v_perm_b32 v54, v37, v36, s53
    v_perm_b32 v139, v39, v38, s52
    v_perm_b32 v55, v39, v38, s53
    ds_write_b128 v1, v[52:55] offset:18432
    s_waitcnt lgkmcnt(3)
    v_perm_b32 v140, v41, v40, s52
    v_perm_b32 v56, v41, v40, s53
    v_perm_b32 v141, v43, v42, s52
    v_perm_b32 v57, v43, v42, s53
    s_waitcnt lgkmcnt(1)
    v_perm_b32 v142, v45, v44, s52
    v_perm_b32 v58, v45, v44, s53
    v_perm_b32 v143, v47, v46, s52
    v_perm_b32 v59, v47, v46, s53
    ds_write_b128 v1, v[56:59] offset:19456
    s_waitcnt vmcnt(12)
    s_barrier
    s_add_u32 m0, s47, 65536
    s_add_u32 s54, s48, 3145728
    buffer_load_dwordx4 v48, s[32:35], s54 offen lds
    s_add_u32 m0, s47, 66560
    s_add_u32 s54, s48, 3178496
    buffer_load_dwordx4 v48, s[32:35], s54 offen lds
    s_add_u32 m0, s47, 67584
    s_add_u32 s54, s48, 3407872
    buffer_load_dwordx4 v48, s[32:35], s54 offen lds
    s_add_u32 m0, s47, 68608
    s_add_u32 s54, s48, 3440640
    buffer_load_dwordx4 v48, s[32:35], s54 offen lds
    ds_read2st64_b32 v[32:33], v51 offset0:0 offset1:1
    ds_read2st64_b32 v[34:35], v51 offset0:2 offset1:3
    ds_read2st64_b32 v[36:37], v51 offset0:4 offset1:5
    ds_read2st64_b32 v[38:39], v51 offset0:6 offset1:7
    ds_read2st64_b32 v[40:41], v51 offset0:8 offset1:9
    ds_read2st64_b32 v[42:43], v51 offset0:10 offset1:11
    ds_read2st64_b32 v[44:45], v51 offset0:12 offset1:13
    ds_read2st64_b32 v[46:47], v51 offset0:14 offset1:15
    s_waitcnt lgkmcnt(6)
    v_perm_b32 v144, v33, v32, s52
    v_perm_b32 v52, v33, v32, s53
    v_perm_b32 v145, v35, v34, s52
    v_perm_b32 v53, v35, v34, s53
    s_waitcnt lgkmcnt(4)
    v_perm_b32 v146, v37, v36, s52
    v_perm_b32 v54, v37, v36, s53
    v_perm_b32 v147, v39, v38, s52
    v_perm_b32 v55, v39, v38, s53
    ds_write_b128 v1, v[52:55] offset:20480
    s_waitcnt lgkmcnt(3)
    v_perm_b32 v148, v41, v40, s52
    v_perm_b32 v56, v41, v40, s53
    v_perm_b32 v149, v43, v42, s52
    v_perm_b32 v57, v43, v42, s53
    s_waitcnt lgkmcnt(1)
    v_perm_b32 v150, v45, v44, s52
    v_perm_b32 v58, v45, v44, s53
    v_perm_b32 v151, v47, v46, s52
    v_perm_b32 v59, v47, v46, s53
    ds_write_b128 v1, v[56:59] offset:21504
    s_waitcnt vmcnt(12)
    s_barrier
    s_add_u32 m0, s47, 98304
    s_add_u32 s54, s48, 3670016
    buffer_load_dwordx4 v48, s[32:35], s54 offen lds
    s_add_u32 m0, s47, 99328
    s_add_u32 s54, s48, 3702784
    buffer_load_dwordx4 v48, s[32:35], s54 offen lds
    s_add_u32 m0, s47, 100352
    s_add_u32 s54, s48, 3932160
    buffer_load_dwordx4 v48, s[32:35], s54 offen lds
    s_add_u32 m0, s47, 101376
    s_add_u32 s54, s48, 3964928
    buffer_load_dwordx4 v48, s[32:35], s54 offen lds
    ds_read2st64_b32 v[32:33], v51 offset0:128 offset1:129
    ds_read2st64_b32 v[34:35], v51 offset0:130 offset1:131
    ds_read2st64_b32 v[36:37], v51 offset0:132 offset1:133
    ds_read2st64_b32 v[38:39], v51 offset0:134 offset1:135
    ds_read2st64_b32 v[40:41], v51 offset0:136 offset1:137
    ds_read2st64_b32 v[42:43], v51 offset0:138 offset1:139
    ds_read2st64_b32 v[44:45], v51 offset0:140 offset1:141
    ds_read2st64_b32 v[46:47], v51 offset0:142 offset1:143
    s_waitcnt lgkmcnt(6)
    v_perm_b32 v152, v33, v32, s52
    v_perm_b32 v52, v33, v32, s53
    v_perm_b32 v153, v35, v34, s52
    v_perm_b32 v53, v35, v34, s53
    s_waitcnt lgkmcnt(4)
    v_perm_b32 v154, v37, v36, s52
    v_perm_b32 v54, v37, v36, s53
    v_perm_b32 v155, v39, v38, s52
    v_perm_b32 v55, v39, v38, s53
    ds_write_b128 v1, v[52:55] offset:22528
    s_waitcnt lgkmcnt(3)
    v_perm_b32 v156, v41, v40, s52
    v_perm_b32 v56, v41, v40, s53
    v_perm_b32 v157, v43, v42, s52
    v_perm_b32 v57, v43, v42, s53
    s_waitcnt lgkmcnt(1)
    v_perm_b32 v158, v45, v44, s52
    v_perm_b32 v58, v45, v44, s53
    v_perm_b32 v159, v47, v46, s52
    v_perm_b32 v59, v47, v46, s53
    ds_write_b128 v1, v[56:59] offset:23552
    s_waitcnt vmcnt(12)
    s_barrier
    s_mov_b32 s32, s12
    s_and_b32 s33, s13, 0xffff
    s_mov_b32 s34, 4194304
    s_mov_b32 s35, 0x20000
    s_lshl_b32 s48, s65, 8
    s_lshl_b32 s54, s47, 4
    s_add_u32 s48, s48, s54
    s_add_u32 m0, s47, 131072
    s_add_u32 s54, s48, 0
    buffer_load_dwordx4 v48, s[32:35], s54 offen lds
    s_add_u32 m0, s47, 132096
    s_add_u32 s54, s48, 32768
    buffer_load_dwordx4 v48, s[32:35], s54 offen lds
    s_add_u32 m0, s47, 133120
    s_add_u32 s54, s48, 262144
    buffer_load_dwordx4 v48, s[32:35], s54 offen lds
    s_add_u32 m0, s47, 134144
    s_add_u32 s54, s48, 294912
    buffer_load_dwordx4 v48, s[32:35], s54 offen lds
    ds_read2st64_b32 v[32:33], v21 offset0:0 offset1:1
    ds_read2st64_b32 v[34:35], v21 offset0:2 offset1:3
    ds_read2st64_b32 v[36:37], v21 offset0:4 offset1:5
    ds_read2st64_b32 v[38:39], v21 offset0:6 offset1:7
    ds_read2st64_b32 v[40:41], v21 offset0:8 offset1:9
    ds_read2st64_b32 v[42:43], v21 offset0:10 offset1:11
    ds_read2st64_b32 v[44:45], v21 offset0:12 offset1:13
    ds_read2st64_b32 v[46:47], v21 offset0:14 offset1:15
    s_waitcnt lgkmcnt(6)
    v_perm_b32 v160, v33, v32, s52
    v_perm_b32 v52, v33, v32, s53
    v_perm_b32 v161, v35, v34, s52
    v_perm_b32 v53, v35, v34, s53
    s_waitcnt lgkmcnt(4)
    v_perm_b32 v162, v37, v36, s52
    v_perm_b32 v54, v37, v36, s53
    v_perm_b32 v163, v39, v38, s52
    v_perm_b32 v55, v39, v38, s53
    ds_write_b128 v1, v[52:55] offset:24576
    s_waitcnt lgkmcnt(3)
    v_perm_b32 v164, v41, v40, s52
    v_perm_b32 v56, v41, v40, s53
    v_perm_b32 v165, v43, v42, s52
    v_perm_b32 v57, v43, v42, s53
    s_waitcnt lgkmcnt(1)
    v_perm_b32 v166, v45, v44, s52
    v_perm_b32 v58, v45, v44, s53
    v_perm_b32 v167, v47, v46, s52
    v_perm_b32 v59, v47, v46, s53
    ds_write_b128 v1, v[56:59] offset:25600
    s_waitcnt vmcnt(12)
    s_barrier
    s_add_u32 m0, s47, 8192
    s_add_u32 s54, s48, 524288
    buffer_load_dwordx4 v48, s[32:35], s54 offen lds
    s_add_u32 m0, s47, 9216
    s_add_u32 s54, s48, 557056
    buffer_load_dwordx4 v48, s[32:35], s54 offen lds
    s_add_u32 m0, s47, 10240
    s_add_u32 s54, s48, 786432
    buffer_load_dwordx4 v48, s[32:35], s54 offen lds
    s_add_u32 m0, s47, 11264
    s_add_u32 s54, s48, 819200
    buffer_load_dwordx4 v48, s[32:35], s54 offen lds
    ds_read2st64_b32 v[32:33], v50 offset0:0 offset1:1
    ds_read2st64_b32 v[34:35], v50 offset0:2 offset1:3
    ds_read2st64_b32 v[36:37], v50 offset0:4 offset1:5
    ds_read2st64_b32 v[38:39], v50 offset0:6 offset1:7
    ds_read2st64_b32 v[40:41], v50 offset0:8 offset1:9
    ds_read2st64_b32 v[42:43], v50 offset0:10 offset1:11
    ds_read2st64_b32 v[44:45], v50 offset0:12 offset1:13
    ds_read2st64_b32 v[46:47], v50 offset0:14 offset1:15
    s_waitcnt lgkmcnt(6)
    v_perm_b32 v168, v33, v32, s52
    v_perm_b32 v52, v33, v32, s53
    v_perm_b32 v169, v35, v34, s52
    v_perm_b32 v53, v35, v34, s53
    s_waitcnt lgkmcnt(4)
    v_perm_b32 v170, v37, v36, s52
    v_perm_b32 v54, v37, v36, s53
    v_perm_b32 v171, v39, v38, s52
    v_perm_b32 v55, v39, v38, s53
    ds_write_b128 v1, v[52:55] offset:26624
    s_waitcnt lgkmcnt(3)
    v_perm_b32 v172, v41, v40, s52
    v_perm_b32 v56, v41, v40, s53
    v_perm_b32 v173, v43, v42, s52
    v_perm_b32 v57, v43, v42, s53
    s_waitcnt lgkmcnt(1)
    v_perm_b32 v174, v45, v44, s52
    v_perm_b32 v58, v45, v44, s53
    v_perm_b32 v175, v47, v46, s52
    v_perm_b32 v59, v47, v46, s53
    ds_write_b128 v1, v[56:59] offset:27648
    s_waitcnt vmcnt(12)
    s_barrier
    s_add_u32 m0, s47, 32768
    s_add_u32 s54, s48, 1048576
    buffer_load_dwordx4 v48, s[32:35], s54 offen lds
    s_add_u32 m0, s47, 33792
    s_add_u32 s54, s48, 1081344
    buffer_load_dwordx4 v48, s[32:35], s54 offen lds
    s_add_u32 m0, s47, 34816
    s_add_u32 s54, s48, 1310720
    buffer_load_dwordx4 v48, s[32:35], s54 offen lds
    s_add_u32 m0, s47, 35840
    s_add_u32 s54, s48, 1343488
    buffer_load_dwordx4 v48, s[32:35], s54 offen lds
    ds_read2st64_b32 v[32:33], v50 offset0:128 offset1:129
    ds_read2st64_b32 v[34:35], v50 offset0:130 offset1:131
    ds_read2st64_b32 v[36:37], v50 offset0:132 offset1:133
    ds_read2st64_b32 v[38:39], v50 offset0:134 offset1:135
    ds_read2st64_b32 v[40:41], v50 offset0:136 offset1:137
    ds_read2st64_b32 v[42:43], v50 offset0:138 offset1:139
    ds_read2st64_b32 v[44:45], v50 offset0:140 offset1:141
    ds_read2st64_b32 v[46:47], v50 offset0:142 offset1:143
    s_waitcnt lgkmcnt(6)
    v_perm_b32 v176, v33, v32, s52
    v_perm_b32 v52, v33, v32, s53
    v_perm_b32 v177, v35, v34, s52
    v_perm_b32 v53, v35, v34, s53
    s_waitcnt lgkmcnt(4)
    v_perm_b32 v178, v37, v36, s52
    v_perm_b32 v54, v37, v36, s53
    v_perm_b32 v179, v39, v38, s52
    v_perm_b32 v55, v39, v38, s53
    ds_write_b128 v1, v[52:55] offset:28672
    s_waitcnt lgkmcnt(3)
    v_perm_b32 v180, v41, v40, s52
    v_perm_b32 v56, v41, v40, s53
    v_perm_b32 v181, v43, v42, s52
    v_perm_b32 v57, v43, v42, s53
    s_waitcnt lgkmcnt(1)
    v_perm_b32 v182, v45, v44, s52
    v_perm_b32 v58, v45, v44, s53
    v_perm_b32 v183, v47, v46, s52
    v_perm_b32 v59, v47, v46, s53
    ds_write_b128 v1, v[56:59] offset:29696
    s_waitcnt vmcnt(12)
    s_barrier
    s_add_u32 m0, s47, 65536
    s_add_u32 s54, s48, 1572864
    buffer_load_dwordx4 v48, s[32:35], s54 offen lds
    s_add_u32 m0, s47, 66560
    s_add_u32 s54, s48, 1605632
    buffer_load_dwordx4 v48, s[32:35], s54 offen lds
    s_add_u32 m0, s47, 67584
    s_add_u32 s54, s48, 1835008
    buffer_load_dwordx4 v48, s[32:35], s54 offen lds
    s_add_u32 m0, s47, 68608
    s_add_u32 s54, s48, 1867776
    buffer_load_dwordx4 v48, s[32:35], s54 offen lds
    ds_read2st64_b32 v[32:33], v51 offset0:0 offset1:1
    ds_read2st64_b32 v[34:35], v51 offset0:2 offset1:3
    ds_read2st64_b32 v[36:37], v51 offset0:4 offset1:5
    ds_read2st64_b32 v[38:39], v51 offset0:6 offset1:7
    ds_read2st64_b32 v[40:41], v51 offset0:8 offset1:9
    ds_read2st64_b32 v[42:43], v51 offset0:10 offset1:11
    ds_read2st64_b32 v[44:45], v51 offset0:12 offset1:13
    ds_read2st64_b32 v[46:47], v51 offset0:14 offset1:15
    s_waitcnt lgkmcnt(6)
    v_perm_b32 v184, v33, v32, s52
    v_perm_b32 v52, v33, v32, s53
    v_perm_b32 v185, v35, v34, s52
    v_perm_b32 v53, v35, v34, s53
    s_waitcnt lgkmcnt(4)
    v_perm_b32 v186, v37, v36, s52
    v_perm_b32 v54, v37, v36, s53
    v_perm_b32 v187, v39, v38, s52
    v_perm_b32 v55, v39, v38, s53
    ds_write_b128 v1, v[52:55] offset:30720
    s_waitcnt lgkmcnt(3)
    v_perm_b32 v188, v41, v40, s52
    v_perm_b32 v56, v41, v40, s53
    v_perm_b32 v189, v43, v42, s52
    v_perm_b32 v57, v43, v42, s53
    s_waitcnt lgkmcnt(1)
    v_perm_b32 v190, v45, v44, s52
    v_perm_b32 v58, v45, v44, s53
    v_perm_b32 v191, v47, v46, s52
    v_perm_b32 v59, v47, v46, s53
    ds_write_b128 v1, v[56:59] offset:31744
    s_waitcnt vmcnt(12)
    s_barrier
    s_add_u32 m0, s47, 98304
    s_add_u32 s54, s48, 2097152
    buffer_load_dwordx4 v48, s[32:35], s54 offen lds
    s_add_u32 m0, s47, 99328
    s_add_u32 s54, s48, 2129920
    buffer_load_dwordx4 v48, s[32:35], s54 offen lds
    s_add_u32 m0, s47, 100352
    s_add_u32 s54, s48, 2359296
    buffer_load_dwordx4 v48, s[32:35], s54 offen lds
    s_add_u32 m0, s47, 101376
    s_add_u32 s54, s48, 2392064
    buffer_load_dwordx4 v48, s[32:35], s54 offen lds
    ds_read2st64_b32 v[32:33], v51 offset0:128 offset1:129
    ds_read2st64_b32 v[34:35], v51 offset0:130 offset1:131
    ds_read2st64_b32 v[36:37], v51 offset0:132 offset1:133
    ds_read2st64_b32 v[38:39], v51 offset0:134 offset1:135
    ds_read2st64_b32 v[40:41], v51 offset0:136 offset1:137
    ds_read2st64_b32 v[42:43], v51 offset0:138 offset1:139
    ds_read2st64_b32 v[44:45], v51 offset0:140 offset1:141
    ds_read2st64_b32 v[46:47], v51 offset0:142 offset1:143
    s_waitcnt lgkmcnt(6)
    v_perm_b32 v60, v33, v32, s52
    v_accvgpr_write_b32 a128, v60
    v_perm_b32 v61, v33, v32, s53
    v_accvgpr_write_b32 a136, v61
    v_perm_b32 v62, v35, v34, s52
    v_accvgpr_write_b32 a129, v62
    v_perm_b32 v63, v35, v34, s53
    v_accvgpr_write_b32 a137, v63
    s_waitcnt lgkmcnt(4)
    v_perm_b32 v60, v37, v36, s52
    v_accvgpr_write_b32 a130, v60
    v_perm_b32 v61, v37, v36, s53
    v_accvgpr_write_b32 a138, v61
    v_perm_b32 v62, v39, v38, s52
    v_accvgpr_write_b32 a131, v62
    v_perm_b32 v63, v39, v38, s53
    v_accvgpr_write_b32 a139, v63
    s_waitcnt lgkmcnt(2)
    v_perm_b32 v60, v41, v40, s52
    v_accvgpr_write_b32 a132, v60
    v_perm_b32 v61, v41, v40, s53
    v_accvgpr_write_b32 a140, v61
    v_perm_b32 v62, v43, v42, s52
    v_accvgpr_write_b32 a133, v62
    v_perm_b32 v63, v43, v42, s53
    v_accvgpr_write_b32 a141, v63
    s_waitcnt lgkmcnt(0)
    v_perm_b32 v60, v45, v44, s52
    v_accvgpr_write_b32 a134, v60
    v_perm_b32 v61, v45, v44, s53
    v_accvgpr_write_b32 a142, v61
    v_perm_b32 v62, v47, v46, s52
    v_accvgpr_write_b32 a135, v62
    v_perm_b32 v63, v47, v46, s53
    v_accvgpr_write_b32 a143, v63
    s_waitcnt vmcnt(12)
    s_barrier
    s_add_u32 m0, s47, 131072
    s_add_u32 s54, s48, 2621440
    buffer_load_dwordx4 v48, s[32:35], s54 offen lds
    s_add_u32 m0, s47, 132096
    s_add_u32 s54, s48, 2654208
    buffer_load_dwordx4 v48, s[32:35], s54 offen lds
    s_add_u32 m0, s47, 133120
    s_add_u32 s54, s48, 2883584
    buffer_load_dwordx4 v48, s[32:35], s54 offen lds
    s_add_u32 m0, s47, 134144
    s_add_u32 s54, s48, 2916352
    buffer_load_dwordx4 v48, s[32:35], s54 offen lds
    ds_read2st64_b32 v[32:33], v21 offset0:0 offset1:1
    ds_read2st64_b32 v[34:35], v21 offset0:2 offset1:3
    ds_read2st64_b32 v[36:37], v21 offset0:4 offset1:5
    ds_read2st64_b32 v[38:39], v21 offset0:6 offset1:7
    ds_read2st64_b32 v[40:41], v21 offset0:8 offset1:9
    ds_read2st64_b32 v[42:43], v21 offset0:10 offset1:11
    ds_read2st64_b32 v[44:45], v21 offset0:12 offset1:13
    ds_read2st64_b32 v[46:47], v21 offset0:14 offset1:15
    s_waitcnt lgkmcnt(6)
    v_perm_b32 v60, v33, v32, s52
    v_accvgpr_write_b32 a144, v60
    v_perm_b32 v61, v33, v32, s53
    v_accvgpr_write_b32 a152, v61
    v_perm_b32 v62, v35, v34, s52
    v_accvgpr_write_b32 a145, v62
    v_perm_b32 v63, v35, v34, s53
    v_accvgpr_write_b32 a153, v63
    s_waitcnt lgkmcnt(4)
    v_perm_b32 v60, v37, v36, s52
    v_accvgpr_write_b32 a146, v60
    v_perm_b32 v61, v37, v36, s53
    v_accvgpr_write_b32 a154, v61
    v_perm_b32 v62, v39, v38, s52
    v_accvgpr_write_b32 a147, v62
    v_perm_b32 v63, v39, v38, s53
    v_accvgpr_write_b32 a155, v63
    s_waitcnt lgkmcnt(2)
    v_perm_b32 v60, v41, v40, s52
    v_accvgpr_write_b32 a148, v60
    v_perm_b32 v61, v41, v40, s53
    v_accvgpr_write_b32 a156, v61
    v_perm_b32 v62, v43, v42, s52
    v_accvgpr_write_b32 a149, v62
    v_perm_b32 v63, v43, v42, s53
    v_accvgpr_write_b32 a157, v63
    s_waitcnt lgkmcnt(0)
    v_perm_b32 v60, v45, v44, s52
    v_accvgpr_write_b32 a150, v60
    v_perm_b32 v61, v45, v44, s53
    v_accvgpr_write_b32 a158, v61
    v_perm_b32 v62, v47, v46, s52
    v_accvgpr_write_b32 a151, v62
    v_perm_b32 v63, v47, v46, s53
    v_accvgpr_write_b32 a159, v63
    s_waitcnt vmcnt(12)
    s_barrier
    s_add_u32 m0, s47, 8192
    s_add_u32 s54, s48, 3145728
    buffer_load_dwordx4 v48, s[32:35], s54 offen lds
    s_add_u32 m0, s47, 9216
    s_add_u32 s54, s48, 3178496
    buffer_load_dwordx4 v48, s[32:35], s54 offen lds
    s_add_u32 m0, s47, 10240
    s_add_u32 s54, s48, 3407872
    buffer_load_dwordx4 v48, s[32:35], s54 offen lds
    s_add_u32 m0, s47, 11264
    s_add_u32 s54, s48, 3440640
    buffer_load_dwordx4 v48, s[32:35], s54 offen lds
    ds_read2st64_b32 v[32:33], v50 offset0:0 offset1:1
    ds_read2st64_b32 v[34:35], v50 offset0:2 offset1:3
    ds_read2st64_b32 v[36:37], v50 offset0:4 offset1:5
    ds_read2st64_b32 v[38:39], v50 offset0:6 offset1:7
    ds_read2st64_b32 v[40:41], v50 offset0:8 offset1:9
    ds_read2st64_b32 v[42:43], v50 offset0:10 offset1:11
    ds_read2st64_b32 v[44:45], v50 offset0:12 offset1:13
    ds_read2st64_b32 v[46:47], v50 offset0:14 offset1:15
    s_waitcnt lgkmcnt(6)
    v_perm_b32 v60, v33, v32, s52
    v_accvgpr_write_b32 a160, v60
    v_perm_b32 v61, v33, v32, s53
    v_accvgpr_write_b32 a168, v61
    v_perm_b32 v62, v35, v34, s52
    v_accvgpr_write_b32 a161, v62
    v_perm_b32 v63, v35, v34, s53
    v_accvgpr_write_b32 a169, v63
    s_waitcnt lgkmcnt(4)
    v_perm_b32 v60, v37, v36, s52
    v_accvgpr_write_b32 a162, v60
    v_perm_b32 v61, v37, v36, s53
    v_accvgpr_write_b32 a170, v61
    v_perm_b32 v62, v39, v38, s52
    v_accvgpr_write_b32 a163, v62
    v_perm_b32 v63, v39, v38, s53
    v_accvgpr_write_b32 a171, v63
    s_waitcnt lgkmcnt(2)
    v_perm_b32 v60, v41, v40, s52
    v_accvgpr_write_b32 a164, v60
    v_perm_b32 v61, v41, v40, s53
    v_accvgpr_write_b32 a172, v61
    v_perm_b32 v62, v43, v42, s52
    v_accvgpr_write_b32 a165, v62
    v_perm_b32 v63, v43, v42, s53
    v_accvgpr_write_b32 a173, v63
    s_waitcnt lgkmcnt(0)
    v_perm_b32 v60, v45, v44, s52
    v_accvgpr_write_b32 a166, v60
    v_perm_b32 v61, v45, v44, s53
    v_accvgpr_write_b32 a174, v61
    v_perm_b32 v62, v47, v46, s52
    v_accvgpr_write_b32 a167, v62
    v_perm_b32 v63, v47, v46, s53
    v_accvgpr_write_b32 a175, v63
    s_waitcnt vmcnt(12)
    s_barrier
    s_add_u32 m0, s47, 32768
    s_add_u32 s54, s48, 3670016
    buffer_load_dwordx4 v48, s[32:35], s54 offen lds
    s_add_u32 m0, s47, 33792
    s_add_u32 s54, s48, 3702784
    buffer_load_dwordx4 v48, s[32:35], s54 offen lds
    s_add_u32 m0, s47, 34816
    s_add_u32 s54, s48, 3932160
    buffer_load_dwordx4 v48, s[32:35], s54 offen lds
    s_add_u32 m0, s47, 35840
    s_add_u32 s54, s48, 3964928
    buffer_load_dwordx4 v48, s[32:35], s54 offen lds
    ds_read2st64_b32 v[32:33], v50 offset0:128 offset1:129
    ds_read2st64_b32 v[34:35], v50 offset0:130 offset1:131
    ds_read2st64_b32 v[36:37], v50 offset0:132 offset1:133
    ds_read2st64_b32 v[38:39], v50 offset0:134 offset1:135
    ds_read2st64_b32 v[40:41], v50 offset0:136 offset1:137
    ds_read2st64_b32 v[42:43], v50 offset0:138 offset1:139
    ds_read2st64_b32 v[44:45], v50 offset0:140 offset1:141
    ds_read2st64_b32 v[46:47], v50 offset0:142 offset1:143
    s_waitcnt lgkmcnt(6)
    v_perm_b32 v60, v33, v32, s52
    v_accvgpr_write_b32 a176, v60
    v_perm_b32 v61, v33, v32, s53
    v_accvgpr_write_b32 a184, v61
    v_perm_b32 v62, v35, v34, s52
    v_accvgpr_write_b32 a177, v62
    v_perm_b32 v63, v35, v34, s53
    v_accvgpr_write_b32 a185, v63
    s_waitcnt lgkmcnt(4)
    v_perm_b32 v60, v37, v36, s52
    v_accvgpr_write_b32 a178, v60
    v_perm_b32 v61, v37, v36, s53
    v_accvgpr_write_b32 a186, v61
    v_perm_b32 v62, v39, v38, s52
    v_accvgpr_write_b32 a179, v62
    v_perm_b32 v63, v39, v38, s53
    v_accvgpr_write_b32 a187, v63
    s_waitcnt lgkmcnt(2)
    v_perm_b32 v60, v41, v40, s52
    v_accvgpr_write_b32 a180, v60
    v_perm_b32 v61, v41, v40, s53
    v_accvgpr_write_b32 a188, v61
    v_perm_b32 v62, v43, v42, s52
    v_accvgpr_write_b32 a181, v62
    v_perm_b32 v63, v43, v42, s53
    v_accvgpr_write_b32 a189, v63
    s_waitcnt lgkmcnt(0)
    v_perm_b32 v60, v45, v44, s52
    v_accvgpr_write_b32 a182, v60
    v_perm_b32 v61, v45, v44, s53
    v_accvgpr_write_b32 a190, v61
    v_perm_b32 v62, v47, v46, s52
    v_accvgpr_write_b32 a183, v62
    v_perm_b32 v63, v47, v46, s53
    v_accvgpr_write_b32 a191, v63
    s_waitcnt vmcnt(12)
    s_barrier
    s_mov_b32 s32, s8
    s_and_b32 s33, s9, 0xffff
    s_mov_b32 s34, 4194304
    s_mov_b32 s35, 0x20000
    s_lshl_b32 s48, s65, 8
    s_lshl_b32 s54, s47, 4
    s_add_u32 s48, s48, s54
    s_add_u32 m0, s47, 65536
    s_add_u32 s54, s48, 0
    buffer_load_dwordx4 v48, s[32:35], s54 offen lds
    s_add_u32 m0, s47, 66560
    s_add_u32 s54, s48, 32768
    buffer_load_dwordx4 v48, s[32:35], s54 offen lds
    s_add_u32 m0, s47, 67584
    s_add_u32 s54, s48, 262144
    buffer_load_dwordx4 v48, s[32:35], s54 offen lds
    s_add_u32 m0, s47, 68608
    s_add_u32 s54, s48, 294912
    buffer_load_dwordx4 v48, s[32:35], s54 offen lds
    ds_read2st64_b32 v[32:33], v51 offset0:0 offset1:1
    ds_read2st64_b32 v[34:35], v51 offset0:2 offset1:3
    ds_read2st64_b32 v[36:37], v51 offset0:4 offset1:5
    ds_read2st64_b32 v[38:39], v51 offset0:6 offset1:7
    ds_read2st64_b32 v[40:41], v51 offset0:8 offset1:9
    ds_read2st64_b32 v[42:43], v51 offset0:10 offset1:11
    ds_read2st64_b32 v[44:45], v51 offset0:12 offset1:13
    ds_read2st64_b32 v[46:47], v51 offset0:14 offset1:15
    s_waitcnt lgkmcnt(6)
    v_perm_b32 v60, v33, v32, s52
    v_accvgpr_write_b32 a192, v60
    v_perm_b32 v61, v33, v32, s53
    v_accvgpr_write_b32 a200, v61
    v_perm_b32 v62, v35, v34, s52
    v_accvgpr_write_b32 a193, v62
    v_perm_b32 v63, v35, v34, s53
    v_accvgpr_write_b32 a201, v63
    s_waitcnt lgkmcnt(4)
    v_perm_b32 v60, v37, v36, s52
    v_accvgpr_write_b32 a194, v60
    v_perm_b32 v61, v37, v36, s53
    v_accvgpr_write_b32 a202, v61
    v_perm_b32 v62, v39, v38, s52
    v_accvgpr_write_b32 a195, v62
    v_perm_b32 v63, v39, v38, s53
    v_accvgpr_write_b32 a203, v63
    s_waitcnt lgkmcnt(2)
    v_perm_b32 v60, v41, v40, s52
    v_accvgpr_write_b32 a196, v60
    v_perm_b32 v61, v41, v40, s53
    v_accvgpr_write_b32 a204, v61
    v_perm_b32 v62, v43, v42, s52
    v_accvgpr_write_b32 a197, v62
    v_perm_b32 v63, v43, v42, s53
    v_accvgpr_write_b32 a205, v63
    s_waitcnt lgkmcnt(0)
    v_perm_b32 v60, v45, v44, s52
    v_accvgpr_write_b32 a198, v60
    v_perm_b32 v61, v45, v44, s53
    v_accvgpr_write_b32 a206, v61
    v_perm_b32 v62, v47, v46, s52
    v_accvgpr_write_b32 a199, v62
    v_perm_b32 v63, v47, v46, s53
    v_accvgpr_write_b32 a207, v63
    s_waitcnt vmcnt(12)
    s_barrier
    s_add_u32 m0, s47, 98304
    s_add_u32 s54, s48, 524288
    buffer_load_dwordx4 v48, s[32:35], s54 offen lds
    s_add_u32 m0, s47, 99328
    s_add_u32 s54, s48, 557056
    buffer_load_dwordx4 v48, s[32:35], s54 offen lds
    s_add_u32 m0, s47, 100352
    s_add_u32 s54, s48, 786432
    buffer_load_dwordx4 v48, s[32:35], s54 offen lds
    s_add_u32 m0, s47, 101376
    s_add_u32 s54, s48, 819200
    buffer_load_dwordx4 v48, s[32:35], s54 offen lds
    ds_read2st64_b32 v[32:33], v51 offset0:128 offset1:129
    ds_read2st64_b32 v[34:35], v51 offset0:130 offset1:131
    ds_read2st64_b32 v[36:37], v51 offset0:132 offset1:133
    ds_read2st64_b32 v[38:39], v51 offset0:134 offset1:135
    ds_read2st64_b32 v[40:41], v51 offset0:136 offset1:137
    ds_read2st64_b32 v[42:43], v51 offset0:138 offset1:139
    ds_read2st64_b32 v[44:45], v51 offset0:140 offset1:141
    ds_read2st64_b32 v[46:47], v51 offset0:142 offset1:143
    s_waitcnt lgkmcnt(6)
    v_perm_b32 v60, v33, v32, s52
    v_accvgpr_write_b32 a208, v60
    v_perm_b32 v61, v33, v32, s53
    v_accvgpr_write_b32 a216, v61
    v_perm_b32 v62, v35, v34, s52
    v_accvgpr_write_b32 a209, v62
    v_perm_b32 v63, v35, v34, s53
    v_accvgpr_write_b32 a217, v63
    s_waitcnt lgkmcnt(4)
    v_perm_b32 v60, v37, v36, s52
    v_accvgpr_write_b32 a210, v60
    v_perm_b32 v61, v37, v36, s53
    v_accvgpr_write_b32 a218, v61
    v_perm_b32 v62, v39, v38, s52
    v_accvgpr_write_b32 a211, v62
    v_perm_b32 v63, v39, v38, s53
    v_accvgpr_write_b32 a219, v63
    s_waitcnt lgkmcnt(2)
    v_perm_b32 v60, v41, v40, s52
    v_accvgpr_write_b32 a212, v60
    v_perm_b32 v61, v41, v40, s53
    v_accvgpr_write_b32 a220, v61
    v_perm_b32 v62, v43, v42, s52
    v_accvgpr_write_b32 a213, v62
    v_perm_b32 v63, v43, v42, s53
    v_accvgpr_write_b32 a221, v63
    s_waitcnt lgkmcnt(0)
    v_perm_b32 v60, v45, v44, s52
    v_accvgpr_write_b32 a214, v60
    v_perm_b32 v61, v45, v44, s53
    v_accvgpr_write_b32 a222, v61
    v_perm_b32 v62, v47, v46, s52
    v_accvgpr_write_b32 a215, v62
    v_perm_b32 v63, v47, v46, s53
    v_accvgpr_write_b32 a223, v63
    s_waitcnt vmcnt(12)
    s_barrier
    s_add_u32 m0, s47, 131072
    s_add_u32 s54, s48, 1048576
    buffer_load_dwordx4 v48, s[32:35], s54 offen lds
    s_add_u32 m0, s47, 132096
    s_add_u32 s54, s48, 1081344
    buffer_load_dwordx4 v48, s[32:35], s54 offen lds
    s_add_u32 m0, s47, 133120
    s_add_u32 s54, s48, 1310720
    buffer_load_dwordx4 v48, s[32:35], s54 offen lds
    s_add_u32 m0, s47, 134144
    s_add_u32 s54, s48, 1343488
    buffer_load_dwordx4 v48, s[32:35], s54 offen lds
    ds_read2st64_b32 v[32:33], v21 offset0:0 offset1:1
    ds_read2st64_b32 v[34:35], v21 offset0:2 offset1:3
    ds_read2st64_b32 v[36:37], v21 offset0:4 offset1:5
    ds_read2st64_b32 v[38:39], v21 offset0:6 offset1:7
    ds_read2st64_b32 v[40:41], v21 offset0:8 offset1:9
    ds_read2st64_b32 v[42:43], v21 offset0:10 offset1:11
    ds_read2st64_b32 v[44:45], v21 offset0:12 offset1:13
    ds_read2st64_b32 v[46:47], v21 offset0:14 offset1:15
    s_waitcnt lgkmcnt(6)
    v_perm_b32 v60, v33, v32, s52
    v_accvgpr_write_b32 a224, v60
    v_perm_b32 v61, v33, v32, s53
    v_accvgpr_write_b32 a232, v61
    v_perm_b32 v62, v35, v34, s52
    v_accvgpr_write_b32 a225, v62
    v_perm_b32 v63, v35, v34, s53
    v_accvgpr_write_b32 a233, v63
    s_waitcnt lgkmcnt(4)
    v_perm_b32 v60, v37, v36, s52
    v_accvgpr_write_b32 a226, v60
    v_perm_b32 v61, v37, v36, s53
    v_accvgpr_write_b32 a234, v61
    v_perm_b32 v62, v39, v38, s52
    v_accvgpr_write_b32 a227, v62
    v_perm_b32 v63, v39, v38, s53
    v_accvgpr_write_b32 a235, v63
    s_waitcnt lgkmcnt(2)
    v_perm_b32 v60, v41, v40, s52
    v_accvgpr_write_b32 a228, v60
    v_perm_b32 v61, v41, v40, s53
    v_accvgpr_write_b32 a236, v61
    v_perm_b32 v62, v43, v42, s52
    v_accvgpr_write_b32 a229, v62
    v_perm_b32 v63, v43, v42, s53
    v_accvgpr_write_b32 a237, v63
    s_waitcnt lgkmcnt(0)
    v_perm_b32 v60, v45, v44, s52
    v_accvgpr_write_b32 a230, v60
    v_perm_b32 v61, v45, v44, s53
    v_accvgpr_write_b32 a238, v61
    v_perm_b32 v62, v47, v46, s52
    v_accvgpr_write_b32 a231, v62
    v_perm_b32 v63, v47, v46, s53
    v_accvgpr_write_b32 a239, v63
    s_waitcnt vmcnt(12)
    s_barrier
    s_add_u32 m0, s47, 8192
    s_add_u32 s54, s48, 1572864
    buffer_load_dwordx4 v48, s[32:35], s54 offen lds
    s_add_u32 m0, s47, 9216
    s_add_u32 s54, s48, 1605632
    buffer_load_dwordx4 v48, s[32:35], s54 offen lds
    s_add_u32 m0, s47, 10240
    s_add_u32 s54, s48, 1835008
    buffer_load_dwordx4 v48, s[32:35], s54 offen lds
    s_add_u32 m0, s47, 11264
    s_add_u32 s54, s48, 1867776
    buffer_load_dwordx4 v48, s[32:35], s54 offen lds
    ds_read2st64_b32 v[32:33], v50 offset0:0 offset1:1
    ds_read2st64_b32 v[34:35], v50 offset0:2 offset1:3
    ds_read2st64_b32 v[36:37], v50 offset0:4 offset1:5
    ds_read2st64_b32 v[38:39], v50 offset0:6 offset1:7
    ds_read2st64_b32 v[40:41], v50 offset0:8 offset1:9
    ds_read2st64_b32 v[42:43], v50 offset0:10 offset1:11
    ds_read2st64_b32 v[44:45], v50 offset0:12 offset1:13
    ds_read2st64_b32 v[46:47], v50 offset0:14 offset1:15
    s_waitcnt lgkmcnt(6)
    v_perm_b32 v60, v33, v32, s52
    v_accvgpr_write_b32 a240, v60
    v_perm_b32 v61, v33, v32, s53
    v_accvgpr_write_b32 a248, v61
    v_perm_b32 v62, v35, v34, s52
    v_accvgpr_write_b32 a241, v62
    v_perm_b32 v63, v35, v34, s53
    v_accvgpr_write_b32 a249, v63
    s_waitcnt lgkmcnt(4)
    v_perm_b32 v60, v37, v36, s52
    v_accvgpr_write_b32 a242, v60
    v_perm_b32 v61, v37, v36, s53
    v_accvgpr_write_b32 a250, v61
    v_perm_b32 v62, v39, v38, s52
    v_accvgpr_write_b32 a243, v62
    v_perm_b32 v63, v39, v38, s53
    v_accvgpr_write_b32 a251, v63
    s_waitcnt lgkmcnt(2)
    v_perm_b32 v60, v41, v40, s52
    v_accvgpr_write_b32 a244, v60
    v_perm_b32 v61, v41, v40, s53
    v_accvgpr_write_b32 a252, v61
    v_perm_b32 v62, v43, v42, s52
    v_accvgpr_write_b32 a245, v62
    v_perm_b32 v63, v43, v42, s53
    v_accvgpr_write_b32 a253, v63
    s_waitcnt lgkmcnt(0)
    v_perm_b32 v60, v45, v44, s52
    v_accvgpr_write_b32 a246, v60
    v_perm_b32 v61, v45, v44, s53
    v_accvgpr_write_b32 a254, v61
    v_perm_b32 v62, v47, v46, s52
    v_accvgpr_write_b32 a247, v62
    v_perm_b32 v63, v47, v46, s53
    v_accvgpr_write_b32 a255, v63
    s_waitcnt vmcnt(12)
    s_barrier
    s_add_u32 m0, s47, 32768
    s_add_u32 s54, s48, 2097152
    buffer_load_dwordx4 v48, s[32:35], s54 offen lds
    s_add_u32 m0, s47, 33792
    s_add_u32 s54, s48, 2129920
    buffer_load_dwordx4 v48, s[32:35], s54 offen lds
    s_add_u32 m0, s47, 34816
    s_add_u32 s54, s48, 2359296
    buffer_load_dwordx4 v48, s[32:35], s54 offen lds
    s_add_u32 m0, s47, 35840
    s_add_u32 s54, s48, 2392064
    buffer_load_dwordx4 v48, s[32:35], s54 offen lds
    buffer_load_dwordx2 v[8:9], v6, s[28:31], s74 offen sc1
    s_mov_b32 s55, 4096
    buffer_load_dwordx2 v[26:27], v29, s[28:31], s55 offen sc1
    ds_read2st64_b32 v[32:33], v50 offset0:128 offset1:129
    ds_read2st64_b32 v[34:35], v50 offset0:130 offset1:131
    ds_read2st64_b32 v[36:37], v50 offset0:132 offset1:133
    ds_read2st64_b32 v[38:39], v50 offset0:134 offset1:135
    ds_read2st64_b32 v[40:41], v50 offset0:136 offset1:137
    ds_read2st64_b32 v[42:43], v50 offset0:138 offset1:139
    ds_read2st64_b32 v[44:45], v50 offset0:140 offset1:141
    ds_read2st64_b32 v[46:47], v50 offset0:142 offset1:143
    s_waitcnt lgkmcnt(6)
    v_perm_b32 v64, v33, v32, s52
    v_perm_b32 v192, v33, v32, s53
    v_perm_b32 v65, v35, v34, s52
    v_perm_b32 v193, v35, v34, s53
    s_waitcnt lgkmcnt(4)
    v_perm_b32 v66, v37, v36, s52
    v_perm_b32 v194, v37, v36, s53
    v_perm_b32 v67, v39, v38, s52
    v_perm_b32 v195, v39, v38, s53
    s_waitcnt lgkmcnt(2)
    v_perm_b32 v68, v41, v40, s52
    v_perm_b32 v196, v41, v40, s53
    v_perm_b32 v69, v43, v42, s52
    v_perm_b32 v197, v43, v42, s53
    s_waitcnt lgkmcnt(0)
    v_perm_b32 v70, v45, v44, s52
    v_perm_b32 v198, v45, v44, s53
    v_perm_b32 v71, v47, v46, s52
    v_perm_b32 v199, v47, v46, s53
    s_waitcnt vmcnt(14)
    s_barrier
    s_add_u32 m0, s47, 65536
    s_add_u32 s54, s48, 2621440
    buffer_load_dwordx4 v48, s[32:35], s54 offen lds
    s_add_u32 m0, s47, 66560
    s_add_u32 s54, s48, 2654208
    buffer_load_dwordx4 v48, s[32:35], s54 offen lds
    s_add_u32 m0, s47, 67584
    s_add_u32 s54, s48, 2883584
    buffer_load_dwordx4 v48, s[32:35], s54 offen lds
    s_add_u32 m0, s47, 68608
    s_add_u32 s54, s48, 2916352
    buffer_load_dwordx4 v48, s[32:35], s54 offen lds
    ds_read2st64_b32 v[32:33], v51 offset0:0 offset1:1
    ds_read2st64_b32 v[34:35], v51 offset0:2 offset1:3
    ds_read2st64_b32 v[36:37], v51 offset0:4 offset1:5
    ds_read2st64_b32 v[38:39], v51 offset0:6 offset1:7
    ds_read2st64_b32 v[40:41], v51 offset0:8 offset1:9
    ds_read2st64_b32 v[42:43], v51 offset0:10 offset1:11
    ds_read2st64_b32 v[44:45], v51 offset0:12 offset1:13
    ds_read2st64_b32 v[46:47], v51 offset0:14 offset1:15
    s_waitcnt lgkmcnt(6)
    v_perm_b32 v72, v33, v32, s52
    v_perm_b32 v200, v33, v32, s53
    v_perm_b32 v73, v35, v34, s52
    v_perm_b32 v201, v35, v34, s53
    s_waitcnt lgkmcnt(4)
    v_perm_b32 v74, v37, v36, s52
    v_perm_b32 v202, v37, v36, s53
    v_perm_b32 v75, v39, v38, s52
    v_perm_b32 v203, v39, v38, s53
    s_waitcnt lgkmcnt(2)
    v_perm_b32 v76, v41, v40, s52
    v_perm_b32 v204, v41, v40, s53
    v_perm_b32 v77, v43, v42, s52
    v_perm_b32 v205, v43, v42, s53
    s_waitcnt lgkmcnt(0)
    v_perm_b32 v78, v45, v44, s52
    v_perm_b32 v206, v45, v44, s53
    v_perm_b32 v79, v47, v46, s52
    v_perm_b32 v207, v47, v46, s53
    s_waitcnt vmcnt(14)
    s_barrier
    s_add_u32 m0, s47, 98304
    s_add_u32 s54, s48, 3145728
    buffer_load_dwordx4 v48, s[32:35], s54 offen lds
    s_add_u32 m0, s47, 99328
    s_add_u32 s54, s48, 3178496
    buffer_load_dwordx4 v48, s[32:35], s54 offen lds
    s_add_u32 m0, s47, 100352
    s_add_u32 s54, s48, 3407872
    buffer_load_dwordx4 v48, s[32:35], s54 offen lds
    s_add_u32 m0, s47, 101376
    s_add_u32 s54, s48, 3440640
    buffer_load_dwordx4 v48, s[32:35], s54 offen lds
    ds_read2st64_b32 v[32:33], v51 offset0:128 offset1:129
    ds_read2st64_b32 v[34:35], v51 offset0:130 offset1:131
    ds_read2st64_b32 v[36:37], v51 offset0:132 offset1:133
    ds_read2st64_b32 v[38:39], v51 offset0:134 offset1:135
    ds_read2st64_b32 v[40:41], v51 offset0:136 offset1:137
    ds_read2st64_b32 v[42:43], v51 offset0:138 offset1:139
    ds_read2st64_b32 v[44:45], v51 offset0:140 offset1:141
    ds_read2st64_b32 v[46:47], v51 offset0:142 offset1:143
    s_waitcnt lgkmcnt(6)
    v_perm_b32 v80, v33, v32, s52
    v_perm_b32 v208, v33, v32, s53
    v_perm_b32 v81, v35, v34, s52
    v_perm_b32 v209, v35, v34, s53
    s_waitcnt lgkmcnt(4)
    v_perm_b32 v82, v37, v36, s52
    v_perm_b32 v210, v37, v36, s53
    v_perm_b32 v83, v39, v38, s52
    v_perm_b32 v211, v39, v38, s53
    s_waitcnt lgkmcnt(2)
    v_perm_b32 v84, v41, v40, s52
    v_perm_b32 v212, v41, v40, s53
    v_perm_b32 v85, v43, v42, s52
    v_perm_b32 v213, v43, v42, s53
    s_waitcnt lgkmcnt(0)
    v_perm_b32 v86, v45, v44, s52
    v_perm_b32 v214, v45, v44, s53
    v_perm_b32 v87, v47, v46, s52
    v_perm_b32 v215, v47, v46, s53
    s_waitcnt vmcnt(14)
    s_barrier
    s_add_u32 m0, s47, 131072
    s_add_u32 s54, s48, 3670016
    buffer_load_dwordx4 v48, s[32:35], s54 offen lds
    s_add_u32 m0, s47, 132096
    s_add_u32 s54, s48, 3702784
    buffer_load_dwordx4 v48, s[32:35], s54 offen lds
    s_add_u32 m0, s47, 133120
    s_add_u32 s54, s48, 3932160
    buffer_load_dwordx4 v48, s[32:35], s54 offen lds
    s_add_u32 m0, s47, 134144
    s_add_u32 s54, s48, 3964928
    buffer_load_dwordx4 v48, s[32:35], s54 offen lds
    ds_read2st64_b32 v[32:33], v21 offset0:0 offset1:1
    ds_read2st64_b32 v[34:35], v21 offset0:2 offset1:3
    ds_read2st64_b32 v[36:37], v21 offset0:4 offset1:5
    ds_read2st64_b32 v[38:39], v21 offset0:6 offset1:7
    ds_read2st64_b32 v[40:41], v21 offset0:8 offset1:9
    ds_read2st64_b32 v[42:43], v21 offset0:10 offset1:11
    ds_read2st64_b32 v[44:45], v21 offset0:12 offset1:13
    ds_read2st64_b32 v[46:47], v21 offset0:14 offset1:15
    s_waitcnt lgkmcnt(6)
    v_perm_b32 v88, v33, v32, s52
    v_perm_b32 v216, v33, v32, s53
    v_perm_b32 v89, v35, v34, s52
    v_perm_b32 v217, v35, v34, s53
    s_waitcnt lgkmcnt(4)
    v_perm_b32 v90, v37, v36, s52
    v_perm_b32 v218, v37, v36, s53
    v_perm_b32 v91, v39, v38, s52
    v_perm_b32 v219, v39, v38, s53
    s_waitcnt lgkmcnt(2)
    v_perm_b32 v92, v41, v40, s52
    v_perm_b32 v220, v41, v40, s53
    v_perm_b32 v93, v43, v42, s52
    v_perm_b32 v221, v43, v42, s53
    s_waitcnt lgkmcnt(0)
    v_perm_b32 v94, v45, v44, s52
    v_perm_b32 v222, v45, v44, s53
    v_perm_b32 v95, v47, v46, s52
    v_perm_b32 v223, v47, v46, s53
    s_waitcnt vmcnt(14)
    s_barrier
    s_waitcnt vmcnt(12)
    v_cmp_eq_u64 s[60:61], s[42:43], v[8:9]
    s_nop 0
    s_bitcmp1_b64 s[60:61], 0
    s_cselect_b32 s55, s71, 917504
    s_mov_b32 m0, s73
    s_nop 0
    buffer_load_dwordx4 v0, s[28:31], s55 offen sc1 lds
    buffer_load_dwordx4 v0, s[28:31], s55 offen offset:1024 sc1 lds
    buffer_load_dwordx4 v[16:19], v0, s[28:31], s66 offen offset:0 sc1
    buffer_load_dwordx4 v[16:19], v0, s[28:31], s66 offen offset:1024 sc1
    buffer_load_dwordx4 v[16:19], v0, s[28:31], s67 offen offset:0 sc1
    buffer_load_dwordx4 v[16:19], v0, s[28:31], s67 offen offset:1024 sc1
    buffer_load_dword v16, v5, s[28:31], s68 offen sc1
    buffer_load_dword v16, v5, s[28:31], s69 offen sc1
    buffer_load_dword v16, v5, s[28:31], s70 offen sc1
    ds_read2st64_b32 v[32:33], v50 offset0:0 offset1:1
    ds_read2st64_b32 v[34:35], v50 offset0:2 offset1:3
    ds_read2st64_b32 v[36:37], v50 offset0:4 offset1:5
    ds_read2st64_b32 v[38:39], v50 offset0:6 offset1:7
    ds_read2st64_b32 v[40:41], v50 offset0:8 offset1:9
    ds_read2st64_b32 v[42:43], v50 offset0:10 offset1:11
    ds_read2st64_b32 v[44:45], v50 offset0:12 offset1:13
    ds_read2st64_b32 v[46:47], v50 offset0:14 offset1:15
    s_waitcnt lgkmcnt(6)
    v_perm_b32 v96, v33, v32, s52
    v_perm_b32 v224, v33, v32, s53
    v_perm_b32 v97, v35, v34, s52
    v_perm_b32 v225, v35, v34, s53
    s_waitcnt lgkmcnt(4)
    v_perm_b32 v98, v37, v36, s52
    v_perm_b32 v226, v37, v36, s53
    v_perm_b32 v99, v39, v38, s52
    v_perm_b32 v227, v39, v38, s53
    s_waitcnt lgkmcnt(2)
    v_perm_b32 v100, v41, v40, s52
    v_perm_b32 v228, v41, v40, s53
    v_perm_b32 v101, v43, v42, s52
    v_perm_b32 v229, v43, v42, s53
    s_waitcnt lgkmcnt(0)
    v_perm_b32 v102, v45, v44, s52
    v_perm_b32 v230, v45, v44, s53
    v_perm_b32 v103, v47, v46, s52
    v_perm_b32 v231, v47, v46, s53
    s_waitcnt vmcnt(17)
    s_barrier
    ds_read2st64_b32 v[32:33], v50 offset0:128 offset1:129
    ds_read2st64_b32 v[34:35], v50 offset0:130 offset1:131
    ds_read2st64_b32 v[36:37], v50 offset0:132 offset1:133
    ds_read2st64_b32 v[38:39], v50 offset0:134 offset1:135
    ds_read2st64_b32 v[40:41], v50 offset0:136 offset1:137
    ds_read2st64_b32 v[42:43], v50 offset0:138 offset1:139
    ds_read2st64_b32 v[44:45], v50 offset0:140 offset1:141
    ds_read2st64_b32 v[46:47], v50 offset0:142 offset1:143
    s_waitcnt lgkmcnt(6)
    v_perm_b32 v104, v33, v32, s52
    v_perm_b32 v232, v33, v32, s53
    v_perm_b32 v105, v35, v34, s52
    v_perm_b32 v233, v35, v34, s53
    s_waitcnt lgkmcnt(4)
    v_perm_b32 v106, v37, v36, s52
    v_perm_b32 v234, v37, v36, s53
    v_perm_b32 v107, v39, v38, s52
    v_perm_b32 v235, v39, v38, s53
    s_waitcnt lgkmcnt(2)
    v_perm_b32 v108, v41, v40, s52
    v_perm_b32 v236, v41, v40, s53
    v_perm_b32 v109, v43, v42, s52
    v_perm_b32 v237, v43, v42, s53
    s_waitcnt lgkmcnt(0)
    v_perm_b32 v110, v45, v44, s52
    v_perm_b32 v238, v45, v44, s53
    v_perm_b32 v111, v47, v46, s52
    v_perm_b32 v239, v47, v46, s53
    s_waitcnt vmcnt(13)
    s_barrier
    ds_read2st64_b32 v[32:33], v51 offset0:0 offset1:1
    ds_read2st64_b32 v[34:35], v51 offset0:2 offset1:3
    ds_read2st64_b32 v[36:37], v51 offset0:4 offset1:5
    ds_read2st64_b32 v[38:39], v51 offset0:6 offset1:7
    ds_read2st64_b32 v[40:41], v51 offset0:8 offset1:9
    ds_read2st64_b32 v[42:43], v51 offset0:10 offset1:11
    ds_read2st64_b32 v[44:45], v51 offset0:12 offset1:13
    ds_read2st64_b32 v[46:47], v51 offset0:14 offset1:15
    s_waitcnt lgkmcnt(6)
    v_perm_b32 v112, v33, v32, s52
    v_perm_b32 v240, v33, v32, s53
    v_perm_b32 v113, v35, v34, s52
    v_perm_b32 v241, v35, v34, s53
    s_waitcnt lgkmcnt(4)
    v_perm_b32 v114, v37, v36, s52
    v_perm_b32 v242, v37, v36, s53
    v_perm_b32 v115, v39, v38, s52
    v_perm_b32 v243, v39, v38, s53
    s_waitcnt lgkmcnt(2)
    v_perm_b32 v116, v41, v40, s52
    v_perm_b32 v244, v41, v40, s53
    v_perm_b32 v117, v43, v42, s52
    v_perm_b32 v245, v43, v42, s53
    s_waitcnt lgkmcnt(0)
    v_perm_b32 v118, v45, v44, s52
    v_perm_b32 v246, v45, v44, s53
    v_perm_b32 v119, v47, v46, s52
    v_perm_b32 v247, v47, v46, s53
    s_waitcnt vmcnt(9)
    s_barrier
    ds_read2st64_b32 v[32:33], v51 offset0:128 offset1:129
    ds_read2st64_b32 v[34:35], v51 offset0:130 offset1:131
    ds_read2st64_b32 v[36:37], v51 offset0:132 offset1:133
    ds_read2st64_b32 v[38:39], v51 offset0:134 offset1:135
    ds_read2st64_b32 v[40:41], v51 offset0:136 offset1:137
    ds_read2st64_b32 v[42:43], v51 offset0:138 offset1:139
    ds_read2st64_b32 v[44:45], v51 offset0:140 offset1:141
    ds_read2st64_b32 v[46:47], v51 offset0:142 offset1:143
    s_waitcnt lgkmcnt(6)
    v_perm_b32 v120, v33, v32, s52
    v_perm_b32 v248, v33, v32, s53
    v_perm_b32 v121, v35, v34, s52
    v_perm_b32 v249, v35, v34, s53
    s_waitcnt lgkmcnt(4)
    v_perm_b32 v122, v37, v36, s52
    v_perm_b32 v250, v37, v36, s53
    v_perm_b32 v123, v39, v38, s52
    v_perm_b32 v251, v39, v38, s53
    s_waitcnt lgkmcnt(2)
    v_perm_b32 v124, v41, v40, s52
    v_perm_b32 v252, v41, v40, s53
    v_perm_b32 v125, v43, v42, s52
    v_perm_b32 v253, v43, v42, s53
    s_waitcnt lgkmcnt(0)
    v_perm_b32 v126, v45, v44, s52
    v_perm_b32 v254, v45, v44, s53
    v_perm_b32 v127, v47, v46, s52
    v_perm_b32 v255, v47, v46, s53
    s_bitcmp1_b64 s[60:61], 0
    s_cbranch_scc1 L_kv0_9
    s_add_u32 s54, s64, 0
    s_min_u32 s54, s54, 63
    s_mov_b32 s58, 0
L_kvp_11:
    v_cmp_eq_u64 s[60:61], s[42:43], v[8:9]
    s_nop 1
    s_bitcmp1_b64 s[60:61], s54
    s_cbranch_scc1 L_kvok_10
    buffer_load_dwordx2 v[8:9], v6, s[28:31], s74 offen sc1
    s_waitcnt vmcnt(0)
    s_add_u32 s58, s58, 1
    s_cmp_lt_u32 s58, 1048576
    s_cbranch_scc1 L_kvp_11
    s_branch L_abort
L_kvok_10:
    s_mov_b32 m0, s73
    s_nop 0
    buffer_load_dwordx4 v0, s[28:31], s71 offen sc1 lds
    buffer_load_dwordx4 v0, s[28:31], s71 offen offset:1024 sc1 lds
L_kv0_9:
    s_xor_b32 m0, s73, 0x800
    s_add_u32 s71, s71, 262144
    s_add_u32 s54, s64, 1
    s_min_u32 s54, s54, 63
    s_mov_b32 s58, 0
L_kvp_14:
    v_cmp_eq_u64 s[60:61], s[42:43], v[8:9]
    s_nop 1
    s_bitcmp1_b64 s[60:61], s54
    s_cbranch_scc1 L_kvok_13
    buffer_load_dwordx2 v[8:9], v6, s[28:31], s74 offen sc1
    s_waitcnt vmcnt(0)
    s_add_u32 s58, s58, 1
    s_cmp_lt_u32 s58, 1048576
    s_cbranch_scc1 L_kvp_14
    s_branch L_abort
L_kvok_13:
    s_mov_b32 s58, 0
    s_mov_b32 s55, 4096
    s_branch L_trc_17
L_trp_16:
    buffer_load_dwordx2 v[26:27], v29, s[28:31], s55 offen sc1
    s_waitcnt vmcnt(0)
L_trc_17:
    v_mov_b32 v35, s43
    v_subrev_co_u32 v32, vcc, s42, v26
    s_nop 1
    v_subb_co_u32 v33, vcc, v27, v35, vcc
    v_lshrrev_b32 v35, 3, v32
    v_or_b32 v33, v33, v35
    v_cmp_ne_u32 vcc, 0, v33
    s_cbranch_vccz L_trd_18
    s_add_u32 s58, s58, 1
    s_cmp_lt_u32 s58, 1048576
    s_cbranch_scc1 L_trp_16
    s_branch L_abort
L_trd_18:
    v_cmp_ne_u32 vcc, s46, v32
    v_mov_b32 v24, 0
    v_mov_b32 v25, 0
    v_mov_b32 v26, 0
    v_mov_b32 v27, 0
    v_mov_b32 v28, 0
    v_mov_b32 v29, 0
    v_mov_b32 v30, 0
    v_mov_b32 v31, 0
    s_mov_b32 s62, 0x3f803f80
    s_mov_b32 s63, 0x3f803f80
    s_waitcnt vmcnt(0) lgkmcnt(0)
    s_barrier
    ds_write_b128 v1, v[64:67] offset:0
    ds_write_b128 v1, v[68:71] offset:1024
    ds_write_b128 v1, v[72:75] offset:2048
    ds_write_b128 v1, v[76:79] offset:3072
    ds_write_b128 v1, v[80:83] offset:4096
    ds_write_b128 v1, v[84:87] offset:5120
    ds_write_b128 v1, v[88:91] offset:6144
    ds_write_b128 v1, v[92:95] offset:7168
    ds_write_b128 v1, v[96:99] offset:8192
    ds_write_b128 v1, v[100:103] offset:9216
    ds_write_b128 v1, v[104:107] offset:10240
    ds_write_b128 v1, v[108:111] offset:11264
    ds_write_b128 v1, v[112:115] offset:12288
    ds_write_b128 v1, v[116:119] offset:13312
    ds_write_b128 v1, v[120:123] offset:14336
    ds_write_b128 v1, v[124:127] offset:15360
    s_mov_b32 s47, 262144
    s_mov_b32 s48, 327680
    s_mov_b32 s49, 393216
    s_mov_b32 s50, 458752
    v_and_b32 v2, 32, v0
    v_lshrrev_b32 v2, 2, v2
    v_add_u32 v2, v2, v4
    s_mov_b32 s76, 0xcccccccc
    s_mov_b32 s77, 0xcccccccc
    s_cbranch_vccnz L_slow
    s_cmp_eq_u32 s44, 1
    s_cbranch_scc1 L_ent_f1
    s_cmp_eq_u32 s44, 2
    s_cbranch_scc1 L_ent_f2
    s_cmp_eq_u32 s44, 3
    s_cbranch_scc1 L_ent_f3
L_ent_f0:
    ds_read_b128 v[64:67], v1 offset:0
    ds_read_b128 v[68:71], v1 offset:1024
    ds_read_b128 v[72:75], v1 offset:2048
    ds_read_b128 v[76:79], v1 offset:3072
    ds_read_b128 v[80:83], v1 offset:4096
    ds_read_b128 v[84:87], v1 offset:5120
    ds_read_b128 v[88:91], v1 offset:6144
    ds_read_b128 v[92:95], v1 offset:7168
    ds_read_b128 v[96:99], v1 offset:8192
    ds_read_b128 v[100:103], v1 offset:9216
    ds_read_b128 v[104:107], v1 offset:10240
    ds_read_b128 v[108:111], v1 offset:11264
    ds_read_b128 v[112:115], v1 offset:12288
    ds_read_b128 v[116:119], v1 offset:13312
    ds_read_b128 v[120:123], v1 offset:14336
    ds_read_b128 v[124:127], v1 offset:15360
    ds_read_b128 v[56:59], v0 offset:0
    ds_read_b128 v[60:63], v0 offset:1024
    s_waitcnt lgkmcnt(0)
    v_smfmac_f32_16x16x64_bf16 v[24:27], v[56:59], v[64:71], v10
    v_smfmac_f32_16x16x64_bf16 v[24:27], v[60:63], v[72:79], v10
    s_branch L_top_f0
L_p2_f0:
    buffer_load_dwordx4 v[56:59], v0, s[28:31], s55 offen sc1
    buffer_load_dwordx4 v[60:63], v0, s[28:31], s55 offen offset:1024 sc1
    s_add_u32 s58, s58, 4096
    s_cbranch_scc1 L_tabort
    s_nop 1
    s_nop 0
    v_mov_b64 v[24:25], 0
    v_mov_b64 v[26:27], 0
L_p2e_f0:
    s_waitcnt vmcnt(3)
    v_max3_u32 v37, v56, v57, v58
    v_max_u32 v37, v37, v59
    v_smfmac_f32_16x16x64_bf16 v[24:27], v[56:59], v[64:71], v10
    ds_write_b128 v0, v[56:59] offset:0
    s_waitcnt vmcnt(2)
    v_max3_u32 v37, v37, v60, v61
    v_max3_u32 v37, v37, v62, v63
    v_cmp_eq_u32 vcc, -1, v37
    v_smfmac_f32_16x16x64_bf16 v[24:27], v[60:63], v[72:79], v10
    s_cbranch_vccnz L_p2_f0
L_top_f0:
    v_mov_b64 v[64:65], 0
    v_smfmac_f32_16x16x64_bf16 v[28:31], v[56:59], v[192:199], v10
    ds_write_b128 v0, v[60:63] offset:1024
    v_mov_b64 v[66:67], 0
    v_smfmac_f32_16x16x64_bf16 v[28:31], v[60:63], v[200:207], v10
    buffer_load_dwordx4 v[16:19], v0, s[28:31], s78 offen
    v_mov_b64 v[72:73], 0
    v_smfmac_f32_16x16x64_bf16 v[64:67], v[56:59], v[128:135], v10
    buffer_load_dwordx4 v[20:23], v0, s[28:31], s78 offen offset:1024
    v_mov_b64 v[74:75], 0
    v_smfmac_f32_16x16x64_bf16 v[64:67], v[60:63], v[136:143], v10
    s_waitcnt lgkmcnt(0)
    s_barrier
    ds_read_b128 v[32:35], v0 offset:2048
    ds_read_b128 v[36:39], v0 offset:3072
    v_mov_b64 v[76:77], 0
    v_smfmac_f32_16x16x64_bf16 v[72:75], v[56:59], a[128:135], v10
    ds_read_b128 v[40:43], v0 offset:4096
    v_mov_b64 v[78:79], 0
    v_smfmac_f32_16x16x64_bf16 v[72:75], v[60:63], a[144:151], v10
    ds_read_b128 v[44:47], v0 offset:5120
    v_smfmac_f32_16x16x64_bf16 v[76:79], v[56:59], a[136:143], v10
    ds_read_b128 v[48:51], v0 offset:6144
    buffer_store_dwordx2 v[52:53], v6, s[28:31], s72 offen offset:0 sc1
    v_smfmac_f32_16x16x64_bf16 v[76:79], v[60:63], a[152:159], v10
    s_waitcnt lgkmcnt(3)
    v_smfmac_f32_16x16x64_bf16 v[24:27], v[32:35], v[80:87], v10
    ds_read_b128 v[80:83], v1 offset:16384
    buffer_store_dwordx2 v[54:55], v6, s[28:31], s72 offen offset:512 sc1
    v_smfmac_f32_16x16x64_bf16 v[24:27], v[36:39], v[88:95], v10
    ds_read_b128 v[52:55], v0 offset:7168
    ds_read_b128 v[84:87], v1 offset:17408
    s_waitcnt lgkmcnt(3)
    v_smfmac_f32_16x16x64_bf16 v[24:27], v[40:43], v[96:103], v10
    ds_read_b128 v[88:91], v1 offset:18432
    v_mov_b64 v[68:69], 0
    v_smfmac_f32_16x16x64_bf16 v[24:27], v[44:47], v[104:111], v10
    ds_read_b128 v[92:95], v1 offset:19456
    v_mov_b64 v[70:71], 0
    v_smfmac_f32_16x16x64_bf16 v[24:27], v[48:51], v[112:119], v10
    ds_read_b128 v[96:99], v1 offset:20480
    s_waitcnt lgkmcnt(4)
    v_smfmac_f32_16x16x64_bf16 v[24:27], v[52:55], v[120:127], v10
    ds_read_b128 v[100:103], v1 offset:21504
    v_smfmac_f32_16x16x64_bf16 v[28:31], v[32:35], v[208:215], v10
    ds_read_b128 v[104:107], v1 offset:22528
    v_smfmac_f32_16x16x64_bf16 v[28:31], v[36:39], v[216:223], v10
    ds_read_b128 v[108:111], v1 offset:23552
    v_add_f32 v24, v24, v26
    v_smfmac_f32_16x16x64_bf16 v[28:31], v[40:43], v[224:231], v10
    ds_read_b128 v[112:115], v1 offset:24576
    v_add_f32 v25, v25, v27
    v_smfmac_f32_16x16x64_bf16 v[28:31], v[44:47], v[232:239], v10
    ds_read_b128 v[116:119], v1 offset:25600
    v_mul_f32 v24, s59, v24
    v_smfmac_f32_16x16x64_bf16 v[28:31], v[48:51], v[240:247], v10
    ds_read_b128 v[120:123], v1 offset:26624
    v_mul_f32 v25, s59, v25
    v_smfmac_f32_16x16x64_bf16 v[28:31], v[52:55], v[248:255], v10
    ds_read_b128 v[124:127], v1 offset:27648
    s_cmp_lg_u64 s[60:61], -1
    s_cbranch_scc1 L_rf_19
L_rb_20:
    s_waitcnt lgkmcnt(6)
    v_smfmac_f32_16x16x64_bf16 v[68:71], v[56:59], v[80:87], v10
    ds_read_b128 v[80:83], v1 offset:28672
    v_smfmac_f32_16x16x64_bf16 v[68:71], v[60:63], v[88:95], v10
    ds_read_b128 v[84:87], v1 offset:29696
    v_add_f32 v28, v28, v30
    v_smfmac_f32_16x16x64_bf16 v[68:71], v[32:35], v[96:103], v10
    ds_read_b128 v[88:91], v1 offset:30720
    s_waitcnt lgkmcnt(5)
    v_add_f32 v29, v29, v31
    v_smfmac_f32_16x16x64_bf16 v[68:71], v[36:39], v[104:111], v10
    ds_read_b128 v[92:95], v1 offset:31744
    v_mul_f32 v28, s59, v28
    v_smfmac_f32_16x16x64_bf16 v[68:71], v[40:43], v[112:119], v10
    ds_read_b128 v[96:99], v11 offset:8192
    s_waitcnt lgkmcnt(5)
    v_mul_f32 v29, s59, v29
    v_smfmac_f32_16x16x64_bf16 v[68:71], v[44:47], v[120:127], v10
    ds_read_b128 v[100:103], v11 offset:9216
    v_cvt_pk_bf16_f32 v24, v24, v28
    v_smfmac_f32_16x16x64_bf16 v[64:67], v[32:35], v[144:151], v10
    ds_read_b128 v[104:107], v11 offset:12288
    v_cvt_pk_bf16_f32 v25, v25, v29
    v_smfmac_f32_16x16x64_bf16 v[64:67], v[36:39], v[152:159], v10
    ds_write2_b32 v3, v24, v25 offset0:0 offset1:4
    v_mov_b64 v[28:29], -1
    v_smfmac_f32_16x16x64_bf16 v[64:67], v[40:43], v[160:167], v10
    ds_read_b128 v[108:111], v11 offset:13312
    s_waitcnt lgkmcnt(5)
    v_mov_b64 v[30:31], -1
    v_smfmac_f32_16x16x64_bf16 v[68:71], v[48:51], v[80:87], v10
    ds_read_b128 v[112:115], v11 offset:16384
    v_smfmac_f32_16x16x64_bf16 v[68:71], v[52:55], v[88:95], v10
    ds_read_b128 v[116:119], v11 offset:17408
    buffer_store_dword v28, v5, s[28:31], s69 offen
    v_smfmac_f32_16x16x64_bf16 v[64:67], v[44:47], v[168:175], v10
    ds_read_b128 v[120:123], v11 offset:20480
    v_smfmac_f32_16x16x64_bf16 v[64:67], v[48:51], v[176:183], v10
    ds_read_b128 v[124:127], v11 offset:21504
    s_waitcnt lgkmcnt(5)
    s_barrier
    ds_read_b128 v[80:83], v4 offset:0
    v_smfmac_f32_16x16x64_bf16 v[64:67], v[52:55], v[184:191], v10
    ds_read_b128 v[84:87], v4 offset:1024
    v_add_f32 v68, v68, v70
    v_smfmac_f32_16x16x64_bf16 v[72:75], v[32:35], a[160:167], v10
    ds_read_b128 v[88:91], v4 offset:2048
    v_add_f32 v69, v69, v71
    v_smfmac_f32_16x16x64_bf16 v[76:79], v[32:35], a[168:175], v10
    ds_read_b128 v[92:95], v4 offset:3072
    v_add_f32 v64, v64, v66
    v_smfmac_f32_16x16x64_bf16 v[72:75], v[36:39], a[176:183], v10
    s_waitcnt vmcnt(5)
    buffer_store_dwordx4 v[28:31], v0, s[28:31], s67 offen
    v_add_f32 v65, v65, v67
    v_smfmac_f32_16x16x64_bf16 v[76:79], v[36:39], a[184:191], v10
    s_waitcnt lgkmcnt(3)
    v_cvt_pk_bf16_f32 v24, v64, v68
    v_mfma_f32_16x16x32_bf16 v[56:59], v[96:99], v[80:83], 0
    s_waitcnt lgkmcnt(2)
    v_cvt_pk_bf16_f32 v25, v65, v69
    v_mfma_f32_16x16x32_bf16 v[56:59], v[100:103], v[84:87], v[56:59]
    ds_write2_b32 v3, v24, v25 offset0:128 offset1:132
    s_waitcnt lgkmcnt(2)
    v_mfma_f32_16x16x32_bf16 v[56:59], v[104:107], v[88:91], v[56:59]
    buffer_store_dwordx4 v[28:31], v0, s[28:31], s67 offen offset:1024
    s_waitcnt lgkmcnt(1)
    v_mfma_f32_16x16x32_bf16 v[56:59], v[108:111], v[92:95], v[56:59]
    v_mfma_f32_16x16x32_bf16 v[60:63], v[112:115], v[80:83], 0
    v_mov_b64 v[96:97], 0
    v_mov_b64 v[98:99], 0
    v_mfma_f32_16x16x32_bf16 v[60:63], v[116:119], v[84:87], v[60:63]
    v_exp_f32 v56, v56
    v_mov_b64 v[100:101], 0
    v_mfma_f32_16x16x32_bf16 v[60:63], v[120:123], v[88:91], v[60:63]
    v_mov_b64 v[102:103], 0
    v_mov_b64 v[104:105], 0
    v_mfma_f32_16x16x32_bf16 v[60:63], v[124:127], v[92:95], v[60:63]
    s_waitcnt lgkmcnt(0)
    s_barrier
    ds_read_b128 v[64:67], v4 offset:512
    v_exp_f32 v57, v57
    v_exp_f32 v58, v58
    v_smfmac_f32_16x16x64_bf16 v[72:75], v[40:43], a[192:199], v10
    ds_read_b128 v[68:71], v4 offset:1536
    v_cvt_pk_bf16_f32 v28, v56, v57
    v_smfmac_f32_16x16x64_bf16 v[76:79], v[40:43], a[200:207], v10
    ds_read_b128 v[32:35], v4 offset:2560
    v_mov_b64 v[106:107], 0
    v_smfmac_f32_16x16x64_bf16 v[72:75], v[44:47], a[208:215], v10
    ds_read_b128 v[36:39], v4 offset:3584
    buffer_load_dwordx4 v0, s[28:31], s71 offen lds
    v_exp_f32 v59, v59
    v_smfmac_f32_16x16x64_bf16 v[76:79], v[44:47], a[216:223], v10
    buffer_load_dwordx4 v0, s[28:31], s71 offen offset:1024 lds
    v_exp_f32 v60, v60
    v_smfmac_f32_16x16x64_bf16 v[72:75], v[48:51], a[224:231], v10
    s_waitcnt lgkmcnt(2)
    v_cvt_pk_bf16_f32 v29, v58, v59
    v_mfma_f32_16x16x32_bf16 v[40:43], v[64:67], v[80:83], 0
    v_exp_f32 v61, v61
    v_mov_b64 v[44:45], s[62:63]
    v_mfma_f32_16x16x32_bf16 v[40:43], v[68:71], v[84:87], v[40:43]
    s_waitcnt lgkmcnt(0)
    v_exp_f32 v62, v62
    v_mov_b64 v[46:47], s[62:63]
    v_mov_b64 v[108:109], 0
    v_mfma_f32_16x16x32_bf16 v[40:43], v[32:35], v[88:91], v[40:43]
    v_exp_f32 v63, v63
    v_cvt_pk_bf16_f32 v30, v60, v61
    v_mfma_f32_16x16x32_bf16 v[40:43], v[36:39], v[92:95], v[40:43]
    v_cvt_pk_bf16_f32 v31, v62, v63
    v_mov_b64 v[110:111], 0
    v_smfmac_f32_16x16x64_bf16 v[76:79], v[48:51], a[232:239], v10
    v_mov_b32 v49, 0
    v_smfmac_f32_16x16x64_bf16 v[72:75], v[52:55], a[240:247], v10
    s_waitcnt vmcnt(7)
    v_exp_f32 v40, v40
    v_smfmac_f32_16x16x64_bf16 v[76:79], v[52:55], a[248:255], v10
    v_exp_f32 v41, v41
    v_mfma_f32_16x16x32_bf16 v[52:55], v[44:47], v[28:31], 0
    v_add_f32 v72, v72, v74
    v_cvt_pk_bf16_f32 v48, v40, v41
    v_mfma_f32_16x16x32_bf16 v[56:59], v[16:19], v[28:31], 0
    v_add_f32 v73, v73, v75
    v_add_f32 v76, v76, v78
    v_mfma_f32_16x16x16_bf16 v[52:55], v[44:45], v[48:49], v[52:55]
    v_add_f32 v77, v77, v79
    v_cvt_pk_bf16_f32 v26, v72, v73
    v_cvt_pk_bf16_f32 v27, v76, v77
    v_mfma_f32_16x16x32_bf16 v[60:63], v[20:23], v[28:31], 0
    v_cvt_pk_bf16_f32 v51, v40, v41
    v_mov_b32 v50, 0
    v_mfma_f32_16x16x16_bf16 v[56:59], v[26:27], v[48:49], v[56:59]
    v_subrev_u32 v53, s79, v52
    v_rcp_f32 v52, v52
    v_mfma_f32_16x16x16_bf16 v[60:63], v[26:27], v[50:51], v[60:63]
    v_cmp_lt_u32 vcc, s100, v53
    s_nop 2
    v_cndmask_b32 v56, v56, v58, s[76:77]
    v_cndmask_b32 v57, v57, v59, s[76:77]
    v_pk_mul_f32 v[56:57], v[56:57], v[52:53] op_sel_hi:[1,0]
    s_nop 0
    v_cndmask_b32 v60, v60, v62, s[76:77]
    v_cndmask_b32 v61, v61, v63, s[76:77]
    v_pk_mul_f32 v[60:61], v[60:61], v[52:53] op_sel_hi:[1,0]
    v_cvt_pk_bf16_f32 v58, v56, v60
    v_cvt_pk_bf16_f32 v59, v57, v61
    ds_write_b64 v2, v[58:59] offset:4096
    v_mov_b32_dpp v28, v58 quad_perm:[0,1,0,1] row_mask:0xf bank_mask:0xf
    v_mov_b32_dpp v29, v59 quad_perm:[0,1,0,1] row_mask:0xf bank_mask:0xf
    v_mov_b32_dpp v30, v58 quad_perm:[2,3,2,3] row_mask:0xf bank_mask:0xf
    v_mov_b32_dpp v31, v59 quad_perm:[2,3,2,3] row_mask:0xf bank_mask:0xf
    s_cbranch_vccnz L_fb_22
L_rj_21:
    s_nop 0
    v_smfmac_f32_16x16x64_bf16 v[96:99], v[28:31], a[0:7], v10
    v_mov_b64 v[52:53], v[24:25]
    v_smfmac_f32_16x16x64_bf16 v[100:103], v[28:31], a[32:39], v10
    s_waitcnt lgkmcnt(0)
    s_barrier
    ds_read_b128 v[32:35], v4 offset:4608
    ds_read_b128 v[36:39], v4 offset:5120
    ds_read_b128 v[40:43], v4 offset:5632
    v_smfmac_f32_16x16x64_bf16 v[104:107], v[28:31], a[64:71], v10
    v_mov_b64 v[54:55], v[26:27]
    v_smfmac_f32_16x16x64_bf16 v[108:111], v[28:31], a[96:103], v10
    s_waitcnt lgkmcnt(2)
    v_smfmac_f32_16x16x64_bf16 v[96:99], v[32:35], a[8:15], v10
    s_waitcnt lgkmcnt(1)
    v_smfmac_f32_16x16x64_bf16 v[96:99], v[36:39], a[16:23], v10
    s_waitcnt lgkmcnt(0)
    v_smfmac_f32_16x16x64_bf16 v[96:99], v[40:43], a[24:31], v10
    ds_read_b128 v[64:67], v1 offset:0
    v_mov_b64 v[24:25], 0
    v_smfmac_f32_16x16x64_bf16 v[100:103], v[32:35], a[40:47], v10
    ds_read_b128 v[68:71], v1 offset:1024
    v_mov_b64 v[26:27], 0
    v_smfmac_f32_16x16x64_bf16 v[100:103], v[36:39], a[48:55], v10
    v_cvt_pk_bf16_f32 v96, v96, v98
    v_cvt_pk_bf16_f32 v97, v97, v99
    v_smfmac_f32_16x16x64_bf16 v[100:103], v[40:43], a[56:63], v10
    buffer_store_dwordx2 v[96:97], v7, s[28:31], s47 offen
    v_smfmac_f32_16x16x64_bf16 v[104:107], v[32:35], a[72:79], v10
    ds_read_b128 v[72:75], v1 offset:2048
    v_mov_b64 v[28:29], 0
    v_smfmac_f32_16x16x64_bf16 v[104:107], v[36:39], a[80:87], v10
    v_cvt_pk_bf16_f32 v100, v100, v102
    v_cvt_pk_bf16_f32 v101, v101, v103
    v_smfmac_f32_16x16x64_bf16 v[104:107], v[40:43], a[88:95], v10
    buffer_store_dwordx2 v[100:101], v7, s[28:31], s48 offen
    v_smfmac_f32_16x16x64_bf16 v[108:111], v[32:35], a[104:111], v10
    ds_read_b128 v[76:79], v1 offset:3072
    v_mov_b64 v[30:31], 0
    v_smfmac_f32_16x16x64_bf16 v[108:111], v[36:39], a[112:119], v10
    v_cvt_pk_bf16_f32 v104, v104, v106
    v_cvt_pk_bf16_f32 v105, v105, v107
    v_smfmac_f32_16x16x64_bf16 v[108:111], v[40:43], a[120:127], v10
    buffer_store_dwordx2 v[104:105], v7, s[28:31], s49 offen
    s_nop 6
    v_cvt_pk_bf16_f32 v108, v108, v110
    v_cvt_pk_bf16_f32 v109, v109, v111
    buffer_store_dwordx2 v[108:109], v7, s[28:31], s50 offen
    ds_read_b128 v[80:83], v1 offset:4096
    ds_read_b128 v[84:87], v1 offset:5120
    ds_read_b128 v[88:91], v1 offset:6144
    ds_read_b128 v[92:95], v1 offset:7168
    ds_read_b128 v[112:115], v1 offset:12288
    ds_read_b128 v[116:119], v1 offset:13312
    ds_read_b128 v[120:123], v1 offset:14336
    ds_read_b128 v[124:127], v1 offset:15360
    ds_read_b128 v[96:99], v1 offset:8192
    ds_read_b128 v[100:103], v1 offset:9216
    s_add_u32 s64, s64, 1
    s_add_u32 s71, s71, 262144
    ds_read_b128 v[104:107], v1 offset:10240
    s_add_u32 s78, s78, 262144
    s_add_u32 s72, s72, 131072
    ds_read_b128 v[108:111], v1 offset:11264
    s_xor_b32 m0, m0, 0x800
    v_xor_b32 v11, 0x800, v11
    s_add_u32 s55, s68, s101
    s_nop 3
    s_nop 3
    buffer_load_dwordx4 v[40:43], v0, s[28:31], s66 offen sc1
    buffer_load_dwordx4 v[44:47], v0, s[28:31], s66 offen offset:1024 sc1
    s_mov_b32 s58, 0
    s_branch L_p1e_24
L_p1_23:
    buffer_load_dwordx4 v[40:43], v0, s[28:31], s66 offen sc1
    buffer_load_dwordx4 v[44:47], v0, s[28:31], s66 offen offset:1024 sc1
    s_add_u32 s58, s58, 4096
    s_cbranch_scc1 L_tabort
L_p1e_24:
    s_waitcnt vmcnt(1)
    v_max3_u32 v36, v40, v41, v42
    v_max_u32 v36, v36, v43
    v_mfma_f32_16x16x32_bf16 v[32:35], v[12:15], v[40:43], 0
    s_waitcnt vmcnt(0)
    v_max3_u32 v36, v36, v44, v45
    v_max3_u32 v36, v36, v46, v47
    v_mfma_f32_16x16x32_bf16 v[32:35], v[12:15], v[44:47], v[32:35]
    v_cmp_eq_u32 vcc, -1, v36
    s_cbranch_vccnz L_p1_23
    s_nop 5
    v_add_f32_dpp v32, v32, v32 row_ror:4 row_mask:0xf bank_mask:0xf
    v_add_f32_dpp v33, v33, v33 row_ror:4 row_mask:0xf bank_mask:0xf
    s_nop 0
    v_add_f32_dpp v32, v32, v32 row_ror:8 row_mask:0xf bank_mask:0xf
    v_add_f32_dpp v33, v33, v33 row_ror:8 row_mask:0xf bank_mask:0xf
    v_cvt_pk_bf16_f32 v32, v32, v33
    buffer_store_dword v32, v5, s[28:31], s68 offen
    s_waitcnt lgkmcnt(0)
    s_barrier
    s_nop 12
    buffer_load_dwordx4 v[56:59], v0, s[28:31], s55 offen sc1
    buffer_load_dwordx4 v[60:63], v0, s[28:31], s55 offen offset:1024 sc1
    s_xor_b32 s66, s66, 0xc0000
    s_xor_b32 s67, s67, 0xc0000
    s_mov_b32 s54, s68
    s_mov_b32 s68, s69
    s_mov_b32 s69, s70
    s_mov_b32 s70, s54
    s_xor_b32 s47, s47, 0xc0000
    s_xor_b32 s48, s48, 0xc0000
    s_xor_b32 s49, s49, 0xc0000
    s_xor_b32 s50, s50, 0xc0000
    s_add_u32 s54, s64, 1
    s_min_u32 s54, s54, 63
    s_mov_b32 s58, 0
L_kvp_26:
    v_cmp_eq_u64 s[60:61], s[42:43], v[8:9]
    s_nop 1
    s_bitcmp1_b64 s[60:61], s54
    s_cbranch_scc1 L_kvok_25
    buffer_load_dwordx2 v[8:9], v6, s[28:31], s74 offen sc1
    s_waitcnt vmcnt(0)
    s_add_u32 s58, s58, 1
    s_cmp_lt_u32 s58, 1048576
    s_cbranch_scc1 L_kvp_26
    s_branch L_abort
L_kvok_25:
    s_mov_b32 s58, 0
    s_nop 7
    buffer_load_dwordx4 v[56:59], v0, s[28:31], s55 offen sc1
    buffer_load_dwordx4 v[60:63], v0, s[28:31], s55 offen offset:1024 sc1
    s_cmp_eq_u32 s64, 63
    s_cbranch_scc0 L_p2e_f0
    s_branch L_last_e
L_rf_19:
    buffer_load_dwordx2 v[8:9], v6, s[28:31], s74 offen sc1
    s_branch L_rb_20
L_fb_22:
    ds_read_b128 v[96:99], v11 offset:8192
    ds_read_b128 v[100:103], v11 offset:9216
    ds_read_b128 v[104:107], v11 offset:12288
    ds_read_b128 v[108:111], v11 offset:13312
    s_waitcnt lgkmcnt(0)
    s_nop 7
    v_mfma_f32_16x16x32_bf16 v[56:59], v[96:99], v[80:83], 0
    v_mfma_f32_16x16x32_bf16 v[56:59], v[100:103], v[84:87], v[56:59]
    v_mfma_f32_16x16x32_bf16 v[56:59], v[104:107], v[88:91], v[56:59]
    v_mfma_f32_16x16x32_bf16 v[56:59], v[108:111], v[92:95], v[56:59]
    v_mfma_f32_16x16x32_bf16 v[60:63], v[112:115], v[80:83], 0
    v_mfma_f32_16x16x32_bf16 v[60:63], v[116:119], v[84:87], v[60:63]
    v_mfma_f32_16x16x32_bf16 v[60:63], v[120:123], v[88:91], v[60:63]
    v_mfma_f32_16x16x32_bf16 v[60:63], v[124:127], v[92:95], v[60:63]
    v_mfma_f32_16x16x32_bf16 v[40:43], v[64:67], v[80:83], 0
    v_mfma_f32_16x16x32_bf16 v[40:43], v[68:71], v[84:87], v[40:43]
    v_mfma_f32_16x16x32_bf16 v[40:43], v[32:35], v[88:91], v[40:43]
    v_mfma_f32_16x16x32_bf16 v[40:43], v[36:39], v[92:95], v[40:43]
    v_max3_f32 v52, v56, v57, v58
    v_max3_f32 v53, v59, v60, v61
    v_max3_f32 v52, v52, v62, v63
    s_nop 4
    v_max3_f32 v53, v53, v40, v41
    v_max_f32 v52, v52, v53
    v_mov_b32 v53, v52
    s_nop 1
    v_permlane16_swap_b32 v52, v53
    v_max_f32 v52, v52, v53
    v_mov_b32 v53, v52
    s_nop 1
    v_permlane32_swap_b32 v52, v53
    v_max_f32 v52, v52, v53
    v_sub_f32 v56, v56, v52
    v_sub_f32 v57, v57, v52
    v_sub_f32 v58, v58, v52
    v_sub_f32 v59, v59, v52
    v_sub_f32 v60, v60, v52
    v_sub_f32 v61, v61, v52
    v_sub_f32 v62, v62, v52
    v_sub_f32 v63, v63, v52
    v_sub_f32 v40, v40, v52
    v_sub_f32 v41, v41, v52
    v_exp_f32 v56, v56
    v_exp_f32 v57, v57
    v_exp_f32 v58, v58
    v_exp_f32 v59, v59
    v_exp_f32 v60, v60
    v_exp_f32 v61, v61
    v_exp_f32 v62, v62
    v_exp_f32 v63, v63
    v_exp_f32 v40, v40
    v_exp_f32 v41, v41
    v_cvt_pk_bf16_f32 v28, v56, v57
    v_cvt_pk_bf16_f32 v29, v58, v59
    v_cvt_pk_bf16_f32 v30, v60, v61
    v_cvt_pk_bf16_f32 v31, v62, v63
    v_cvt_pk_bf16_f32 v48, v40, v41
    v_cvt_pk_bf16_f32 v51, v40, v41
    v_mfma_f32_16x16x32_bf16 v[52:55], v[44:47], v[28:31], 0
    v_mfma_f32_16x16x32_bf16 v[56:59], v[16:19], v[28:31], 0
    v_mfma_f32_16x16x32_bf16 v[60:63], v[20:23], v[28:31], 0
    v_mfma_f32_16x16x16_bf16 v[52:55], v[44:45], v[48:49], v[52:55]
    v_mfma_f32_16x16x16_bf16 v[56:59], v[26:27], v[48:49], v[56:59]
    v_mfma_f32_16x16x16_bf16 v[60:63], v[26:27], v[50:51], v[60:63]
    v_rcp_f32 v52, v52
    s_nop 2
    v_cndmask_b32 v56, v56, v58, s[76:77]
    v_cndmask_b32 v57, v57, v59, s[76:77]
    v_pk_mul_f32 v[56:57], v[56:57], v[52:53] op_sel_hi:[1,0]
    s_nop 0
    v_cndmask_b32 v60, v60, v62, s[76:77]
    v_cndmask_b32 v61, v61, v63, s[76:77]
    v_pk_mul_f32 v[60:61], v[60:61], v[52:53] op_sel_hi:[1,0]
    v_cvt_pk_bf16_f32 v58, v56, v60
    v_cvt_pk_bf16_f32 v59, v57, v61
    ds_write_b64 v2, v[58:59] offset:4096
    v_mov_b32_dpp v28, v58 quad_perm:[0,1,0,1] row_mask:0xf bank_mask:0xf
    v_mov_b32_dpp v29, v59 quad_perm:[0,1,0,1] row_mask:0xf bank_mask:0xf
    v_mov_b32_dpp v30, v58 quad_perm:[2,3,2,3] row_mask:0xf bank_mask:0xf
    v_mov_b32_dpp v31, v59 quad_perm:[2,3,2,3] row_mask:0xf bank_mask:0xf
    v_mov_b64 v[96:97], 0
    v_mov_b64 v[98:99], 0
    v_mov_b64 v[100:101], 0
    v_mov_b64 v[102:103], 0
    v_mov_b64 v[104:105], 0
    v_mov_b64 v[106:107], 0
    v_mov_b64 v[108:109], 0
    v_mov_b64 v[110:111], 0
    s_nop 7
    s_branch L_rj_21
L_ent_f1:
    ds_read_b128 v[64:67], v1 offset:4096
    ds_read_b128 v[68:71], v1 offset:5120
    ds_read_b128 v[72:75], v1 offset:6144
    ds_read_b128 v[76:79], v1 offset:7168
    ds_read_b128 v[80:83], v1 offset:0
    ds_read_b128 v[84:87], v1 offset:1024
    ds_read_b128 v[88:91], v1 offset:2048
    ds_read_b128 v[92:95], v1 offset:3072
    ds_read_b128 v[96:99], v1 offset:12288
    ds_read_b128 v[100:103], v1 offset:13312
    ds_read_b128 v[104:107], v1 offset:14336
    ds_read_b128 v[108:111], v1 offset:15360
    ds_read_b128 v[112:115], v1 offset:8192
    ds_read_b128 v[116:119], v1 offset:9216
    ds_read_b128 v[120:123], v1 offset:10240
    ds_read_b128 v[124:127], v1 offset:11264
    ds_read_b128 v[56:59], v0 offset:2048
    ds_read_b128 v[60:63], v0 offset:3072
    s_waitcnt lgkmcnt(0)
    v_smfmac_f32_16x16x64_bf16 v[24:27], v[56:59], v[64:71], v10
    v_smfmac_f32_16x16x64_bf16 v[24:27], v[60:63], v[72:79], v10
    s_branch L_top_f1
L_p2_f1:
    buffer_load_dwordx4 v[56:59], v0, s[28:31], s55 offen sc1
    buffer_load_dwordx4 v[60:63], v0, s[28:31], s55 offen offset:1024 sc1
    s_add_u32 s58, s58, 4096
    s_cbranch_scc1 L_tabort
    s_nop 1
    s_nop 0
    v_mov_b64 v[24:25], 0
    v_mov_b64 v[26:27], 0
L_p2e_f1:
    s_waitcnt vmcnt(3)
    v_max3_u32 v37, v56, v57, v58
    v_max_u32 v37, v37, v59
    v_smfmac_f32_16x16x64_bf16 v[24:27], v[56:59], v[64:71], v10
    ds_write_b128 v0, v[56:59] offset:2048
    s_waitcnt vmcnt(2)
    v_max3_u32 v37, v37, v60, v61
    v_max3_u32 v37, v37, v62, v63
    v_cmp_eq_u32 vcc, -1, v37
    v_smfmac_f32_16x16x64_bf16 v[24:27], v[60:63], v[72:79], v10
    s_cbranch_vccnz L_p2_f1
L_top_f1:
    v_mov_b64 v[64:65], 0
    v_smfmac_f32_16x16x64_bf16 v[28:31], v[56:59], v[208:215], v10
    ds_write_b128 v0, v[60:63] offset:3072
    v_mov_b64 v[66:67], 0
    v_smfmac_f32_16x16x64_bf16 v[28:31], v[60:63], v[216:223], v10
    buffer_load_dwordx4 v[16:19], v0, s[28:31], s78 offen
    v_mov_b64 v[72:73], 0
    v_smfmac_f32_16x16x64_bf16 v[64:67], v[56:59], v[144:151], v10
    buffer_load_dwordx4 v[20:23], v0, s[28:31], s78 offen offset:1024
    v_mov_b64 v[74:75], 0
    v_smfmac_f32_16x16x64_bf16 v[64:67], v[60:63], v[152:159], v10
    s_waitcnt lgkmcnt(0)
    s_barrier
    ds_read_b128 v[32:35], v0 offset:0
    ds_read_b128 v[36:39], v0 offset:1024
    v_mov_b64 v[76:77], 0
    v_smfmac_f32_16x16x64_bf16 v[72:75], v[56:59], a[160:167], v10
    ds_read_b128 v[40:43], v0 offset:6144
    v_mov_b64 v[78:79], 0
    v_smfmac_f32_16x16x64_bf16 v[72:75], v[60:63], a[176:183], v10
    ds_read_b128 v[44:47], v0 offset:7168
    buffer_store_dwordx2 v[52:53], v6, s[28:31], s72 offen offset:0 sc1
    v_smfmac_f32_16x16x64_bf16 v[76:79], v[56:59], a[168:175], v10
    ds_read_b128 v[48:51], v0 offset:4096
    v_smfmac_f32_16x16x64_bf16 v[76:79], v[60:63], a[184:191], v10
    buffer_store_dwordx2 v[54:55], v6, s[28:31], s72 offen offset:512 sc1
    s_waitcnt lgkmcnt(3)
    v_smfmac_f32_16x16x64_bf16 v[24:27], v[32:35], v[80:87], v10
    ds_read_b128 v[52:55], v0 offset:5120
    ds_read_b128 v[80:83], v1 offset:20480
    v_smfmac_f32_16x16x64_bf16 v[24:27], v[36:39], v[88:95], v10
    ds_read_b128 v[84:87], v1 offset:21504
    s_waitcnt lgkmcnt(3)
    v_smfmac_f32_16x16x64_bf16 v[24:27], v[40:43], v[96:103], v10
    ds_read_b128 v[88:91], v1 offset:22528
    v_mov_b64 v[68:69], 0
    v_smfmac_f32_16x16x64_bf16 v[24:27], v[44:47], v[104:111], v10
    ds_read_b128 v[92:95], v1 offset:23552
    v_mov_b64 v[70:71], 0
    v_smfmac_f32_16x16x64_bf16 v[24:27], v[48:51], v[112:119], v10
    ds_read_b128 v[96:99], v1 offset:16384
    s_waitcnt lgkmcnt(5)
    v_smfmac_f32_16x16x64_bf16 v[24:27], v[52:55], v[120:127], v10
    ds_read_b128 v[100:103], v1 offset:17408
    v_smfmac_f32_16x16x64_bf16 v[28:31], v[32:35], v[192:199], v10
    ds_read_b128 v[104:107], v1 offset:18432
    v_smfmac_f32_16x16x64_bf16 v[28:31], v[36:39], v[200:207], v10
    ds_read_b128 v[108:111], v1 offset:19456
    v_add_f32 v24, v24, v26
    v_smfmac_f32_16x16x64_bf16 v[28:31], v[40:43], v[240:247], v10
    ds_read_b128 v[112:115], v1 offset:28672
    v_add_f32 v25, v25, v27
    v_smfmac_f32_16x16x64_bf16 v[28:31], v[44:47], v[248:255], v10
    ds_read_b128 v[116:119], v1 offset:29696
    v_mul_f32 v24, s59, v24
    v_smfmac_f32_16x16x64_bf16 v[28:31], v[48:51], v[224:231], v10
    ds_read_b128 v[120:123], v1 offset:30720
    v_mul_f32 v25, s59, v25
    v_smfmac_f32_16x16x64_bf16 v[28:31], v[52:55], v[232:239], v10
    ds_read_b128 v[124:127], v1 offset:31744
    s_cmp_lg_u64 s[60:61], -1
    s_cbranch_scc1 L_rf_28
L_rb_29:
    s_waitcnt lgkmcnt(6)
    v_smfmac_f32_16x16x64_bf16 v[68:71], v[56:59], v[80:87], v10
    ds_read_b128 v[80:83], v1 offset:24576
    v_smfmac_f32_16x16x64_bf16 v[68:71], v[60:63], v[88:95], v10
    ds_read_b128 v[84:87], v1 offset:25600
    v_add_f32 v28, v28, v30
    v_smfmac_f32_16x16x64_bf16 v[68:71], v[32:35], v[96:103], v10
    ds_read_b128 v[88:91], v1 offset:26624
    s_waitcnt lgkmcnt(5)
    v_add_f32 v29, v29, v31
    v_smfmac_f32_16x16x64_bf16 v[68:71], v[36:39], v[104:111], v10
    ds_read_b128 v[92:95], v1 offset:27648
    v_mul_f32 v28, s59, v28
    v_smfmac_f32_16x16x64_bf16 v[68:71], v[40:43], v[112:119], v10
    ds_read_b128 v[96:99], v11 offset:8192
    s_waitcnt lgkmcnt(5)
    v_mul_f32 v29, s59, v29
    v_smfmac_f32_16x16x64_bf16 v[68:71], v[44:47], v[120:127], v10
    ds_read_b128 v[100:103], v11 offset:9216
    v_cvt_pk_bf16_f32 v24, v24, v28
    v_smfmac_f32_16x16x64_bf16 v[64:67], v[32:35], v[128:135], v10
    ds_read_b128 v[104:107], v11 offset:12288
    v_cvt_pk_bf16_f32 v25, v25, v29
    v_smfmac_f32_16x16x64_bf16 v[64:67], v[36:39], v[136:143], v10
    ds_write2_b32 v3, v24, v25 offset0:0 offset1:4
    v_mov_b64 v[28:29], -1
    v_smfmac_f32_16x16x64_bf16 v[64:67], v[40:43], v[176:183], v10
    ds_read_b128 v[108:111], v11 offset:13312
    s_waitcnt lgkmcnt(5)
    v_mov_b64 v[30:31], -1
    v_smfmac_f32_16x16x64_bf16 v[68:71], v[48:51], v[80:87], v10
    ds_read_b128 v[112:115], v11 offset:16384
    v_smfmac_f32_16x16x64_bf16 v[68:71], v[52:55], v[88:95], v10
    ds_read_b128 v[116:119], v11 offset:17408
    buffer_store_dword v28, v5, s[28:31], s69 offen
    v_smfmac_f32_16x16x64_bf16 v[64:67], v[44:47], v[184:191], v10
    ds_read_b128 v[120:123], v11 offset:20480
    v_smfmac_f32_16x16x64_bf16 v[64:67], v[48:51], v[160:167], v10
    ds_read_b128 v[124:127], v11 offset:21504
    s_waitcnt lgkmcnt(5)
    s_barrier
    ds_read_b128 v[80:83], v4 offset:0
    v_smfmac_f32_16x16x64_bf16 v[64:67], v[52:55], v[168:175], v10
    ds_read_b128 v[84:87], v4 offset:1024
    v_add_f32 v68, v68, v70
    v_smfmac_f32_16x16x64_bf16 v[72:75], v[32:35], a[128:135], v10
    ds_read_b128 v[88:91], v4 offset:2048
    v_add_f32 v69, v69, v71
    v_smfmac_f32_16x16x64_bf16 v[76:79], v[32:35], a[136:143], v10
    ds_read_b128 v[92:95], v4 offset:3072
    v_add_f32 v64, v64, v66
    v_smfmac_f32_16x16x64_bf16 v[72:75], v[36:39], a[144:151], v10
    s_waitcnt vmcnt(5)
    v_add_f32 v65, v65, v67
    v_smfmac_f32_16x16x64_bf16 v[76:79], v[36:39], a[152:159], v10
    buffer_store_dwordx4 v[28:31], v0, s[28:31], s67 offen
    s_waitcnt lgkmcnt(3)
    v_cvt_pk_bf16_f32 v24, v64, v68
    v_mfma_f32_16x16x32_bf16 v[56:59], v[96:99], v[80:83], 0
    s_waitcnt lgkmcnt(2)
    v_cvt_pk_bf16_f32 v25, v65, v69
    v_mfma_f32_16x16x32_bf16 v[56:59], v[100:103], v[84:87], v[56:59]
    ds_write2_b32 v3, v24, v25 offset0:128 offset1:132
    s_waitcnt lgkmcnt(2)
    v_mfma_f32_16x16x32_bf16 v[56:59], v[104:107], v[88:91], v[56:59]
    s_waitcnt lgkmcnt(1)
    v_mfma_f32_16x16x32_bf16 v[56:59], v[108:111], v[92:95], v[56:59]
    buffer_store_dwordx4 v[28:31], v0, s[28:31], s67 offen offset:1024
    v_mfma_f32_16x16x32_bf16 v[60:63], v[112:115], v[80:83], 0
    v_mov_b64 v[96:97], 0
    v_mov_b64 v[98:99], 0
    v_mfma_f32_16x16x32_bf16 v[60:63], v[116:119], v[84:87], v[60:63]
    v_exp_f32 v56, v56
    v_mov_b64 v[100:101], 0
    v_mfma_f32_16x16x32_bf16 v[60:63], v[120:123], v[88:91], v[60:63]
    v_mov_b64 v[102:103], 0
    v_mov_b64 v[104:105], 0
    v_mfma_f32_16x16x32_bf16 v[60:63], v[124:127], v[92:95], v[60:63]
    s_waitcnt lgkmcnt(0)
    s_barrier
    ds_read_b128 v[64:67], v4 offset:512
    v_exp_f32 v57, v57
    v_exp_f32 v58, v58
    v_smfmac_f32_16x16x64_bf16 v[72:75], v[40:43], a[224:231], v10
    ds_read_b128 v[68:71], v4 offset:1536
    v_cvt_pk_bf16_f32 v28, v56, v57
    v_smfmac_f32_16x16x64_bf16 v[76:79], v[40:43], a[232:239], v10
    ds_read_b128 v[32:35], v4 offset:2560
    v_mov_b64 v[106:107], 0
    v_smfmac_f32_16x16x64_bf16 v[72:75], v[44:47], a[240:247], v10
    ds_read_b128 v[36:39], v4 offset:3584
    buffer_load_dwordx4 v0, s[28:31], s71 offen lds
    v_exp_f32 v59, v59
    v_smfmac_f32_16x16x64_bf16 v[76:79], v[44:47], a[248:255], v10
    buffer_load_dwordx4 v0, s[28:31], s71 offen offset:1024 lds
    v_exp_f32 v60, v60
    v_smfmac_f32_16x16x64_bf16 v[72:75], v[48:51], a[192:199], v10
    s_waitcnt lgkmcnt(2)
    v_cvt_pk_bf16_f32 v29, v58, v59
    v_mfma_f32_16x16x32_bf16 v[40:43], v[64:67], v[80:83], 0
    v_exp_f32 v61, v61
    v_mov_b64 v[44:45], s[62:63]
    v_mfma_f32_16x16x32_bf16 v[40:43], v[68:71], v[84:87], v[40:43]
    s_waitcnt lgkmcnt(0)
    v_exp_f32 v62, v62
    v_mov_b64 v[46:47], s[62:63]
    v_mov_b64 v[108:109], 0
    v_mfma_f32_16x16x32_bf16 v[40:43], v[32:35], v[88:91], v[40:43]
    v_exp_f32 v63, v63
    v_cvt_pk_bf16_f32 v30, v60, v61
    v_mfma_f32_16x16x32_bf16 v[40:43], v[36:39], v[92:95], v[40:43]
    v_cvt_pk_bf16_f32 v31, v62, v63
    v_mov_b64 v[110:111], 0
    v_smfmac_f32_16x16x64_bf16 v[76:79], v[48:51], a[200:207], v10
    v_mov_b32 v49, 0
    v_smfmac_f32_16x16x64_bf16 v[72:75], v[52:55], a[208:215], v10
    s_waitcnt vmcnt(7)
    v_exp_f32 v40, v40
    v_smfmac_f32_16x16x64_bf16 v[76:79], v[52:55], a[216:223], v10
    v_exp_f32 v41, v41
    v_mfma_f32_16x16x32_bf16 v[52:55], v[44:47], v[28:31], 0
    v_add_f32 v72, v72, v74
    v_cvt_pk_bf16_f32 v48, v40, v41
    v_mfma_f32_16x16x32_bf16 v[56:59], v[16:19], v[28:31], 0
    v_add_f32 v73, v73, v75
    v_add_f32 v76, v76, v78
    v_mfma_f32_16x16x16_bf16 v[52:55], v[44:45], v[48:49], v[52:55]
    v_add_f32 v77, v77, v79
    v_cvt_pk_bf16_f32 v26, v72, v73
    v_cvt_pk_bf16_f32 v27, v76, v77
    v_mfma_f32_16x16x32_bf16 v[60:63], v[20:23], v[28:31], 0
    v_cvt_pk_bf16_f32 v51, v40, v41
    v_mov_b32 v50, 0
    v_mfma_f32_16x16x16_bf16 v[56:59], v[26:27], v[48:49], v[56:59]
    v_subrev_u32 v53, s79, v52
    v_rcp_f32 v52, v52
    v_mfma_f32_16x16x16_bf16 v[60:63], v[26:27], v[50:51], v[60:63]
    v_cmp_lt_u32 vcc, s100, v53
    s_nop 2
    v_cndmask_b32 v56, v56, v58, s[76:77]
    v_cndmask_b32 v57, v57, v59, s[76:77]
    v_pk_mul_f32 v[56:57], v[56:57], v[52:53] op_sel_hi:[1,0]
    s_nop 0
    v_cndmask_b32 v60, v60, v62, s[76:77]
    v_cndmask_b32 v61, v61, v63, s[76:77]
    v_pk_mul_f32 v[60:61], v[60:61], v[52:53] op_sel_hi:[1,0]
    v_cvt_pk_bf16_f32 v58, v56, v60
    v_cvt_pk_bf16_f32 v59, v57, v61
    ds_write_b64 v2, v[58:59] offset:4608
    v_mov_b32_dpp v28, v58 quad_perm:[0,1,0,1] row_mask:0xf bank_mask:0xf
    v_mov_b32_dpp v29, v59 quad_perm:[0,1,0,1] row_mask:0xf bank_mask:0xf
    v_mov_b32_dpp v30, v58 quad_perm:[2,3,2,3] row_mask:0xf bank_mask:0xf
    v_mov_b32_dpp v31, v59 quad_perm:[2,3,2,3] row_mask:0xf bank_mask:0xf
    s_cbranch_vccnz L_fb_31
L_rj_30:
    s_nop 0
    v_smfmac_f32_16x16x64_bf16 v[96:99], v[28:31], a[8:15], v10
    v_mov_b64 v[52:53], v[24:25]
    v_smfmac_f32_16x16x64_bf16 v[100:103], v[28:31], a[40:47], v10
    s_waitcnt lgkmcnt(0)
    s_barrier
    ds_read_b128 v[32:35], v4 offset:4096
    ds_read_b128 v[36:39], v4 offset:5632
    ds_read_b128 v[40:43], v4 offset:5120
    v_smfmac_f32_16x16x64_bf16 v[104:107], v[28:31], a[72:79], v10
    v_mov_b64 v[54:55], v[26:27]
    v_smfmac_f32_16x16x64_bf16 v[108:111], v[28:31], a[104:111], v10
    s_waitcnt lgkmcnt(2)
    v_smfmac_f32_16x16x64_bf16 v[96:99], v[32:35], a[0:7], v10
    s_waitcnt lgkmcnt(1)
    v_smfmac_f32_16x16x64_bf16 v[96:99], v[36:39], a[24:31], v10
    s_waitcnt lgkmcnt(0)
    v_smfmac_f32_16x16x64_bf16 v[96:99], v[40:43], a[16:23], v10
    ds_read_b128 v[64:67], v1 offset:4096
    v_mov_b64 v[24:25], 0
    v_smfmac_f32_16x16x64_bf16 v[100:103], v[32:35], a[32:39], v10
    ds_read_b128 v[68:71], v1 offset:5120
    v_mov_b64 v[26:27], 0
    v_smfmac_f32_16x16x64_bf16 v[100:103], v[36:39], a[56:63], v10
    v_cvt_pk_bf16_f32 v96, v96, v98
    v_cvt_pk_bf16_f32 v97, v97, v99
    v_smfmac_f32_16x16x64_bf16 v[100:103], v[40:43], a[48:55], v10
    buffer_store_dwordx2 v[96:97], v7, s[28:31], s47 offen
    v_smfmac_f32_16x16x64_bf16 v[104:107], v[32:35], a[64:71], v10
    ds_read_b128 v[72:75], v1 offset:6144
    v_mov_b64 v[28:29], 0
    v_smfmac_f32_16x16x64_bf16 v[104:107], v[36:39], a[88:95], v10
    v_cvt_pk_bf16_f32 v100, v100, v102
    v_cvt_pk_bf16_f32 v101, v101, v103
    v_smfmac_f32_16x16x64_bf16 v[104:107], v[40:43], a[80:87], v10
    buffer_store_dwordx2 v[100:101], v7, s[28:31], s48 offen
    v_smfmac_f32_16x16x64_bf16 v[108:111], v[32:35], a[96:103], v10
    ds_read_b128 v[76:79], v1 offset:7168
    v_mov_b64 v[30:31], 0
    v_smfmac_f32_16x16x64_bf16 v[108:111], v[36:39], a[120:127], v10
    v_cvt_pk_bf16_f32 v104, v104, v106
    v_cvt_pk_bf16_f32 v105, v105, v107
    v_smfmac_f32_16x16x64_bf16 v[108:111], v[40:43], a[112:119], v10
    buffer_store_dwordx2 v[104:105], v7, s[28:31], s49 offen
    s_nop 6
    v_cvt_pk_bf16_f32 v108, v108, v110
    v_cvt_pk_bf16_f32 v109, v109, v111
    buffer_store_dwordx2 v[108:109], v7, s[28:31], s50 offen
    ds_read_b128 v[80:83], v1 offset:0
    ds_read_b128 v[84:87], v1 offset:1024
    ds_read_b128 v[88:91], v1 offset:2048
    ds_read_b128 v[92:95], v1 offset:3072
    ds_read_b128 v[112:115], v1 offset:8192
    ds_read_b128 v[116:119], v1 offset:9216
    ds_read_b128 v[120:123], v1 offset:10240
    ds_read_b128 v[124:127], v1 offset:11264
    ds_read_b128 v[96:99], v1 offset:12288
    ds_read_b128 v[100:103], v1 offset:13312
    s_add_u32 s64, s64, 1
    s_add_u32 s71, s71, 262144
    ds_read_b128 v[104:107], v1 offset:14336
    s_add_u32 s78, s78, 262144
    s_add_u32 s72, s72, 131072
    ds_read_b128 v[108:111], v1 offset:15360
    s_xor_b32 m0, m0, 0x800
    v_xor_b32 v11, 0x800, v11
    s_add_u32 s55, s68, s101
    s_nop 3
    s_nop 3
    s_nop 3
    s_nop 3
    buffer_load_dwordx4 v[40:43], v0, s[28:31], s66 offen sc1
    buffer_load_dwordx4 v[44:47], v0, s[28:31], s66 offen offset:1024 sc1
    s_mov_b32 s58, 0
    s_branch L_p1e_33
L_p1_32:
    buffer_load_dwordx4 v[40:43], v0, s[28:31], s66 offen sc1
    buffer_load_dwordx4 v[44:47], v0, s[28:31], s66 offen offset:1024 sc1
    s_add_u32 s58, s58, 4096
    s_cbranch_scc1 L_tabort
L_p1e_33:
    s_waitcnt vmcnt(1)
    v_max3_u32 v36, v40, v41, v42
    v_max_u32 v36, v36, v43
    v_mfma_f32_16x16x32_bf16 v[32:35], v[12:15], v[40:43], 0
    s_waitcnt vmcnt(0)
    v_max3_u32 v36, v36, v44, v45
    v_max3_u32 v36, v36, v46, v47
    v_mfma_f32_16x16x32_bf16 v[32:35], v[12:15], v[44:47], v[32:35]
    v_cmp_eq_u32 vcc, -1, v36
    s_cbranch_vccnz L_p1_32
    s_nop 5
    v_add_f32_dpp v32, v32, v32 row_ror:4 row_mask:0xf bank_mask:0xf
    v_add_f32_dpp v33, v33, v33 row_ror:4 row_mask:0xf bank_mask:0xf
    s_nop 0
    v_add_f32_dpp v32, v32, v32 row_ror:8 row_mask:0xf bank_mask:0xf
    v_add_f32_dpp v33, v33, v33 row_ror:8 row_mask:0xf bank_mask:0xf
    v_cvt_pk_bf16_f32 v32, v32, v33
    buffer_store_dword v32, v5, s[28:31], s68 offen
    s_waitcnt lgkmcnt(0)
    s_barrier
    s_nop 12
    buffer_load_dwordx4 v[56:59], v0, s[28:31], s55 offen sc1
    buffer_load_dwordx4 v[60:63], v0, s[28:31], s55 offen offset:1024 sc1
    s_xor_b32 s66, s66, 0xc0000
    s_xor_b32 s67, s67, 0xc0000
    s_mov_b32 s54, s68
    s_mov_b32 s68, s69
    s_mov_b32 s69, s70
    s_mov_b32 s70, s54
    s_xor_b32 s47, s47, 0xc0000
    s_xor_b32 s48, s48, 0xc0000
    s_xor_b32 s49, s49, 0xc0000
    s_xor_b32 s50, s50, 0xc0000
    s_add_u32 s54, s64, 1
    s_min_u32 s54, s54, 63
    s_mov_b32 s58, 0
L_kvp_35:
    v_cmp_eq_u64 s[60:61], s[42:43], v[8:9]
    s_nop 1
    s_bitcmp1_b64 s[60:61], s54
    s_cbranch_scc1 L_kvok_34
    buffer_load_dwordx2 v[8:9], v6, s[28:31], s74 offen sc1
    s_waitcnt vmcnt(0)
    s_add_u32 s58, s58, 1
    s_cmp_lt_u32 s58, 1048576
    s_cbranch_scc1 L_kvp_35
    s_branch L_abort
L_kvok_34:
    s_mov_b32 s58, 0
    s_nop 7
    buffer_load_dwordx4 v[56:59], v0, s[28:31], s55 offen sc1
    buffer_load_dwordx4 v[60:63], v0, s[28:31], s55 offen offset:1024 sc1
    s_cmp_eq_u32 s64, 63
    s_cbranch_scc0 L_p2e_f1
    s_branch L_last_e
L_rf_28:
    buffer_load_dwordx2 v[8:9], v6, s[28:31], s74 offen sc1
    s_branch L_rb_29
L_fb_31:
    ds_read_b128 v[96:99], v11 offset:8192
    ds_read_b128 v[100:103], v11 offset:9216
    ds_read_b128 v[104:107], v11 offset:12288
    ds_read_b128 v[108:111], v11 offset:13312
    s_waitcnt lgkmcnt(0)
    s_nop 7
    v_mfma_f32_16x16x32_bf16 v[56:59], v[96:99], v[80:83], 0
    v_mfma_f32_16x16x32_bf16 v[56:59], v[100:103], v[84:87], v[56:59]
    v_mfma_f32_16x16x32_bf16 v[56:59], v[104:107], v[88:91], v[56:59]
    v_mfma_f32_16x16x32_bf16 v[56:59], v[108:111], v[92:95], v[56:59]
    v_mfma_f32_16x16x32_bf16 v[60:63], v[112:115], v[80:83], 0
    v_mfma_f32_16x16x32_bf16 v[60:63], v[116:119], v[84:87], v[60:63]
    v_mfma_f32_16x16x32_bf16 v[60:63], v[120:123], v[88:91], v[60:63]
    v_mfma_f32_16x16x32_bf16 v[60:63], v[124:127], v[92:95], v[60:63]
    v_mfma_f32_16x16x32_bf16 v[40:43], v[64:67], v[80:83], 0
    v_mfma_f32_16x16x32_bf16 v[40:43], v[68:71], v[84:87], v[40:43]
    v_mfma_f32_16x16x32_bf16 v[40:43], v[32:35], v[88:91], v[40:43]
    v_mfma_f32_16x16x32_bf16 v[40:43], v[36:39], v[92:95], v[40:43]
    v_max3_f32 v52, v56, v57, v58
    v_max3_f32 v53, v59, v60, v61
    v_max3_f32 v52, v52, v62, v63
    s_nop 4
    v_max3_f32 v53, v53, v40, v41
    v_max_f32 v52, v52, v53
    v_mov_b32 v53, v52
    s_nop 1
    v_permlane16_swap_b32 v52, v53
    v_max_f32 v52, v52, v53
    v_mov_b32 v53, v52
    s_nop 1
    v_permlane32_swap_b32 v52, v53
    v_max_f32 v52, v52, v53
    v_sub_f32 v56, v56, v52
    v_sub_f32 v57, v57, v52
    v_sub_f32 v58, v58, v52
    v_sub_f32 v59, v59, v52
    v_sub_f32 v60, v60, v52
    v_sub_f32 v61, v61, v52
    v_sub_f32 v62, v62, v52
    v_sub_f32 v63, v63, v52
    v_sub_f32 v40, v40, v52
    v_sub_f32 v41, v41, v52
    v_exp_f32 v56, v56
    v_exp_f32 v57, v57
    v_exp_f32 v58, v58
    v_exp_f32 v59, v59
    v_exp_f32 v60, v60
    v_exp_f32 v61, v61
    v_exp_f32 v62, v62
    v_exp_f32 v63, v63
    v_exp_f32 v40, v40
    v_exp_f32 v41, v41
    v_cvt_pk_bf16_f32 v28, v56, v57
    v_cvt_pk_bf16_f32 v29, v58, v59
    v_cvt_pk_bf16_f32 v30, v60, v61
    v_cvt_pk_bf16_f32 v31, v62, v63
    v_cvt_pk_bf16_f32 v48, v40, v41
    v_cvt_pk_bf16_f32 v51, v40, v41
    v_mfma_f32_16x16x32_bf16 v[52:55], v[44:47], v[28:31], 0
    v_mfma_f32_16x16x32_bf16 v[56:59], v[16:19], v[28:31], 0
    v_mfma_f32_16x16x32_bf16 v[60:63], v[20:23], v[28:31], 0
    v_mfma_f32_16x16x16_bf16 v[52:55], v[44:45], v[48:49], v[52:55]
    v_mfma_f32_16x16x16_bf16 v[56:59], v[26:27], v[48:49], v[56:59]
    v_mfma_f32_16x16x16_bf16 v[60:63], v[26:27], v[50:51], v[60:63]
    v_rcp_f32 v52, v52
    s_nop 2
    v_cndmask_b32 v56, v56, v58, s[76:77]
    v_cndmask_b32 v57, v57, v59, s[76:77]
    v_pk_mul_f32 v[56:57], v[56:57], v[52:53] op_sel_hi:[1,0]
    s_nop 0
    v_cndmask_b32 v60, v60, v62, s[76:77]
    v_cndmask_b32 v61, v61, v63, s[76:77]
    v_pk_mul_f32 v[60:61], v[60:61], v[52:53] op_sel_hi:[1,0]
    v_cvt_pk_bf16_f32 v58, v56, v60
    v_cvt_pk_bf16_f32 v59, v57, v61
    ds_write_b64 v2, v[58:59] offset:4608
    v_mov_b32_dpp v28, v58 quad_perm:[0,1,0,1] row_mask:0xf bank_mask:0xf
    v_mov_b32_dpp v29, v59 quad_perm:[0,1,0,1] row_mask:0xf bank_mask:0xf
    v_mov_b32_dpp v30, v58 quad_perm:[2,3,2,3] row_mask:0xf bank_mask:0xf
    v_mov_b32_dpp v31, v59 quad_perm:[2,3,2,3] row_mask:0xf bank_mask:0xf
    v_mov_b64 v[96:97], 0
    v_mov_b64 v[98:99], 0
    v_mov_b64 v[100:101], 0
    v_mov_b64 v[102:103], 0
    v_mov_b64 v[104:105], 0
    v_mov_b64 v[106:107], 0
    v_mov_b64 v[108:109], 0
    v_mov_b64 v[110:111], 0
    s_nop 7
    s_branch L_rj_30
L_ent_f2:
    ds_read_b128 v[64:67], v1 offset:8192
    ds_read_b128 v[68:71], v1 offset:9216
    ds_read_b128 v[72:75], v1 offset:10240
    ds_read_b128 v[76:79], v1 offset:11264
    ds_read_b128 v[80:83], v1 offset:12288
    ds_read_b128 v[84:87], v1 offset:13312
    ds_read_b128 v[88:91], v1 offset:14336
    ds_read_b128 v[92:95], v1 offset:15360
    ds_read_b128 v[96:99], v1 offset:0
    ds_read_b128 v[100:103], v1 offset:1024
    ds_read_b128 v[104:107], v1 offset:2048
    ds_read_b128 v[108:111], v1 offset:3072
    ds_read_b128 v[112:115], v1 offset:4096
    ds_read_b128 v[116:119], v1 offset:5120
    ds_read_b128 v[120:123], v1 offset:6144
    ds_read_b128 v[124:127], v1 offset:7168
    ds_read_b128 v[56:59], v0 offset:4096
    ds_read_b128 v[60:63], v0 offset:5120
    s_waitcnt lgkmcnt(0)
    v_smfmac_f32_16x16x64_bf16 v[24:27], v[56:59], v[64:71], v10
    v_smfmac_f32_16x16x64_bf16 v[24:27], v[60:63], v[72:79], v10
    s_branch L_top_f2
L_p2_f2:
    buffer_load_dwordx4 v[56:59], v0, s[28:31], s55 offen sc1
    buffer_load_dwordx4 v[60:63], v0, s[28:31], s55 offen offset:1024 sc1
    s_add_u32 s58, s58, 4096
    s_cbranch_scc1 L_tabort
    s_nop 1
    s_nop 0
    v_mov_b64 v[24:25], 0
    v_mov_b64 v[26:27], 0
L_p2e_f2:
    s_waitcnt vmcnt(3)
    v_max3_u32 v37, v56, v57, v58
    v_max_u32 v37, v37, v59
    v_smfmac_f32_16x16x64_bf16 v[24:27], v[56:59], v[64:71], v10
    ds_write_b128 v0, v[56:59] offset:4096
    s_waitcnt vmcnt(2)
    v_max3_u32 v37, v37, v60, v61
    v_max3_u32 v37, v37, v62, v63
    v_cmp_eq_u32 vcc, -1, v37
    v_smfmac_f32_16x16x64_bf16 v[24:27], v[60:63], v[72:79], v10
    s_cbranch_vccnz L_p2_f2
L_top_f2:
    v_mov_b64 v[64:65], 0
    v_smfmac_f32_16x16x64_bf16 v[28:31], v[56:59], v[224:231], v10
    ds_write_b128 v0, v[60:63] offset:5120
    v_mov_b64 v[66:67], 0
    v_smfmac_f32_16x16x64_bf16 v[28:31], v[60:63], v[232:239], v10
    buffer_load_dwordx4 v[16:19], v0, s[28:31], s78 offen
    v_mov_b64 v[72:73], 0
    v_smfmac_f32_16x16x64_bf16 v[64:67], v[56:59], v[160:167], v10
    buffer_load_dwordx4 v[20:23], v0, s[28:31], s78 offen offset:1024
    v_mov_b64 v[74:75], 0
    v_smfmac_f32_16x16x64_bf16 v[64:67], v[60:63], v[168:175], v10
    s_waitcnt lgkmcnt(0)
    s_barrier
    ds_read_b128 v[32:35], v0 offset:6144
    ds_read_b128 v[36:39], v0 offset:7168
    v_mov_b64 v[76:77], 0
    v_smfmac_f32_16x16x64_bf16 v[72:75], v[56:59], a[192:199], v10
    ds_read_b128 v[40:43], v0 offset:0
    v_mov_b64 v[78:79], 0
    v_smfmac_f32_16x16x64_bf16 v[72:75], v[60:63], a[208:215], v10
    ds_read_b128 v[44:47], v0 offset:1024
    v_smfmac_f32_16x16x64_bf16 v[76:79], v[56:59], a[200:207], v10
    ds_read_b128 v[48:51], v0 offset:2048
    buffer_store_dwordx2 v[52:53], v6, s[28:31], s72 offen offset:0 sc1
    v_smfmac_f32_16x16x64_bf16 v[76:79], v[60:63], a[216:223], v10
    s_waitcnt lgkmcnt(3)
    v_smfmac_f32_16x16x64_bf16 v[24:27], v[32:35], v[80:87], v10
    ds_read_b128 v[80:83], v1 offset:24576
    buffer_store_dwordx2 v[54:55], v6, s[28:31], s72 offen offset:512 sc1
    v_smfmac_f32_16x16x64_bf16 v[24:27], v[36:39], v[88:95], v10
    ds_read_b128 v[52:55], v0 offset:3072
    ds_read_b128 v[84:87], v1 offset:25600
    s_waitcnt lgkmcnt(3)
    v_smfmac_f32_16x16x64_bf16 v[24:27], v[40:43], v[96:103], v10
    ds_read_b128 v[88:91], v1 offset:26624
    v_mov_b64 v[68:69], 0
    v_smfmac_f32_16x16x64_bf16 v[24:27], v[44:47], v[104:111], v10
    ds_read_b128 v[92:95], v1 offset:27648
    v_mov_b64 v[70:71], 0
    v_smfmac_f32_16x16x64_bf16 v[24:27], v[48:51], v[112:119], v10
    ds_read_b128 v[96:99], v1 offset:28672
    s_waitcnt lgkmcnt(4)
    v_smfmac_f32_16x16x64_bf16 v[24:27], v[52:55], v[120:127], v10
    ds_read_b128 v[100:103], v1 offset:29696
    v_smfmac_f32_16x16x64_bf16 v[28:31], v[32:35], v[240:247], v10
    ds_read_b128 v[104:107], v1 offset:30720
    v_smfmac_f32_16x16x64_bf16 v[28:31], v[36:39], v[248:255], v10
    ds_read_b128 v[108:111], v1 offset:31744
    v_add_f32 v24, v24, v26
    v_smfmac_f32_16x16x64_bf16 v[28:31], v[40:43], v[192:199], v10
    ds_read_b128 v[112:115], v1 offset:16384
    v_add_f32 v25, v25, v27
    v_smfmac_f32_16x16x64_bf16 v[28:31], v[44:47], v[200:207], v10
    ds_read_b128 v[116:119], v1 offset:17408
    v_mul_f32 v24, s59, v24
    v_smfmac_f32_16x16x64_bf16 v[28:31], v[48:51], v[208:215], v10
    ds_read_b128 v[120:123], v1 offset:18432
    v_mul_f32 v25, s59, v25
    v_smfmac_f32_16x16x64_bf16 v[28:31], v[52:55], v[216:223], v10
    ds_read_b128 v[124:127], v1 offset:19456
    s_cmp_lg_u64 s[60:61], -1
    s_cbranch_scc1 L_rf_37
L_rb_38:
    s_waitcnt lgkmcnt(6)
    v_smfmac_f32_16x16x64_bf16 v[68:71], v[56:59], v[80:87], v10
    ds_read_b128 v[80:83], v1 offset:20480
    v_smfmac_f32_16x16x64_bf16 v[68:71], v[60:63], v[88:95], v10
    ds_read_b128 v[84:87], v1 offset:21504
    v_add_f32 v28, v28, v30
    v_smfmac_f32_16x16x64_bf16 v[68:71], v[32:35], v[96:103], v10
    ds_read_b128 v[88:91], v1 offset:22528
    s_waitcnt lgkmcnt(5)
    v_add_f32 v29, v29, v31
    v_smfmac_f32_16x16x64_bf16 v[68:71], v[36:39], v[104:111], v10
    ds_read_b128 v[92:95], v1 offset:23552
    v_mul_f32 v28, s59, v28
    v_smfmac_f32_16x16x64_bf16 v[68:71], v[40:43], v[112:119], v10
    ds_read_b128 v[96:99], v11 offset:8192
    s_waitcnt lgkmcnt(5)
    v_mul_f32 v29, s59, v29
    v_smfmac_f32_16x16x64_bf16 v[68:71], v[44:47], v[120:127], v10
    ds_read_b128 v[100:103], v11 offset:9216
    v_cvt_pk_bf16_f32 v24, v24, v28
    v_smfmac_f32_16x16x64_bf16 v[64:67], v[32:35], v[176:183], v10
    ds_read_b128 v[104:107], v11 offset:12288
    v_cvt_pk_bf16_f32 v25, v25, v29
    v_smfmac_f32_16x16x64_bf16 v[64:67], v[36:39], v[184:191], v10
    ds_write2_b32 v3, v24, v25 offset0:0 offset1:4
    v_mov_b64 v[28:29], -1
    v_smfmac_f32_16x16x64_bf16 v[64:67], v[40:43], v[128:135], v10
    ds_read_b128 v[108:111], v11 offset:13312
    s_waitcnt lgkmcnt(5)
    v_mov_b64 v[30:31], -1
    v_smfmac_f32_16x16x64_bf16 v[68:71], v[48:51], v[80:87], v10
    ds_read_b128 v[112:115], v11 offset:16384
    v_smfmac_f32_16x16x64_bf16 v[68:71], v[52:55], v[88:95], v10
    ds_read_b128 v[116:119], v11 offset:17408
    buffer_store_dword v28, v5, s[28:31], s69 offen
    v_smfmac_f32_16x16x64_bf16 v[64:67], v[44:47], v[136:143], v10
    ds_read_b128 v[120:123], v11 offset:20480
    v_smfmac_f32_16x16x64_bf16 v[64:67], v[48:51], v[144:151], v10
    ds_read_b128 v[124:127], v11 offset:21504
    s_waitcnt lgkmcnt(5)
    s_barrier
    ds_read_b128 v[80:83], v4 offset:0
    v_smfmac_f32_16x16x64_bf16 v[64:67], v[52:55], v[152:159], v10
    ds_read_b128 v[84:87], v4 offset:1024
    v_add_f32 v68, v68, v70
    v_smfmac_f32_16x16x64_bf16 v[72:75], v[32:35], a[224:231], v10
    ds_read_b128 v[88:91], v4 offset:2048
    v_add_f32 v69, v69, v71
    v_smfmac_f32_16x16x64_bf16 v[76:79], v[32:35], a[232:239], v10
    ds_read_b128 v[92:95], v4 offset:3072
    v_add_f32 v64, v64, v66
    v_smfmac_f32_16x16x64_bf16 v[72:75], v[36:39], a[240:247], v10
    s_waitcnt vmcnt(5)
    v_add_f32 v65, v65, v67
    v_smfmac_f32_16x16x64_bf16 v[76:79], v[36:39], a[248:255], v10
    s_waitcnt lgkmcnt(3)
    v_cvt_pk_bf16_f32 v24, v64, v68
    v_mfma_f32_16x16x32_bf16 v[56:59], v[96:99], v[80:83], 0
    buffer_store_dwordx4 v[28:31], v0, s[28:31], s67 offen
    s_waitcnt lgkmcnt(2)
    v_cvt_pk_bf16_f32 v25, v65, v69
    v_mfma_f32_16x16x32_bf16 v[56:59], v[100:103], v[84:87], v[56:59]
    ds_write2_b32 v3, v24, v25 offset0:128 offset1:132
    s_waitcnt lgkmcnt(2)
    v_mfma_f32_16x16x32_bf16 v[56:59], v[104:107], v[88:91], v[56:59]
    s_waitcnt lgkmcnt(1)
    v_mfma_f32_16x16x32_bf16 v[56:59], v[108:111], v[92:95], v[56:59]
    v_mfma_f32_16x16x32_bf16 v[60:63], v[112:115], v[80:83], 0
    buffer_store_dwordx4 v[28:31], v0, s[28:31], s67 offen offset:1024
    v_mov_b64 v[96:97], 0
    v_mov_b64 v[98:99], 0
    v_mfma_f32_16x16x32_bf16 v[60:63], v[116:119], v[84:87], v[60:63]
    v_exp_f32 v56, v56
    v_mov_b64 v[100:101], 0
    v_mfma_f32_16x16x32_bf16 v[60:63], v[120:123], v[88:91], v[60:63]
    v_mov_b64 v[102:103], 0
    v_mov_b64 v[104:105], 0
    v_mfma_f32_16x16x32_bf16 v[60:63], v[124:127], v[92:95], v[60:63]
    s_waitcnt lgkmcnt(0)
    s_barrier
    ds_read_b128 v[64:67], v4 offset:512
    v_exp_f32 v57, v57
    v_exp_f32 v58, v58
    v_smfmac_f32_16x16x64_bf16 v[72:75], v[40:43], a[128:135], v10
    ds_read_b128 v[68:71], v4 offset:1536
    v_cvt_pk_bf16_f32 v28, v56, v57
    v_smfmac_f32_16x16x64_bf16 v[76:79], v[40:43], a[136:143], v10
    ds_read_b128 v[32:35], v4 offset:2560
    v_mov_b64 v[106:107], 0
    v_smfmac_f32_16x16x64_bf16 v[72:75], v[44:47], a[144:151], v10
    ds_read_b128 v[36:39], v4 offset:3584
    buffer_load_dwordx4 v0, s[28:31], s71 offen lds
    v_exp_f32 v59, v59
    v_smfmac_f32_16x16x64_bf16 v[76:79], v[44:47], a[152:159], v10
    buffer_load_dwordx4 v0, s[28:31], s71 offen offset:1024 lds
    v_exp_f32 v60, v60
    v_smfmac_f32_16x16x64_bf16 v[72:75], v[48:51], a[160:167], v10
    s_waitcnt lgkmcnt(2)
    v_cvt_pk_bf16_f32 v29, v58, v59
    v_mfma_f32_16x16x32_bf16 v[40:43], v[64:67], v[80:83], 0
    v_exp_f32 v61, v61
    v_mov_b64 v[44:45], s[62:63]
    v_mfma_f32_16x16x32_bf16 v[40:43], v[68:71], v[84:87], v[40:43]
    s_waitcnt lgkmcnt(0)
    v_exp_f32 v62, v62
    v_mov_b64 v[46:47], s[62:63]
    v_mov_b64 v[108:109], 0
    v_mfma_f32_16x16x32_bf16 v[40:43], v[32:35], v[88:91], v[40:43]
    v_exp_f32 v63, v63
    v_cvt_pk_bf16_f32 v30, v60, v61
    v_mfma_f32_16x16x32_bf16 v[40:43], v[36:39], v[92:95], v[40:43]
    v_cvt_pk_bf16_f32 v31, v62, v63
    v_mov_b64 v[110:111], 0
    v_smfmac_f32_16x16x64_bf16 v[76:79], v[48:51], a[168:175], v10
    v_mov_b32 v49, 0
    v_smfmac_f32_16x16x64_bf16 v[72:75], v[52:55], a[176:183], v10
    s_waitcnt vmcnt(7)
    v_exp_f32 v40, v40
    v_smfmac_f32_16x16x64_bf16 v[76:79], v[52:55], a[184:191], v10
    v_exp_f32 v41, v41
    v_mfma_f32_16x16x32_bf16 v[52:55], v[44:47], v[28:31], 0
    v_add_f32 v72, v72, v74
    v_cvt_pk_bf16_f32 v48, v40, v41
    v_mfma_f32_16x16x32_bf16 v[56:59], v[16:19], v[28:31], 0
    v_add_f32 v73, v73, v75
    v_add_f32 v76, v76, v78
    v_mfma_f32_16x16x16_bf16 v[52:55], v[44:45], v[48:49], v[52:55]
    v_add_f32 v77, v77, v79
    v_cvt_pk_bf16_f32 v26, v72, v73
    v_cvt_pk_bf16_f32 v27, v76, v77
    v_mfma_f32_16x16x32_bf16 v[60:63], v[20:23], v[28:31], 0
    v_cvt_pk_bf16_f32 v51, v40, v41
    v_mov_b32 v50, 0
    v_mfma_f32_16x16x16_bf16 v[56:59], v[26:27], v[48:49], v[56:59]
    v_subrev_u32 v53, s79, v52
    v_rcp_f32 v52, v52
    v_mfma_f32_16x16x16_bf16 v[60:63], v[26:27], v[50:51], v[60:63]
    v_cmp_lt_u32 vcc, s100, v53
    s_nop 2
    v_cndmask_b32 v56, v56, v58, s[76:77]
    v_cndmask_b32 v57, v57, v59, s[76:77]
    v_pk_mul_f32 v[56:57], v[56:57], v[52:53] op_sel_hi:[1,0]
    s_nop 0
    v_cndmask_b32 v60, v60, v62, s[76:77]
    v_cndmask_b32 v61, v61, v63, s[76:77]
    v_pk_mul_f32 v[60:61], v[60:61], v[52:53] op_sel_hi:[1,0]
    v_cvt_pk_bf16_f32 v58, v56, v60
    v_cvt_pk_bf16_f32 v59, v57, v61
    ds_write_b64 v2, v[58:59] offset:5120
    v_mov_b32_dpp v28, v58 quad_perm:[0,1,0,1] row_mask:0xf bank_mask:0xf
    v_mov_b32_dpp v29, v59 quad_perm:[0,1,0,1] row_mask:0xf bank_mask:0xf
    v_mov_b32_dpp v30, v58 quad_perm:[2,3,2,3] row_mask:0xf bank_mask:0xf
    v_mov_b32_dpp v31, v59 quad_perm:[2,3,2,3] row_mask:0xf bank_mask:0xf
    s_cbranch_vccnz L_fb_40
L_rj_39:
    s_nop 0
    v_smfmac_f32_16x16x64_bf16 v[96:99], v[28:31], a[16:23], v10
    v_mov_b64 v[52:53], v[24:25]
    v_smfmac_f32_16x16x64_bf16 v[100:103], v[28:31], a[48:55], v10
    s_waitcnt lgkmcnt(0)
    s_barrier
    ds_read_b128 v[32:35], v4 offset:5632
    ds_read_b128 v[36:39], v4 offset:4096
    ds_read_b128 v[40:43], v4 offset:4608
    v_smfmac_f32_16x16x64_bf16 v[104:107], v[28:31], a[80:87], v10
    v_mov_b64 v[54:55], v[26:27]
    v_smfmac_f32_16x16x64_bf16 v[108:111], v[28:31], a[112:119], v10
    s_waitcnt lgkmcnt(2)
    v_smfmac_f32_16x16x64_bf16 v[96:99], v[32:35], a[24:31], v10
    s_waitcnt lgkmcnt(1)
    v_smfmac_f32_16x16x64_bf16 v[96:99], v[36:39], a[0:7], v10
    s_waitcnt lgkmcnt(0)
    v_smfmac_f32_16x16x64_bf16 v[96:99], v[40:43], a[8:15], v10
    ds_read_b128 v[64:67], v1 offset:8192
    v_mov_b64 v[24:25], 0
    v_smfmac_f32_16x16x64_bf16 v[100:103], v[32:35], a[56:63], v10
    ds_read_b128 v[68:71], v1 offset:9216
    v_mov_b64 v[26:27], 0
    v_smfmac_f32_16x16x64_bf16 v[100:103], v[36:39], a[32:39], v10
    v_cvt_pk_bf16_f32 v96, v96, v98
    v_cvt_pk_bf16_f32 v97, v97, v99
    v_smfmac_f32_16x16x64_bf16 v[100:103], v[40:43], a[40:47], v10
    buffer_store_dwordx2 v[96:97], v7, s[28:31], s47 offen
    v_smfmac_f32_16x16x64_bf16 v[104:107], v[32:35], a[88:95], v10
    ds_read_b128 v[72:75], v1 offset:10240
    v_mov_b64 v[28:29], 0
    v_smfmac_f32_16x16x64_bf16 v[104:107], v[36:39], a[64:71], v10
    v_cvt_pk_bf16_f32 v100, v100, v102
    v_cvt_pk_bf16_f32 v101, v101, v103
    v_smfmac_f32_16x16x64_bf16 v[104:107], v[40:43], a[72:79], v10
    buffer_store_dwordx2 v[100:101], v7, s[28:31], s48 offen
    v_smfmac_f32_16x16x64_bf16 v[108:111], v[32:35], a[120:127], v10
    ds_read_b128 v[76:79], v1 offset:11264
    v_mov_b64 v[30:31], 0
    v_smfmac_f32_16x16x64_bf16 v[108:111], v[36:39], a[96:103], v10
    v_cvt_pk_bf16_f32 v104, v104, v106
    v_cvt_pk_bf16_f32 v105, v105, v107
    v_smfmac_f32_16x16x64_bf16 v[108:111], v[40:43], a[104:111], v10
    buffer_store_dwordx2 v[104:105], v7, s[28:31], s49 offen
    s_nop 6
    v_cvt_pk_bf16_f32 v108, v108, v110
    v_cvt_pk_bf16_f32 v109, v109, v111
    buffer_store_dwordx2 v[108:109], v7, s[28:31], s50 offen
    ds_read_b128 v[80:83], v1 offset:12288
    ds_read_b128 v[84:87], v1 offset:13312
    ds_read_b128 v[88:91], v1 offset:14336
    ds_read_b128 v[92:95], v1 offset:15360
    ds_read_b128 v[112:115], v1 offset:4096
    ds_read_b128 v[116:119], v1 offset:5120
    ds_read_b128 v[120:123], v1 offset:6144
    ds_read_b128 v[124:127], v1 offset:7168
    ds_read_b128 v[96:99], v1 offset:0
    ds_read_b128 v[100:103], v1 offset:1024
    s_add_u32 s64, s64, 1
    s_add_u32 s71, s71, 262144
    ds_read_b128 v[104:107], v1 offset:2048
    s_add_u32 s78, s78, 262144
    s_add_u32 s72, s72, 131072
    ds_read_b128 v[108:111], v1 offset:3072
    s_xor_b32 m0, m0, 0x800
    v_xor_b32 v11, 0x800, v11
    s_add_u32 s55, s68, s101
    s_nop 3
    s_nop 3
    s_nop 3
    s_nop 3
    s_nop 3
    buffer_load_dwordx4 v[40:43], v0, s[28:31], s66 offen sc1
    buffer_load_dwordx4 v[44:47], v0, s[28:31], s66 offen offset:1024 sc1
    s_nop 3
    s_nop 3
    s_nop 3
    s_nop 3
    s_nop 3
    s_nop 3
    buffer_load_dwordx4 v[40:43], v0, s[28:31], s66 offen sc1
    buffer_load_dwordx4 v[44:47], v0, s[28:31], s66 offen offset:1024 sc1
    s_mov_b32 s58, 0
    s_branch L_p1e_42
L_p1_41:
    buffer_load_dwordx4 v[40:43], v0, s[28:31], s66 offen sc1
    buffer_load_dwordx4 v[44:47], v0, s[28:31], s66 offen offset:1024 sc1
    s_add_u32 s58, s58, 4096
    s_cbranch_scc1 L_tabort
L_p1e_42:
    s_waitcnt vmcnt(3)
    v_max3_u32 v36, v40, v41, v42
    v_max_u32 v36, v36, v43
    v_mfma_f32_16x16x32_bf16 v[32:35], v[12:15], v[40:43], 0
    s_waitcnt vmcnt(2)
    v_max3_u32 v36, v36, v44, v45
    v_max3_u32 v36, v36, v46, v47
    v_mfma_f32_16x16x32_bf16 v[32:35], v[12:15], v[44:47], v[32:35]
    v_cmp_eq_u32 vcc, -1, v36
    s_cbranch_vccnz L_p1_41
    s_nop 5
    v_add_f32_dpp v32, v32, v32 row_ror:4 row_mask:0xf bank_mask:0xf
    v_add_f32_dpp v33, v33, v33 row_ror:4 row_mask:0xf bank_mask:0xf
    s_nop 0
    v_add_f32_dpp v32, v32, v32 row_ror:8 row_mask:0xf bank_mask:0xf
    v_add_f32_dpp v33, v33, v33 row_ror:8 row_mask:0xf bank_mask:0xf
    v_cvt_pk_bf16_f32 v32, v32, v33
    buffer_store_dword v32, v5, s[28:31], s68 offen
    s_waitcnt lgkmcnt(0)
    s_barrier
    s_nop 12
    buffer_load_dwordx4 v[56:59], v0, s[28:31], s55 offen sc1
    buffer_load_dwordx4 v[60:63], v0, s[28:31], s55 offen offset:1024 sc1
    s_xor_b32 s66, s66, 0xc0000
    s_xor_b32 s67, s67, 0xc0000
    s_mov_b32 s54, s68
    s_mov_b32 s68, s69
    s_mov_b32 s69, s70
    s_mov_b32 s70, s54
    s_xor_b32 s47, s47, 0xc0000
    s_xor_b32 s48, s48, 0xc0000
    s_xor_b32 s49, s49, 0xc0000
    s_xor_b32 s50, s50, 0xc0000
    s_add_u32 s54, s64, 1
    s_min_u32 s54, s54, 63
    s_mov_b32 s58, 0
L_kvp_44:
    v_cmp_eq_u64 s[60:61], s[42:43], v[8:9]
    s_nop 1
    s_bitcmp1_b64 s[60:61], s54
    s_cbranch_scc1 L_kvok_43
    buffer_load_dwordx2 v[8:9], v6, s[28:31], s74 offen sc1
    s_waitcnt vmcnt(0)
    s_add_u32 s58, s58, 1
    s_cmp_lt_u32 s58, 1048576
    s_cbranch_scc1 L_kvp_44
    s_branch L_abort
L_kvok_43:
    s_mov_b32 s58, 0
    s_nop 7
    buffer_load_dwordx4 v[56:59], v0, s[28:31], s55 offen sc1
    buffer_load_dwordx4 v[60:63], v0, s[28:31], s55 offen offset:1024 sc1
    s_cmp_eq_u32 s64, 63
    s_cbranch_scc0 L_p2e_f2
    s_branch L_last_e
L_rf_37:
    buffer_load_dwordx2 v[8:9], v6, s[28:31], s74 offen sc1
    s_branch L_rb_38
L_fb_40:
    ds_read_b128 v[96:99], v11 offset:8192
    ds_read_b128 v[100:103], v11 offset:9216
    ds_read_b128 v[104:107], v11 offset:12288
    ds_read_b128 v[108:111], v11 offset:13312
    s_waitcnt lgkmcnt(0)
    s_nop 7
    v_mfma_f32_16x16x32_bf16 v[56:59], v[96:99], v[80:83], 0
    v_mfma_f32_16x16x32_bf16 v[56:59], v[100:103], v[84:87], v[56:59]
    v_mfma_f32_16x16x32_bf16 v[56:59], v[104:107], v[88:91], v[56:59]
    v_mfma_f32_16x16x32_bf16 v[56:59], v[108:111], v[92:95], v[56:59]
    v_mfma_f32_16x16x32_bf16 v[60:63], v[112:115], v[80:83], 0
    v_mfma_f32_16x16x32_bf16 v[60:63], v[116:119], v[84:87], v[60:63]
    v_mfma_f32_16x16x32_bf16 v[60:63], v[120:123], v[88:91], v[60:63]
    v_mfma_f32_16x16x32_bf16 v[60:63], v[124:127], v[92:95], v[60:63]
    v_mfma_f32_16x16x32_bf16 v[40:43], v[64:67], v[80:83], 0
    v_mfma_f32_16x16x32_bf16 v[40:43], v[68:71], v[84:87], v[40:43]
    v_mfma_f32_16x16x32_bf16 v[40:43], v[32:35], v[88:91], v[40:43]
    v_mfma_f32_16x16x32_bf16 v[40:43], v[36:39], v[92:95], v[40:43]
    v_max3_f32 v52, v56, v57, v58
    v_max3_f32 v53, v59, v60, v61
    v_max3_f32 v52, v52, v62, v63
    s_nop 4
    v_max3_f32 v53, v53, v40, v41
    v_max_f32 v52, v52, v53
    v_mov_b32 v53, v52
    s_nop 1
    v_permlane16_swap_b32 v52, v53
    v_max_f32 v52, v52, v53
    v_mov_b32 v53, v52
    s_nop 1
    v_permlane32_swap_b32 v52, v53
    v_max_f32 v52, v52, v53
    v_sub_f32 v56, v56, v52
    v_sub_f32 v57, v57, v52
    v_sub_f32 v58, v58, v52
    v_sub_f32 v59, v59, v52
    v_sub_f32 v60, v60, v52
    v_sub_f32 v61, v61, v52
    v_sub_f32 v62, v62, v52
    v_sub_f32 v63, v63, v52
    v_sub_f32 v40, v40, v52
    v_sub_f32 v41, v41, v52
    v_exp_f32 v56, v56
    v_exp_f32 v57, v57
    v_exp_f32 v58, v58
    v_exp_f32 v59, v59
    v_exp_f32 v60, v60
    v_exp_f32 v61, v61
    v_exp_f32 v62, v62
    v_exp_f32 v63, v63
    v_exp_f32 v40, v40
    v_exp_f32 v41, v41
    v_cvt_pk_bf16_f32 v28, v56, v57
    v_cvt_pk_bf16_f32 v29, v58, v59
    v_cvt_pk_bf16_f32 v30, v60, v61
    v_cvt_pk_bf16_f32 v31, v62, v63
    v_cvt_pk_bf16_f32 v48, v40, v41
    v_cvt_pk_bf16_f32 v51, v40, v41
    v_mfma_f32_16x16x32_bf16 v[52:55], v[44:47], v[28:31], 0
    v_mfma_f32_16x16x32_bf16 v[56:59], v[16:19], v[28:31], 0
    v_mfma_f32_16x16x32_bf16 v[60:63], v[20:23], v[28:31], 0
    v_mfma_f32_16x16x16_bf16 v[52:55], v[44:45], v[48:49], v[52:55]
    v_mfma_f32_16x16x16_bf16 v[56:59], v[26:27], v[48:49], v[56:59]
    v_mfma_f32_16x16x16_bf16 v[60:63], v[26:27], v[50:51], v[60:63]
    v_rcp_f32 v52, v52
    s_nop 2
    v_cndmask_b32 v56, v56, v58, s[76:77]
    v_cndmask_b32 v57, v57, v59, s[76:77]
    v_pk_mul_f32 v[56:57], v[56:57], v[52:53] op_sel_hi:[1,0]
    s_nop 0
    v_cndmask_b32 v60, v60, v62, s[76:77]
    v_cndmask_b32 v61, v61, v63, s[76:77]
    v_pk_mul_f32 v[60:61], v[60:61], v[52:53] op_sel_hi:[1,0]
    v_cvt_pk_bf16_f32 v58, v56, v60
    v_cvt_pk_bf16_f32 v59, v57, v61
    ds_write_b64 v2, v[58:59] offset:5120
    v_mov_b32_dpp v28, v58 quad_perm:[0,1,0,1] row_mask:0xf bank_mask:0xf
    v_mov_b32_dpp v29, v59 quad_perm:[0,1,0,1] row_mask:0xf bank_mask:0xf
    v_mov_b32_dpp v30, v58 quad_perm:[2,3,2,3] row_mask:0xf bank_mask:0xf
    v_mov_b32_dpp v31, v59 quad_perm:[2,3,2,3] row_mask:0xf bank_mask:0xf
    v_mov_b64 v[96:97], 0
    v_mov_b64 v[98:99], 0
    v_mov_b64 v[100:101], 0
    v_mov_b64 v[102:103], 0
    v_mov_b64 v[104:105], 0
    v_mov_b64 v[106:107], 0
    v_mov_b64 v[108:109], 0
    v_mov_b64 v[110:111], 0
    s_nop 7
    s_branch L_rj_39
L_ent_f3:
    ds_read_b128 v[64:67], v1 offset:12288
    ds_read_b128 v[68:71], v1 offset:13312
    ds_read_b128 v[72:75], v1 offset:14336
    ds_read_b128 v[76:79], v1 offset:15360
    ds_read_b128 v[80:83], v1 offset:8192
    ds_read_b128 v[84:87], v1 offset:9216
    ds_read_b128 v[88:91], v1 offset:10240
    ds_read_b128 v[92:95], v1 offset:11264
    ds_read_b128 v[96:99], v1 offset:4096
    ds_read_b128 v[100:103], v1 offset:5120
    ds_read_b128 v[104:107], v1 offset:6144
    ds_read_b128 v[108:111], v1 offset:7168
    ds_read_b128 v[112:115], v1 offset:0
    ds_read_b128 v[116:119], v1 offset:1024
    ds_read_b128 v[120:123], v1 offset:2048
    ds_read_b128 v[124:127], v1 offset:3072
    ds_read_b128 v[56:59], v0 offset:6144
    ds_read_b128 v[60:63], v0 offset:7168
    s_waitcnt lgkmcnt(0)
    v_smfmac_f32_16x16x64_bf16 v[24:27], v[56:59], v[64:71], v10
    v_smfmac_f32_16x16x64_bf16 v[24:27], v[60:63], v[72:79], v10
    s_branch L_top_f3
L_p2_f3:
    buffer_load_dwordx4 v[56:59], v0, s[28:31], s55 offen sc1
    buffer_load_dwordx4 v[60:63], v0, s[28:31], s55 offen offset:1024 sc1
    s_add_u32 s58, s58, 4096
    s_cbranch_scc1 L_tabort
    s_nop 1
    s_nop 0
    v_mov_b64 v[24:25], 0
    v_mov_b64 v[26:27], 0
L_p2e_f3:
    s_waitcnt vmcnt(3)
    v_max3_u32 v37, v56, v57, v58
    v_max_u32 v37, v37, v59
    v_smfmac_f32_16x16x64_bf16 v[24:27], v[56:59], v[64:71], v10
    ds_write_b128 v0, v[56:59] offset:6144
    s_waitcnt vmcnt(2)
    v_max3_u32 v37, v37, v60, v61
    v_max3_u32 v37, v37, v62, v63
    v_cmp_eq_u32 vcc, -1, v37
    v_smfmac_f32_16x16x64_bf16 v[24:27], v[60:63], v[72:79], v10
    s_cbranch_vccnz L_p2_f3
L_top_f3:
    v_mov_b64 v[64:65], 0
    v_smfmac_f32_16x16x64_bf16 v[28:31], v[56:59], v[240:247], v10
    ds_write_b128 v0, v[60:63] offset:7168
    v_mov_b64 v[66:67], 0
    v_smfmac_f32_16x16x64_bf16 v[28:31], v[60:63], v[248:255], v10
    buffer_load_dwordx4 v[16:19], v0, s[28:31], s78 offen
    v_mov_b64 v[72:73], 0
    v_smfmac_f32_16x16x64_bf16 v[64:67], v[56:59], v[176:183], v10
    buffer_load_dwordx4 v[20:23], v0, s[28:31], s78 offen offset:1024
    v_mov_b64 v[74:75], 0
    v_smfmac_f32_16x16x64_bf16 v[64:67], v[60:63], v[184:191], v10
    s_waitcnt lgkmcnt(0)
    s_barrier
    ds_read_b128 v[32:35], v0 offset:4096
    ds_read_b128 v[36:39], v0 offset:5120
    v_mov_b64 v[76:77], 0
    v_smfmac_f32_16x16x64_bf16 v[72:75], v[56:59], a[224:231], v10
    ds_read_b128 v[40:43], v0 offset:2048
    v_mov_b64 v[78:79], 0
    v_smfmac_f32_16x16x64_bf16 v[72:75], v[60:63], a[240:247], v10
    ds_read_b128 v[44:47], v0 offset:3072
    buffer_store_dwordx2 v[52:53], v6, s[28:31], s72 offen offset:0 sc1
    v_smfmac_f32_16x16x64_bf16 v[76:79], v[56:59], a[232:239], v10
    ds_read_b128 v[48:51], v0 offset:0
    v_smfmac_f32_16x16x64_bf16 v[76:79], v[60:63], a[248:255], v10
    buffer_store_dwordx2 v[54:55], v6, s[28:31], s72 offen offset:512 sc1
    s_waitcnt lgkmcnt(3)
    v_smfmac_f32_16x16x64_bf16 v[24:27], v[32:35], v[80:87], v10
    ds_read_b128 v[52:55], v0 offset:1024
    ds_read_b128 v[80:83], v1 offset:28672
    v_smfmac_f32_16x16x64_bf16 v[24:27], v[36:39], v[88:95], v10
    ds_read_b128 v[84:87], v1 offset:29696
    s_waitcnt lgkmcnt(3)
    v_smfmac_f32_16x16x64_bf16 v[24:27], v[40:43], v[96:103], v10
    ds_read_b128 v[88:91], v1 offset:30720
    v_mov_b64 v[68:69], 0
    v_smfmac_f32_16x16x64_bf16 v[24:27], v[44:47], v[104:111], v10
    ds_read_b128 v[92:95], v1 offset:31744
    v_mov_b64 v[70:71], 0
    v_smfmac_f32_16x16x64_bf16 v[24:27], v[48:51], v[112:119], v10
    ds_read_b128 v[96:99], v1 offset:24576
    s_waitcnt lgkmcnt(5)
    v_smfmac_f32_16x16x64_bf16 v[24:27], v[52:55], v[120:127], v10
    ds_read_b128 v[100:103], v1 offset:25600
    v_smfmac_f32_16x16x64_bf16 v[28:31], v[32:35], v[224:231], v10
    ds_read_b128 v[104:107], v1 offset:26624
    v_smfmac_f32_16x16x64_bf16 v[28:31], v[36:39], v[232:239], v10
    ds_read_b128 v[108:111], v1 offset:27648
    v_add_f32 v24, v24, v26
    v_smfmac_f32_16x16x64_bf16 v[28:31], v[40:43], v[208:215], v10
    ds_read_b128 v[112:115], v1 offset:20480
    v_add_f32 v25, v25, v27
    v_smfmac_f32_16x16x64_bf16 v[28:31], v[44:47], v[216:223], v10
    ds_read_b128 v[116:119], v1 offset:21504
    v_mul_f32 v24, s59, v24
    v_smfmac_f32_16x16x64_bf16 v[28:31], v[48:51], v[192:199], v10
    ds_read_b128 v[120:123], v1 offset:22528
    v_mul_f32 v25, s59, v25
    v_smfmac_f32_16x16x64_bf16 v[28:31], v[52:55], v[200:207], v10
    ds_read_b128 v[124:127], v1 offset:23552
    s_cmp_lg_u64 s[60:61], -1
    s_cbranch_scc1 L_rf_46
L_rb_47:
    s_waitcnt lgkmcnt(6)
    v_smfmac_f32_16x16x64_bf16 v[68:71], v[56:59], v[80:87], v10
    ds_read_b128 v[80:83], v1 offset:16384
    v_smfmac_f32_16x16x64_bf16 v[68:71], v[60:63], v[88:95], v10
    ds_read_b128 v[84:87], v1 offset:17408
    v_add_f32 v28, v28, v30
    v_smfmac_f32_16x16x64_bf16 v[68:71], v[32:35], v[96:103], v10
    ds_read_b128 v[88:91], v1 offset:18432
    s_waitcnt lgkmcnt(5)
    v_add_f32 v29, v29, v31
    v_smfmac_f32_16x16x64_bf16 v[68:71], v[36:39], v[104:111], v10
    ds_read_b128 v[92:95], v1 offset:19456
    v_mul_f32 v28, s59, v28
    v_smfmac_f32_16x16x64_bf16 v[68:71], v[40:43], v[112:119], v10
    ds_read_b128 v[96:99], v11 offset:8192
    s_waitcnt lgkmcnt(5)
    v_mul_f32 v29, s59, v29
    v_smfmac_f32_16x16x64_bf16 v[68:71], v[44:47], v[120:127], v10
    ds_read_b128 v[100:103], v11 offset:9216
    v_cvt_pk_bf16_f32 v24, v24, v28
    v_smfmac_f32_16x16x64_bf16 v[64:67], v[32:35], v[160:167], v10
    ds_read_b128 v[104:107], v11 offset:12288
    v_cvt_pk_bf16_f32 v25, v25, v29
    v_smfmac_f32_16x16x64_bf16 v[64:67], v[36:39], v[168:175], v10
    ds_write2_b32 v3, v24, v25 offset0:0 offset1:4
    v_mov_b64 v[28:29], -1
    v_smfmac_f32_16x16x64_bf16 v[64:67], v[40:43], v[144:151], v10
    ds_read_b128 v[108:111], v11 offset:13312
    s_waitcnt lgkmcnt(5)
    v_mov_b64 v[30:31], -1
    v_smfmac_f32_16x16x64_bf16 v[68:71], v[48:51], v[80:87], v10
    ds_read_b128 v[112:115], v11 offset:16384
    v_smfmac_f32_16x16x64_bf16 v[68:71], v[52:55], v[88:95], v10
    ds_read_b128 v[116:119], v11 offset:17408
    buffer_store_dword v28, v5, s[28:31], s69 offen
    v_smfmac_f32_16x16x64_bf16 v[64:67], v[44:47], v[152:159], v10
    ds_read_b128 v[120:123], v11 offset:20480
    v_smfmac_f32_16x16x64_bf16 v[64:67], v[48:51], v[128:135], v10
    ds_read_b128 v[124:127], v11 offset:21504
    s_waitcnt lgkmcnt(5)
    s_barrier
    ds_read_b128 v[80:83], v4 offset:0
    v_smfmac_f32_16x16x64_bf16 v[64:67], v[52:55], v[136:143], v10
    ds_read_b128 v[84:87], v4 offset:1024
    v_add_f32 v68, v68, v70
    v_smfmac_f32_16x16x64_bf16 v[72:75], v[32:35], a[192:199], v10
    ds_read_b128 v[88:91], v4 offset:2048
    v_add_f32 v69, v69, v71
    v_smfmac_f32_16x16x64_bf16 v[76:79], v[32:35], a[200:207], v10
    ds_read_b128 v[92:95], v4 offset:3072
    v_add_f32 v64, v64, v66
    v_smfmac_f32_16x16x64_bf16 v[72:75], v[36:39], a[208:215], v10
    s_waitcnt vmcnt(5)
    v_add_f32 v65, v65, v67
    v_smfmac_f32_16x16x64_bf16 v[76:79], v[36:39], a[216:223], v10
    s_waitcnt lgkmcnt(3)
    v_cvt_pk_bf16_f32 v24, v64, v68
    v_mfma_f32_16x16x32_bf16 v[56:59], v[96:99], v[80:83], 0
    s_waitcnt lgkmcnt(2)
    v_cvt_pk_bf16_f32 v25, v65, v69
    v_mfma_f32_16x16x32_bf16 v[56:59], v[100:103], v[84:87], v[56:59]
    buffer_store_dwordx4 v[28:31], v0, s[28:31], s67 offen
    ds_write2_b32 v3, v24, v25 offset0:128 offset1:132
    s_waitcnt lgkmcnt(2)
    v_mfma_f32_16x16x32_bf16 v[56:59], v[104:107], v[88:91], v[56:59]
    s_waitcnt lgkmcnt(1)
    v_mfma_f32_16x16x32_bf16 v[56:59], v[108:111], v[92:95], v[56:59]
    v_mfma_f32_16x16x32_bf16 v[60:63], v[112:115], v[80:83], 0
    v_mov_b64 v[96:97], 0
    v_mov_b64 v[98:99], 0
    v_mfma_f32_16x16x32_bf16 v[60:63], v[116:119], v[84:87], v[60:63]
    buffer_store_dwordx4 v[28:31], v0, s[28:31], s67 offen offset:1024
    v_exp_f32 v56, v56
    v_mov_b64 v[100:101], 0
    v_mfma_f32_16x16x32_bf16 v[60:63], v[120:123], v[88:91], v[60:63]
    v_mov_b64 v[102:103], 0
    v_mov_b64 v[104:105], 0
    v_mfma_f32_16x16x32_bf16 v[60:63], v[124:127], v[92:95], v[60:63]
    s_waitcnt lgkmcnt(0)
    s_barrier
    ds_read_b128 v[64:67], v4 offset:512
    v_exp_f32 v57, v57
    v_exp_f32 v58, v58
    v_smfmac_f32_16x16x64_bf16 v[72:75], v[40:43], a[160:167], v10
    ds_read_b128 v[68:71], v4 offset:1536
    v_cvt_pk_bf16_f32 v28, v56, v57
    v_smfmac_f32_16x16x64_bf16 v[76:79], v[40:43], a[168:175], v10
    ds_read_b128 v[32:35], v4 offset:2560
    v_mov_b64 v[106:107], 0
    v_smfmac_f32_16x16x64_bf16 v[72:75], v[44:47], a[176:183], v10
    ds_read_b128 v[36:39], v4 offset:3584
    buffer_load_dwordx4 v0, s[28:31], s71 offen lds
    v_exp_f32 v59, v59
    v_smfmac_f32_16x16x64_bf16 v[76:79], v[44:47], a[184:191], v10
    buffer_load_dwordx4 v0, s[28:31], s71 offen offset:1024 lds
    v_exp_f32 v60, v60
    v_smfmac_f32_16x16x64_bf16 v[72:75], v[48:51], a[128:135], v10
    s_waitcnt lgkmcnt(2)
    v_cvt_pk_bf16_f32 v29, v58, v59
    v_mfma_f32_16x16x32_bf16 v[40:43], v[64:67], v[80:83], 0
    v_exp_f32 v61, v61
    v_mov_b64 v[44:45], s[62:63]
    v_mfma_f32_16x16x32_bf16 v[40:43], v[68:71], v[84:87], v[40:43]
    s_waitcnt lgkmcnt(0)
    v_exp_f32 v62, v62
    v_mov_b64 v[46:47], s[62:63]
    v_mov_b64 v[108:109], 0
    v_mfma_f32_16x16x32_bf16 v[40:43], v[32:35], v[88:91], v[40:43]
    v_exp_f32 v63, v63
    v_cvt_pk_bf16_f32 v30, v60, v61
    v_mfma_f32_16x16x32_bf16 v[40:43], v[36:39], v[92:95], v[40:43]
    v_cvt_pk_bf16_f32 v31, v62, v63
    v_mov_b64 v[110:111], 0
    v_smfmac_f32_16x16x64_bf16 v[76:79], v[48:51], a[136:143], v10
    v_mov_b32 v49, 0
    v_smfmac_f32_16x16x64_bf16 v[72:75], v[52:55], a[144:151], v10
    s_waitcnt vmcnt(7)
    v_exp_f32 v40, v40
    v_smfmac_f32_16x16x64_bf16 v[76:79], v[52:55], a[152:159], v10
    v_exp_f32 v41, v41
    v_mfma_f32_16x16x32_bf16 v[52:55], v[44:47], v[28:31], 0
    v_add_f32 v72, v72, v74
    v_cvt_pk_bf16_f32 v48, v40, v41
    v_mfma_f32_16x16x32_bf16 v[56:59], v[16:19], v[28:31], 0
    v_add_f32 v73, v73, v75
    v_add_f32 v76, v76, v78
    v_mfma_f32_16x16x16_bf16 v[52:55], v[44:45], v[48:49], v[52:55]
    v_add_f32 v77, v77, v79
    v_cvt_pk_bf16_f32 v26, v72, v73
    v_cvt_pk_bf16_f32 v27, v76, v77
    v_mfma_f32_16x16x32_bf16 v[60:63], v[20:23], v[28:31], 0
    v_cvt_pk_bf16_f32 v51, v40, v41
    v_mov_b32 v50, 0
    v_mfma_f32_16x16x16_bf16 v[56:59], v[26:27], v[48:49], v[56:59]
    v_subrev_u32 v53, s79, v52
    v_rcp_f32 v52, v52
    v_mfma_f32_16x16x16_bf16 v[60:63], v[26:27], v[50:51], v[60:63]
    v_cmp_lt_u32 vcc, s100, v53
    s_nop 2
    v_cndmask_b32 v56, v56, v58, s[76:77]
    v_cndmask_b32 v57, v57, v59, s[76:77]
    v_pk_mul_f32 v[56:57], v[56:57], v[52:53] op_sel_hi:[1,0]
    s_nop 0
    v_cndmask_b32 v60, v60, v62, s[76:77]
    v_cndmask_b32 v61, v61, v63, s[76:77]
    v_pk_mul_f32 v[60:61], v[60:61], v[52:53] op_sel_hi:[1,0]
    v_cvt_pk_bf16_f32 v58, v56, v60
    v_cvt_pk_bf16_f32 v59, v57, v61
    ds_write_b64 v2, v[58:59] offset:5632
    v_mov_b32_dpp v28, v58 quad_perm:[0,1,0,1] row_mask:0xf bank_mask:0xf
    v_mov_b32_dpp v29, v59 quad_perm:[0,1,0,1] row_mask:0xf bank_mask:0xf
    v_mov_b32_dpp v30, v58 quad_perm:[2,3,2,3] row_mask:0xf bank_mask:0xf
    v_mov_b32_dpp v31, v59 quad_perm:[2,3,2,3] row_mask:0xf bank_mask:0xf
    s_cbranch_vccnz L_fb_49
L_rj_48:
    s_nop 0
    v_smfmac_f32_16x16x64_bf16 v[96:99], v[28:31], a[24:31], v10
    v_mov_b64 v[52:53], v[24:25]
    v_smfmac_f32_16x16x64_bf16 v[100:103], v[28:31], a[56:63], v10
    s_waitcnt lgkmcnt(0)
    s_barrier
    ds_read_b128 v[32:35], v4 offset:5120
    ds_read_b128 v[36:39], v4 offset:4608
    ds_read_b128 v[40:43], v4 offset:4096
    v_smfmac_f32_16x16x64_bf16 v[104:107], v[28:31], a[88:95], v10
    v_mov_b64 v[54:55], v[26:27]
    v_smfmac_f32_16x16x64_bf16 v[108:111], v[28:31], a[120:127], v10
    s_waitcnt lgkmcnt(2)
    v_smfmac_f32_16x16x64_bf16 v[96:99], v[32:35], a[16:23], v10
    s_waitcnt lgkmcnt(1)
    v_smfmac_f32_16x16x64_bf16 v[96:99], v[36:39], a[8:15], v10
    s_waitcnt lgkmcnt(0)
    v_smfmac_f32_16x16x64_bf16 v[96:99], v[40:43], a[0:7], v10
    ds_read_b128 v[64:67], v1 offset:12288
    v_mov_b64 v[24:25], 0
    v_smfmac_f32_16x16x64_bf16 v[100:103], v[32:35], a[48:55], v10
    ds_read_b128 v[68:71], v1 offset:13312
    v_mov_b64 v[26:27], 0
    v_smfmac_f32_16x16x64_bf16 v[100:103], v[36:39], a[40:47], v10
    v_cvt_pk_bf16_f32 v96, v96, v98
    v_cvt_pk_bf16_f32 v97, v97, v99
    v_smfmac_f32_16x16x64_bf16 v[100:103], v[40:43], a[32:39], v10
    buffer_store_dwordx2 v[96:97], v7, s[28:31], s47 offen
    v_smfmac_f32_16x16x64_bf16 v[104:107], v[32:35], a[80:87], v10
    ds_read_b128 v[72:75], v1 offset:14336
    v_mov_b64 v[28:29], 0
    v_smfmac_f32_16x16x64_bf16 v[104:107], v[36:39], a[72:79], v10
    v_cvt_pk_bf16_f32 v100, v100, v102
    v_cvt_pk_bf16_f32 v101, v101, v103
    v_smfmac_f32_16x16x64_bf16 v[104:107], v[40:43], a[64:71], v10
    buffer_store_dwordx2 v[100:101], v7, s[28:31], s48 offen
    v_smfmac_f32_16x16x64_bf16 v[108:111], v[32:35], a[112:119], v10
    ds_read_b128 v[76:79], v1 offset:15360
    v_mov_b64 v[30:31], 0
    v_smfmac_f32_16x16x64_bf16 v[108:111], v[36:39], a[104:111], v10
    v_cvt_pk_bf16_f32 v104, v104, v106
    v_cvt_pk_bf16_f32 v105, v105, v107
    v_smfmac_f32_16x16x64_bf16 v[108:111], v[40:43], a[96:103], v10
    buffer_store_dwordx2 v[104:105], v7, s[28:31], s49 offen
    s_nop 6
    v_cvt_pk_bf16_f32 v108, v108, v110
    v_cvt_pk_bf16_f32 v109, v109, v111
    buffer_store_dwordx2 v[108:109], v7, s[28:31], s50 offen
    ds_read_b128 v[80:83], v1 offset:8192
    ds_read_b128 v[84:87], v1 offset:9216
    ds_read_b128 v[88:91], v1 offset:10240
    ds_read_b128 v[92:95], v1 offset:11264
    ds_read_b128 v[112:115], v1 offset:0
    ds_read_b128 v[116:119], v1 offset:1024
    ds_read_b128 v[120:123], v1 offset:2048
    ds_read_b128 v[124:127], v1 offset:3072
    ds_read_b128 v[96:99], v1 offset:4096
    ds_read_b128 v[100:103], v1 offset:5120
    s_add_u32 s64, s64, 1
    s_add_u32 s71, s71, 262144
    ds_read_b128 v[104:107], v1 offset:6144
    s_add_u32 s78, s78, 262144
    s_add_u32 s72, s72, 131072
    ds_read_b128 v[108:111], v1 offset:7168
    s_xor_b32 m0, m0, 0x800
    v_xor_b32 v11, 0x800, v11
    s_add_u32 s55, s68, s101
    s_nop 3
    s_nop 3
    s_nop 3
    s_nop 3
    s_nop 3
    s_nop 3
    buffer_load_dwordx4 v[40:43], v0, s[28:31], s66 offen sc1
    buffer_load_dwordx4 v[44:47], v0, s[28:31], s66 offen offset:1024 sc1
    s_nop 3
    s_nop 3
    s_nop 3
    s_nop 3
    s_nop 3
    s_nop 3
    buffer_load_dwordx4 v[40:43], v0, s[28:31], s66 offen sc1
    buffer_load_dwordx4 v[44:47], v0, s[28:31], s66 offen offset:1024 sc1
    s_mov_b32 s58, 0
    s_branch L_p1e_51
L_p1_50:
    buffer_load_dwordx4 v[40:43], v0, s[28:31], s66 offen sc1
    buffer_load_dwordx4 v[44:47], v0, s[28:31], s66 offen offset:1024 sc1
    s_add_u32 s58, s58, 4096
    s_cbranch_scc1 L_tabort
L_p1e_51:
    s_waitcnt vmcnt(3)
    v_max3_u32 v36, v40, v41, v42
    v_max_u32 v36, v36, v43
    v_mfma_f32_16x16x32_bf16 v[32:35], v[12:15], v[40:43], 0
    s_waitcnt vmcnt(2)
    v_max3_u32 v36, v36, v44, v45
    v_max3_u32 v36, v36, v46, v47
    v_mfma_f32_16x16x32_bf16 v[32:35], v[12:15], v[44:47], v[32:35]
    v_cmp_eq_u32 vcc, -1, v36
    s_cbranch_vccnz L_p1_50
    s_nop 5
    v_add_f32_dpp v32, v32, v32 row_ror:4 row_mask:0xf bank_mask:0xf
    v_add_f32_dpp v33, v33, v33 row_ror:4 row_mask:0xf bank_mask:0xf
    s_nop 0
    v_add_f32_dpp v32, v32, v32 row_ror:8 row_mask:0xf bank_mask:0xf
    v_add_f32_dpp v33, v33, v33 row_ror:8 row_mask:0xf bank_mask:0xf
    v_cvt_pk_bf16_f32 v32, v32, v33
    buffer_store_dword v32, v5, s[28:31], s68 offen
    s_waitcnt lgkmcnt(0)
    s_barrier
    s_nop 12
    buffer_load_dwordx4 v[56:59], v0, s[28:31], s55 offen sc1
    buffer_load_dwordx4 v[60:63], v0, s[28:31], s55 offen offset:1024 sc1
    s_xor_b32 s66, s66, 0xc0000
    s_xor_b32 s67, s67, 0xc0000
    s_mov_b32 s54, s68
    s_mov_b32 s68, s69
    s_mov_b32 s69, s70
    s_mov_b32 s70, s54
    s_xor_b32 s47, s47, 0xc0000
    s_xor_b32 s48, s48, 0xc0000
    s_xor_b32 s49, s49, 0xc0000
    s_xor_b32 s50, s50, 0xc0000
    s_add_u32 s54, s64, 1
    s_min_u32 s54, s54, 63
    s_mov_b32 s58, 0
L_kvp_53:
    v_cmp_eq_u64 s[60:61], s[42:43], v[8:9]
    s_nop 1
    s_bitcmp1_b64 s[60:61], s54
    s_cbranch_scc1 L_kvok_52
    buffer_load_dwordx2 v[8:9], v6, s[28:31], s74 offen sc1
    s_waitcnt vmcnt(0)
    s_add_u32 s58, s58, 1
    s_cmp_lt_u32 s58, 1048576
    s_cbranch_scc1 L_kvp_53
    s_branch L_abort
L_kvok_52:
    s_mov_b32 s58, 0
    s_nop 7
    buffer_load_dwordx4 v[56:59], v0, s[28:31], s55 offen sc1
    buffer_load_dwordx4 v[60:63], v0, s[28:31], s55 offen offset:1024 sc1
    s_cmp_eq_u32 s64, 63
    s_cbranch_scc0 L_p2e_f3
    s_branch L_last_e
L_rf_46:
    buffer_load_dwordx2 v[8:9], v6, s[28:31], s74 offen sc1
    s_branch L_rb_47
L_fb_49:
    ds_read_b128 v[96:99], v11 offset:8192
    ds_read_b128 v[100:103], v11 offset:9216
    ds_read_b128 v[104:107], v11 offset:12288
    ds_read_b128 v[108:111], v11 offset:13312
    s_waitcnt lgkmcnt(0)
    s_nop 7
    v_mfma_f32_16x16x32_bf16 v[56:59], v[96:99], v[80:83], 0
    v_mfma_f32_16x16x32_bf16 v[56:59], v[100:103], v[84:87], v[56:59]
    v_mfma_f32_16x16x32_bf16 v[56:59], v[104:107], v[88:91], v[56:59]
    v_mfma_f32_16x16x32_bf16 v[56:59], v[108:111], v[92:95], v[56:59]
    v_mfma_f32_16x16x32_bf16 v[60:63], v[112:115], v[80:83], 0
    v_mfma_f32_16x16x32_bf16 v[60:63], v[116:119], v[84:87], v[60:63]
    v_mfma_f32_16x16x32_bf16 v[60:63], v[120:123], v[88:91], v[60:63]
    v_mfma_f32_16x16x32_bf16 v[60:63], v[124:127], v[92:95], v[60:63]
    v_mfma_f32_16x16x32_bf16 v[40:43], v[64:67], v[80:83], 0
    v_mfma_f32_16x16x32_bf16 v[40:43], v[68:71], v[84:87], v[40:43]
    v_mfma_f32_16x16x32_bf16 v[40:43], v[32:35], v[88:91], v[40:43]
    v_mfma_f32_16x16x32_bf16 v[40:43], v[36:39], v[92:95], v[40:43]
    v_max3_f32 v52, v56, v57, v58
    v_max3_f32 v53, v59, v60, v61
    v_max3_f32 v52, v52, v62, v63
    s_nop 4
    v_max3_f32 v53, v53, v40, v41
    v_max_f32 v52, v52, v53
    v_mov_b32 v53, v52
    s_nop 1
    v_permlane16_swap_b32 v52, v53
    v_max_f32 v52, v52, v53
    v_mov_b32 v53, v52
    s_nop 1
    v_permlane32_swap_b32 v52, v53
    v_max_f32 v52, v52, v53
    v_sub_f32 v56, v56, v52
    v_sub_f32 v57, v57, v52
    v_sub_f32 v58, v58, v52
    v_sub_f32 v59, v59, v52
    v_sub_f32 v60, v60, v52
    v_sub_f32 v61, v61, v52
    v_sub_f32 v62, v62, v52
    v_sub_f32 v63, v63, v52
    v_sub_f32 v40, v40, v52
    v_sub_f32 v41, v41, v52
    v_exp_f32 v56, v56
    v_exp_f32 v57, v57
    v_exp_f32 v58, v58
    v_exp_f32 v59, v59
    v_exp_f32 v60, v60
    v_exp_f32 v61, v61
    v_exp_f32 v62, v62
    v_exp_f32 v63, v63
    v_exp_f32 v40, v40
    v_exp_f32 v41, v41
    v_cvt_pk_bf16_f32 v28, v56, v57
    v_cvt_pk_bf16_f32 v29, v58, v59
    v_cvt_pk_bf16_f32 v30, v60, v61
    v_cvt_pk_bf16_f32 v31, v62, v63
    v_cvt_pk_bf16_f32 v48, v40, v41
    v_cvt_pk_bf16_f32 v51, v40, v41
    v_mfma_f32_16x16x32_bf16 v[52:55], v[44:47], v[28:31], 0
    v_mfma_f32_16x16x32_bf16 v[56:59], v[16:19], v[28:31], 0
    v_mfma_f32_16x16x32_bf16 v[60:63], v[20:23], v[28:31], 0
    v_mfma_f32_16x16x16_bf16 v[52:55], v[44:45], v[48:49], v[52:55]
    v_mfma_f32_16x16x16_bf16 v[56:59], v[26:27], v[48:49], v[56:59]
    v_mfma_f32_16x16x16_bf16 v[60:63], v[26:27], v[50:51], v[60:63]
    v_rcp_f32 v52, v52
    s_nop 2
    v_cndmask_b32 v56, v56, v58, s[76:77]
    v_cndmask_b32 v57, v57, v59, s[76:77]
    v_pk_mul_f32 v[56:57], v[56:57], v[52:53] op_sel_hi:[1,0]
    s_nop 0
    v_cndmask_b32 v60, v60, v62, s[76:77]
    v_cndmask_b32 v61, v61, v63, s[76:77]
    v_pk_mul_f32 v[60:61], v[60:61], v[52:53] op_sel_hi:[1,0]
    v_cvt_pk_bf16_f32 v58, v56, v60
    v_cvt_pk_bf16_f32 v59, v57, v61
    ds_write_b64 v2, v[58:59] offset:5632
    v_mov_b32_dpp v28, v58 quad_perm:[0,1,0,1] row_mask:0xf bank_mask:0xf
    v_mov_b32_dpp v29, v59 quad_perm:[0,1,0,1] row_mask:0xf bank_mask:0xf
    v_mov_b32_dpp v30, v58 quad_perm:[2,3,2,3] row_mask:0xf bank_mask:0xf
    v_mov_b32_dpp v31, v59 quad_perm:[2,3,2,3] row_mask:0xf bank_mask:0xf
    v_mov_b64 v[96:97], 0
    v_mov_b64 v[98:99], 0
    v_mov_b64 v[100:101], 0
    v_mov_b64 v[102:103], 0
    v_mov_b64 v[104:105], 0
    v_mov_b64 v[106:107], 0
    v_mov_b64 v[108:109], 0
    v_mov_b64 v[110:111], 0
    s_nop 7
    s_branch L_rj_48
L_last_e:
    ds_read_b128 v[64:67], v1 offset:16384
    ds_read_b128 v[68:71], v1 offset:17408
    ds_read_b128 v[72:75], v1 offset:18432
    ds_read_b128 v[76:79], v1 offset:19456
    ds_read_b128 v[80:83], v1 offset:20480
    ds_read_b128 v[84:87], v1 offset:21504
    ds_read_b128 v[88:91], v1 offset:22528
    ds_read_b128 v[92:95], v1 offset:23552
    ds_read_b128 v[96:99], v1 offset:24576
    ds_read_b128 v[100:103], v1 offset:25600
    ds_read_b128 v[104:107], v1 offset:26624
    ds_read_b128 v[108:111], v1 offset:27648
    ds_read_b128 v[112:115], v1 offset:28672
    ds_read_b128 v[116:119], v1 offset:29696
    ds_read_b128 v[120:123], v1 offset:30720
    ds_read_b128 v[124:127], v1 offset:31744
    v_mov_b64 v[192:193], 0
    v_mov_b64 v[194:195], 0
    v_mov_b64 v[196:197], 0
    v_mov_b64 v[198:199], 0
    s_lshl_b32 s54, s44, 11
    v_add_u32 v200, s54, v0
    s_branch L_last_p
L_last_l:
    buffer_load_dwordx4 v[56:59], v0, s[28:31], s55 offen sc1
    buffer_load_dwordx4 v[60:63], v0, s[28:31], s55 offen offset:1024 sc1
    s_add_u32 s58, s58, 4096
    s_cbranch_scc1 L_tabort
L_last_p:
    s_waitcnt vmcnt(3)
    v_max3_u32 v37, v56, v57, v58
    v_max_u32 v37, v37, v59
    ds_write_b128 v200, v[56:59] offset:0
    s_waitcnt vmcnt(2)
    v_max3_u32 v37, v37, v60, v61
    v_max3_u32 v37, v37, v62, v63
    ds_write_b128 v200, v[60:63] offset:1024
    v_cmp_eq_u32 vcc, -1, v37
    s_cbranch_vccnz L_last_l
    buffer_store_dwordx2 v[52:53], v6, s[28:31], s72 offen offset:0 sc1
    buffer_store_dwordx2 v[54:55], v6, s[28:31], s72 offen offset:512 sc1
    s_add_u32 s72, s72, 131072
    s_waitcnt lgkmcnt(0)
    s_barrier
    ds_read_b128 v[32:35], v0 offset:0
    ds_read_b128 v[36:39], v0 offset:1024
    ds_read_b128 v[40:43], v0 offset:2048
    ds_read_b128 v[44:47], v0 offset:3072
    ds_read_b128 v[48:51], v0 offset:4096
    ds_read_b128 v[52:55], v0 offset:5120
    s_waitcnt vmcnt(2)
    ds_read_b128 v[56:59], v0 offset:6144
    ds_read_b128 v[60:63], v0 offset:7168
    s_waitcnt lgkmcnt(7)
    v_smfmac_f32_16x16x64_bf16 v[192:195], v[32:35], v[128:135], v10
    v_smfmac_f32_16x16x64_bf16 v[196:199], v[32:35], v[64:71], v10
    v_smfmac_f32_16x16x64_bf16 v[24:27], v[32:35], a[128:135], v10
    v_smfmac_f32_16x16x64_bf16 v[28:31], v[32:35], a[136:143], v10
    s_waitcnt lgkmcnt(6)
    v_smfmac_f32_16x16x64_bf16 v[192:195], v[36:39], v[136:143], v10
    v_smfmac_f32_16x16x64_bf16 v[196:199], v[36:39], v[72:79], v10
    v_smfmac_f32_16x16x64_bf16 v[24:27], v[36:39], a[144:151], v10
    v_smfmac_f32_16x16x64_bf16 v[28:31], v[36:39], a[152:159], v10
    s_waitcnt lgkmcnt(5)
    v_smfmac_f32_16x16x64_bf16 v[192:195], v[40:43], v[144:151], v10
    v_smfmac_f32_16x16x64_bf16 v[196:199], v[40:43], v[80:87], v10
    v_smfmac_f32_16x16x64_bf16 v[24:27], v[40:43], a[160:167], v10
    v_smfmac_f32_16x16x64_bf16 v[28:31], v[40:43], a[168:175], v10
    s_waitcnt lgkmcnt(4)
    v_smfmac_f32_16x16x64_bf16 v[192:195], v[44:47], v[152:159], v10
    v_smfmac_f32_16x16x64_bf16 v[196:199], v[44:47], v[88:95], v10
    v_smfmac_f32_16x16x64_bf16 v[24:27], v[44:47], a[176:183], v10
    v_smfmac_f32_16x16x64_bf16 v[28:31], v[44:47], a[184:191], v10
    s_waitcnt lgkmcnt(3)
    v_smfmac_f32_16x16x64_bf16 v[192:195], v[48:51], v[160:167], v10
    v_smfmac_f32_16x16x64_bf16 v[196:199], v[48:51], v[96:103], v10
    v_smfmac_f32_16x16x64_bf16 v[24:27], v[48:51], a[192:199], v10
    v_smfmac_f32_16x16x64_bf16 v[28:31], v[48:51], a[200:207], v10
    s_waitcnt lgkmcnt(2)
    v_smfmac_f32_16x16x64_bf16 v[192:195], v[52:55], v[168:175], v10
    v_smfmac_f32_16x16x64_bf16 v[196:199], v[52:55], v[104:111], v10
    v_smfmac_f32_16x16x64_bf16 v[24:27], v[52:55], a[208:215], v10
    v_smfmac_f32_16x16x64_bf16 v[28:31], v[52:55], a[216:223], v10
    s_waitcnt lgkmcnt(1)
    v_smfmac_f32_16x16x64_bf16 v[192:195], v[56:59], v[176:183], v10
    v_smfmac_f32_16x16x64_bf16 v[196:199], v[56:59], v[112:119], v10
    v_smfmac_f32_16x16x64_bf16 v[24:27], v[56:59], a[224:231], v10
    v_smfmac_f32_16x16x64_bf16 v[28:31], v[56:59], a[232:239], v10
    s_waitcnt lgkmcnt(0)
    v_smfmac_f32_16x16x64_bf16 v[192:195], v[60:63], v[184:191], v10
    v_smfmac_f32_16x16x64_bf16 v[196:199], v[60:63], v[120:127], v10
    v_smfmac_f32_16x16x64_bf16 v[24:27], v[60:63], a[240:247], v10
    v_smfmac_f32_16x16x64_bf16 v[28:31], v[60:63], a[248:255], v10
    v_pk_add_f32 v[192:193], v[192:193], v[194:195]
    v_pk_add_f32 v[196:197], v[196:197], v[198:199]
    s_nop 1
    v_pk_add_f32 v[24:25], v[24:25], v[26:27]
    s_nop 2
    v_pk_add_f32 v[28:29], v[28:29], v[30:31]
    v_cvt_pk_bf16_f32 v192, v192, v196
    v_cvt_pk_bf16_f32 v193, v193, v197
    v_cvt_pk_bf16_f32 v194, v24, v25
    v_cvt_pk_bf16_f32 v195, v28, v29
    buffer_store_dwordx2 v[192:193], v6, s[28:31], s72 offen offset:0 sc1
    buffer_store_dwordx2 v[194:195], v6, s[28:31], s72 offen offset:512 sc1
    s_waitcnt vmcnt(0)
    s_barrier
    s_cmp_lg_u32 s44, 0
    s_cbranch_scc1 L_tabort
    v_mov_b32 v24, s42
    v_mov_b32 v25, s43
    s_mov_b64 exec, 1
    buffer_store_dwordx2 v[24:25], off, s[28:31], s75 sc1
    s_mov_b64 exec, -1
    s_cmp_lg_u32 s65, 0
    s_cbranch_scc1 L_tabort
    s_mov_b32 s55, 0
    v_mov_b32 v26, s42
    v_mov_b32 v27, s43
    s_mov_b64 exec, 1
    buffer_store_dwordx2 v[26:27], off, s[28:31], s55 sc1
    s_mov_b64 exec, -1
L_tabort:
    s_endpgm
L_slow:
    s_cmp_eq_u32 s44, 1
    s_cbranch_scc1 L_ent_s1
    s_cmp_eq_u32 s44, 2
    s_cbranch_scc1 L_ent_s2
    s_cmp_eq_u32 s44, 3
    s_cbranch_scc1 L_ent_s3
L_ent_s0:
    ds_read_b128 v[64:67], v1 offset:0
    ds_read_b128 v[68:71], v1 offset:1024
    ds_read_b128 v[72:75], v1 offset:2048
    ds_read_b128 v[76:79], v1 offset:3072
    ds_read_b128 v[80:83], v1 offset:4096
    ds_read_b128 v[84:87], v1 offset:5120
    ds_read_b128 v[88:91], v1 offset:6144
    ds_read_b128 v[92:95], v1 offset:7168
    ds_read_b128 v[96:99], v1 offset:8192
    ds_read_b128 v[100:103], v1 offset:9216
    ds_read_b128 v[104:107], v1 offset:10240
    ds_read_b128 v[108:111], v1 offset:11264
    ds_read_b128 v[112:115], v1 offset:12288
    ds_read_b128 v[116:119], v1 offset:13312
    ds_read_b128 v[120:123], v1 offset:14336
    ds_read_b128 v[124:127], v1 offset:15360
    ds_read_b128 v[56:59], v0 offset:0
    ds_read_b128 v[60:63], v0 offset:1024
    s_waitcnt lgkmcnt(0)
    v_smfmac_f32_16x16x64_bf16 v[24:27], v[56:59], v[64:71], v10
    v_smfmac_f32_16x16x64_bf16 v[24:27], v[60:63], v[72:79], v10
    s_branch L_top_s0
L_p2_s0:
    buffer_load_dwordx4 v[56:59], v0, s[28:31], s55 offen sc1
    buffer_load_dwordx4 v[60:63], v0, s[28:31], s55 offen offset:1024 sc1
    s_add_u32 s58, s58, 4096
    s_cbranch_scc1 L_tabort
    s_nop 1
    s_nop 0
    v_mov_b64 v[24:25], 0
    v_mov_b64 v[26:27], 0
L_p2e_s0:
    s_waitcnt vmcnt(3)
    v_max3_u32 v37, v56, v57, v58
    v_max_u32 v37, v37, v59
    v_smfmac_f32_16x16x64_bf16 v[24:27], v[56:59], v[64:71], v10
    ds_write_b128 v0, v[56:59] offset:0
    s_waitcnt vmcnt(2)
    v_max3_u32 v37, v37, v60, v61
    v_max3_u32 v37, v37, v62, v63
    v_cmp_eq_u32 vcc, -1, v37
    v_smfmac_f32_16x16x64_bf16 v[24:27], v[60:63], v[72:79], v10
    s_cbranch_vccnz L_p2_s0
L_top_s0:
    v_mov_b64 v[64:65], 0
    v_smfmac_f32_16x16x64_bf16 v[28:31], v[56:59], v[192:199], v10
    ds_write_b128 v0, v[60:63] offset:1024
    v_mov_b64 v[66:67], 0
    v_smfmac_f32_16x16x64_bf16 v[28:31], v[60:63], v[200:207], v10
    buffer_load_dwordx4 v[16:19], v0, s[28:31], s78 offen
    v_mov_b64 v[72:73], 0
    v_smfmac_f32_16x16x64_bf16 v[64:67], v[56:59], v[128:135], v10
    buffer_load_dwordx4 v[20:23], v0, s[28:31], s78 offen offset:1024
    v_mov_b64 v[74:75], 0
    v_smfmac_f32_16x16x64_bf16 v[64:67], v[60:63], v[136:143], v10
    s_waitcnt lgkmcnt(0)
    s_barrier
    ds_read_b128 v[32:35], v0 offset:2048
    ds_read_b128 v[36:39], v0 offset:3072
    v_mov_b64 v[76:77], 0
    v_smfmac_f32_16x16x64_bf16 v[72:75], v[56:59], a[128:135], v10
    ds_read_b128 v[40:43], v0 offset:4096
    v_mov_b64 v[78:79], 0
    v_smfmac_f32_16x16x64_bf16 v[72:75], v[60:63], a[144:151], v10
    ds_read_b128 v[44:47], v0 offset:5120
    v_smfmac_f32_16x16x64_bf16 v[76:79], v[56:59], a[136:143], v10
    ds_read_b128 v[48:51], v0 offset:6144
    buffer_store_dwordx2 v[52:53], v6, s[28:31], s72 offen offset:0 sc1
    v_smfmac_f32_16x16x64_bf16 v[76:79], v[60:63], a[152:159], v10
    s_waitcnt lgkmcnt(3)
    v_smfmac_f32_16x16x64_bf16 v[24:27], v[32:35], v[80:87], v10
    ds_read_b128 v[80:83], v1 offset:16384
    buffer_store_dwordx2 v[54:55], v6, s[28:31], s72 offen offset:512 sc1
    v_smfmac_f32_16x16x64_bf16 v[24:27], v[36:39], v[88:95], v10
    ds_read_b128 v[52:55], v0 offset:7168
    ds_read_b128 v[84:87], v1 offset:17408
    s_waitcnt lgkmcnt(3)
    v_smfmac_f32_16x16x64_bf16 v[24:27], v[40:43], v[96:103], v10
    ds_read_b128 v[88:91], v1 offset:18432
    v_mov_b64 v[68:69], 0
    v_smfmac_f32_16x16x64_bf16 v[24:27], v[44:47], v[104:111], v10
    ds_read_b128 v[92:95], v1 offset:19456
    v_mov_b64 v[70:71], 0
    v_smfmac_f32_16x16x64_bf16 v[24:27], v[48:51], v[112:119], v10
    ds_read_b128 v[96:99], v1 offset:20480
    s_waitcnt lgkmcnt(4)
    v_smfmac_f32_16x16x64_bf16 v[24:27], v[52:55], v[120:127], v10
    ds_read_b128 v[100:103], v1 offset:21504
    v_smfmac_f32_16x16x64_bf16 v[28:31], v[32:35], v[208:215], v10
    ds_read_b128 v[104:107], v1 offset:22528
    v_smfmac_f32_16x16x64_bf16 v[28:31], v[36:39], v[216:223], v10
    ds_read_b128 v[108:111], v1 offset:23552
    v_add_f32 v24, v24, v26
    v_smfmac_f32_16x16x64_bf16 v[28:31], v[40:43], v[224:231], v10
    ds_read_b128 v[112:115], v1 offset:24576
    v_add_f32 v25, v25, v27
    v_smfmac_f32_16x16x64_bf16 v[28:31], v[44:47], v[232:239], v10
    ds_read_b128 v[116:119], v1 offset:25600
    v_mul_f32 v24, s59, v24
    v_smfmac_f32_16x16x64_bf16 v[28:31], v[48:51], v[240:247], v10
    ds_read_b128 v[120:123], v1 offset:26624
    v_mul_f32 v25, s59, v25
    v_smfmac_f32_16x16x64_bf16 v[28:31], v[52:55], v[248:255], v10
    ds_read_b128 v[124:127], v1 offset:27648
    s_cmp_lg_u64 s[60:61], -1
    s_cbranch_scc1 L_rf_55
L_rb_56:
    s_waitcnt lgkmcnt(6)
    v_smfmac_f32_16x16x64_bf16 v[68:71], v[56:59], v[80:87], v10
    ds_read_b128 v[80:83], v1 offset:28672
    v_smfmac_f32_16x16x64_bf16 v[68:71], v[60:63], v[88:95], v10
    ds_read_b128 v[84:87], v1 offset:29696
    v_add_f32 v28, v28, v30
    v_smfmac_f32_16x16x64_bf16 v[68:71], v[32:35], v[96:103], v10
    ds_read_b128 v[88:91], v1 offset:30720
    s_waitcnt lgkmcnt(5)
    v_add_f32 v29, v29, v31
    v_smfmac_f32_16x16x64_bf16 v[68:71], v[36:39], v[104:111], v10
    ds_read_b128 v[92:95], v1 offset:31744
    v_mul_f32 v28, s59, v28
    v_smfmac_f32_16x16x64_bf16 v[68:71], v[40:43], v[112:119], v10
    ds_read_b128 v[96:99], v11 offset:8192
    s_waitcnt lgkmcnt(5)
    v_mul_f32 v29, s59, v29
    v_smfmac_f32_16x16x64_bf16 v[68:71], v[44:47], v[120:127], v10
    ds_read_b128 v[100:103], v11 offset:9216
    v_cvt_pk_bf16_f32 v24, v24, v28
    v_smfmac_f32_16x16x64_bf16 v[64:67], v[32:35], v[144:151], v10
    ds_read_b128 v[104:107], v11 offset:12288
    v_cvt_pk_bf16_f32 v25, v25, v29
    v_smfmac_f32_16x16x64_bf16 v[64:67], v[36:39], v[152:159], v10
    ds_write2_b32 v3, v24, v25 offset0:0 offset1:4
    v_mov_b64 v[28:29], -1
    v_smfmac_f32_16x16x64_bf16 v[64:67], v[40:43], v[160:167], v10
    ds_read_b128 v[108:111], v11 offset:13312
    s_waitcnt lgkmcnt(5)
    v_mov_b64 v[30:31], -1
    v_smfmac_f32_16x16x64_bf16 v[68:71], v[48:51], v[80:87], v10
    ds_read_b128 v[112:115], v11 offset:16384
    v_smfmac_f32_16x16x64_bf16 v[68:71], v[52:55], v[88:95], v10
    ds_read_b128 v[116:119], v11 offset:17408
    buffer_store_dword v28, v5, s[28:31], s69 offen sc1
    v_smfmac_f32_16x16x64_bf16 v[64:67], v[44:47], v[168:175], v10
    ds_read_b128 v[120:123], v11 offset:20480
    v_smfmac_f32_16x16x64_bf16 v[64:67], v[48:51], v[176:183], v10
    ds_read_b128 v[124:127], v11 offset:21504
    s_waitcnt lgkmcnt(5)
    s_barrier
    ds_read_b128 v[80:83], v4 offset:0
    v_smfmac_f32_16x16x64_bf16 v[64:67], v[52:55], v[184:191], v10
    ds_read_b128 v[84:87], v4 offset:1024
    v_add_f32 v68, v68, v70
    v_smfmac_f32_16x16x64_bf16 v[72:75], v[32:35], a[160:167], v10
    ds_read_b128 v[88:91], v4 offset:2048
    v_add_f32 v69, v69, v71
    v_smfmac_f32_16x16x64_bf16 v[76:79], v[32:35], a[168:175], v10
    ds_read_b128 v[92:95], v4 offset:3072
    v_add_f32 v64, v64, v66
    v_smfmac_f32_16x16x64_bf16 v[72:75], v[36:39], a[176:183], v10
    s_waitcnt vmcnt(5)
    buffer_store_dwordx4 v[28:31], v0, s[28:31], s67 offen sc1
    v_add_f32 v65, v65, v67
    v_smfmac_f32_16x16x64_bf16 v[76:79], v[36:39], a[184:191], v10
    s_waitcnt lgkmcnt(3)
    v_cvt_pk_bf16_f32 v24, v64, v68
    v_mfma_f32_16x16x32_bf16 v[56:59], v[96:99], v[80:83], 0
    s_waitcnt lgkmcnt(2)
    v_cvt_pk_bf16_f32 v25, v65, v69
    v_mfma_f32_16x16x32_bf16 v[56:59], v[100:103], v[84:87], v[56:59]
    ds_write2_b32 v3, v24, v25 offset0:128 offset1:132
    s_waitcnt lgkmcnt(2)
    v_mfma_f32_16x16x32_bf16 v[56:59], v[104:107], v[88:91], v[56:59]
    buffer_store_dwordx4 v[28:31], v0, s[28:31], s67 offen offset:1024 sc1
    s_waitcnt lgkmcnt(1)
    v_mfma_f32_16x16x32_bf16 v[56:59], v[108:111], v[92:95], v[56:59]
    v_mfma_f32_16x16x32_bf16 v[60:63], v[112:115], v[80:83], 0
    v_mov_b64 v[96:97], 0
    v_mov_b64 v[98:99], 0
    v_mfma_f32_16x16x32_bf16 v[60:63], v[116:119], v[84:87], v[60:63]
    v_exp_f32 v56, v56
    v_mov_b64 v[100:101], 0
    v_mfma_f32_16x16x32_bf16 v[60:63], v[120:123], v[88:91], v[60:63]
    v_mov_b64 v[102:103], 0
    v_mov_b64 v[104:105], 0
    v_mfma_f32_16x16x32_bf16 v[60:63], v[124:127], v[92:95], v[60:63]
    s_waitcnt lgkmcnt(0)
    s_barrier
    ds_read_b128 v[64:67], v4 offset:512
    v_exp_f32 v57, v57
    v_exp_f32 v58, v58
    v_smfmac_f32_16x16x64_bf16 v[72:75], v[40:43], a[192:199], v10
    ds_read_b128 v[68:71], v4 offset:1536
    v_cvt_pk_bf16_f32 v28, v56, v57
    v_smfmac_f32_16x16x64_bf16 v[76:79], v[40:43], a[200:207], v10
    ds_read_b128 v[32:35], v4 offset:2560
    v_mov_b64 v[106:107], 0
    v_smfmac_f32_16x16x64_bf16 v[72:75], v[44:47], a[208:215], v10
    ds_read_b128 v[36:39], v4 offset:3584
    buffer_load_dwordx4 v0, s[28:31], s71 offen lds
    v_exp_f32 v59, v59
    v_smfmac_f32_16x16x64_bf16 v[76:79], v[44:47], a[216:223], v10
    buffer_load_dwordx4 v0, s[28:31], s71 offen offset:1024 lds
    v_exp_f32 v60, v60
    v_smfmac_f32_16x16x64_bf16 v[72:75], v[48:51], a[224:231], v10
    s_waitcnt lgkmcnt(2)
    v_cvt_pk_bf16_f32 v29, v58, v59
    v_mfma_f32_16x16x32_bf16 v[40:43], v[64:67], v[80:83], 0
    v_exp_f32 v61, v61
    v_mov_b64 v[44:45], s[62:63]
    v_mfma_f32_16x16x32_bf16 v[40:43], v[68:71], v[84:87], v[40:43]
    s_waitcnt lgkmcnt(0)
    v_exp_f32 v62, v62
    v_mov_b64 v[46:47], s[62:63]
    v_mov_b64 v[108:109], 0
    v_mfma_f32_16x16x32_bf16 v[40:43], v[32:35], v[88:91], v[40:43]
    v_exp_f32 v63, v63
    v_cvt_pk_bf16_f32 v30, v60, v61
    v_mfma_f32_16x16x32_bf16 v[40:43], v[36:39], v[92:95], v[40:43]
    v_cvt_pk_bf16_f32 v31, v62, v63
    v_mov_b64 v[110:111], 0
    v_smfmac_f32_16x16x64_bf16 v[76:79], v[48:51], a[232:239], v10
    v_mov_b32 v49, 0
    v_smfmac_f32_16x16x64_bf16 v[72:75], v[52:55], a[240:247], v10
    s_waitcnt vmcnt(7)
    v_exp_f32 v40, v40
    v_smfmac_f32_16x16x64_bf16 v[76:79], v[52:55], a[248:255], v10
    v_exp_f32 v41, v41
    v_mfma_f32_16x16x32_bf16 v[52:55], v[44:47], v[28:31], 0
    v_add_f32 v72, v72, v74
    v_cvt_pk_bf16_f32 v48, v40, v41
    v_mfma_f32_16x16x32_bf16 v[56:59], v[16:19], v[28:31], 0
    v_add_f32 v73, v73, v75
    v_add_f32 v76, v76, v78
    v_mfma_f32_16x16x16_bf16 v[52:55], v[44:45], v[48:49], v[52:55]
    v_add_f32 v77, v77, v79
    v_cvt_pk_bf16_f32 v26, v72, v73
    v_cvt_pk_bf16_f32 v27, v76, v77
    v_mfma_f32_16x16x32_bf16 v[60:63], v[20:23], v[28:31], 0
    v_cvt_pk_bf16_f32 v51, v40, v41
    v_mov_b32 v50, 0
    v_mfma_f32_16x16x16_bf16 v[56:59], v[26:27], v[48:49], v[56:59]
    v_subrev_u32 v53, s79, v52
    v_rcp_f32 v52, v52
    v_mfma_f32_16x16x16_bf16 v[60:63], v[26:27], v[50:51], v[60:63]
    v_cmp_lt_u32 vcc, s100, v53
    s_nop 2
    v_cndmask_b32 v56, v56, v58, s[76:77]
    v_cndmask_b32 v57, v57, v59, s[76:77]
    v_pk_mul_f32 v[56:57], v[56:57], v[52:53] op_sel_hi:[1,0]
    s_nop 0
    v_cndmask_b32 v60, v60, v62, s[76:77]
    v_cndmask_b32 v61, v61, v63, s[76:77]
    v_pk_mul_f32 v[60:61], v[60:61], v[52:53] op_sel_hi:[1,0]
    v_cvt_pk_bf16_f32 v58, v56, v60
    v_cvt_pk_bf16_f32 v59, v57, v61
    ds_write_b64 v2, v[58:59] offset:4096
    v_mov_b32_dpp v28, v58 quad_perm:[0,1,0,1] row_mask:0xf bank_mask:0xf
    v_mov_b32_dpp v29, v59 quad_perm:[0,1,0,1] row_mask:0xf bank_mask:0xf
    v_mov_b32_dpp v30, v58 quad_perm:[2,3,2,3] row_mask:0xf bank_mask:0xf
    v_mov_b32_dpp v31, v59 quad_perm:[2,3,2,3] row_mask:0xf bank_mask:0xf
    s_cbranch_vccnz L_fb_58
L_rj_57:
    s_nop 0
    v_smfmac_f32_16x16x64_bf16 v[96:99], v[28:31], a[0:7], v10
    v_mov_b64 v[52:53], v[24:25]
    v_smfmac_f32_16x16x64_bf16 v[100:103], v[28:31], a[32:39], v10
    s_waitcnt lgkmcnt(0)
    s_barrier
    ds_read_b128 v[32:35], v4 offset:4608
    ds_read_b128 v[36:39], v4 offset:5120
    ds_read_b128 v[40:43], v4 offset:5632
    v_smfmac_f32_16x16x64_bf16 v[104:107], v[28:31], a[64:71], v10
    v_mov_b64 v[54:55], v[26:27]
    v_smfmac_f32_16x16x64_bf16 v[108:111], v[28:31], a[96:103], v10
    s_waitcnt lgkmcnt(2)
    v_smfmac_f32_16x16x64_bf16 v[96:99], v[32:35], a[8:15], v10
    s_waitcnt lgkmcnt(1)
    v_smfmac_f32_16x16x64_bf16 v[96:99], v[36:39], a[16:23], v10
    s_waitcnt lgkmcnt(0)
    v_smfmac_f32_16x16x64_bf16 v[96:99], v[40:43], a[24:31], v10
    ds_read_b128 v[64:67], v1 offset:0
    v_mov_b64 v[24:25], 0
    v_smfmac_f32_16x16x64_bf16 v[100:103], v[32:35], a[40:47], v10
    ds_read_b128 v[68:71], v1 offset:1024
    v_mov_b64 v[26:27], 0
    v_smfmac_f32_16x16x64_bf16 v[100:103], v[36:39], a[48:55], v10
    v_cvt_pk_bf16_f32 v96, v96, v98
    v_cvt_pk_bf16_f32 v97, v97, v99
    v_smfmac_f32_16x16x64_bf16 v[100:103], v[40:43], a[56:63], v10
    buffer_store_dwordx2 v[96:97], v7, s[28:31], s47 offen sc1
    v_smfmac_f32_16x16x64_bf16 v[104:107], v[32:35], a[72:79], v10
    ds_read_b128 v[72:75], v1 offset:2048
    v_mov_b64 v[28:29], 0
    v_smfmac_f32_16x16x64_bf16 v[104:107], v[36:39], a[80:87], v10
    v_cvt_pk_bf16_f32 v100, v100, v102
    v_cvt_pk_bf16_f32 v101, v101, v103
    v_smfmac_f32_16x16x64_bf16 v[104:107], v[40:43], a[88:95], v10
    buffer_store_dwordx2 v[100:101], v7, s[28:31], s48 offen sc1
    v_smfmac_f32_16x16x64_bf16 v[108:111], v[32:35], a[104:111], v10
    ds_read_b128 v[76:79], v1 offset:3072
    v_mov_b64 v[30:31], 0
    v_smfmac_f32_16x16x64_bf16 v[108:111], v[36:39], a[112:119], v10
    v_cvt_pk_bf16_f32 v104, v104, v106
    v_cvt_pk_bf16_f32 v105, v105, v107
    v_smfmac_f32_16x16x64_bf16 v[108:111], v[40:43], a[120:127], v10
    buffer_store_dwordx2 v[104:105], v7, s[28:31], s49 offen sc1
    s_nop 6
    v_cvt_pk_bf16_f32 v108, v108, v110
    v_cvt_pk_bf16_f32 v109, v109, v111
    buffer_store_dwordx2 v[108:109], v7, s[28:31], s50 offen sc1
    ds_read_b128 v[80:83], v1 offset:4096
    ds_read_b128 v[84:87], v1 offset:5120
    ds_read_b128 v[88:91], v1 offset:6144
    ds_read_b128 v[92:95], v1 offset:7168
    ds_read_b128 v[112:115], v1 offset:12288
    ds_read_b128 v[116:119], v1 offset:13312
    ds_read_b128 v[120:123], v1 offset:14336
    ds_read_b128 v[124:127], v1 offset:15360
    ds_read_b128 v[96:99], v1 offset:8192
    ds_read_b128 v[100:103], v1 offset:9216
    s_add_u32 s64, s64, 1
    s_add_u32 s71, s71, 262144
    ds_read_b128 v[104:107], v1 offset:10240
    s_add_u32 s78, s78, 262144
    s_add_u32 s72, s72, 131072
    ds_read_b128 v[108:111], v1 offset:11264
    s_xor_b32 m0, m0, 0x800
    v_xor_b32 v11, 0x800, v11
    s_add_u32 s55, s68, s101
    s_nop 3
    s_nop 3
    buffer_load_dwordx4 v[40:43], v0, s[28:31], s66 offen sc1
    buffer_load_dwordx4 v[44:47], v0, s[28:31], s66 offen offset:1024 sc1
    s_mov_b32 s58, 0
    s_branch L_p1e_60
L_p1_59:
    buffer_load_dwordx4 v[40:43], v0, s[28:31], s66 offen sc1
    buffer_load_dwordx4 v[44:47], v0, s[28:31], s66 offen offset:1024 sc1
    s_add_u32 s58, s58, 4096
    s_cbranch_scc1 L_tabort
L_p1e_60:
    s_waitcnt vmcnt(1)
    v_max3_u32 v36, v40, v41, v42
    v_max_u32 v36, v36, v43
    v_mfma_f32_16x16x32_bf16 v[32:35], v[12:15], v[40:43], 0
    s_waitcnt vmcnt(0)
    v_max3_u32 v36, v36, v44, v45
    v_max3_u32 v36, v36, v46, v47
    v_mfma_f32_16x16x32_bf16 v[32:35], v[12:15], v[44:47], v[32:35]
    v_cmp_eq_u32 vcc, -1, v36
    s_cbranch_vccnz L_p1_59
    s_nop 5
    v_add_f32_dpp v32, v32, v32 row_ror:4 row_mask:0xf bank_mask:0xf
    v_add_f32_dpp v33, v33, v33 row_ror:4 row_mask:0xf bank_mask:0xf
    s_nop 0
    v_add_f32_dpp v32, v32, v32 row_ror:8 row_mask:0xf bank_mask:0xf
    v_add_f32_dpp v33, v33, v33 row_ror:8 row_mask:0xf bank_mask:0xf
    v_cvt_pk_bf16_f32 v32, v32, v33
    buffer_store_dword v32, v5, s[28:31], s68 offen sc1
    s_waitcnt lgkmcnt(0)
    s_barrier
    s_nop 12
    buffer_load_dwordx4 v[56:59], v0, s[28:31], s55 offen sc1
    buffer_load_dwordx4 v[60:63], v0, s[28:31], s55 offen offset:1024 sc1
    s_xor_b32 s66, s66, 0xc0000
    s_xor_b32 s67, s67, 0xc0000
    s_mov_b32 s54, s68
    s_mov_b32 s68, s69
    s_mov_b32 s69, s70
    s_mov_b32 s70, s54
    s_xor_b32 s47, s47, 0xc0000
    s_xor_b32 s48, s48, 0xc0000
    s_xor_b32 s49, s49, 0xc0000
    s_xor_b32 s50, s50, 0xc0000
    s_add_u32 s54, s64, 1
    s_min_u32 s54, s54, 63
    s_mov_b32 s58, 0
L_kvp_62:
    v_cmp_eq_u64 s[60:61], s[42:43], v[8:9]
    s_nop 1
    s_bitcmp1_b64 s[60:61], s54
    s_cbranch_scc1 L_kvok_61
    buffer_load_dwordx2 v[8:9], v6, s[28:31], s74 offen sc1
    s_waitcnt vmcnt(0)
    s_add_u32 s58, s58, 1
    s_cmp_lt_u32 s58, 1048576
    s_cbranch_scc1 L_kvp_62
    s_branch L_abort
L_kvok_61:
    s_mov_b32 s58, 0
    s_nop 7
    buffer_load_dwordx4 v[56:59], v0, s[28:31], s55 offen sc1
    buffer_load_dwordx4 v[60:63], v0, s[28:31], s55 offen offset:1024 sc1
    s_cmp_eq_u32 s64, 63
    s_cbranch_scc0 L_p2e_s0
    s_branch L_last_e
L_rf_55:
    buffer_load_dwordx2 v[8:9], v6, s[28:31], s74 offen sc1
    s_branch L_rb_56
L_fb_58:
    ds_read_b128 v[96:99], v11 offset:8192
    ds_read_b128 v[100:103], v11 offset:9216
    ds_read_b128 v[104:107], v11 offset:12288
    ds_read_b128 v[108:111], v11 offset:13312
    s_waitcnt lgkmcnt(0)
    s_nop 7
    v_mfma_f32_16x16x32_bf16 v[56:59], v[96:99], v[80:83], 0
    v_mfma_f32_16x16x32_bf16 v[56:59], v[100:103], v[84:87], v[56:59]
    v_mfma_f32_16x16x32_bf16 v[56:59], v[104:107], v[88:91], v[56:59]
    v_mfma_f32_16x16x32_bf16 v[56:59], v[108:111], v[92:95], v[56:59]
    v_mfma_f32_16x16x32_bf16 v[60:63], v[112:115], v[80:83], 0
    v_mfma_f32_16x16x32_bf16 v[60:63], v[116:119], v[84:87], v[60:63]
    v_mfma_f32_16x16x32_bf16 v[60:63], v[120:123], v[88:91], v[60:63]
    v_mfma_f32_16x16x32_bf16 v[60:63], v[124:127], v[92:95], v[60:63]
    v_mfma_f32_16x16x32_bf16 v[40:43], v[64:67], v[80:83], 0
    v_mfma_f32_16x16x32_bf16 v[40:43], v[68:71], v[84:87], v[40:43]
    v_mfma_f32_16x16x32_bf16 v[40:43], v[32:35], v[88:91], v[40:43]
    v_mfma_f32_16x16x32_bf16 v[40:43], v[36:39], v[92:95], v[40:43]
    v_max3_f32 v52, v56, v57, v58
    v_max3_f32 v53, v59, v60, v61
    v_max3_f32 v52, v52, v62, v63
    s_nop 4
    v_max3_f32 v53, v53, v40, v41
    v_max_f32 v52, v52, v53
    v_mov_b32 v53, v52
    s_nop 1
    v_permlane16_swap_b32 v52, v53
    v_max_f32 v52, v52, v53
    v_mov_b32 v53, v52
    s_nop 1
    v_permlane32_swap_b32 v52, v53
    v_max_f32 v52, v52, v53
    v_sub_f32 v56, v56, v52
    v_sub_f32 v57, v57, v52
    v_sub_f32 v58, v58, v52
    v_sub_f32 v59, v59, v52
    v_sub_f32 v60, v60, v52
    v_sub_f32 v61, v61, v52
    v_sub_f32 v62, v62, v52
    v_sub_f32 v63, v63, v52
    v_sub_f32 v40, v40, v52
    v_sub_f32 v41, v41, v52
    v_exp_f32 v56, v56
    v_exp_f32 v57, v57
    v_exp_f32 v58, v58
    v_exp_f32 v59, v59
    v_exp_f32 v60, v60
    v_exp_f32 v61, v61
    v_exp_f32 v62, v62
    v_exp_f32 v63, v63
    v_exp_f32 v40, v40
    v_exp_f32 v41, v41
    v_cvt_pk_bf16_f32 v28, v56, v57
    v_cvt_pk_bf16_f32 v29, v58, v59
    v_cvt_pk_bf16_f32 v30, v60, v61
    v_cvt_pk_bf16_f32 v31, v62, v63
    v_cvt_pk_bf16_f32 v48, v40, v41
    v_cvt_pk_bf16_f32 v51, v40, v41
    v_mfma_f32_16x16x32_bf16 v[52:55], v[44:47], v[28:31], 0
    v_mfma_f32_16x16x32_bf16 v[56:59], v[16:19], v[28:31], 0
    v_mfma_f32_16x16x32_bf16 v[60:63], v[20:23], v[28:31], 0
    v_mfma_f32_16x16x16_bf16 v[52:55], v[44:45], v[48:49], v[52:55]
    v_mfma_f32_16x16x16_bf16 v[56:59], v[26:27], v[48:49], v[56:59]
    v_mfma_f32_16x16x16_bf16 v[60:63], v[26:27], v[50:51], v[60:63]
    v_rcp_f32 v52, v52
    s_nop 2
    v_cndmask_b32 v56, v56, v58, s[76:77]
    v_cndmask_b32 v57, v57, v59, s[76:77]
    v_pk_mul_f32 v[56:57], v[56:57], v[52:53] op_sel_hi:[1,0]
    s_nop 0
    v_cndmask_b32 v60, v60, v62, s[76:77]
    v_cndmask_b32 v61, v61, v63, s[76:77]
    v_pk_mul_f32 v[60:61], v[60:61], v[52:53] op_sel_hi:[1,0]
    v_cvt_pk_bf16_f32 v58, v56, v60
    v_cvt_pk_bf16_f32 v59, v57, v61
    ds_write_b64 v2, v[58:59] offset:4096
    v_mov_b32_dpp v28, v58 quad_perm:[0,1,0,1] row_mask:0xf bank_mask:0xf
    v_mov_b32_dpp v29, v59 quad_perm:[0,1,0,1] row_mask:0xf bank_mask:0xf
    v_mov_b32_dpp v30, v58 quad_perm:[2,3,2,3] row_mask:0xf bank_mask:0xf
    v_mov_b32_dpp v31, v59 quad_perm:[2,3,2,3] row_mask:0xf bank_mask:0xf
    v_mov_b64 v[96:97], 0
    v_mov_b64 v[98:99], 0
    v_mov_b64 v[100:101], 0
    v_mov_b64 v[102:103], 0
    v_mov_b64 v[104:105], 0
    v_mov_b64 v[106:107], 0
    v_mov_b64 v[108:109], 0
    v_mov_b64 v[110:111], 0
    s_nop 7
    s_branch L_rj_57
L_ent_s1:
    ds_read_b128 v[64:67], v1 offset:4096
    ds_read_b128 v[68:71], v1 offset:5120
    ds_read_b128 v[72:75], v1 offset:6144
    ds_read_b128 v[76:79], v1 offset:7168
    ds_read_b128 v[80:83], v1 offset:0
    ds_read_b128 v[84:87], v1 offset:1024
    ds_read_b128 v[88:91], v1 offset:2048
    ds_read_b128 v[92:95], v1 offset:3072
    ds_read_b128 v[96:99], v1 offset:12288
    ds_read_b128 v[100:103], v1 offset:13312
    ds_read_b128 v[104:107], v1 offset:14336
    ds_read_b128 v[108:111], v1 offset:15360
    ds_read_b128 v[112:115], v1 offset:8192
    ds_read_b128 v[116:119], v1 offset:9216
    ds_read_b128 v[120:123], v1 offset:10240
    ds_read_b128 v[124:127], v1 offset:11264
    ds_read_b128 v[56:59], v0 offset:2048
    ds_read_b128 v[60:63], v0 offset:3072
    s_waitcnt lgkmcnt(0)
    v_smfmac_f32_16x16x64_bf16 v[24:27], v[56:59], v[64:71], v10
    v_smfmac_f32_16x16x64_bf16 v[24:27], v[60:63], v[72:79], v10
    s_branch L_top_s1
L_p2_s1:
    buffer_load_dwordx4 v[56:59], v0, s[28:31], s55 offen sc1
    buffer_load_dwordx4 v[60:63], v0, s[28:31], s55 offen offset:1024 sc1
    s_add_u32 s58, s58, 4096
    s_cbranch_scc1 L_tabort
    s_nop 1
    s_nop 0
    v_mov_b64 v[24:25], 0
    v_mov_b64 v[26:27], 0
L_p2e_s1:
    s_waitcnt vmcnt(3)
    v_max3_u32 v37, v56, v57, v58
    v_max_u32 v37, v37, v59
    v_smfmac_f32_16x16x64_bf16 v[24:27], v[56:59], v[64:71], v10
    ds_write_b128 v0, v[56:59] offset:2048
    s_waitcnt vmcnt(2)
    v_max3_u32 v37, v37, v60, v61
    v_max3_u32 v37, v37, v62, v63
    v_cmp_eq_u32 vcc, -1, v37
    v_smfmac_f32_16x16x64_bf16 v[24:27], v[60:63], v[72:79], v10
    s_cbranch_vccnz L_p2_s1
L_top_s1:
    v_mov_b64 v[64:65], 0
    v_smfmac_f32_16x16x64_bf16 v[28:31], v[56:59], v[208:215], v10
    ds_write_b128 v0, v[60:63] offset:3072
    v_mov_b64 v[66:67], 0
    v_smfmac_f32_16x16x64_bf16 v[28:31], v[60:63], v[216:223], v10
    buffer_load_dwordx4 v[16:19], v0, s[28:31], s78 offen
    v_mov_b64 v[72:73], 0
    v_smfmac_f32_16x16x64_bf16 v[64:67], v[56:59], v[144:151], v10
    buffer_load_dwordx4 v[20:23], v0, s[28:31], s78 offen offset:1024
    v_mov_b64 v[74:75], 0
    v_smfmac_f32_16x16x64_bf16 v[64:67], v[60:63], v[152:159], v10
    s_waitcnt lgkmcnt(0)
    s_barrier
    ds_read_b128 v[32:35], v0 offset:0
    ds_read_b128 v[36:39], v0 offset:1024
    v_mov_b64 v[76:77], 0
    v_smfmac_f32_16x16x64_bf16 v[72:75], v[56:59], a[160:167], v10
    ds_read_b128 v[40:43], v0 offset:6144
    v_mov_b64 v[78:79], 0
    v_smfmac_f32_16x16x64_bf16 v[72:75], v[60:63], a[176:183], v10
    ds_read_b128 v[44:47], v0 offset:7168
    buffer_store_dwordx2 v[52:53], v6, s[28:31], s72 offen offset:0 sc1
    v_smfmac_f32_16x16x64_bf16 v[76:79], v[56:59], a[168:175], v10
    ds_read_b128 v[48:51], v0 offset:4096
    v_smfmac_f32_16x16x64_bf16 v[76:79], v[60:63], a[184:191], v10
    buffer_store_dwordx2 v[54:55], v6, s[28:31], s72 offen offset:512 sc1
    s_waitcnt lgkmcnt(3)
    v_smfmac_f32_16x16x64_bf16 v[24:27], v[32:35], v[80:87], v10
    ds_read_b128 v[52:55], v0 offset:5120
    ds_read_b128 v[80:83], v1 offset:20480
    v_smfmac_f32_16x16x64_bf16 v[24:27], v[36:39], v[88:95], v10
    ds_read_b128 v[84:87], v1 offset:21504
    s_waitcnt lgkmcnt(3)
    v_smfmac_f32_16x16x64_bf16 v[24:27], v[40:43], v[96:103], v10
    ds_read_b128 v[88:91], v1 offset:22528
    v_mov_b64 v[68:69], 0
    v_smfmac_f32_16x16x64_bf16 v[24:27], v[44:47], v[104:111], v10
    ds_read_b128 v[92:95], v1 offset:23552
    v_mov_b64 v[70:71], 0
    v_smfmac_f32_16x16x64_bf16 v[24:27], v[48:51], v[112:119], v10
    ds_read_b128 v[96:99], v1 offset:16384
    s_waitcnt lgkmcnt(5)
    v_smfmac_f32_16x16x64_bf16 v[24:27], v[52:55], v[120:127], v10
    ds_read_b128 v[100:103], v1 offset:17408
    v_smfmac_f32_16x16x64_bf16 v[28:31], v[32:35], v[192:199], v10
    ds_read_b128 v[104:107], v1 offset:18432
    v_smfmac_f32_16x16x64_bf16 v[28:31], v[36:39], v[200:207], v10
    ds_read_b128 v[108:111], v1 offset:19456
    v_add_f32 v24, v24, v26
    v_smfmac_f32_16x16x64_bf16 v[28:31], v[40:43], v[240:247], v10
    ds_read_b128 v[112:115], v1 offset:28672
    v_add_f32 v25, v25, v27
    v_smfmac_f32_16x16x64_bf16 v[28:31], v[44:47], v[248:255], v10
    ds_read_b128 v[116:119], v1 offset:29696
    v_mul_f32 v24, s59, v24
    v_smfmac_f32_16x16x64_bf16 v[28:31], v[48:51], v[224:231], v10
    ds_read_b128 v[120:123], v1 offset:30720
    v_mul_f32 v25, s59, v25
    v_smfmac_f32_16x16x64_bf16 v[28:31], v[52:55], v[232:239], v10
    ds_read_b128 v[124:127], v1 offset:31744
    s_cmp_lg_u64 s[60:61], -1
    s_cbranch_scc1 L_rf_64
L_rb_65:
    s_waitcnt lgkmcnt(6)
    v_smfmac_f32_16x16x64_bf16 v[68:71], v[56:59], v[80:87], v10
    ds_read_b128 v[80:83], v1 offset:24576
    v_smfmac_f32_16x16x64_bf16 v[68:71], v[60:63], v[88:95], v10
    ds_read_b128 v[84:87], v1 offset:25600
    v_add_f32 v28, v28, v30
    v_smfmac_f32_16x16x64_bf16 v[68:71], v[32:35], v[96:103], v10
    ds_read_b128 v[88:91], v1 offset:26624
    s_waitcnt lgkmcnt(5)
    v_add_f32 v29, v29, v31
    v_smfmac_f32_16x16x64_bf16 v[68:71], v[36:39], v[104:111], v10
    ds_read_b128 v[92:95], v1 offset:27648
    v_mul_f32 v28, s59, v28
    v_smfmac_f32_16x16x64_bf16 v[68:71], v[40:43], v[112:119], v10
    ds_read_b128 v[96:99], v11 offset:8192
    s_waitcnt lgkmcnt(5)
    v_mul_f32 v29, s59, v29
    v_smfmac_f32_16x16x64_bf16 v[68:71], v[44:47], v[120:127], v10
    ds_read_b128 v[100:103], v11 offset:9216
    v_cvt_pk_bf16_f32 v24, v24, v28
    v_smfmac_f32_16x16x64_bf16 v[64:67], v[32:35], v[128:135], v10
    ds_read_b128 v[104:107], v11 offset:12288
    v_cvt_pk_bf16_f32 v25, v25, v29
    v_smfmac_f32_16x16x64_bf16 v[64:67], v[36:39], v[136:143], v10
    ds_write2_b32 v3, v24, v25 offset0:0 offset1:4
    v_mov_b64 v[28:29], -1
    v_smfmac_f32_16x16x64_bf16 v[64:67], v[40:43], v[176:183], v10
    ds_read_b128 v[108:111], v11 offset:13312
    s_waitcnt lgkmcnt(5)
    v_mov_b64 v[30:31], -1
    v_smfmac_f32_16x16x64_bf16 v[68:71], v[48:51], v[80:87], v10
    ds_read_b128 v[112:115], v11 offset:16384
    v_smfmac_f32_16x16x64_bf16 v[68:71], v[52:55], v[88:95], v10
    ds_read_b128 v[116:119], v11 offset:17408
    buffer_store_dword v28, v5, s[28:31], s69 offen sc1
    v_smfmac_f32_16x16x64_bf16 v[64:67], v[44:47], v[184:191], v10
    ds_read_b128 v[120:123], v11 offset:20480
    v_smfmac_f32_16x16x64_bf16 v[64:67], v[48:51], v[160:167], v10
    ds_read_b128 v[124:127], v11 offset:21504
    s_waitcnt lgkmcnt(5)
    s_barrier
    ds_read_b128 v[80:83], v4 offset:0
    v_smfmac_f32_16x16x64_bf16 v[64:67], v[52:55], v[168:175], v10
    ds_read_b128 v[84:87], v4 offset:1024
    v_add_f32 v68, v68, v70
    v_smfmac_f32_16x16x64_bf16 v[72:75], v[32:35], a[128:135], v10
    ds_read_b128 v[88:91], v4 offset:2048
    v_add_f32 v69, v69, v71
    v_smfmac_f32_16x16x64_bf16 v[76:79], v[32:35], a[136:143], v10
    ds_read_b128 v[92:95], v4 offset:3072
    v_add_f32 v64, v64, v66
    v_smfmac_f32_16x16x64_bf16 v[72:75], v[36:39], a[144:151], v10
    s_waitcnt vmcnt(5)
    v_add_f32 v65, v65, v67
    v_smfmac_f32_16x16x64_bf16 v[76:79], v[36:39], a[152:159], v10
    buffer_store_dwordx4 v[28:31], v0, s[28:31], s67 offen sc1
    s_waitcnt lgkmcnt(3)
    v_cvt_pk_bf16_f32 v24, v64, v68
    v_mfma_f32_16x16x32_bf16 v[56:59], v[96:99], v[80:83], 0
    s_waitcnt lgkmcnt(2)
    v_cvt_pk_bf16_f32 v25, v65, v69
    v_mfma_f32_16x16x32_bf16 v[56:59], v[100:103], v[84:87], v[56:59]
    ds_write2_b32 v3, v24, v25 offset0:128 offset1:132
    s_waitcnt lgkmcnt(2)
    v_mfma_f32_16x16x32_bf16 v[56:59], v[104:107], v[88:91], v[56:59]
    s_waitcnt lgkmcnt(1)
    v_mfma_f32_16x16x32_bf16 v[56:59], v[108:111], v[92:95], v[56:59]
    buffer_store_dwordx4 v[28:31], v0, s[28:31], s67 offen offset:1024 sc1
    v_mfma_f32_16x16x32_bf16 v[60:63], v[112:115], v[80:83], 0
    v_mov_b64 v[96:97], 0
    v_mov_b64 v[98:99], 0
    v_mfma_f32_16x16x32_bf16 v[60:63], v[116:119], v[84:87], v[60:63]
    v_exp_f32 v56, v56
    v_mov_b64 v[100:101], 0
    v_mfma_f32_16x16x32_bf16 v[60:63], v[120:123], v[88:91], v[60:63]
    v_mov_b64 v[102:103], 0
    v_mov_b64 v[104:105], 0
    v_mfma_f32_16x16x32_bf16 v[60:63], v[124:127], v[92:95], v[60:63]
    s_waitcnt lgkmcnt(0)
    s_barrier
    ds_read_b128 v[64:67], v4 offset:512
    v_exp_f32 v57, v57
    v_exp_f32 v58, v58
    v_smfmac_f32_16x16x64_bf16 v[72:75], v[40:43], a[224:231], v10
    ds_read_b128 v[68:71], v4 offset:1536
    v_cvt_pk_bf16_f32 v28, v56, v57
    v_smfmac_f32_16x16x64_bf16 v[76:79], v[40:43], a[232:239], v10
    ds_read_b128 v[32:35], v4 offset:2560
    v_mov_b64 v[106:107], 0
    v_smfmac_f32_16x16x64_bf16 v[72:75], v[44:47], a[240:247], v10
    ds_read_b128 v[36:39], v4 offset:3584
    buffer_load_dwordx4 v0, s[28:31], s71 offen lds
    v_exp_f32 v59, v59
    v_smfmac_f32_16x16x64_bf16 v[76:79], v[44:47], a[248:255], v10
    buffer_load_dwordx4 v0, s[28:31], s71 offen offset:1024 lds
    v_exp_f32 v60, v60
    v_smfmac_f32_16x16x64_bf16 v[72:75], v[48:51], a[192:199], v10
    s_waitcnt lgkmcnt(2)
    v_cvt_pk_bf16_f32 v29, v58, v59
    v_mfma_f32_16x16x32_bf16 v[40:43], v[64:67], v[80:83], 0
    v_exp_f32 v61, v61
    v_mov_b64 v[44:45], s[62:63]
    v_mfma_f32_16x16x32_bf16 v[40:43], v[68:71], v[84:87], v[40:43]
    s_waitcnt lgkmcnt(0)
    v_exp_f32 v62, v62
    v_mov_b64 v[46:47], s[62:63]
    v_mov_b64 v[108:109], 0
    v_mfma_f32_16x16x32_bf16 v[40:43], v[32:35], v[88:91], v[40:43]
    v_exp_f32 v63, v63
    v_cvt_pk_bf16_f32 v30, v60, v61
    v_mfma_f32_16x16x32_bf16 v[40:43], v[36:39], v[92:95], v[40:43]
    v_cvt_pk_bf16_f32 v31, v62, v63
    v_mov_b64 v[110:111], 0
    v_smfmac_f32_16x16x64_bf16 v[76:79], v[48:51], a[200:207], v10
    v_mov_b32 v49, 0
    v_smfmac_f32_16x16x64_bf16 v[72:75], v[52:55], a[208:215], v10
    s_waitcnt vmcnt(7)
    v_exp_f32 v40, v40
    v_smfmac_f32_16x16x64_bf16 v[76:79], v[52:55], a[216:223], v10
    v_exp_f32 v41, v41
    v_mfma_f32_16x16x32_bf16 v[52:55], v[44:47], v[28:31], 0
    v_add_f32 v72, v72, v74
    v_cvt_pk_bf16_f32 v48, v40, v41
    v_mfma_f32_16x16x32_bf16 v[56:59], v[16:19], v[28:31], 0
    v_add_f32 v73, v73, v75
    v_add_f32 v76, v76, v78
    v_mfma_f32_16x16x16_bf16 v[52:55], v[44:45], v[48:49], v[52:55]
    v_add_f32 v77, v77, v79
    v_cvt_pk_bf16_f32 v26, v72, v73
    v_cvt_pk_bf16_f32 v27, v76, v77
    v_mfma_f32_16x16x32_bf16 v[60:63], v[20:23], v[28:31], 0
    v_cvt_pk_bf16_f32 v51, v40, v41
    v_mov_b32 v50, 0
    v_mfma_f32_16x16x16_bf16 v[56:59], v[26:27], v[48:49], v[56:59]
    v_subrev_u32 v53, s79, v52
    v_rcp_f32 v52, v52
    v_mfma_f32_16x16x16_bf16 v[60:63], v[26:27], v[50:51], v[60:63]
    v_cmp_lt_u32 vcc, s100, v53
    s_nop 2
    v_cndmask_b32 v56, v56, v58, s[76:77]
    v_cndmask_b32 v57, v57, v59, s[76:77]
    v_pk_mul_f32 v[56:57], v[56:57], v[52:53] op_sel_hi:[1,0]
    s_nop 0
    v_cndmask_b32 v60, v60, v62, s[76:77]
    v_cndmask_b32 v61, v61, v63, s[76:77]
    v_pk_mul_f32 v[60:61], v[60:61], v[52:53] op_sel_hi:[1,0]
    v_cvt_pk_bf16_f32 v58, v56, v60
    v_cvt_pk_bf16_f32 v59, v57, v61
    ds_write_b64 v2, v[58:59] offset:4608
    v_mov_b32_dpp v28, v58 quad_perm:[0,1,0,1] row_mask:0xf bank_mask:0xf
    v_mov_b32_dpp v29, v59 quad_perm:[0,1,0,1] row_mask:0xf bank_mask:0xf
    v_mov_b32_dpp v30, v58 quad_perm:[2,3,2,3] row_mask:0xf bank_mask:0xf
    v_mov_b32_dpp v31, v59 quad_perm:[2,3,2,3] row_mask:0xf bank_mask:0xf
    s_cbranch_vccnz L_fb_67
L_rj_66:
    s_nop 0
    v_smfmac_f32_16x16x64_bf16 v[96:99], v[28:31], a[8:15], v10
    v_mov_b64 v[52:53], v[24:25]
    v_smfmac_f32_16x16x64_bf16 v[100:103], v[28:31], a[40:47], v10
    s_waitcnt lgkmcnt(0)
    s_barrier
    ds_read_b128 v[32:35], v4 offset:4096
    ds_read_b128 v[36:39], v4 offset:5632
    ds_read_b128 v[40:43], v4 offset:5120
    v_smfmac_f32_16x16x64_bf16 v[104:107], v[28:31], a[72:79], v10
    v_mov_b64 v[54:55], v[26:27]
    v_smfmac_f32_16x16x64_bf16 v[108:111], v[28:31], a[104:111], v10
    s_waitcnt lgkmcnt(2)
    v_smfmac_f32_16x16x64_bf16 v[96:99], v[32:35], a[0:7], v10
    s_waitcnt lgkmcnt(1)
    v_smfmac_f32_16x16x64_bf16 v[96:99], v[36:39], a[24:31], v10
    s_waitcnt lgkmcnt(0)
    v_smfmac_f32_16x16x64_bf16 v[96:99], v[40:43], a[16:23], v10
    ds_read_b128 v[64:67], v1 offset:4096
    v_mov_b64 v[24:25], 0
    v_smfmac_f32_16x16x64_bf16 v[100:103], v[32:35], a[32:39], v10
    ds_read_b128 v[68:71], v1 offset:5120
    v_mov_b64 v[26:27], 0
    v_smfmac_f32_16x16x64_bf16 v[100:103], v[36:39], a[56:63], v10
    v_cvt_pk_bf16_f32 v96, v96, v98
    v_cvt_pk_bf16_f32 v97, v97, v99
    v_smfmac_f32_16x16x64_bf16 v[100:103], v[40:43], a[48:55], v10
    buffer_store_dwordx2 v[96:97], v7, s[28:31], s47 offen sc1
    v_smfmac_f32_16x16x64_bf16 v[104:107], v[32:35], a[64:71], v10
    ds_read_b128 v[72:75], v1 offset:6144
    v_mov_b64 v[28:29], 0
    v_smfmac_f32_16x16x64_bf16 v[104:107], v[36:39], a[88:95], v10
    v_cvt_pk_bf16_f32 v100, v100, v102
    v_cvt_pk_bf16_f32 v101, v101, v103
    v_smfmac_f32_16x16x64_bf16 v[104:107], v[40:43], a[80:87], v10
    buffer_store_dwordx2 v[100:101], v7, s[28:31], s48 offen sc1
    v_smfmac_f32_16x16x64_bf16 v[108:111], v[32:35], a[96:103], v10
    ds_read_b128 v[76:79], v1 offset:7168
    v_mov_b64 v[30:31], 0
    v_smfmac_f32_16x16x64_bf16 v[108:111], v[36:39], a[120:127], v10
    v_cvt_pk_bf16_f32 v104, v104, v106
    v_cvt_pk_bf16_f32 v105, v105, v107
    v_smfmac_f32_16x16x64_bf16 v[108:111], v[40:43], a[112:119], v10
    buffer_store_dwordx2 v[104:105], v7, s[28:31], s49 offen sc1
    s_nop 6
    v_cvt_pk_bf16_f32 v108, v108, v110
    v_cvt_pk_bf16_f32 v109, v109, v111
    buffer_store_dwordx2 v[108:109], v7, s[28:31], s50 offen sc1
    ds_read_b128 v[80:83], v1 offset:0
    ds_read_b128 v[84:87], v1 offset:1024
    ds_read_b128 v[88:91], v1 offset:2048
    ds_read_b128 v[92:95], v1 offset:3072
    ds_read_b128 v[112:115], v1 offset:8192
    ds_read_b128 v[116:119], v1 offset:9216
    ds_read_b128 v[120:123], v1 offset:10240
    ds_read_b128 v[124:127], v1 offset:11264
    ds_read_b128 v[96:99], v1 offset:12288
    ds_read_b128 v[100:103], v1 offset:13312
    s_add_u32 s64, s64, 1
    s_add_u32 s71, s71, 262144
    ds_read_b128 v[104:107], v1 offset:14336
    s_add_u32 s78, s78, 262144
    s_add_u32 s72, s72, 131072
    ds_read_b128 v[108:111], v1 offset:15360
    s_xor_b32 m0, m0, 0x800
    v_xor_b32 v11, 0x800, v11
    s_add_u32 s55, s68, s101
    s_nop 3
    s_nop 3
    s_nop 3
    s_nop 3
    buffer_load_dwordx4 v[40:43], v0, s[28:31], s66 offen sc1
    buffer_load_dwordx4 v[44:47], v0, s[28:31], s66 offen offset:1024 sc1
    s_mov_b32 s58, 0
    s_branch L_p1e_69
L_p1_68:
    buffer_load_dwordx4 v[40:43], v0, s[28:31], s66 offen sc1
    buffer_load_dwordx4 v[44:47], v0, s[28:31], s66 offen offset:1024 sc1
    s_add_u32 s58, s58, 4096
    s_cbranch_scc1 L_tabort
L_p1e_69:
    s_waitcnt vmcnt(1)
    v_max3_u32 v36, v40, v41, v42
    v_max_u32 v36, v36, v43
    v_mfma_f32_16x16x32_bf16 v[32:35], v[12:15], v[40:43], 0
    s_waitcnt vmcnt(0)
    v_max3_u32 v36, v36, v44, v45
    v_max3_u32 v36, v36, v46, v47
    v_mfma_f32_16x16x32_bf16 v[32:35], v[12:15], v[44:47], v[32:35]
    v_cmp_eq_u32 vcc, -1, v36
    s_cbranch_vccnz L_p1_68
    s_nop 5
    v_add_f32_dpp v32, v32, v32 row_ror:4 row_mask:0xf bank_mask:0xf
    v_add_f32_dpp v33, v33, v33 row_ror:4 row_mask:0xf bank_mask:0xf
    s_nop 0
    v_add_f32_dpp v32, v32, v32 row_ror:8 row_mask:0xf bank_mask:0xf
    v_add_f32_dpp v33, v33, v33 row_ror:8 row_mask:0xf bank_mask:0xf
    v_cvt_pk_bf16_f32 v32, v32, v33
    buffer_store_dword v32, v5, s[28:31], s68 offen sc1
    s_waitcnt lgkmcnt(0)
    s_barrier
    s_nop 12
    buffer_load_dwordx4 v[56:59], v0, s[28:31], s55 offen sc1
    buffer_load_dwordx4 v[60:63], v0, s[28:31], s55 offen offset:1024 sc1
    s_xor_b32 s66, s66, 0xc0000
    s_xor_b32 s67, s67, 0xc0000
    s_mov_b32 s54, s68
    s_mov_b32 s68, s69
    s_mov_b32 s69, s70
    s_mov_b32 s70, s54
    s_xor_b32 s47, s47, 0xc0000
    s_xor_b32 s48, s48, 0xc0000
    s_xor_b32 s49, s49, 0xc0000
    s_xor_b32 s50, s50, 0xc0000
    s_add_u32 s54, s64, 1
    s_min_u32 s54, s54, 63
    s_mov_b32 s58, 0
L_kvp_71:
    v_cmp_eq_u64 s[60:61], s[42:43], v[8:9]
    s_nop 1
    s_bitcmp1_b64 s[60:61], s54
    s_cbranch_scc1 L_kvok_70
    buffer_load_dwordx2 v[8:9], v6, s[28:31], s74 offen sc1
    s_waitcnt vmcnt(0)
    s_add_u32 s58, s58, 1
    s_cmp_lt_u32 s58, 1048576
    s_cbranch_scc1 L_kvp_71
    s_branch L_abort
L_kvok_70:
    s_mov_b32 s58, 0
    s_nop 7
    buffer_load_dwordx4 v[56:59], v0, s[28:31], s55 offen sc1
    buffer_load_dwordx4 v[60:63], v0, s[28:31], s55 offen offset:1024 sc1
    s_cmp_eq_u32 s64, 63
    s_cbranch_scc0 L_p2e_s1
    s_branch L_last_e
L_rf_64:
    buffer_load_dwordx2 v[8:9], v6, s[28:31], s74 offen sc1
    s_branch L_rb_65
L_fb_67:
    ds_read_b128 v[96:99], v11 offset:8192
    ds_read_b128 v[100:103], v11 offset:9216
    ds_read_b128 v[104:107], v11 offset:12288
    ds_read_b128 v[108:111], v11 offset:13312
    s_waitcnt lgkmcnt(0)
    s_nop 7
    v_mfma_f32_16x16x32_bf16 v[56:59], v[96:99], v[80:83], 0
    v_mfma_f32_16x16x32_bf16 v[56:59], v[100:103], v[84:87], v[56:59]
    v_mfma_f32_16x16x32_bf16 v[56:59], v[104:107], v[88:91], v[56:59]
    v_mfma_f32_16x16x32_bf16 v[56:59], v[108:111], v[92:95], v[56:59]
    v_mfma_f32_16x16x32_bf16 v[60:63], v[112:115], v[80:83], 0
    v_mfma_f32_16x16x32_bf16 v[60:63], v[116:119], v[84:87], v[60:63]
    v_mfma_f32_16x16x32_bf16 v[60:63], v[120:123], v[88:91], v[60:63]
    v_mfma_f32_16x16x32_bf16 v[60:63], v[124:127], v[92:95], v[60:63]
    v_mfma_f32_16x16x32_bf16 v[40:43], v[64:67], v[80:83], 0
    v_mfma_f32_16x16x32_bf16 v[40:43], v[68:71], v[84:87], v[40:43]
    v_mfma_f32_16x16x32_bf16 v[40:43], v[32:35], v[88:91], v[40:43]
    v_mfma_f32_16x16x32_bf16 v[40:43], v[36:39], v[92:95], v[40:43]
    v_max3_f32 v52, v56, v57, v58
    v_max3_f32 v53, v59, v60, v61
    v_max3_f32 v52, v52, v62, v63
    s_nop 4
    v_max3_f32 v53, v53, v40, v41
    v_max_f32 v52, v52, v53
    v_mov_b32 v53, v52
    s_nop 1
    v_permlane16_swap_b32 v52, v53
    v_max_f32 v52, v52, v53
    v_mov_b32 v53, v52
    s_nop 1
    v_permlane32_swap_b32 v52, v53
    v_max_f32 v52, v52, v53
    v_sub_f32 v56, v56, v52
    v_sub_f32 v57, v57, v52
    v_sub_f32 v58, v58, v52
    v_sub_f32 v59, v59, v52
    v_sub_f32 v60, v60, v52
    v_sub_f32 v61, v61, v52
    v_sub_f32 v62, v62, v52
    v_sub_f32 v63, v63, v52
    v_sub_f32 v40, v40, v52
    v_sub_f32 v41, v41, v52
    v_exp_f32 v56, v56
    v_exp_f32 v57, v57
    v_exp_f32 v58, v58
    v_exp_f32 v59, v59
    v_exp_f32 v60, v60
    v_exp_f32 v61, v61
    v_exp_f32 v62, v62
    v_exp_f32 v63, v63
    v_exp_f32 v40, v40
    v_exp_f32 v41, v41
    v_cvt_pk_bf16_f32 v28, v56, v57
    v_cvt_pk_bf16_f32 v29, v58, v59
    v_cvt_pk_bf16_f32 v30, v60, v61
    v_cvt_pk_bf16_f32 v31, v62, v63
    v_cvt_pk_bf16_f32 v48, v40, v41
    v_cvt_pk_bf16_f32 v51, v40, v41
    v_mfma_f32_16x16x32_bf16 v[52:55], v[44:47], v[28:31], 0
    v_mfma_f32_16x16x32_bf16 v[56:59], v[16:19], v[28:31], 0
    v_mfma_f32_16x16x32_bf16 v[60:63], v[20:23], v[28:31], 0
    v_mfma_f32_16x16x16_bf16 v[52:55], v[44:45], v[48:49], v[52:55]
    v_mfma_f32_16x16x16_bf16 v[56:59], v[26:27], v[48:49], v[56:59]
    v_mfma_f32_16x16x16_bf16 v[60:63], v[26:27], v[50:51], v[60:63]
    v_rcp_f32 v52, v52
    s_nop 2
    v_cndmask_b32 v56, v56, v58, s[76:77]
    v_cndmask_b32 v57, v57, v59, s[76:77]
    v_pk_mul_f32 v[56:57], v[56:57], v[52:53] op_sel_hi:[1,0]
    s_nop 0
    v_cndmask_b32 v60, v60, v62, s[76:77]
    v_cndmask_b32 v61, v61, v63, s[76:77]
    v_pk_mul_f32 v[60:61], v[60:61], v[52:53] op_sel_hi:[1,0]
    v_cvt_pk_bf16_f32 v58, v56, v60
    v_cvt_pk_bf16_f32 v59, v57, v61
    ds_write_b64 v2, v[58:59] offset:4608
    v_mov_b32_dpp v28, v58 quad_perm:[0,1,0,1] row_mask:0xf bank_mask:0xf
    v_mov_b32_dpp v29, v59 quad_perm:[0,1,0,1] row_mask:0xf bank_mask:0xf
    v_mov_b32_dpp v30, v58 quad_perm:[2,3,2,3] row_mask:0xf bank_mask:0xf
    v_mov_b32_dpp v31, v59 quad_perm:[2,3,2,3] row_mask:0xf bank_mask:0xf
    v_mov_b64 v[96:97], 0
    v_mov_b64 v[98:99], 0
    v_mov_b64 v[100:101], 0
    v_mov_b64 v[102:103], 0
    v_mov_b64 v[104:105], 0
    v_mov_b64 v[106:107], 0
    v_mov_b64 v[108:109], 0
    v_mov_b64 v[110:111], 0
    s_nop 7
    s_branch L_rj_66
L_ent_s2:
    ds_read_b128 v[64:67], v1 offset:8192
    ds_read_b128 v[68:71], v1 offset:9216
    ds_read_b128 v[72:75], v1 offset:10240
    ds_read_b128 v[76:79], v1 offset:11264
    ds_read_b128 v[80:83], v1 offset:12288
    ds_read_b128 v[84:87], v1 offset:13312
    ds_read_b128 v[88:91], v1 offset:14336
    ds_read_b128 v[92:95], v1 offset:15360
    ds_read_b128 v[96:99], v1 offset:0
    ds_read_b128 v[100:103], v1 offset:1024
    ds_read_b128 v[104:107], v1 offset:2048
    ds_read_b128 v[108:111], v1 offset:3072
    ds_read_b128 v[112:115], v1 offset:4096
    ds_read_b128 v[116:119], v1 offset:5120
    ds_read_b128 v[120:123], v1 offset:6144
    ds_read_b128 v[124:127], v1 offset:7168
    ds_read_b128 v[56:59], v0 offset:4096
    ds_read_b128 v[60:63], v0 offset:5120
    s_waitcnt lgkmcnt(0)
    v_smfmac_f32_16x16x64_bf16 v[24:27], v[56:59], v[64:71], v10
    v_smfmac_f32_16x16x64_bf16 v[24:27], v[60:63], v[72:79], v10
    s_branch L_top_s2
L_p2_s2:
    buffer_load_dwordx4 v[56:59], v0, s[28:31], s55 offen sc1
    buffer_load_dwordx4 v[60:63], v0, s[28:31], s55 offen offset:1024 sc1
    s_add_u32 s58, s58, 4096
    s_cbranch_scc1 L_tabort
    s_nop 1
    s_nop 0
    v_mov_b64 v[24:25], 0
    v_mov_b64 v[26:27], 0
L_p2e_s2:
    s_waitcnt vmcnt(3)
    v_max3_u32 v37, v56, v57, v58
    v_max_u32 v37, v37, v59
    v_smfmac_f32_16x16x64_bf16 v[24:27], v[56:59], v[64:71], v10
    ds_write_b128 v0, v[56:59] offset:4096
    s_waitcnt vmcnt(2)
    v_max3_u32 v37, v37, v60, v61
    v_max3_u32 v37, v37, v62, v63
    v_cmp_eq_u32 vcc, -1, v37
    v_smfmac_f32_16x16x64_bf16 v[24:27], v[60:63], v[72:79], v10
    s_cbranch_vccnz L_p2_s2
L_top_s2:
    v_mov_b64 v[64:65], 0
    v_smfmac_f32_16x16x64_bf16 v[28:31], v[56:59], v[224:231], v10
    ds_write_b128 v0, v[60:63] offset:5120
    v_mov_b64 v[66:67], 0
    v_smfmac_f32_16x16x64_bf16 v[28:31], v[60:63], v[232:239], v10
    buffer_load_dwordx4 v[16:19], v0, s[28:31], s78 offen
    v_mov_b64 v[72:73], 0
    v_smfmac_f32_16x16x64_bf16 v[64:67], v[56:59], v[160:167], v10
    buffer_load_dwordx4 v[20:23], v0, s[28:31], s78 offen offset:1024
    v_mov_b64 v[74:75], 0
    v_smfmac_f32_16x16x64_bf16 v[64:67], v[60:63], v[168:175], v10
    s_waitcnt lgkmcnt(0)
    s_barrier
    ds_read_b128 v[32:35], v0 offset:6144
    ds_read_b128 v[36:39], v0 offset:7168
    v_mov_b64 v[76:77], 0
    v_smfmac_f32_16x16x64_bf16 v[72:75], v[56:59], a[192:199], v10
    ds_read_b128 v[40:43], v0 offset:0
    v_mov_b64 v[78:79], 0
    v_smfmac_f32_16x16x64_bf16 v[72:75], v[60:63], a[208:215], v10
    ds_read_b128 v[44:47], v0 offset:1024
    v_smfmac_f32_16x16x64_bf16 v[76:79], v[56:59], a[200:207], v10
    ds_read_b128 v[48:51], v0 offset:2048
    buffer_store_dwordx2 v[52:53], v6, s[28:31], s72 offen offset:0 sc1
    v_smfmac_f32_16x16x64_bf16 v[76:79], v[60:63], a[216:223], v10
    s_waitcnt lgkmcnt(3)
    v_smfmac_f32_16x16x64_bf16 v[24:27], v[32:35], v[80:87], v10
    ds_read_b128 v[80:83], v1 offset:24576
    buffer_store_dwordx2 v[54:55], v6, s[28:31], s72 offen offset:512 sc1
    v_smfmac_f32_16x16x64_bf16 v[24:27], v[36:39], v[88:95], v10
    ds_read_b128 v[52:55], v0 offset:3072
    ds_read_b128 v[84:87], v1 offset:25600
    s_waitcnt lgkmcnt(3)
    v_smfmac_f32_16x16x64_bf16 v[24:27], v[40:43], v[96:103], v10
    ds_read_b128 v[88:91], v1 offset:26624
    v_mov_b64 v[68:69], 0
    v_smfmac_f32_16x16x64_bf16 v[24:27], v[44:47], v[104:111], v10
    ds_read_b128 v[92:95], v1 offset:27648
    v_mov_b64 v[70:71], 0
    v_smfmac_f32_16x16x64_bf16 v[24:27], v[48:51], v[112:119], v10
    ds_read_b128 v[96:99], v1 offset:28672
    s_waitcnt lgkmcnt(4)
    v_smfmac_f32_16x16x64_bf16 v[24:27], v[52:55], v[120:127], v10
    ds_read_b128 v[100:103], v1 offset:29696
    v_smfmac_f32_16x16x64_bf16 v[28:31], v[32:35], v[240:247], v10
    ds_read_b128 v[104:107], v1 offset:30720
    v_smfmac_f32_16x16x64_bf16 v[28:31], v[36:39], v[248:255], v10
    ds_read_b128 v[108:111], v1 offset:31744
    v_add_f32 v24, v24, v26
    v_smfmac_f32_16x16x64_bf16 v[28:31], v[40:43], v[192:199], v10
    ds_read_b128 v[112:115], v1 offset:16384
    v_add_f32 v25, v25, v27
    v_smfmac_f32_16x16x64_bf16 v[28:31], v[44:47], v[200:207], v10
    ds_read_b128 v[116:119], v1 offset:17408
    v_mul_f32 v24, s59, v24
    v_smfmac_f32_16x16x64_bf16 v[28:31], v[48:51], v[208:215], v10
    ds_read_b128 v[120:123], v1 offset:18432
    v_mul_f32 v25, s59, v25
    v_smfmac_f32_16x16x64_bf16 v[28:31], v[52:55], v[216:223], v10
    ds_read_b128 v[124:127], v1 offset:19456
    s_cmp_lg_u64 s[60:61], -1
    s_cbranch_scc1 L_rf_73
L_rb_74:
    s_waitcnt lgkmcnt(6)
    v_smfmac_f32_16x16x64_bf16 v[68:71], v[56:59], v[80:87], v10
    ds_read_b128 v[80:83], v1 offset:20480
    v_smfmac_f32_16x16x64_bf16 v[68:71], v[60:63], v[88:95], v10
    ds_read_b128 v[84:87], v1 offset:21504
    v_add_f32 v28, v28, v30
    v_smfmac_f32_16x16x64_bf16 v[68:71], v[32:35], v[96:103], v10
    ds_read_b128 v[88:91], v1 offset:22528
    s_waitcnt lgkmcnt(5)
    v_add_f32 v29, v29, v31
    v_smfmac_f32_16x16x64_bf16 v[68:71], v[36:39], v[104:111], v10
    ds_read_b128 v[92:95], v1 offset:23552
    v_mul_f32 v28, s59, v28
    v_smfmac_f32_16x16x64_bf16 v[68:71], v[40:43], v[112:119], v10
    ds_read_b128 v[96:99], v11 offset:8192
    s_waitcnt lgkmcnt(5)
    v_mul_f32 v29, s59, v29
    v_smfmac_f32_16x16x64_bf16 v[68:71], v[44:47], v[120:127], v10
    ds_read_b128 v[100:103], v11 offset:9216
    v_cvt_pk_bf16_f32 v24, v24, v28
    v_smfmac_f32_16x16x64_bf16 v[64:67], v[32:35], v[176:183], v10
    ds_read_b128 v[104:107], v11 offset:12288
    v_cvt_pk_bf16_f32 v25, v25, v29
    v_smfmac_f32_16x16x64_bf16 v[64:67], v[36:39], v[184:191], v10
    ds_write2_b32 v3, v24, v25 offset0:0 offset1:4
    v_mov_b64 v[28:29], -1
    v_smfmac_f32_16x16x64_bf16 v[64:67], v[40:43], v[128:135], v10
    ds_read_b128 v[108:111], v11 offset:13312
    s_waitcnt lgkmcnt(5)
    v_mov_b64 v[30:31], -1
    v_smfmac_f32_16x16x64_bf16 v[68:71], v[48:51], v[80:87], v10
    ds_read_b128 v[112:115], v11 offset:16384
    v_smfmac_f32_16x16x64_bf16 v[68:71], v[52:55], v[88:95], v10
    ds_read_b128 v[116:119], v11 offset:17408
    buffer_store_dword v28, v5, s[28:31], s69 offen sc1
    v_smfmac_f32_16x16x64_bf16 v[64:67], v[44:47], v[136:143], v10
    ds_read_b128 v[120:123], v11 offset:20480
    v_smfmac_f32_16x16x64_bf16 v[64:67], v[48:51], v[144:151], v10
    ds_read_b128 v[124:127], v11 offset:21504
    s_waitcnt lgkmcnt(5)
    s_barrier
    ds_read_b128 v[80:83], v4 offset:0
    v_smfmac_f32_16x16x64_bf16 v[64:67], v[52:55], v[152:159], v10
    ds_read_b128 v[84:87], v4 offset:1024
    v_add_f32 v68, v68, v70
    v_smfmac_f32_16x16x64_bf16 v[72:75], v[32:35], a[224:231], v10
    ds_read_b128 v[88:91], v4 offset:2048
    v_add_f32 v69, v69, v71
    v_smfmac_f32_16x16x64_bf16 v[76:79], v[32:35], a[232:239], v10
    ds_read_b128 v[92:95], v4 offset:3072
    v_add_f32 v64, v64, v66
    v_smfmac_f32_16x16x64_bf16 v[72:75], v[36:39], a[240:247], v10
    s_waitcnt vmcnt(5)
    v_add_f32 v65, v65, v67
    v_smfmac_f32_16x16x64_bf16 v[76:79], v[36:39], a[248:255], v10
    s_waitcnt lgkmcnt(3)
    v_cvt_pk_bf16_f32 v24, v64, v68
    v_mfma_f32_16x16x32_bf16 v[56:59], v[96:99], v[80:83], 0
    buffer_store_dwordx4 v[28:31], v0, s[28:31], s67 offen sc1
    s_waitcnt lgkmcnt(2)
    v_cvt_pk_bf16_f32 v25, v65, v69
    v_mfma_f32_16x16x32_bf16 v[56:59], v[100:103], v[84:87], v[56:59]
    ds_write2_b32 v3, v24, v25 offset0:128 offset1:132
    s_waitcnt lgkmcnt(2)
    v_mfma_f32_16x16x32_bf16 v[56:59], v[104:107], v[88:91], v[56:59]
    s_waitcnt lgkmcnt(1)
    v_mfma_f32_16x16x32_bf16 v[56:59], v[108:111], v[92:95], v[56:59]
    v_mfma_f32_16x16x32_bf16 v[60:63], v[112:115], v[80:83], 0
    buffer_store_dwordx4 v[28:31], v0, s[28:31], s67 offen offset:1024 sc1
    v_mov_b64 v[96:97], 0
    v_mov_b64 v[98:99], 0
    v_mfma_f32_16x16x32_bf16 v[60:63], v[116:119], v[84:87], v[60:63]
    v_exp_f32 v56, v56
    v_mov_b64 v[100:101], 0
    v_mfma_f32_16x16x32_bf16 v[60:63], v[120:123], v[88:91], v[60:63]
    v_mov_b64 v[102:103], 0
    v_mov_b64 v[104:105], 0
    v_mfma_f32_16x16x32_bf16 v[60:63], v[124:127], v[92:95], v[60:63]
    s_waitcnt lgkmcnt(0)
    s_barrier
    ds_read_b128 v[64:67], v4 offset:512
    v_exp_f32 v57, v57
    v_exp_f32 v58, v58
    v_smfmac_f32_16x16x64_bf16 v[72:75], v[40:43], a[128:135], v10
    ds_read_b128 v[68:71], v4 offset:1536
    v_cvt_pk_bf16_f32 v28, v56, v57
    v_smfmac_f32_16x16x64_bf16 v[76:79], v[40:43], a[136:143], v10
    ds_read_b128 v[32:35], v4 offset:2560
    v_mov_b64 v[106:107], 0
    v_smfmac_f32_16x16x64_bf16 v[72:75], v[44:47], a[144:151], v10
    ds_read_b128 v[36:39], v4 offset:3584
    buffer_load_dwordx4 v0, s[28:31], s71 offen lds
    v_exp_f32 v59, v59
    v_smfmac_f32_16x16x64_bf16 v[76:79], v[44:47], a[152:159], v10
    buffer_load_dwordx4 v0, s[28:31], s71 offen offset:1024 lds
    v_exp_f32 v60, v60
    v_smfmac_f32_16x16x64_bf16 v[72:75], v[48:51], a[160:167], v10
    s_waitcnt lgkmcnt(2)
    v_cvt_pk_bf16_f32 v29, v58, v59
    v_mfma_f32_16x16x32_bf16 v[40:43], v[64:67], v[80:83], 0
    v_exp_f32 v61, v61
    v_mov_b64 v[44:45], s[62:63]
    v_mfma_f32_16x16x32_bf16 v[40:43], v[68:71], v[84:87], v[40:43]
    s_waitcnt lgkmcnt(0)
    v_exp_f32 v62, v62
    v_mov_b64 v[46:47], s[62:63]
    v_mov_b64 v[108:109], 0
    v_mfma_f32_16x16x32_bf16 v[40:43], v[32:35], v[88:91], v[40:43]
    v_exp_f32 v63, v63
    v_cvt_pk_bf16_f32 v30, v60, v61
    v_mfma_f32_16x16x32_bf16 v[40:43], v[36:39], v[92:95], v[40:43]
    v_cvt_pk_bf16_f32 v31, v62, v63
    v_mov_b64 v[110:111], 0
    v_smfmac_f32_16x16x64_bf16 v[76:79], v[48:51], a[168:175], v10
    v_mov_b32 v49, 0
    v_smfmac_f32_16x16x64_bf16 v[72:75], v[52:55], a[176:183], v10
    s_waitcnt vmcnt(7)
    v_exp_f32 v40, v40
    v_smfmac_f32_16x16x64_bf16 v[76:79], v[52:55], a[184:191], v10
    v_exp_f32 v41, v41
    v_mfma_f32_16x16x32_bf16 v[52:55], v[44:47], v[28:31], 0
    v_add_f32 v72, v72, v74
    v_cvt_pk_bf16_f32 v48, v40, v41
    v_mfma_f32_16x16x32_bf16 v[56:59], v[16:19], v[28:31], 0
    v_add_f32 v73, v73, v75
    v_add_f32 v76, v76, v78
    v_mfma_f32_16x16x16_bf16 v[52:55], v[44:45], v[48:49], v[52:55]
    v_add_f32 v77, v77, v79
    v_cvt_pk_bf16_f32 v26, v72, v73
    v_cvt_pk_bf16_f32 v27, v76, v77
    v_mfma_f32_16x16x32_bf16 v[60:63], v[20:23], v[28:31], 0
    v_cvt_pk_bf16_f32 v51, v40, v41
    v_mov_b32 v50, 0
    v_mfma_f32_16x16x16_bf16 v[56:59], v[26:27], v[48:49], v[56:59]
    v_subrev_u32 v53, s79, v52
    v_rcp_f32 v52, v52
    v_mfma_f32_16x16x16_bf16 v[60:63], v[26:27], v[50:51], v[60:63]
    v_cmp_lt_u32 vcc, s100, v53
    s_nop 2
    v_cndmask_b32 v56, v56, v58, s[76:77]
    v_cndmask_b32 v57, v57, v59, s[76:77]
    v_pk_mul_f32 v[56:57], v[56:57], v[52:53] op_sel_hi:[1,0]
    s_nop 0
    v_cndmask_b32 v60, v60, v62, s[76:77]
    v_cndmask_b32 v61, v61, v63, s[76:77]
    v_pk_mul_f32 v[60:61], v[60:61], v[52:53] op_sel_hi:[1,0]
    v_cvt_pk_bf16_f32 v58, v56, v60
    v_cvt_pk_bf16_f32 v59, v57, v61
    ds_write_b64 v2, v[58:59] offset:5120
    v_mov_b32_dpp v28, v58 quad_perm:[0,1,0,1] row_mask:0xf bank_mask:0xf
    v_mov_b32_dpp v29, v59 quad_perm:[0,1,0,1] row_mask:0xf bank_mask:0xf
    v_mov_b32_dpp v30, v58 quad_perm:[2,3,2,3] row_mask:0xf bank_mask:0xf
    v_mov_b32_dpp v31, v59 quad_perm:[2,3,2,3] row_mask:0xf bank_mask:0xf
    s_cbranch_vccnz L_fb_76
L_rj_75:
    s_nop 0
    v_smfmac_f32_16x16x64_bf16 v[96:99], v[28:31], a[16:23], v10
    v_mov_b64 v[52:53], v[24:25]
    v_smfmac_f32_16x16x64_bf16 v[100:103], v[28:31], a[48:55], v10
    s_waitcnt lgkmcnt(0)
    s_barrier
    ds_read_b128 v[32:35], v4 offset:5632
    ds_read_b128 v[36:39], v4 offset:4096
    ds_read_b128 v[40:43], v4 offset:4608
    v_smfmac_f32_16x16x64_bf16 v[104:107], v[28:31], a[80:87], v10
    v_mov_b64 v[54:55], v[26:27]
    v_smfmac_f32_16x16x64_bf16 v[108:111], v[28:31], a[112:119], v10
    s_waitcnt lgkmcnt(2)
    v_smfmac_f32_16x16x64_bf16 v[96:99], v[32:35], a[24:31], v10
    s_waitcnt lgkmcnt(1)
    v_smfmac_f32_16x16x64_bf16 v[96:99], v[36:39], a[0:7], v10
    s_waitcnt lgkmcnt(0)
    v_smfmac_f32_16x16x64_bf16 v[96:99], v[40:43], a[8:15], v10
    ds_read_b128 v[64:67], v1 offset:8192
    v_mov_b64 v[24:25], 0
    v_smfmac_f32_16x16x64_bf16 v[100:103], v[32:35], a[56:63], v10
    ds_read_b128 v[68:71], v1 offset:9216
    v_mov_b64 v[26:27], 0
    v_smfmac_f32_16x16x64_bf16 v[100:103], v[36:39], a[32:39], v10
    v_cvt_pk_bf16_f32 v96, v96, v98
    v_cvt_pk_bf16_f32 v97, v97, v99
    v_smfmac_f32_16x16x64_bf16 v[100:103], v[40:43], a[40:47], v10
    buffer_store_dwordx2 v[96:97], v7, s[28:31], s47 offen sc1
    v_smfmac_f32_16x16x64_bf16 v[104:107], v[32:35], a[88:95], v10
    ds_read_b128 v[72:75], v1 offset:10240
    v_mov_b64 v[28:29], 0
    v_smfmac_f32_16x16x64_bf16 v[104:107], v[36:39], a[64:71], v10
    v_cvt_pk_bf16_f32 v100, v100, v102
    v_cvt_pk_bf16_f32 v101, v101, v103
    v_smfmac_f32_16x16x64_bf16 v[104:107], v[40:43], a[72:79], v10
    buffer_store_dwordx2 v[100:101], v7, s[28:31], s48 offen sc1
    v_smfmac_f32_16x16x64_bf16 v[108:111], v[32:35], a[120:127], v10
    ds_read_b128 v[76:79], v1 offset:11264
    v_mov_b64 v[30:31], 0
    v_smfmac_f32_16x16x64_bf16 v[108:111], v[36:39], a[96:103], v10
    v_cvt_pk_bf16_f32 v104, v104, v106
    v_cvt_pk_bf16_f32 v105, v105, v107
    v_smfmac_f32_16x16x64_bf16 v[108:111], v[40:43], a[104:111], v10
    buffer_store_dwordx2 v[104:105], v7, s[28:31], s49 offen sc1
    s_nop 6
    v_cvt_pk_bf16_f32 v108, v108, v110
    v_cvt_pk_bf16_f32 v109, v109, v111
    buffer_store_dwordx2 v[108:109], v7, s[28:31], s50 offen sc1
    ds_read_b128 v[80:83], v1 offset:12288
    ds_read_b128 v[84:87], v1 offset:13312
    ds_read_b128 v[88:91], v1 offset:14336
    ds_read_b128 v[92:95], v1 offset:15360
    ds_read_b128 v[112:115], v1 offset:4096
    ds_read_b128 v[116:119], v1 offset:5120
    ds_read_b128 v[120:123], v1 offset:6144
    ds_read_b128 v[124:127], v1 offset:7168
    ds_read_b128 v[96:99], v1 offset:0
    ds_read_b128 v[100:103], v1 offset:1024
    s_add_u32 s64, s64, 1
    s_add_u32 s71, s71, 262144
    ds_read_b128 v[104:107], v1 offset:2048
    s_add_u32 s78, s78, 262144
    s_add_u32 s72, s72, 131072
    ds_read_b128 v[108:111], v1 offset:3072
    s_xor_b32 m0, m0, 0x800
    v_xor_b32 v11, 0x800, v11
    s_add_u32 s55, s68, s101
    s_nop 3
    s_nop 3
    s_nop 3
    s_nop 3
    s_nop 3
    buffer_load_dwordx4 v[40:43], v0, s[28:31], s66 offen sc1
    buffer_load_dwordx4 v[44:47], v0, s[28:31], s66 offen offset:1024 sc1
    s_nop 3
    s_nop 3
    s_nop 3
    s_nop 3
    s_nop 3
    s_nop 3
    buffer_load_dwordx4 v[40:43], v0, s[28:31], s66 offen sc1
    buffer_load_dwordx4 v[44:47], v0, s[28:31], s66 offen offset:1024 sc1
    s_mov_b32 s58, 0
    s_branch L_p1e_78
L_p1_77:
    buffer_load_dwordx4 v[40:43], v0, s[28:31], s66 offen sc1
    buffer_load_dwordx4 v[44:47], v0, s[28:31], s66 offen offset:1024 sc1
    s_add_u32 s58, s58, 4096
    s_cbranch_scc1 L_tabort
L_p1e_78:
    s_waitcnt vmcnt(3)
    v_max3_u32 v36, v40, v41, v42
    v_max_u32 v36, v36, v43
    v_mfma_f32_16x16x32_bf16 v[32:35], v[12:15], v[40:43], 0
    s_waitcnt vmcnt(2)
    v_max3_u32 v36, v36, v44, v45
    v_max3_u32 v36, v36, v46, v47
    v_mfma_f32_16x16x32_bf16 v[32:35], v[12:15], v[44:47], v[32:35]
    v_cmp_eq_u32 vcc, -1, v36
    s_cbranch_vccnz L_p1_77
    s_nop 5
    v_add_f32_dpp v32, v32, v32 row_ror:4 row_mask:0xf bank_mask:0xf
    v_add_f32_dpp v33, v33, v33 row_ror:4 row_mask:0xf bank_mask:0xf
    s_nop 0
    v_add_f32_dpp v32, v32, v32 row_ror:8 row_mask:0xf bank_mask:0xf
    v_add_f32_dpp v33, v33, v33 row_ror:8 row_mask:0xf bank_mask:0xf
    v_cvt_pk_bf16_f32 v32, v32, v33
    buffer_store_dword v32, v5, s[28:31], s68 offen sc1
    s_waitcnt lgkmcnt(0)
    s_barrier
    s_nop 12
    buffer_load_dwordx4 v[56:59], v0, s[28:31], s55 offen sc1
    buffer_load_dwordx4 v[60:63], v0, s[28:31], s55 offen offset:1024 sc1
    s_xor_b32 s66, s66, 0xc0000
    s_xor_b32 s67, s67, 0xc0000
    s_mov_b32 s54, s68
    s_mov_b32 s68, s69
    s_mov_b32 s69, s70
    s_mov_b32 s70, s54
    s_xor_b32 s47, s47, 0xc0000
    s_xor_b32 s48, s48, 0xc0000
    s_xor_b32 s49, s49, 0xc0000
    s_xor_b32 s50, s50, 0xc0000
    s_add_u32 s54, s64, 1
    s_min_u32 s54, s54, 63
    s_mov_b32 s58, 0
L_kvp_80:
    v_cmp_eq_u64 s[60:61], s[42:43], v[8:9]
    s_nop 1
    s_bitcmp1_b64 s[60:61], s54
    s_cbranch_scc1 L_kvok_79
    buffer_load_dwordx2 v[8:9], v6, s[28:31], s74 offen sc1
    s_waitcnt vmcnt(0)
    s_add_u32 s58, s58, 1
    s_cmp_lt_u32 s58, 1048576
    s_cbranch_scc1 L_kvp_80
    s_branch L_abort
L_kvok_79:
    s_mov_b32 s58, 0
    s_nop 7
    buffer_load_dwordx4 v[56:59], v0, s[28:31], s55 offen sc1
    buffer_load_dwordx4 v[60:63], v0, s[28:31], s55 offen offset:1024 sc1
    s_cmp_eq_u32 s64, 63
    s_cbranch_scc0 L_p2e_s2
    s_branch L_last_e
L_rf_73:
    buffer_load_dwordx2 v[8:9], v6, s[28:31], s74 offen sc1
    s_branch L_rb_74
L_fb_76:
    ds_read_b128 v[96:99], v11 offset:8192
    ds_read_b128 v[100:103], v11 offset:9216
    ds_read_b128 v[104:107], v11 offset:12288
    ds_read_b128 v[108:111], v11 offset:13312
    s_waitcnt lgkmcnt(0)
    s_nop 7
    v_mfma_f32_16x16x32_bf16 v[56:59], v[96:99], v[80:83], 0
    v_mfma_f32_16x16x32_bf16 v[56:59], v[100:103], v[84:87], v[56:59]
    v_mfma_f32_16x16x32_bf16 v[56:59], v[104:107], v[88:91], v[56:59]
    v_mfma_f32_16x16x32_bf16 v[56:59], v[108:111], v[92:95], v[56:59]
    v_mfma_f32_16x16x32_bf16 v[60:63], v[112:115], v[80:83], 0
    v_mfma_f32_16x16x32_bf16 v[60:63], v[116:119], v[84:87], v[60:63]
    v_mfma_f32_16x16x32_bf16 v[60:63], v[120:123], v[88:91], v[60:63]
    v_mfma_f32_16x16x32_bf16 v[60:63], v[124:127], v[92:95], v[60:63]
    v_mfma_f32_16x16x32_bf16 v[40:43], v[64:67], v[80:83], 0
    v_mfma_f32_16x16x32_bf16 v[40:43], v[68:71], v[84:87], v[40:43]
    v_mfma_f32_16x16x32_bf16 v[40:43], v[32:35], v[88:91], v[40:43]
    v_mfma_f32_16x16x32_bf16 v[40:43], v[36:39], v[92:95], v[40:43]
    v_max3_f32 v52, v56, v57, v58
    v_max3_f32 v53, v59, v60, v61
    v_max3_f32 v52, v52, v62, v63
    s_nop 4
    v_max3_f32 v53, v53, v40, v41
    v_max_f32 v52, v52, v53
    v_mov_b32 v53, v52
    s_nop 1
    v_permlane16_swap_b32 v52, v53
    v_max_f32 v52, v52, v53
    v_mov_b32 v53, v52
    s_nop 1
    v_permlane32_swap_b32 v52, v53
    v_max_f32 v52, v52, v53
    v_sub_f32 v56, v56, v52
    v_sub_f32 v57, v57, v52
    v_sub_f32 v58, v58, v52
    v_sub_f32 v59, v59, v52
    v_sub_f32 v60, v60, v52
    v_sub_f32 v61, v61, v52
    v_sub_f32 v62, v62, v52
    v_sub_f32 v63, v63, v52
    v_sub_f32 v40, v40, v52
    v_sub_f32 v41, v41, v52
    v_exp_f32 v56, v56
    v_exp_f32 v57, v57
    v_exp_f32 v58, v58
    v_exp_f32 v59, v59
    v_exp_f32 v60, v60
    v_exp_f32 v61, v61
    v_exp_f32 v62, v62
    v_exp_f32 v63, v63
    v_exp_f32 v40, v40
    v_exp_f32 v41, v41
    v_cvt_pk_bf16_f32 v28, v56, v57
    v_cvt_pk_bf16_f32 v29, v58, v59
    v_cvt_pk_bf16_f32 v30, v60, v61
    v_cvt_pk_bf16_f32 v31, v62, v63
    v_cvt_pk_bf16_f32 v48, v40, v41
    v_cvt_pk_bf16_f32 v51, v40, v41
    v_mfma_f32_16x16x32_bf16 v[52:55], v[44:47], v[28:31], 0
    v_mfma_f32_16x16x32_bf16 v[56:59], v[16:19], v[28:31], 0
    v_mfma_f32_16x16x32_bf16 v[60:63], v[20:23], v[28:31], 0
    v_mfma_f32_16x16x16_bf16 v[52:55], v[44:45], v[48:49], v[52:55]
    v_mfma_f32_16x16x16_bf16 v[56:59], v[26:27], v[48:49], v[56:59]
    v_mfma_f32_16x16x16_bf16 v[60:63], v[26:27], v[50:51], v[60:63]
    v_rcp_f32 v52, v52
    s_nop 2
    v_cndmask_b32 v56, v56, v58, s[76:77]
    v_cndmask_b32 v57, v57, v59, s[76:77]
    v_pk_mul_f32 v[56:57], v[56:57], v[52:53] op_sel_hi:[1,0]
    s_nop 0
    v_cndmask_b32 v60, v60, v62, s[76:77]
    v_cndmask_b32 v61, v61, v63, s[76:77]
    v_pk_mul_f32 v[60:61], v[60:61], v[52:53] op_sel_hi:[1,0]
    v_cvt_pk_bf16_f32 v58, v56, v60
    v_cvt_pk_bf16_f32 v59, v57, v61
    ds_write_b64 v2, v[58:59] offset:5120
    v_mov_b32_dpp v28, v58 quad_perm:[0,1,0,1] row_mask:0xf bank_mask:0xf
    v_mov_b32_dpp v29, v59 quad_perm:[0,1,0,1] row_mask:0xf bank_mask:0xf
    v_mov_b32_dpp v30, v58 quad_perm:[2,3,2,3] row_mask:0xf bank_mask:0xf
    v_mov_b32_dpp v31, v59 quad_perm:[2,3,2,3] row_mask:0xf bank_mask:0xf
    v_mov_b64 v[96:97], 0
    v_mov_b64 v[98:99], 0
    v_mov_b64 v[100:101], 0
    v_mov_b64 v[102:103], 0
    v_mov_b64 v[104:105], 0
    v_mov_b64 v[106:107], 0
    v_mov_b64 v[108:109], 0
    v_mov_b64 v[110:111], 0
    s_nop 7
    s_branch L_rj_75
L_ent_s3:
    ds_read_b128 v[64:67], v1 offset:12288
    ds_read_b128 v[68:71], v1 offset:13312
    ds_read_b128 v[72:75], v1 offset:14336
    ds_read_b128 v[76:79], v1 offset:15360
    ds_read_b128 v[80:83], v1 offset:8192
    ds_read_b128 v[84:87], v1 offset:9216
    ds_read_b128 v[88:91], v1 offset:10240
    ds_read_b128 v[92:95], v1 offset:11264
    ds_read_b128 v[96:99], v1 offset:4096
    ds_read_b128 v[100:103], v1 offset:5120
    ds_read_b128 v[104:107], v1 offset:6144
    ds_read_b128 v[108:111], v1 offset:7168
    ds_read_b128 v[112:115], v1 offset:0
    ds_read_b128 v[116:119], v1 offset:1024
    ds_read_b128 v[120:123], v1 offset:2048
    ds_read_b128 v[124:127], v1 offset:3072
    ds_read_b128 v[56:59], v0 offset:6144
    ds_read_b128 v[60:63], v0 offset:7168
    s_waitcnt lgkmcnt(0)
    v_smfmac_f32_16x16x64_bf16 v[24:27], v[56:59], v[64:71], v10
    v_smfmac_f32_16x16x64_bf16 v[24:27], v[60:63], v[72:79], v10
    s_branch L_top_s3
L_p2_s3:
    buffer_load_dwordx4 v[56:59], v0, s[28:31], s55 offen sc1
    buffer_load_dwordx4 v[60:63], v0, s[28:31], s55 offen offset:1024 sc1
    s_add_u32 s58, s58, 4096
    s_cbranch_scc1 L_tabort
    s_nop 1
    s_nop 0
    v_mov_b64 v[24:25], 0
    v_mov_b64 v[26:27], 0
L_p2e_s3:
    s_waitcnt vmcnt(3)
    v_max3_u32 v37, v56, v57, v58
    v_max_u32 v37, v37, v59
    v_smfmac_f32_16x16x64_bf16 v[24:27], v[56:59], v[64:71], v10
    ds_write_b128 v0, v[56:59] offset:6144
    s_waitcnt vmcnt(2)
    v_max3_u32 v37, v37, v60, v61
    v_max3_u32 v37, v37, v62, v63
    v_cmp_eq_u32 vcc, -1, v37
    v_smfmac_f32_16x16x64_bf16 v[24:27], v[60:63], v[72:79], v10
    s_cbranch_vccnz L_p2_s3
L_top_s3:
    v_mov_b64 v[64:65], 0
    v_smfmac_f32_16x16x64_bf16 v[28:31], v[56:59], v[240:247], v10
    ds_write_b128 v0, v[60:63] offset:7168
    v_mov_b64 v[66:67], 0
    v_smfmac_f32_16x16x64_bf16 v[28:31], v[60:63], v[248:255], v10
    buffer_load_dwordx4 v[16:19], v0, s[28:31], s78 offen
    v_mov_b64 v[72:73], 0
    v_smfmac_f32_16x16x64_bf16 v[64:67], v[56:59], v[176:183], v10
    buffer_load_dwordx4 v[20:23], v0, s[28:31], s78 offen offset:1024
    v_mov_b64 v[74:75], 0
    v_smfmac_f32_16x16x64_bf16 v[64:67], v[60:63], v[184:191], v10
    s_waitcnt lgkmcnt(0)
    s_barrier
    ds_read_b128 v[32:35], v0 offset:4096
    ds_read_b128 v[36:39], v0 offset:5120
    v_mov_b64 v[76:77], 0
    v_smfmac_f32_16x16x64_bf16 v[72:75], v[56:59], a[224:231], v10
    ds_read_b128 v[40:43], v0 offset:2048
    v_mov_b64 v[78:79], 0
    v_smfmac_f32_16x16x64_bf16 v[72:75], v[60:63], a[240:247], v10
    ds_read_b128 v[44:47], v0 offset:3072
    buffer_store_dwordx2 v[52:53], v6, s[28:31], s72 offen offset:0 sc1
    v_smfmac_f32_16x16x64_bf16 v[76:79], v[56:59], a[232:239], v10
    ds_read_b128 v[48:51], v0 offset:0
    v_smfmac_f32_16x16x64_bf16 v[76:79], v[60:63], a[248:255], v10
    buffer_store_dwordx2 v[54:55], v6, s[28:31], s72 offen offset:512 sc1
    s_waitcnt lgkmcnt(3)
    v_smfmac_f32_16x16x64_bf16 v[24:27], v[32:35], v[80:87], v10
    ds_read_b128 v[52:55], v0 offset:1024
    ds_read_b128 v[80:83], v1 offset:28672
    v_smfmac_f32_16x16x64_bf16 v[24:27], v[36:39], v[88:95], v10
    ds_read_b128 v[84:87], v1 offset:29696
    s_waitcnt lgkmcnt(3)
    v_smfmac_f32_16x16x64_bf16 v[24:27], v[40:43], v[96:103], v10
    ds_read_b128 v[88:91], v1 offset:30720
    v_mov_b64 v[68:69], 0
    v_smfmac_f32_16x16x64_bf16 v[24:27], v[44:47], v[104:111], v10
    ds_read_b128 v[92:95], v1 offset:31744
    v_mov_b64 v[70:71], 0
    v_smfmac_f32_16x16x64_bf16 v[24:27], v[48:51], v[112:119], v10
    ds_read_b128 v[96:99], v1 offset:24576
    s_waitcnt lgkmcnt(5)
    v_smfmac_f32_16x16x64_bf16 v[24:27], v[52:55], v[120:127], v10
    ds_read_b128 v[100:103], v1 offset:25600
    v_smfmac_f32_16x16x64_bf16 v[28:31], v[32:35], v[224:231], v10
    ds_read_b128 v[104:107], v1 offset:26624
    v_smfmac_f32_16x16x64_bf16 v[28:31], v[36:39], v[232:239], v10
    ds_read_b128 v[108:111], v1 offset:27648
    v_add_f32 v24, v24, v26
    v_smfmac_f32_16x16x64_bf16 v[28:31], v[40:43], v[208:215], v10
    ds_read_b128 v[112:115], v1 offset:20480
    v_add_f32 v25, v25, v27
    v_smfmac_f32_16x16x64_bf16 v[28:31], v[44:47], v[216:223], v10
    ds_read_b128 v[116:119], v1 offset:21504
    v_mul_f32 v24, s59, v24
    v_smfmac_f32_16x16x64_bf16 v[28:31], v[48:51], v[192:199], v10
    ds_read_b128 v[120:123], v1 offset:22528
    v_mul_f32 v25, s59, v25
    v_smfmac_f32_16x16x64_bf16 v[28:31], v[52:55], v[200:207], v10
    ds_read_b128 v[124:127], v1 offset:23552
    s_cmp_lg_u64 s[60:61], -1
    s_cbranch_scc1 L_rf_82
L_rb_83:
    s_waitcnt lgkmcnt(6)
    v_smfmac_f32_16x16x64_bf16 v[68:71], v[56:59], v[80:87], v10
    ds_read_b128 v[80:83], v1 offset:16384
    v_smfmac_f32_16x16x64_bf16 v[68:71], v[60:63], v[88:95], v10
    ds_read_b128 v[84:87], v1 offset:17408
    v_add_f32 v28, v28, v30
    v_smfmac_f32_16x16x64_bf16 v[68:71], v[32:35], v[96:103], v10
    ds_read_b128 v[88:91], v1 offset:18432
    s_waitcnt lgkmcnt(5)
    v_add_f32 v29, v29, v31
    v_smfmac_f32_16x16x64_bf16 v[68:71], v[36:39], v[104:111], v10
    ds_read_b128 v[92:95], v1 offset:19456
    v_mul_f32 v28, s59, v28
    v_smfmac_f32_16x16x64_bf16 v[68:71], v[40:43], v[112:119], v10
    ds_read_b128 v[96:99], v11 offset:8192
    s_waitcnt lgkmcnt(5)
    v_mul_f32 v29, s59, v29
    v_smfmac_f32_16x16x64_bf16 v[68:71], v[44:47], v[120:127], v10
    ds_read_b128 v[100:103], v11 offset:9216
    v_cvt_pk_bf16_f32 v24, v24, v28
    v_smfmac_f32_16x16x64_bf16 v[64:67], v[32:35], v[160:167], v10
    ds_read_b128 v[104:107], v11 offset:12288
    v_cvt_pk_bf16_f32 v25, v25, v29
    v_smfmac_f32_16x16x64_bf16 v[64:67], v[36:39], v[168:175], v10
    ds_write2_b32 v3, v24, v25 offset0:0 offset1:4
    v_mov_b64 v[28:29], -1
    v_smfmac_f32_16x16x64_bf16 v[64:67], v[40:43], v[144:151], v10
    ds_read_b128 v[108:111], v11 offset:13312
    s_waitcnt lgkmcnt(5)
    v_mov_b64 v[30:31], -1
    v_smfmac_f32_16x16x64_bf16 v[68:71], v[48:51], v[80:87], v10
    ds_read_b128 v[112:115], v11 offset:16384
    v_smfmac_f32_16x16x64_bf16 v[68:71], v[52:55], v[88:95], v10
    ds_read_b128 v[116:119], v11 offset:17408
    buffer_store_dword v28, v5, s[28:31], s69 offen sc1
    v_smfmac_f32_16x16x64_bf16 v[64:67], v[44:47], v[152:159], v10
    ds_read_b128 v[120:123], v11 offset:20480
    v_smfmac_f32_16x16x64_bf16 v[64:67], v[48:51], v[128:135], v10
    ds_read_b128 v[124:127], v11 offset:21504
    s_waitcnt lgkmcnt(5)
    s_barrier
    ds_read_b128 v[80:83], v4 offset:0
    v_smfmac_f32_16x16x64_bf16 v[64:67], v[52:55], v[136:143], v10
    ds_read_b128 v[84:87], v4 offset:1024
    v_add_f32 v68, v68, v70
    v_smfmac_f32_16x16x64_bf16 v[72:75], v[32:35], a[192:199], v10
    ds_read_b128 v[88:91], v4 offset:2048
    v_add_f32 v69, v69, v71
    v_smfmac_f32_16x16x64_bf16 v[76:79], v[32:35], a[200:207], v10
    ds_read_b128 v[92:95], v4 offset:3072
    v_add_f32 v64, v64, v66
    v_smfmac_f32_16x16x64_bf16 v[72:75], v[36:39], a[208:215], v10
    s_waitcnt vmcnt(5)
    v_add_f32 v65, v65, v67
    v_smfmac_f32_16x16x64_bf16 v[76:79], v[36:39], a[216:223], v10
    s_waitcnt lgkmcnt(3)
    v_cvt_pk_bf16_f32 v24, v64, v68
    v_mfma_f32_16x16x32_bf16 v[56:59], v[96:99], v[80:83], 0
    s_waitcnt lgkmcnt(2)
    v_cvt_pk_bf16_f32 v25, v65, v69
    v_mfma_f32_16x16x32_bf16 v[56:59], v[100:103], v[84:87], v[56:59]
    buffer_store_dwordx4 v[28:31], v0, s[28:31], s67 offen sc1
    ds_write2_b32 v3, v24, v25 offset0:128 offset1:132
    s_waitcnt lgkmcnt(2)
    v_mfma_f32_16x16x32_bf16 v[56:59], v[104:107], v[88:91], v[56:59]
    s_waitcnt lgkmcnt(1)
    v_mfma_f32_16x16x32_bf16 v[56:59], v[108:111], v[92:95], v[56:59]
    v_mfma_f32_16x16x32_bf16 v[60:63], v[112:115], v[80:83], 0
    v_mov_b64 v[96:97], 0
    v_mov_b64 v[98:99], 0
    v_mfma_f32_16x16x32_bf16 v[60:63], v[116:119], v[84:87], v[60:63]
    buffer_store_dwordx4 v[28:31], v0, s[28:31], s67 offen offset:1024 sc1
    v_exp_f32 v56, v56
    v_mov_b64 v[100:101], 0
    v_mfma_f32_16x16x32_bf16 v[60:63], v[120:123], v[88:91], v[60:63]
    v_mov_b64 v[102:103], 0
    v_mov_b64 v[104:105], 0
    v_mfma_f32_16x16x32_bf16 v[60:63], v[124:127], v[92:95], v[60:63]
    s_waitcnt lgkmcnt(0)
    s_barrier
    ds_read_b128 v[64:67], v4 offset:512
    v_exp_f32 v57, v57
    v_exp_f32 v58, v58
    v_smfmac_f32_16x16x64_bf16 v[72:75], v[40:43], a[160:167], v10
    ds_read_b128 v[68:71], v4 offset:1536
    v_cvt_pk_bf16_f32 v28, v56, v57
    v_smfmac_f32_16x16x64_bf16 v[76:79], v[40:43], a[168:175], v10
    ds_read_b128 v[32:35], v4 offset:2560
    v_mov_b64 v[106:107], 0
    v_smfmac_f32_16x16x64_bf16 v[72:75], v[44:47], a[176:183], v10
    ds_read_b128 v[36:39], v4 offset:3584
    buffer_load_dwordx4 v0, s[28:31], s71 offen lds
    v_exp_f32 v59, v59
    v_smfmac_f32_16x16x64_bf16 v[76:79], v[44:47], a[184:191], v10
    buffer_load_dwordx4 v0, s[28:31], s71 offen offset:1024 lds
    v_exp_f32 v60, v60
    v_smfmac_f32_16x16x64_bf16 v[72:75], v[48:51], a[128:135], v10
    s_waitcnt lgkmcnt(2)
    v_cvt_pk_bf16_f32 v29, v58, v59
    v_mfma_f32_16x16x32_bf16 v[40:43], v[64:67], v[80:83], 0
    v_exp_f32 v61, v61
    v_mov_b64 v[44:45], s[62:63]
    v_mfma_f32_16x16x32_bf16 v[40:43], v[68:71], v[84:87], v[40:43]
    s_waitcnt lgkmcnt(0)
    v_exp_f32 v62, v62
    v_mov_b64 v[46:47], s[62:63]
    v_mov_b64 v[108:109], 0
    v_mfma_f32_16x16x32_bf16 v[40:43], v[32:35], v[88:91], v[40:43]
    v_exp_f32 v63, v63
    v_cvt_pk_bf16_f32 v30, v60, v61
    v_mfma_f32_16x16x32_bf16 v[40:43], v[36:39], v[92:95], v[40:43]
    v_cvt_pk_bf16_f32 v31, v62, v63
    v_mov_b64 v[110:111], 0
    v_smfmac_f32_16x16x64_bf16 v[76:79], v[48:51], a[136:143], v10
    v_mov_b32 v49, 0
    v_smfmac_f32_16x16x64_bf16 v[72:75], v[52:55], a[144:151], v10
    s_waitcnt vmcnt(7)
    v_exp_f32 v40, v40
    v_smfmac_f32_16x16x64_bf16 v[76:79], v[52:55], a[152:159], v10
    v_exp_f32 v41, v41
    v_mfma_f32_16x16x32_bf16 v[52:55], v[44:47], v[28:31], 0
    v_add_f32 v72, v72, v74
    v_cvt_pk_bf16_f32 v48, v40, v41
    v_mfma_f32_16x16x32_bf16 v[56:59], v[16:19], v[28:31], 0
    v_add_f32 v73, v73, v75
    v_add_f32 v76, v76, v78
    v_mfma_f32_16x16x16_bf16 v[52:55], v[44:45], v[48:49], v[52:55]
    v_add_f32 v77, v77, v79
    v_cvt_pk_bf16_f32 v26, v72, v73
    v_cvt_pk_bf16_f32 v27, v76, v77
    v_mfma_f32_16x16x32_bf16 v[60:63], v[20:23], v[28:31], 0
    v_cvt_pk_bf16_f32 v51, v40, v41
    v_mov_b32 v50, 0
    v_mfma_f32_16x16x16_bf16 v[56:59], v[26:27], v[48:49], v[56:59]
    v_subrev_u32 v53, s79, v52
    v_rcp_f32 v52, v52
    v_mfma_f32_16x16x16_bf16 v[60:63], v[26:27], v[50:51], v[60:63]
    v_cmp_lt_u32 vcc, s100, v53
    s_nop 2
    v_cndmask_b32 v56, v56, v58, s[76:77]
    v_cndmask_b32 v57, v57, v59, s[76:77]
    v_pk_mul_f32 v[56:57], v[56:57], v[52:53] op_sel_hi:[1,0]
    s_nop 0
    v_cndmask_b32 v60, v60, v62, s[76:77]
    v_cndmask_b32 v61, v61, v63, s[76:77]
    v_pk_mul_f32 v[60:61], v[60:61], v[52:53] op_sel_hi:[1,0]
    v_cvt_pk_bf16_f32 v58, v56, v60
    v_cvt_pk_bf16_f32 v59, v57, v61
    ds_write_b64 v2, v[58:59] offset:5632
    v_mov_b32_dpp v28, v58 quad_perm:[0,1,0,1] row_mask:0xf bank_mask:0xf
    v_mov_b32_dpp v29, v59 quad_perm:[0,1,0,1] row_mask:0xf bank_mask:0xf
    v_mov_b32_dpp v30, v58 quad_perm:[2,3,2,3] row_mask:0xf bank_mask:0xf
    v_mov_b32_dpp v31, v59 quad_perm:[2,3,2,3] row_mask:0xf bank_mask:0xf
    s_cbranch_vccnz L_fb_85
L_rj_84:
    s_nop 0
    v_smfmac_f32_16x16x64_bf16 v[96:99], v[28:31], a[24:31], v10
    v_mov_b64 v[52:53], v[24:25]
    v_smfmac_f32_16x16x64_bf16 v[100:103], v[28:31], a[56:63], v10
    s_waitcnt lgkmcnt(0)
    s_barrier
    ds_read_b128 v[32:35], v4 offset:5120
    ds_read_b128 v[36:39], v4 offset:4608
    ds_read_b128 v[40:43], v4 offset:4096
    v_smfmac_f32_16x16x64_bf16 v[104:107], v[28:31], a[88:95], v10
    v_mov_b64 v[54:55], v[26:27]
    v_smfmac_f32_16x16x64_bf16 v[108:111], v[28:31], a[120:127], v10
    s_waitcnt lgkmcnt(2)
    v_smfmac_f32_16x16x64_bf16 v[96:99], v[32:35], a[16:23], v10
    s_waitcnt lgkmcnt(1)
    v_smfmac_f32_16x16x64_bf16 v[96:99], v[36:39], a[8:15], v10
    s_waitcnt lgkmcnt(0)
    v_smfmac_f32_16x16x64_bf16 v[96:99], v[40:43], a[0:7], v10
    ds_read_b128 v[64:67], v1 offset:12288
    v_mov_b64 v[24:25], 0
    v_smfmac_f32_16x16x64_bf16 v[100:103], v[32:35], a[48:55], v10
    ds_read_b128 v[68:71], v1 offset:13312
    v_mov_b64 v[26:27], 0
    v_smfmac_f32_16x16x64_bf16 v[100:103], v[36:39], a[40:47], v10
    v_cvt_pk_bf16_f32 v96, v96, v98
    v_cvt_pk_bf16_f32 v97, v97, v99
    v_smfmac_f32_16x16x64_bf16 v[100:103], v[40:43], a[32:39], v10
    buffer_store_dwordx2 v[96:97], v7, s[28:31], s47 offen sc1
    v_smfmac_f32_16x16x64_bf16 v[104:107], v[32:35], a[80:87], v10
    ds_read_b128 v[72:75], v1 offset:14336
    v_mov_b64 v[28:29], 0
    v_smfmac_f32_16x16x64_bf16 v[104:107], v[36:39], a[72:79], v10
    v_cvt_pk_bf16_f32 v100, v100, v102
    v_cvt_pk_bf16_f32 v101, v101, v103
    v_smfmac_f32_16x16x64_bf16 v[104:107], v[40:43], a[64:71], v10
    buffer_store_dwordx2 v[100:101], v7, s[28:31], s48 offen sc1
    v_smfmac_f32_16x16x64_bf16 v[108:111], v[32:35], a[112:119], v10
    ds_read_b128 v[76:79], v1 offset:15360
    v_mov_b64 v[30:31], 0
    v_smfmac_f32_16x16x64_bf16 v[108:111], v[36:39], a[104:111], v10
    v_cvt_pk_bf16_f32 v104, v104, v106
    v_cvt_pk_bf16_f32 v105, v105, v107
    v_smfmac_f32_16x16x64_bf16 v[108:111], v[40:43], a[96:103], v10
    buffer_store_dwordx2 v[104:105], v7, s[28:31], s49 offen sc1
    s_nop 6
    v_cvt_pk_bf16_f32 v108, v108, v110
    v_cvt_pk_bf16_f32 v109, v109, v111
    buffer_store_dwordx2 v[108:109], v7, s[28:31], s50 offen sc1
    ds_read_b128 v[80:83], v1 offset:8192
    ds_read_b128 v[84:87], v1 offset:9216
    ds_read_b128 v[88:91], v1 offset:10240
    ds_read_b128 v[92:95], v1 offset:11264
    ds_read_b128 v[112:115], v1 offset:0
    ds_read_b128 v[116:119], v1 offset:1024
    ds_read_b128 v[120:123], v1 offset:2048
    ds_read_b128 v[124:127], v1 offset:3072
    ds_read_b128 v[96:99], v1 offset:4096
    ds_read_b128 v[100:103], v1 offset:5120
    s_add_u32 s64, s64, 1
    s_add_u32 s71, s71, 262144
    ds_read_b128 v[104:107], v1 offset:6144
    s_add_u32 s78, s78, 262144
    s_add_u32 s72, s72, 131072
    ds_read_b128 v[108:111], v1 offset:7168
    s_xor_b32 m0, m0, 0x800
    v_xor_b32 v11, 0x800, v11
    s_add_u32 s55, s68, s101
    s_nop 3
    s_nop 3
    s_nop 3
    s_nop 3
    s_nop 3
    s_nop 3
    buffer_load_dwordx4 v[40:43], v0, s[28:31], s66 offen sc1
    buffer_load_dwordx4 v[44:47], v0, s[28:31], s66 offen offset:1024 sc1
    s_nop 3
    s_nop 3
    s_nop 3
    s_nop 3
    s_nop 3
    s_nop 3
    buffer_load_dwordx4 v[40:43], v0, s[28:31], s66 offen sc1
    buffer_load_dwordx4 v[44:47], v0, s[28:31], s66 offen offset:1024 sc1
    s_mov_b32 s58, 0
    s_branch L_p1e_87
L_p1_86:
    buffer_load_dwordx4 v[40:43], v0, s[28:31], s66 offen sc1
    buffer_load_dwordx4 v[44:47], v0, s[28:31], s66 offen offset:1024 sc1
    s_add_u32 s58, s58, 4096
    s_cbranch_scc1 L_tabort
L_p1e_87:
    s_waitcnt vmcnt(3)
    v_max3_u32 v36, v40, v41, v42
    v_max_u32 v36, v36, v43
    v_mfma_f32_16x16x32_bf16 v[32:35], v[12:15], v[40:43], 0
    s_waitcnt vmcnt(2)
    v_max3_u32 v36, v36, v44, v45
    v_max3_u32 v36, v36, v46, v47
    v_mfma_f32_16x16x32_bf16 v[32:35], v[12:15], v[44:47], v[32:35]
    v_cmp_eq_u32 vcc, -1, v36
    s_cbranch_vccnz L_p1_86
    s_nop 5
    v_add_f32_dpp v32, v32, v32 row_ror:4 row_mask:0xf bank_mask:0xf
    v_add_f32_dpp v33, v33, v33 row_ror:4 row_mask:0xf bank_mask:0xf
    s_nop 0
    v_add_f32_dpp v32, v32, v32 row_ror:8 row_mask:0xf bank_mask:0xf
    v_add_f32_dpp v33, v33, v33 row_ror:8 row_mask:0xf bank_mask:0xf
    v_cvt_pk_bf16_f32 v32, v32, v33
    buffer_store_dword v32, v5, s[28:31], s68 offen sc1
    s_waitcnt lgkmcnt(0)
    s_barrier
    s_nop 12
    buffer_load_dwordx4 v[56:59], v0, s[28:31], s55 offen sc1
    buffer_load_dwordx4 v[60:63], v0, s[28:31], s55 offen offset:1024 sc1
    s_xor_b32 s66, s66, 0xc0000
    s_xor_b32 s67, s67, 0xc0000
    s_mov_b32 s54, s68
    s_mov_b32 s68, s69
    s_mov_b32 s69, s70
    s_mov_b32 s70, s54
    s_xor_b32 s47, s47, 0xc0000
    s_xor_b32 s48, s48, 0xc0000
    s_xor_b32 s49, s49, 0xc0000
    s_xor_b32 s50, s50, 0xc0000
    s_add_u32 s54, s64, 1
    s_min_u32 s54, s54, 63
    s_mov_b32 s58, 0
L_kvp_89:
    v_cmp_eq_u64 s[60:61], s[42:43], v[8:9]
    s_nop 1
    s_bitcmp1_b64 s[60:61], s54
    s_cbranch_scc1 L_kvok_88
    buffer_load_dwordx2 v[8:9], v6, s[28:31], s74 offen sc1
    s_waitcnt vmcnt(0)
    s_add_u32 s58, s58, 1
    s_cmp_lt_u32 s58, 1048576
    s_cbranch_scc1 L_kvp_89
    s_branch L_abort
L_kvok_88:
    s_mov_b32 s58, 0
    s_nop 7
    buffer_load_dwordx4 v[56:59], v0, s[28:31], s55 offen sc1
    buffer_load_dwordx4 v[60:63], v0, s[28:31], s55 offen offset:1024 sc1
    s_cmp_eq_u32 s64, 63
    s_cbranch_scc0 L_p2e_s3
    s_branch L_last_e
L_rf_82:
    buffer_load_dwordx2 v[8:9], v6, s[28:31], s74 offen sc1
    s_branch L_rb_83
L_fb_85:
    ds_read_b128 v[96:99], v11 offset:8192
    ds_read_b128 v[100:103], v11 offset:9216
    ds_read_b128 v[104:107], v11 offset:12288
    ds_read_b128 v[108:111], v11 offset:13312
    s_waitcnt lgkmcnt(0)
    s_nop 7
    v_mfma_f32_16x16x32_bf16 v[56:59], v[96:99], v[80:83], 0
    v_mfma_f32_16x16x32_bf16 v[56:59], v[100:103], v[84:87], v[56:59]
    v_mfma_f32_16x16x32_bf16 v[56:59], v[104:107], v[88:91], v[56:59]
    v_mfma_f32_16x16x32_bf16 v[56:59], v[108:111], v[92:95], v[56:59]
    v_mfma_f32_16x16x32_bf16 v[60:63], v[112:115], v[80:83], 0
    v_mfma_f32_16x16x32_bf16 v[60:63], v[116:119], v[84:87], v[60:63]
    v_mfma_f32_16x16x32_bf16 v[60:63], v[120:123], v[88:91], v[60:63]
    v_mfma_f32_16x16x32_bf16 v[60:63], v[124:127], v[92:95], v[60:63]
    v_mfma_f32_16x16x32_bf16 v[40:43], v[64:67], v[80:83], 0
    v_mfma_f32_16x16x32_bf16 v[40:43], v[68:71], v[84:87], v[40:43]
    v_mfma_f32_16x16x32_bf16 v[40:43], v[32:35], v[88:91], v[40:43]
    v_mfma_f32_16x16x32_bf16 v[40:43], v[36:39], v[92:95], v[40:43]
    v_max3_f32 v52, v56, v57, v58
    v_max3_f32 v53, v59, v60, v61
    v_max3_f32 v52, v52, v62, v63
    s_nop 4
    v_max3_f32 v53, v53, v40, v41
    v_max_f32 v52, v52, v53
    v_mov_b32 v53, v52
    s_nop 1
    v_permlane16_swap_b32 v52, v53
    v_max_f32 v52, v52, v53
    v_mov_b32 v53, v52
    s_nop 1
    v_permlane32_swap_b32 v52, v53
    v_max_f32 v52, v52, v53
    v_sub_f32 v56, v56, v52
    v_sub_f32 v57, v57, v52
    v_sub_f32 v58, v58, v52
    v_sub_f32 v59, v59, v52
    v_sub_f32 v60, v60, v52
    v_sub_f32 v61, v61, v52
    v_sub_f32 v62, v62, v52
    v_sub_f32 v63, v63, v52
    v_sub_f32 v40, v40, v52
    v_sub_f32 v41, v41, v52
    v_exp_f32 v56, v56
    v_exp_f32 v57, v57
    v_exp_f32 v58, v58
    v_exp_f32 v59, v59
    v_exp_f32 v60, v60
    v_exp_f32 v61, v61
    v_exp_f32 v62, v62
    v_exp_f32 v63, v63
    v_exp_f32 v40, v40
    v_exp_f32 v41, v41
    v_cvt_pk_bf16_f32 v28, v56, v57
    v_cvt_pk_bf16_f32 v29, v58, v59
    v_cvt_pk_bf16_f32 v30, v60, v61
    v_cvt_pk_bf16_f32 v31, v62, v63
    v_cvt_pk_bf16_f32 v48, v40, v41
    v_cvt_pk_bf16_f32 v51, v40, v41
    v_mfma_f32_16x16x32_bf16 v[52:55], v[44:47], v[28:31], 0
    v_mfma_f32_16x16x32_bf16 v[56:59], v[16:19], v[28:31], 0
    v_mfma_f32_16x16x32_bf16 v[60:63], v[20:23], v[28:31], 0
    v_mfma_f32_16x16x16_bf16 v[52:55], v[44:45], v[48:49], v[52:55]
    v_mfma_f32_16x16x16_bf16 v[56:59], v[26:27], v[48:49], v[56:59]
    v_mfma_f32_16x16x16_bf16 v[60:63], v[26:27], v[50:51], v[60:63]
    v_rcp_f32 v52, v52
    s_nop 2
    v_cndmask_b32 v56, v56, v58, s[76:77]
    v_cndmask_b32 v57, v57, v59, s[76:77]
    v_pk_mul_f32 v[56:57], v[56:57], v[52:53] op_sel_hi:[1,0]
    s_nop 0
    v_cndmask_b32 v60, v60, v62, s[76:77]
    v_cndmask_b32 v61, v61, v63, s[76:77]
    v_pk_mul_f32 v[60:61], v[60:61], v[52:53] op_sel_hi:[1,0]
    v_cvt_pk_bf16_f32 v58, v56, v60
    v_cvt_pk_bf16_f32 v59, v57, v61
    ds_write_b64 v2, v[58:59] offset:5632
    v_mov_b32_dpp v28, v58 quad_perm:[0,1,0,1] row_mask:0xf bank_mask:0xf
    v_mov_b32_dpp v29, v59 quad_perm:[0,1,0,1] row_mask:0xf bank_mask:0xf
    v_mov_b32_dpp v30, v58 quad_perm:[2,3,2,3] row_mask:0xf bank_mask:0xf
    v_mov_b32_dpp v31, v59 quad_perm:[2,3,2,3] row_mask:0xf bank_mask:0xf
    v_mov_b64 v[96:97], 0
    v_mov_b64 v[98:99], 0
    v_mov_b64 v[100:101], 0
    v_mov_b64 v[102:103], 0
    v_mov_b64 v[104:105], 0
    v_mov_b64 v[106:107], 0
    v_mov_b64 v[108:109], 0
    v_mov_b64 v[110:111], 0
    s_nop 7
    s_branch L_rj_84
L_worker:
    s_sub_u32 s66, s45, 32
    s_mul_i32 s65, s66, 9363
    s_lshr_b32 s65, s65, 16
    s_mul_i32 s54, s65, 7
    s_sub_u32 s67, s66, s54
    v_lshrrev_b32 v1, 1, v0
    s_cmp_lg_u32 s67, 6
    s_cbranch_scc1 L_noln_91
    s_lshl_b32 s86, s65, 2
    s_add_u32 s86, s86, s44
    s_and_b32 s87, s86, 1
    s_mov_b32 s36, s4
    s_and_b32 s37, s5, 0xffff
    s_mov_b32 s38, 2097152
    s_mov_b32 s39, 0x20000
    v_bfe_u32 v4, v0, 4, 4
    v_lshrrev_b32 v6, 2, v4
    v_and_b32 v5, 3, v4
    v_lshl_add_u32 v5, v6, 3, v5
    s_lshl_b32 s54, s87, 2
    v_add_u32 v5, s54, v5
    v_lshlrev_b32 v5, 10, v5
    v_lshrrev_b32 v6, 8, v0
    v_lshl_add_u32 v5, v6, 4, v5
    s_lshr_b32 s54, s86, 1
    s_lshl_b32 s54, s54, 15
    buffer_load_dwordx4 v[192:195], v5, s[36:39], s54 offen offset:0
    buffer_load_dwordx4 v[196:199], v5, s[36:39], s54 offen offset:64
    buffer_load_dwordx4 v[200:203], v5, s[36:39], s54 offen offset:128
    buffer_load_dwordx4 v[204:207], v5, s[36:39], s54 offen offset:192
    buffer_load_dwordx4 v[208:211], v5, s[36:39], s54 offen offset:256
    buffer_load_dwordx4 v[212:215], v5, s[36:39], s54 offen offset:320
    buffer_load_dwordx4 v[216:219], v5, s[36:39], s54 offen offset:384
    buffer_load_dwordx4 v[220:223], v5, s[36:39], s54 offen offset:448
    buffer_load_dwordx4 v[224:227], v5, s[36:39], s54 offen offset:512
    buffer_load_dwordx4 v[228:231], v5, s[36:39], s54 offen offset:576
    buffer_load_dwordx4 v[232:235], v5, s[36:39], s54 offen offset:640
    buffer_load_dwordx4 v[236:239], v5, s[36:39], s54 offen offset:704
    buffer_load_dwordx4 v[240:243], v5, s[36:39], s54 offen offset:768
    buffer_load_dwordx4 v[244:247], v5, s[36:39], s54 offen offset:832
    buffer_load_dwordx4 v[248:251], v5, s[36:39], s54 offen offset:896
    buffer_load_dwordx4 v[252:255], v5, s[36:39], s54 offen offset:960
    s_waitcnt vmcnt(15)
    v_lshlrev_b32 v64, 16, v192
    v_and_b32 v65, 0xffff0000, v192
    v_mov_b32 v8, v64
    v_mov_b32 v9, v65
    v_lshlrev_b32 v66, 16, v193
    v_and_b32 v67, 0xffff0000, v193
    v_mov_b32 v10, v66
    v_mov_b32 v11, v67
    v_lshlrev_b32 v68, 16, v194
    v_and_b32 v69, 0xffff0000, v194
    v_pk_add_f32 v[8:9], v[8:9], v[68:69]
    v_lshlrev_b32 v70, 16, v195
    v_and_b32 v71, 0xffff0000, v195
    v_pk_add_f32 v[10:11], v[10:11], v[70:71]
    s_waitcnt vmcnt(14)
    v_lshlrev_b32 v72, 16, v196
    v_and_b32 v73, 0xffff0000, v196
    v_pk_add_f32 v[8:9], v[8:9], v[72:73]
    v_lshlrev_b32 v74, 16, v197
    v_and_b32 v75, 0xffff0000, v197
    v_pk_add_f32 v[10:11], v[10:11], v[74:75]
    v_lshlrev_b32 v76, 16, v198
    v_and_b32 v77, 0xffff0000, v198
    v_pk_add_f32 v[8:9], v[8:9], v[76:77]
    v_lshlrev_b32 v78, 16, v199
    v_and_b32 v79, 0xffff0000, v199
    v_pk_add_f32 v[10:11], v[10:11], v[78:79]
    s_waitcnt vmcnt(13)
    v_lshlrev_b32 v80, 16, v200
    v_and_b32 v81, 0xffff0000, v200
    v_pk_add_f32 v[8:9], v[8:9], v[80:81]
    v_lshlrev_b32 v82, 16, v201
    v_and_b32 v83, 0xffff0000, v201
    v_pk_add_f32 v[10:11], v[10:11], v[82:83]
    v_lshlrev_b32 v84, 16, v202
    v_and_b32 v85, 0xffff0000, v202
    v_pk_add_f32 v[8:9], v[8:9], v[84:85]
    v_lshlrev_b32 v86, 16, v203
    v_and_b32 v87, 0xffff0000, v203
    v_pk_add_f32 v[10:11], v[10:11], v[86:87]
    s_waitcnt vmcnt(12)
    v_lshlrev_b32 v88, 16, v204
    v_and_b32 v89, 0xffff0000, v204
    v_pk_add_f32 v[8:9], v[8:9], v[88:89]
    v_lshlrev_b32 v90, 16, v205
    v_and_b32 v91, 0xffff0000, v205
    v_pk_add_f32 v[10:11], v[10:11], v[90:91]
    v_lshlrev_b32 v92, 16, v206
    v_and_b32 v93, 0xffff0000, v206
    v_pk_add_f32 v[8:9], v[8:9], v[92:93]
    v_lshlrev_b32 v94, 16, v207
    v_and_b32 v95, 0xffff0000, v207
    v_pk_add_f32 v[10:11], v[10:11], v[94:95]
    s_waitcnt vmcnt(11)
    v_lshlrev_b32 v96, 16, v208
    v_and_b32 v97, 0xffff0000, v208
    v_pk_add_f32 v[8:9], v[8:9], v[96:97]
    v_lshlrev_b32 v98, 16, v209
    v_and_b32 v99, 0xffff0000, v209
    v_pk_add_f32 v[10:11], v[10:11], v[98:99]
    v_lshlrev_b32 v100, 16, v210
    v_and_b32 v101, 0xffff0000, v210
    v_pk_add_f32 v[8:9], v[8:9], v[100:101]
    v_lshlrev_b32 v102, 16, v211
    v_and_b32 v103, 0xffff0000, v211
    v_pk_add_f32 v[10:11], v[10:11], v[102:103]
    s_waitcnt vmcnt(10)
    v_lshlrev_b32 v104, 16, v212
    v_and_b32 v105, 0xffff0000, v212
    v_pk_add_f32 v[8:9], v[8:9], v[104:105]
    v_lshlrev_b32 v106, 16, v213
    v_and_b32 v107, 0xffff0000, v213
    v_pk_add_f32 v[10:11], v[10:11], v[106:107]
    v_lshlrev_b32 v108, 16, v214
    v_and_b32 v109, 0xffff0000, v214
    v_pk_add_f32 v[8:9], v[8:9], v[108:109]
    v_lshlrev_b32 v110, 16, v215
    v_and_b32 v111, 0xffff0000, v215
    v_pk_add_f32 v[10:11], v[10:11], v[110:111]
    s_waitcnt vmcnt(9)
    v_lshlrev_b32 v112, 16, v216
    v_and_b32 v113, 0xffff0000, v216
    v_pk_add_f32 v[8:9], v[8:9], v[112:113]
    v_lshlrev_b32 v114, 16, v217
    v_and_b32 v115, 0xffff0000, v217
    v_pk_add_f32 v[10:11], v[10:11], v[114:115]
    v_lshlrev_b32 v116, 16, v218
    v_and_b32 v117, 0xffff0000, v218
    v_pk_add_f32 v[8:9], v[8:9], v[116:117]
    v_lshlrev_b32 v118, 16, v219
    v_and_b32 v119, 0xffff0000, v219
    v_pk_add_f32 v[10:11], v[10:11], v[118:119]
    s_waitcnt vmcnt(8)
    v_lshlrev_b32 v120, 16, v220
    v_and_b32 v121, 0xffff0000, v220
    v_pk_add_f32 v[8:9], v[8:9], v[120:121]
    v_lshlrev_b32 v122, 16, v221
    v_and_b32 v123, 0xffff0000, v221
    v_pk_add_f32 v[10:11], v[10:11], v[122:123]
    v_lshlrev_b32 v124, 16, v222
    v_and_b32 v125, 0xffff0000, v222
    v_pk_add_f32 v[8:9], v[8:9], v[124:125]
    v_lshlrev_b32 v126, 16, v223
    v_and_b32 v127, 0xffff0000, v223
    v_pk_add_f32 v[10:11], v[10:11], v[126:127]
    s_waitcnt vmcnt(7)
    v_lshlrev_b32 v128, 16, v224
    v_and_b32 v129, 0xffff0000, v224
    v_pk_add_f32 v[8:9], v[8:9], v[128:129]
    v_lshlrev_b32 v130, 16, v225
    v_and_b32 v131, 0xffff0000, v225
    v_pk_add_f32 v[10:11], v[10:11], v[130:131]
    v_lshlrev_b32 v132, 16, v226
    v_and_b32 v133, 0xffff0000, v226
    v_pk_add_f32 v[8:9], v[8:9], v[132:133]
    v_lshlrev_b32 v134, 16, v227
    v_and_b32 v135, 0xffff0000, v227
    v_pk_add_f32 v[10:11], v[10:11], v[134:135]
    s_waitcnt vmcnt(6)
    v_lshlrev_b32 v136, 16, v228
    v_and_b32 v137, 0xffff0000, v228
    v_pk_add_f32 v[8:9], v[8:9], v[136:137]
    v_lshlrev_b32 v138, 16, v229
    v_and_b32 v139, 0xffff0000, v229
    v_pk_add_f32 v[10:11], v[10:11], v[138:139]
    v_lshlrev_b32 v140, 16, v230
    v_and_b32 v141, 0xffff0000, v230
    v_pk_add_f32 v[8:9], v[8:9], v[140:141]
    v_lshlrev_b32 v142, 16, v231
    v_and_b32 v143, 0xffff0000, v231
    v_pk_add_f32 v[10:11], v[10:11], v[142:143]
    s_waitcnt vmcnt(5)
    v_lshlrev_b32 v144, 16, v232
    v_and_b32 v145, 0xffff0000, v232
    v_pk_add_f32 v[8:9], v[8:9], v[144:145]
    v_lshlrev_b32 v146, 16, v233
    v_and_b32 v147, 0xffff0000, v233
    v_pk_add_f32 v[10:11], v[10:11], v[146:147]
    v_lshlrev_b32 v148, 16, v234
    v_and_b32 v149, 0xffff0000, v234
    v_pk_add_f32 v[8:9], v[8:9], v[148:149]
    v_lshlrev_b32 v150, 16, v235
    v_and_b32 v151, 0xffff0000, v235
    v_pk_add_f32 v[10:11], v[10:11], v[150:151]
    s_waitcnt vmcnt(4)
    v_lshlrev_b32 v152, 16, v236
    v_and_b32 v153, 0xffff0000, v236
    v_pk_add_f32 v[8:9], v[8:9], v[152:153]
    v_lshlrev_b32 v154, 16, v237
    v_and_b32 v155, 0xffff0000, v237
    v_pk_add_f32 v[10:11], v[10:11], v[154:155]
    v_lshlrev_b32 v156, 16, v238
    v_and_b32 v157, 0xffff0000, v238
    v_pk_add_f32 v[8:9], v[8:9], v[156:157]
    v_lshlrev_b32 v158, 16, v239
    v_and_b32 v159, 0xffff0000, v239
    v_pk_add_f32 v[10:11], v[10:11], v[158:159]
    s_waitcnt vmcnt(3)
    v_lshlrev_b32 v160, 16, v240
    v_and_b32 v161, 0xffff0000, v240
    v_pk_add_f32 v[8:9], v[8:9], v[160:161]
    v_lshlrev_b32 v162, 16, v241
    v_and_b32 v163, 0xffff0000, v241
    v_pk_add_f32 v[10:11], v[10:11], v[162:163]
    v_lshlrev_b32 v164, 16, v242
    v_and_b32 v165, 0xffff0000, v242
    v_pk_add_f32 v[8:9], v[8:9], v[164:165]
    v_lshlrev_b32 v166, 16, v243
    v_and_b32 v167, 0xffff0000, v243
    v_pk_add_f32 v[10:11], v[10:11], v[166:167]
    s_waitcnt vmcnt(2)
    v_lshlrev_b32 v168, 16, v244
    v_and_b32 v169, 0xffff0000, v244
    v_pk_add_f32 v[8:9], v[8:9], v[168:169]
    v_lshlrev_b32 v170, 16, v245
    v_and_b32 v171, 0xffff0000, v245
    v_pk_add_f32 v[10:11], v[10:11], v[170:171]
    v_lshlrev_b32 v172, 16, v246
    v_and_b32 v173, 0xffff0000, v246
    v_pk_add_f32 v[8:9], v[8:9], v[172:173]
    v_lshlrev_b32 v174, 16, v247
    v_and_b32 v175, 0xffff0000, v247
    v_pk_add_f32 v[10:11], v[10:11], v[174:175]
    s_waitcnt vmcnt(1)
    v_lshlrev_b32 v176, 16, v248
    v_and_b32 v177, 0xffff0000, v248
    v_pk_add_f32 v[8:9], v[8:9], v[176:177]
    v_lshlrev_b32 v178, 16, v249
    v_and_b32 v179, 0xffff0000, v249
    v_pk_add_f32 v[10:11], v[10:11], v[178:179]
    v_lshlrev_b32 v180, 16, v250
    v_and_b32 v181, 0xffff0000, v250
    v_pk_add_f32 v[8:9], v[8:9], v[180:181]
    v_lshlrev_b32 v182, 16, v251
    v_and_b32 v183, 0xffff0000, v251
    v_pk_add_f32 v[10:11], v[10:11], v[182:183]
    s_waitcnt vmcnt(0)
    v_lshlrev_b32 v184, 16, v252
    v_and_b32 v185, 0xffff0000, v252
    v_pk_add_f32 v[8:9], v[8:9], v[184:185]
    v_lshlrev_b32 v186, 16, v253
    v_and_b32 v187, 0xffff0000, v253
    v_pk_add_f32 v[10:11], v[10:11], v[186:187]
    v_lshlrev_b32 v188, 16, v254
    v_and_b32 v189, 0xffff0000, v254
    v_pk_add_f32 v[8:9], v[8:9], v[188:189]
    v_lshlrev_b32 v190, 16, v255
    v_and_b32 v191, 0xffff0000, v255
    v_pk_add_f32 v[10:11], v[10:11], v[190:191]
    v_pk_add_f32 v[8:9], v[8:9], v[10:11]
    v_add_f32 v8, v8, v9
    v_mov_b32 v9, v8
    s_nop 1
    v_permlane16_swap_b32 v8, v9
    v_add_f32 v8, v8, v9
    v_mov_b32 v9, v8
    s_nop 1
    v_permlane32_swap_b32 v8, v9
    v_add_f32 v8, v8, v9
    v_mul_f32 v8, 3137339392, v8
    v_mov_b32 v9, v8
    v_mov_b32 v12, 0
    v_mov_b32 v13, 0
    v_mov_b32 v14, 0
    v_mov_b32 v15, 0
    v_pk_add_f32 v[64:65], v[64:65], v[8:9]
    v_pk_fma_f32 v[12:13], v[64:65], v[64:65], v[12:13]
    v_pk_add_f32 v[66:67], v[66:67], v[8:9]
    v_pk_fma_f32 v[14:15], v[66:67], v[66:67], v[14:15]
    v_pk_add_f32 v[68:69], v[68:69], v[8:9]
    v_pk_fma_f32 v[12:13], v[68:69], v[68:69], v[12:13]
    v_pk_add_f32 v[70:71], v[70:71], v[8:9]
    v_pk_fma_f32 v[14:15], v[70:71], v[70:71], v[14:15]
    v_pk_add_f32 v[72:73], v[72:73], v[8:9]
    v_pk_fma_f32 v[12:13], v[72:73], v[72:73], v[12:13]
    v_pk_add_f32 v[74:75], v[74:75], v[8:9]
    v_pk_fma_f32 v[14:15], v[74:75], v[74:75], v[14:15]
    v_pk_add_f32 v[76:77], v[76:77], v[8:9]
    v_pk_fma_f32 v[12:13], v[76:77], v[76:77], v[12:13]
    v_pk_add_f32 v[78:79], v[78:79], v[8:9]
    v_pk_fma_f32 v[14:15], v[78:79], v[78:79], v[14:15]
    v_pk_add_f32 v[80:81], v[80:81], v[8:9]
    v_pk_fma_f32 v[12:13], v[80:81], v[80:81], v[12:13]
    v_pk_add_f32 v[82:83], v[82:83], v[8:9]
    v_pk_fma_f32 v[14:15], v[82:83], v[82:83], v[14:15]
    v_pk_add_f32 v[84:85], v[84:85], v[8:9]
    v_pk_fma_f32 v[12:13], v[84:85], v[84:85], v[12:13]
    v_pk_add_f32 v[86:87], v[86:87], v[8:9]
    v_pk_fma_f32 v[14:15], v[86:87], v[86:87], v[14:15]
    v_pk_add_f32 v[88:89], v[88:89], v[8:9]
    v_pk_fma_f32 v[12:13], v[88:89], v[88:89], v[12:13]
    v_pk_add_f32 v[90:91], v[90:91], v[8:9]
    v_pk_fma_f32 v[14:15], v[90:91], v[90:91], v[14:15]
    v_pk_add_f32 v[92:93], v[92:93], v[8:9]
    v_pk_fma_f32 v[12:13], v[92:93], v[92:93], v[12:13]
    v_pk_add_f32 v[94:95], v[94:95], v[8:9]
    v_pk_fma_f32 v[14:15], v[94:95], v[94:95], v[14:15]
    v_pk_add_f32 v[96:97], v[96:97], v[8:9]
    v_pk_fma_f32 v[12:13], v[96:97], v[96:97], v[12:13]
    v_pk_add_f32 v[98:99], v[98:99], v[8:9]
    v_pk_fma_f32 v[14:15], v[98:99], v[98:99], v[14:15]
    v_pk_add_f32 v[100:101], v[100:101], v[8:9]
    v_pk_fma_f32 v[12:13], v[100:101], v[100:101], v[12:13]
    v_pk_add_f32 v[102:103], v[102:103], v[8:9]
    v_pk_fma_f32 v[14:15], v[102:103], v[102:103], v[14:15]
    v_pk_add_f32 v[104:105], v[104:105], v[8:9]
    v_pk_fma_f32 v[12:13], v[104:105], v[104:105], v[12:13]
    v_pk_add_f32 v[106:107], v[106:107], v[8:9]
    v_pk_fma_f32 v[14:15], v[106:107], v[106:107], v[14:15]
    v_pk_add_f32 v[108:109], v[108:109], v[8:9]
    v_pk_fma_f32 v[12:13], v[108:109], v[108:109], v[12:13]
    v_pk_add_f32 v[110:111], v[110:111], v[8:9]
    v_pk_fma_f32 v[14:15], v[110:111], v[110:111], v[14:15]
    v_pk_add_f32 v[112:113], v[112:113], v[8:9]
    v_pk_fma_f32 v[12:13], v[112:113], v[112:113], v[12:13]
    v_pk_add_f32 v[114:115], v[114:115], v[8:9]
    v_pk_fma_f32 v[14:15], v[114:115], v[114:115], v[14:15]
    v_pk_add_f32 v[116:117], v[116:117], v[8:9]
    v_pk_fma_f32 v[12:13], v[116:117], v[116:117], v[12:13]
    v_pk_add_f32 v[118:119], v[118:119], v[8:9]
    v_pk_fma_f32 v[14:15], v[118:119], v[118:119], v[14:15]
    v_pk_add_f32 v[120:121], v[120:121], v[8:9]
    v_pk_fma_f32 v[12:13], v[120:121], v[120:121], v[12:13]
    v_pk_add_f32 v[122:123], v[122:123], v[8:9]
    v_pk_fma_f32 v[14:15], v[122:123], v[122:123], v[14:15]
    v_pk_add_f32 v[124:125], v[124:125], v[8:9]
    v_pk_fma_f32 v[12:13], v[124:125], v[124:125], v[12:13]
    v_pk_add_f32 v[126:127], v[126:127], v[8:9]
    v_pk_fma_f32 v[14:15], v[126:127], v[126:127], v[14:15]
    v_pk_add_f32 v[128:129], v[128:129], v[8:9]
    v_pk_fma_f32 v[12:13], v[128:129], v[128:129], v[12:13]
    v_pk_add_f32 v[130:131], v[130:131], v[8:9]
    v_pk_fma_f32 v[14:15], v[130:131], v[130:131], v[14:15]
    v_pk_add_f32 v[132:133], v[132:133], v[8:9]
    v_pk_fma_f32 v[12:13], v[132:133], v[132:133], v[12:13]
    v_pk_add_f32 v[134:135], v[134:135], v[8:9]
    v_pk_fma_f32 v[14:15], v[134:135], v[134:135], v[14:15]
    v_pk_add_f32 v[136:137], v[136:137], v[8:9]
    v_pk_fma_f32 v[12:13], v[136:137], v[136:137], v[12:13]
    v_pk_add_f32 v[138:139], v[138:139], v[8:9]
    v_pk_fma_f32 v[14:15], v[138:139], v[138:139], v[14:15]
    v_pk_add_f32 v[140:141], v[140:141], v[8:9]
    v_pk_fma_f32 v[12:13], v[140:141], v[140:141], v[12:13]
    v_pk_add_f32 v[142:143], v[142:143], v[8:9]
    v_pk_fma_f32 v[14:15], v[142:143], v[142:143], v[14:15]
    v_pk_add_f32 v[144:145], v[144:145], v[8:9]
    v_pk_fma_f32 v[12:13], v[144:145], v[144:145], v[12:13]
    v_pk_add_f32 v[146:147], v[146:147], v[8:9]
    v_pk_fma_f32 v[14:15], v[146:147], v[146:147], v[14:15]
    v_pk_add_f32 v[148:149], v[148:149], v[8:9]
    v_pk_fma_f32 v[12:13], v[148:149], v[148:149], v[12:13]
    v_pk_add_f32 v[150:151], v[150:151], v[8:9]
    v_pk_fma_f32 v[14:15], v[150:151], v[150:151], v[14:15]
    v_pk_add_f32 v[152:153], v[152:153], v[8:9]
    v_pk_fma_f32 v[12:13], v[152:153], v[152:153], v[12:13]
    v_pk_add_f32 v[154:155], v[154:155], v[8:9]
    v_pk_fma_f32 v[14:15], v[154:155], v[154:155], v[14:15]
    v_pk_add_f32 v[156:157], v[156:157], v[8:9]
    v_pk_fma_f32 v[12:13], v[156:157], v[156:157], v[12:13]
    v_pk_add_f32 v[158:159], v[158:159], v[8:9]
    v_pk_fma_f32 v[14:15], v[158:159], v[158:159], v[14:15]
    v_pk_add_f32 v[160:161], v[160:161], v[8:9]
    v_pk_fma_f32 v[12:13], v[160:161], v[160:161], v[12:13]
    v_pk_add_f32 v[162:163], v[162:163], v[8:9]
    v_pk_fma_f32 v[14:15], v[162:163], v[162:163], v[14:15]
    v_pk_add_f32 v[164:165], v[164:165], v[8:9]
    v_pk_fma_f32 v[12:13], v[164:165], v[164:165], v[12:13]
    v_pk_add_f32 v[166:167], v[166:167], v[8:9]
    v_pk_fma_f32 v[14:15], v[166:167], v[166:167], v[14:15]
    v_pk_add_f32 v[168:169], v[168:169], v[8:9]
    v_pk_fma_f32 v[12:13], v[168:169], v[168:169], v[12:13]
    v_pk_add_f32 v[170:171], v[170:171], v[8:9]
    v_pk_fma_f32 v[14:15], v[170:171], v[170:171], v[14:15]
    v_pk_add_f32 v[172:173], v[172:173], v[8:9]
    v_pk_fma_f32 v[12:13], v[172:173], v[172:173], v[12:13]
    v_pk_add_f32 v[174:175], v[174:175], v[8:9]
    v_pk_fma_f32 v[14:15], v[174:175], v[174:175], v[14:15]
    v_pk_add_f32 v[176:177], v[176:177], v[8:9]
    v_pk_fma_f32 v[12:13], v[176:177], v[176:177], v[12:13]
    v_pk_add_f32 v[178:179], v[178:179], v[8:9]
    v_pk_fma_f32 v[14:15], v[178:179], v[178:179], v[14:15]
    v_pk_add_f32 v[180:181], v[180:181], v[8:9]
    v_pk_fma_f32 v[12:13], v[180:181], v[180:181], v[12:13]
    v_pk_add_f32 v[182:183], v[182:183], v[8:9]
    v_pk_fma_f32 v[14:15], v[182:183], v[182:183], v[14:15]
    v_pk_add_f32 v[184:185], v[184:185], v[8:9]
    v_pk_fma_f32 v[12:13], v[184:185], v[184:185], v[12:13]
    v_pk_add_f32 v[186:187], v[186:187], v[8:9]
    v_pk_fma_f32 v[14:15], v[186:187], v[186:187], v[14:15]
    v_pk_add_f32 v[188:189], v[188:189], v[8:9]
    v_pk_fma_f32 v[12:13], v[188:189], v[188:189], v[12:13]
    v_pk_add_f32 v[190:191], v[190:191], v[8:9]
    v_pk_fma_f32 v[14:15], v[190:191], v[190:191], v[14:15]
    v_pk_add_f32 v[12:13], v[12:13], v[14:15]
    v_add_f32 v12, v12, v13
    v_mov_b32 v13, v12
    s_nop 1
    v_permlane16_swap_b32 v12, v13
    v_add_f32 v12, v12, v13
    v_mov_b32 v13, v12
    s_nop 1
    v_permlane32_swap_b32 v12, v13
    v_add_f32 v12, v12, v13
    v_mov_b32 v13, 925353388
    v_fmac_f32 v13, 989855744, v12
    v_rsq_f32 v12, v13
    s_nop 0
    v_mov_b32 v13, v12
    s_lshl_b32 s54, s86, 14
    s_add_u32 s54, s54, 1048576
    v_pk_mul_f32 v[64:65], v[64:65], v[12:13]
    v_cvt_pk_bf16_f32 v192, v64, v65
    v_pk_mul_f32 v[66:67], v[66:67], v[12:13]
    v_cvt_pk_bf16_f32 v193, v66, v67
    v_pk_mul_f32 v[68:69], v[68:69], v[12:13]
    v_cvt_pk_bf16_f32 v194, v68, v69
    v_pk_mul_f32 v[70:71], v[70:71], v[12:13]
    v_cvt_pk_bf16_f32 v195, v70, v71
    buffer_store_dwordx4 v[192:195], v0, s[28:31], s54 offen offset:0 sc1
    v_pk_mul_f32 v[72:73], v[72:73], v[12:13]
    v_cvt_pk_bf16_f32 v196, v72, v73
    v_pk_mul_f32 v[74:75], v[74:75], v[12:13]
    v_cvt_pk_bf16_f32 v197, v74, v75
    v_pk_mul_f32 v[76:77], v[76:77], v[12:13]
    v_cvt_pk_bf16_f32 v198, v76, v77
    v_pk_mul_f32 v[78:79], v[78:79], v[12:13]
    v_cvt_pk_bf16_f32 v199, v78, v79
    buffer_store_dwordx4 v[196:199], v0, s[28:31], s54 offen offset:1024 sc1
    v_pk_mul_f32 v[80:81], v[80:81], v[12:13]
    v_cvt_pk_bf16_f32 v200, v80, v81
    v_pk_mul_f32 v[82:83], v[82:83], v[12:13]
    v_cvt_pk_bf16_f32 v201, v82, v83
    v_pk_mul_f32 v[84:85], v[84:85], v[12:13]
    v_cvt_pk_bf16_f32 v202, v84, v85
    v_pk_mul_f32 v[86:87], v[86:87], v[12:13]
    v_cvt_pk_bf16_f32 v203, v86, v87
    buffer_store_dwordx4 v[200:203], v0, s[28:31], s54 offen offset:2048 sc1
    v_pk_mul_f32 v[88:89], v[88:89], v[12:13]
    v_cvt_pk_bf16_f32 v204, v88, v89
    v_pk_mul_f32 v[90:91], v[90:91], v[12:13]
    v_cvt_pk_bf16_f32 v205, v90, v91
    v_pk_mul_f32 v[92:93], v[92:93], v[12:13]
    v_cvt_pk_bf16_f32 v206, v92, v93
    v_pk_mul_f32 v[94:95], v[94:95], v[12:13]
    v_cvt_pk_bf16_f32 v207, v94, v95
    buffer_store_dwordx4 v[204:207], v0, s[28:31], s54 offen offset:3072 sc1
    s_add_u32 s54, s54, 4096
    v_pk_mul_f32 v[96:97], v[96:97], v[12:13]
    v_cvt_pk_bf16_f32 v208, v96, v97
    v_pk_mul_f32 v[98:99], v[98:99], v[12:13]
    v_cvt_pk_bf16_f32 v209, v98, v99
    v_pk_mul_f32 v[100:101], v[100:101], v[12:13]
    v_cvt_pk_bf16_f32 v210, v100, v101
    v_pk_mul_f32 v[102:103], v[102:103], v[12:13]
    v_cvt_pk_bf16_f32 v211, v102, v103
    buffer_store_dwordx4 v[208:211], v0, s[28:31], s54 offen offset:0 sc1
    v_pk_mul_f32 v[104:105], v[104:105], v[12:13]
    v_cvt_pk_bf16_f32 v212, v104, v105
    v_pk_mul_f32 v[106:107], v[106:107], v[12:13]
    v_cvt_pk_bf16_f32 v213, v106, v107
    v_pk_mul_f32 v[108:109], v[108:109], v[12:13]
    v_cvt_pk_bf16_f32 v214, v108, v109
    v_pk_mul_f32 v[110:111], v[110:111], v[12:13]
    v_cvt_pk_bf16_f32 v215, v110, v111
    buffer_store_dwordx4 v[212:215], v0, s[28:31], s54 offen offset:1024 sc1
    v_pk_mul_f32 v[112:113], v[112:113], v[12:13]
    v_cvt_pk_bf16_f32 v216, v112, v113
    v_pk_mul_f32 v[114:115], v[114:115], v[12:13]
    v_cvt_pk_bf16_f32 v217, v114, v115
    v_pk_mul_f32 v[116:117], v[116:117], v[12:13]
    v_cvt_pk_bf16_f32 v218, v116, v117
    v_pk_mul_f32 v[118:119], v[118:119], v[12:13]
    v_cvt_pk_bf16_f32 v219, v118, v119
    buffer_store_dwordx4 v[216:219], v0, s[28:31], s54 offen offset:2048 sc1
    v_pk_mul_f32 v[120:121], v[120:121], v[12:13]
    v_cvt_pk_bf16_f32 v220, v120, v121
    v_pk_mul_f32 v[122:123], v[122:123], v[12:13]
    v_cvt_pk_bf16_f32 v221, v122, v123
    v_pk_mul_f32 v[124:125], v[124:125], v[12:13]
    v_cvt_pk_bf16_f32 v222, v124, v125
    v_pk_mul_f32 v[126:127], v[126:127], v[12:13]
    v_cvt_pk_bf16_f32 v223, v126, v127
    buffer_store_dwordx4 v[220:223], v0, s[28:31], s54 offen offset:3072 sc1
    s_add_u32 s54, s54, 4096
    v_pk_mul_f32 v[128:129], v[128:129], v[12:13]
    v_cvt_pk_bf16_f32 v224, v128, v129
    v_pk_mul_f32 v[130:131], v[130:131], v[12:13]
    v_cvt_pk_bf16_f32 v225, v130, v131
    v_pk_mul_f32 v[132:133], v[132:133], v[12:13]
    v_cvt_pk_bf16_f32 v226, v132, v133
    v_pk_mul_f32 v[134:135], v[134:135], v[12:13]
    v_cvt_pk_bf16_f32 v227, v134, v135
    buffer_store_dwordx4 v[224:227], v0, s[28:31], s54 offen offset:0 sc1
    v_pk_mul_f32 v[136:137], v[136:137], v[12:13]
    v_cvt_pk_bf16_f32 v228, v136, v137
    v_pk_mul_f32 v[138:139], v[138:139], v[12:13]
    v_cvt_pk_bf16_f32 v229, v138, v139
    v_pk_mul_f32 v[140:141], v[140:141], v[12:13]
    v_cvt_pk_bf16_f32 v230, v140, v141
    v_pk_mul_f32 v[142:143], v[142:143], v[12:13]
    v_cvt_pk_bf16_f32 v231, v142, v143
    buffer_store_dwordx4 v[228:231], v0, s[28:31], s54 offen offset:1024 sc1
    v_pk_mul_f32 v[144:145], v[144:145], v[12:13]
    v_cvt_pk_bf16_f32 v232, v144, v145
    v_pk_mul_f32 v[146:147], v[146:147], v[12:13]
    v_cvt_pk_bf16_f32 v233, v146, v147
    v_pk_mul_f32 v[148:149], v[148:149], v[12:13]
    v_cvt_pk_bf16_f32 v234, v148, v149
    v_pk_mul_f32 v[150:151], v[150:151], v[12:13]
    v_cvt_pk_bf16_f32 v235, v150, v151
    buffer_store_dwordx4 v[232:235], v0, s[28:31], s54 offen offset:2048 sc1
    v_pk_mul_f32 v[152:153], v[152:153], v[12:13]
    v_cvt_pk_bf16_f32 v236, v152, v153
    v_pk_mul_f32 v[154:155], v[154:155], v[12:13]
    v_cvt_pk_bf16_f32 v237, v154, v155
    v_pk_mul_f32 v[156:157], v[156:157], v[12:13]
    v_cvt_pk_bf16_f32 v238, v156, v157
    v_pk_mul_f32 v[158:159], v[158:159], v[12:13]
    v_cvt_pk_bf16_f32 v239, v158, v159
    buffer_store_dwordx4 v[236:239], v0, s[28:31], s54 offen offset:3072 sc1
    s_add_u32 s54, s54, 4096
    v_pk_mul_f32 v[160:161], v[160:161], v[12:13]
    v_cvt_pk_bf16_f32 v240, v160, v161
    v_pk_mul_f32 v[162:163], v[162:163], v[12:13]
    v_cvt_pk_bf16_f32 v241, v162, v163
    v_pk_mul_f32 v[164:165], v[164:165], v[12:13]
    v_cvt_pk_bf16_f32 v242, v164, v165
    v_pk_mul_f32 v[166:167], v[166:167], v[12:13]
    v_cvt_pk_bf16_f32 v243, v166, v167
    buffer_store_dwordx4 v[240:243], v0, s[28:31], s54 offen offset:0 sc1
    v_pk_mul_f32 v[168:169], v[168:169], v[12:13]
    v_cvt_pk_bf16_f32 v244, v168, v169
    v_pk_mul_f32 v[170:171], v[170:171], v[12:13]
    v_cvt_pk_bf16_f32 v245, v170, v171
    v_pk_mul_f32 v[172:173], v[172:173], v[12:13]
    v_cvt_pk_bf16_f32 v246, v172, v173
    v_pk_mul_f32 v[174:175], v[174:175], v[12:13]
    v_cvt_pk_bf16_f32 v247, v174, v175
    buffer_store_dwordx4 v[244:247], v0, s[28:31], s54 offen offset:1024 sc1
    v_pk_mul_f32 v[176:177], v[176:177], v[12:13]
    v_cvt_pk_bf16_f32 v248, v176, v177
    v_pk_mul_f32 v[178:179], v[178:179], v[12:13]
    v_cvt_pk_bf16_f32 v249, v178, v179
    v_pk_mul_f32 v[180:181], v[180:181], v[12:13]
    v_cvt_pk_bf16_f32 v250, v180, v181
    v_pk_mul_f32 v[182:183], v[182:183], v[12:13]
    v_cvt_pk_bf16_f32 v251, v182, v183
    buffer_store_dwordx4 v[248:251], v0, s[28:31], s54 offen offset:2048 sc1
    v_pk_mul_f32 v[184:185], v[184:185], v[12:13]
    v_cvt_pk_bf16_f32 v252, v184, v185
    v_pk_mul_f32 v[186:187], v[186:187], v[12:13]
    v_cvt_pk_bf16_f32 v253, v186, v187
    v_pk_mul_f32 v[188:189], v[188:189], v[12:13]
    v_cvt_pk_bf16_f32 v254, v188, v189
    v_pk_mul_f32 v[190:191], v[190:191], v[12:13]
    v_cvt_pk_bf16_f32 v255, v190, v191
    buffer_store_dwordx4 v[252:255], v0, s[28:31], s54 offen offset:3072 sc1
    s_add_u32 s54, s54, 4096
    s_waitcnt vmcnt(0)
    s_lshl_b32 s55, s86, 3
    s_add_u32 s55, s55, 8192
    s_waitcnt lgkmcnt(0)
    s_add_u32 s42, s42, 0x7F4A7C15
    s_addc_u32 s43, s43, 0x9E3779B9
    v_mov_b32 v8, s42
    v_mov_b32 v9, s43
    s_mov_b64 exec, 1
    buffer_store_dwordx2 v[8:9], off, s[28:31], s55 sc1
    s_mov_b64 exec, -1
    s_sub_u32 s42, s42, 0x7F4A7C15
    s_subb_u32 s43, s43, 0x9E3779B9
L_noln_91:
    s_mov_b32 s68, s67
    s_mov_b32 s69, 7
    s_mov_b32 s70, 64
    s_lshl_b32 s73, s65, 9
    s_add_u32 s73, s73, 32768
    s_and_b32 s54, s44, 3
    s_lshl_b32 s47, s54, 12
    s_lshl_b32 s54, s54, 6
    v_xor_b32 v49, s54, v0
    v_lshrrev_b32 v48, 8, v0
    v_mul_u32_u24 v48, 7936, v48
    v_add_u32 v48, v48, v49
    s_mov_b32 s32, s10
    s_and_b32 s33, s11, 0xffff
    s_mov_b32 s34, 4194304
    s_mov_b32 s35, 0x20000
    s_lshl_b32 s48, s65, 8
    s_lshl_b32 s54, s44, 16
    s_add_u32 s48, s48, s54
    s_add_u32 m0, s47, 98304
    s_add_u32 s54, s48, 0
    buffer_load_dwordx4 v48, s[32:35], s54 offen lds
    s_add_u32 m0, s47, 99328
    s_add_u32 s54, s48, 32768
    buffer_load_dwordx4 v48, s[32:35], s54 offen lds
    s_add_u32 m0, s47, 100352
    s_add_u32 s54, s48, 262144
    buffer_load_dwordx4 v48, s[32:35], s54 offen lds
    s_add_u32 m0, s47, 101376
    s_add_u32 s54, s48, 294912
    buffer_load_dwordx4 v48, s[32:35], s54 offen lds
    s_add_u32 m0, s47, 114688
    s_add_u32 s54, s48, 524288
    buffer_load_dwordx4 v48, s[32:35], s54 offen lds
    s_add_u32 m0, s47, 115712
    s_add_u32 s54, s48, 557056
    buffer_load_dwordx4 v48, s[32:35], s54 offen lds
    s_add_u32 m0, s47, 116736
    s_add_u32 s54, s48, 786432
    buffer_load_dwordx4 v48, s[32:35], s54 offen lds
    s_add_u32 m0, s47, 117760
    s_add_u32 s54, s48, 819200
    buffer_load_dwordx4 v48, s[32:35], s54 offen lds
    s_add_u32 m0, s47, 131072
    s_add_u32 s54, s48, 1048576
    buffer_load_dwordx4 v48, s[32:35], s54 offen lds
    s_add_u32 m0, s47, 132096
    s_add_u32 s54, s48, 1081344
    buffer_load_dwordx4 v48, s[32:35], s54 offen lds
    s_add_u32 m0, s47, 133120
    s_add_u32 s54, s48, 1310720
    buffer_load_dwordx4 v48, s[32:35], s54 offen lds
    s_add_u32 m0, s47, 134144
    s_add_u32 s54, s48, 1343488
    buffer_load_dwordx4 v48, s[32:35], s54 offen lds
    s_waitcnt lgkmcnt(0)
    s_add_u32 s42, s42, 0x7F4A7C15
    s_addc_u32 s43, s43, 0x9E3779B9
    v_lshrrev_b32 v32, 8, v0
    v_bfe_u32 v33, v0, 4, 4
    v_lshlrev_b32 v33, 2, v33
    v_lshl_add_u32 v33, v32, 12, v33
    v_add_u32 v33, 98304, v33
    v_xor_b32 v50, s44, v32
    v_lshl_add_u32 v50, v50, 6, v33
    v_add_u32 v51, 0x10000, v50
    s_waitcnt vmcnt(8)
    s_barrier
    s_add_u32 m0, s47, 147456
    s_add_u32 s54, s48, 1572864
    buffer_load_dwordx4 v48, s[32:35], s54 offen lds
    s_add_u32 m0, s47, 148480
    s_add_u32 s54, s48, 1605632
    buffer_load_dwordx4 v48, s[32:35], s54 offen lds
    s_add_u32 m0, s47, 149504
    s_add_u32 s54, s48, 1835008
    buffer_load_dwordx4 v48, s[32:35], s54 offen lds
    s_add_u32 m0, s47, 150528
    s_add_u32 s54, s48, 1867776
    buffer_load_dwordx4 v48, s[32:35], s54 offen lds
    buffer_load_dwordx2 v[16:17], off, s[28:31], 0 offset:2048 sc1
    ds_read2st64_b32 v[32:33], v50 offset0:0 offset1:1
    ds_read2st64_b32 v[34:35], v50 offset0:2 offset1:3
    ds_read2st64_b32 v[36:37], v50 offset0:4 offset1:5
    ds_read2st64_b32 v[38:39], v50 offset0:6 offset1:7
    ds_read2st64_b32 v[40:41], v50 offset0:8 offset1:9
    ds_read2st64_b32 v[42:43], v50 offset0:10 offset1:11
    ds_read2st64_b32 v[44:45], v50 offset0:12 offset1:13
    ds_read2st64_b32 v[46:47], v50 offset0:14 offset1:15
    s_waitcnt lgkmcnt(6)
    v_perm_b32 v60, v33, v32, s52
    v_accvgpr_write_b32 a0, v60
    v_perm_b32 v61, v33, v32, s53
    v_accvgpr_write_b32 a8, v61
    v_perm_b32 v62, v35, v34, s52
    v_accvgpr_write_b32 a1, v62
    v_perm_b32 v63, v35, v34, s53
    v_accvgpr_write_b32 a9, v63
    s_waitcnt lgkmcnt(4)
    v_perm_b32 v60, v37, v36, s52
    v_accvgpr_write_b32 a2, v60
    v_perm_b32 v61, v37, v36, s53
    v_accvgpr_write_b32 a10, v61
    v_perm_b32 v62, v39, v38, s52
    v_accvgpr_write_b32 a3, v62
    v_perm_b32 v63, v39, v38, s53
    v_accvgpr_write_b32 a11, v63
    s_waitcnt lgkmcnt(2)
    v_perm_b32 v60, v41, v40, s52
    v_accvgpr_write_b32 a4, v60
    v_perm_b32 v61, v41, v40, s53
    v_accvgpr_write_b32 a12, v61
    v_perm_b32 v62, v43, v42, s52
    v_accvgpr_write_b32 a5, v62
    v_perm_b32 v63, v43, v42, s53
    v_accvgpr_write_b32 a13, v63
    s_waitcnt lgkmcnt(0)
    v_perm_b32 v60, v45, v44, s52
    v_accvgpr_write_b32 a6, v60
    v_perm_b32 v61, v45, v44, s53
    v_accvgpr_write_b32 a14, v61
    v_perm_b32 v62, v47, v46, s52
    v_accvgpr_write_b32 a7, v62
    v_perm_b32 v63, v47, v46, s53
    v_accvgpr_write_b32 a15, v63
    s_waitcnt vmcnt(9)
    s_barrier
    s_add_u32 m0, s47, 98304
    s_add_u32 s54, s48, 2097152
    buffer_load_dwordx4 v48, s[32:35], s54 offen lds
    s_add_u32 m0, s47, 99328
    s_add_u32 s54, s48, 2129920
    buffer_load_dwordx4 v48, s[32:35], s54 offen lds
    s_add_u32 m0, s47, 100352
    s_add_u32 s54, s48, 2359296
    buffer_load_dwordx4 v48, s[32:35], s54 offen lds
    s_add_u32 m0, s47, 101376
    s_add_u32 s54, s48, 2392064
    buffer_load_dwordx4 v48, s[32:35], s54 offen lds
    ds_read2st64_b32 v[32:33], v50 offset0:64 offset1:65
    ds_read2st64_b32 v[34:35], v50 offset0:66 offset1:67
    ds_read2st64_b32 v[36:37], v50 offset0:68 offset1:69
    ds_read2st64_b32 v[38:39], v50 offset0:70 offset1:71
    ds_read2st64_b32 v[40:41], v50 offset0:72 offset1:73
    ds_read2st64_b32 v[42:43], v50 offset0:74 offset1:75
    ds_read2st64_b32 v[44:45], v50 offset0:76 offset1:77
    ds_read2st64_b32 v[46:47], v50 offset0:78 offset1:79
    s_waitcnt lgkmcnt(6)
    v_perm_b32 v60, v33, v32, s52
    v_accvgpr_write_b32 a16, v60
    v_perm_b32 v61, v33, v32, s53
    v_accvgpr_write_b32 a24, v61
    v_perm_b32 v62, v35, v34, s52
    v_accvgpr_write_b32 a17, v62
    v_perm_b32 v63, v35, v34, s53
    v_accvgpr_write_b32 a25, v63
    s_waitcnt lgkmcnt(4)
    v_perm_b32 v60, v37, v36, s52
    v_accvgpr_write_b32 a18, v60
    v_perm_b32 v61, v37, v36, s53
    v_accvgpr_write_b32 a26, v61
    v_perm_b32 v62, v39, v38, s52
    v_accvgpr_write_b32 a19, v62
    v_perm_b32 v63, v39, v38, s53
    v_accvgpr_write_b32 a27, v63
    s_waitcnt lgkmcnt(2)
    v_perm_b32 v60, v41, v40, s52
    v_accvgpr_write_b32 a20, v60
    v_perm_b32 v61, v41, v40, s53
    v_accvgpr_write_b32 a28, v61
    v_perm_b32 v62, v43, v42, s52
    v_accvgpr_write_b32 a21, v62
    v_perm_b32 v63, v43, v42, s53
    v_accvgpr_write_b32 a29, v63
    s_waitcnt lgkmcnt(0)
    v_perm_b32 v60, v45, v44, s52
    v_accvgpr_write_b32 a22, v60
    v_perm_b32 v61, v45, v44, s53
    v_accvgpr_write_b32 a30, v61
    v_perm_b32 v62, v47, v46, s52
    v_accvgpr_write_b32 a23, v62
    v_perm_b32 v63, v47, v46, s53
    v_accvgpr_write_b32 a31, v63
    s_waitcnt vmcnt(9)
    s_barrier
    s_add_u32 m0, s47, 114688
    s_add_u32 s54, s48, 2621440
    buffer_load_dwordx4 v48, s[32:35], s54 offen lds
    s_add_u32 m0, s47, 115712
    s_add_u32 s54, s48, 2654208
    buffer_load_dwordx4 v48, s[32:35], s54 offen lds
    s_add_u32 m0, s47, 116736
    s_add_u32 s54, s48, 2883584
    buffer_load_dwordx4 v48, s[32:35], s54 offen lds
    s_add_u32 m0, s47, 117760
    s_add_u32 s54, s48, 2916352
    buffer_load_dwordx4 v48, s[32:35], s54 offen lds
    ds_read2st64_b32 v[32:33], v50 offset0:128 offset1:129
    ds_read2st64_b32 v[34:35], v50 offset0:130 offset1:131
    ds_read2st64_b32 v[36:37], v50 offset0:132 offset1:133
    ds_read2st64_b32 v[38:39], v50 offset0:134 offset1:135
    ds_read2st64_b32 v[40:41], v50 offset0:136 offset1:137
    ds_read2st64_b32 v[42:43], v50 offset0:138 offset1:139
    ds_read2st64_b32 v[44:45], v50 offset0:140 offset1:141
    ds_read2st64_b32 v[46:47], v50 offset0:142 offset1:143
    s_waitcnt lgkmcnt(6)
    v_perm_b32 v60, v33, v32, s52
    v_accvgpr_write_b32 a32, v60
    v_perm_b32 v61, v33, v32, s53
    v_accvgpr_write_b32 a40, v61
    v_perm_b32 v62, v35, v34, s52
    v_accvgpr_write_b32 a33, v62
    v_perm_b32 v63, v35, v34, s53
    v_accvgpr_write_b32 a41, v63
    s_waitcnt lgkmcnt(4)
    v_perm_b32 v60, v37, v36, s52
    v_accvgpr_write_b32 a34, v60
    v_perm_b32 v61, v37, v36, s53
    v_accvgpr_write_b32 a42, v61
    v_perm_b32 v62, v39, v38, s52
    v_accvgpr_write_b32 a35, v62
    v_perm_b32 v63, v39, v38, s53
    v_accvgpr_write_b32 a43, v63
    s_waitcnt lgkmcnt(2)
    v_perm_b32 v60, v41, v40, s52
    v_accvgpr_write_b32 a36, v60
    v_perm_b32 v61, v41, v40, s53
    v_accvgpr_write_b32 a44, v61
    v_perm_b32 v62, v43, v42, s52
    v_accvgpr_write_b32 a37, v62
    v_perm_b32 v63, v43, v42, s53
    v_accvgpr_write_b32 a45, v63
    s_waitcnt lgkmcnt(0)
    v_perm_b32 v60, v45, v44, s52
    v_accvgpr_write_b32 a38, v60
    v_perm_b32 v61, v45, v44, s53
    v_accvgpr_write_b32 a46, v61
    v_perm_b32 v62, v47, v46, s52
    v_accvgpr_write_b32 a39, v62
    v_perm_b32 v63, v47, v46, s53
    v_accvgpr_write_b32 a47, v63
    s_waitcnt vmcnt(9)
    s_barrier
    s_add_u32 m0, s47, 131072
    s_add_u32 s54, s48, 3145728
    buffer_load_dwordx4 v48, s[32:35], s54 offen lds
    s_add_u32 m0, s47, 132096
    s_add_u32 s54, s48, 3178496
    buffer_load_dwordx4 v48, s[32:35], s54 offen lds
    s_add_u32 m0, s47, 133120
    s_add_u32 s54, s48, 3407872
    buffer_load_dwordx4 v48, s[32:35], s54 offen lds
    s_add_u32 m0, s47, 134144
    s_add_u32 s54, s48, 3440640
    buffer_load_dwordx4 v48, s[32:35], s54 offen lds
    ds_read2st64_b32 v[32:33], v50 offset0:192 offset1:193
    ds_read2st64_b32 v[34:35], v50 offset0:194 offset1:195
    ds_read2st64_b32 v[36:37], v50 offset0:196 offset1:197
    ds_read2st64_b32 v[38:39], v50 offset0:198 offset1:199
    ds_read2st64_b32 v[40:41], v50 offset0:200 offset1:201
    ds_read2st64_b32 v[42:43], v50 offset0:202 offset1:203
    ds_read2st64_b32 v[44:45], v50 offset0:204 offset1:205
    ds_read2st64_b32 v[46:47], v50 offset0:206 offset1:207
    s_waitcnt lgkmcnt(6)
    v_perm_b32 v60, v33, v32, s52
    v_accvgpr_write_b32 a48, v60
    v_perm_b32 v61, v33, v32, s53
    v_accvgpr_write_b32 a56, v61
    v_perm_b32 v62, v35, v34, s52
    v_accvgpr_write_b32 a49, v62
    v_perm_b32 v63, v35, v34, s53
    v_accvgpr_write_b32 a57, v63
    s_waitcnt lgkmcnt(4)
    v_perm_b32 v60, v37, v36, s52
    v_accvgpr_write_b32 a50, v60
    v_perm_b32 v61, v37, v36, s53
    v_accvgpr_write_b32 a58, v61
    v_perm_b32 v62, v39, v38, s52
    v_accvgpr_write_b32 a51, v62
    v_perm_b32 v63, v39, v38, s53
    v_accvgpr_write_b32 a59, v63
    s_waitcnt lgkmcnt(2)
    v_perm_b32 v60, v41, v40, s52
    v_accvgpr_write_b32 a52, v60
    v_perm_b32 v61, v41, v40, s53
    v_accvgpr_write_b32 a60, v61
    v_perm_b32 v62, v43, v42, s52
    v_accvgpr_write_b32 a53, v62
    v_perm_b32 v63, v43, v42, s53
    v_accvgpr_write_b32 a61, v63
    s_waitcnt lgkmcnt(0)
    v_perm_b32 v60, v45, v44, s52
    v_accvgpr_write_b32 a54, v60
    v_perm_b32 v61, v45, v44, s53
    v_accvgpr_write_b32 a62, v61
    v_perm_b32 v62, v47, v46, s52
    v_accvgpr_write_b32 a55, v62
    v_perm_b32 v63, v47, v46, s53
    v_accvgpr_write_b32 a63, v63
    s_waitcnt vmcnt(8)
    s_barrier
    s_add_u32 m0, s47, 147456
    s_add_u32 s54, s48, 3670016
    buffer_load_dwordx4 v48, s[32:35], s54 offen lds
    s_add_u32 m0, s47, 148480
    s_add_u32 s54, s48, 3702784
    buffer_load_dwordx4 v48, s[32:35], s54 offen lds
    s_add_u32 m0, s47, 149504
    s_add_u32 s54, s48, 3932160
    buffer_load_dwordx4 v48, s[32:35], s54 offen lds
    s_add_u32 m0, s47, 150528
    s_add_u32 s54, s48, 3964928
    buffer_load_dwordx4 v48, s[32:35], s54 offen lds
    s_cmp_eq_u32 s51, -1
    s_cbranch_scc1 L_plk_92
    s_mov_b32 s58, 0
    s_branch L_plc_94
L_pll_93:
    buffer_load_dwordx2 v[16:17], off, s[28:31], 0 offset:2048 sc1
    s_waitcnt vmcnt(0)
L_plc_94:
    v_readfirstlane_b32 s56, v16
    v_readfirstlane_b32 s57, v17
    s_sub_u32 s56, s56, s42
    s_subb_u32 s57, s57, s43
    s_lshr_b32 s55, s56, 3
    s_or_b32 s57, s57, s55
    s_cbranch_scc0 L_plo_95
    s_add_u32 s58, s58, 1
    s_cmp_lt_u32 s58, 1048576
    s_cbranch_scc1 L_pll_93
    s_branch L_abort
L_plo_95:
    s_mov_b32 s36, s24
    s_and_b32 s37, s25, 0xffff
    s_mov_b32 s38, 256
    s_mov_b32 s39, 0x20000
    s_cmp_eq_u32 s56, s50
    s_cselect_b32 s51, 0, 128
    s_cbranch_scc1 L_swap
    s_cmp_lg_u32 s44, 0
    s_cbranch_scc1 L_plk_92
    v_mov_b32 v16, 1
    s_mov_b64 exec, 1
    buffer_atomic_add v16, off, s[36:39], s51 sc1
    s_mov_b64 exec, -1
L_plk_92:
    ds_read2st64_b32 v[32:33], v50 offset0:0 offset1:1
    ds_read2st64_b32 v[34:35], v50 offset0:2 offset1:3
    ds_read2st64_b32 v[36:37], v50 offset0:4 offset1:5
    ds_read2st64_b32 v[38:39], v50 offset0:6 offset1:7
    ds_read2st64_b32 v[40:41], v50 offset0:8 offset1:9
    ds_read2st64_b32 v[42:43], v50 offset0:10 offset1:11
    ds_read2st64_b32 v[44:45], v50 offset0:12 offset1:13
    ds_read2st64_b32 v[46:47], v50 offset0:14 offset1:15
    s_waitcnt lgkmcnt(6)
    v_perm_b32 v60, v33, v32, s52
    v_accvgpr_write_b32 a64, v60
    v_perm_b32 v61, v33, v32, s53
    v_accvgpr_write_b32 a72, v61
    v_perm_b32 v62, v35, v34, s52
    v_accvgpr_write_b32 a65, v62
    v_perm_b32 v63, v35, v34, s53
    v_accvgpr_write_b32 a73, v63
    s_waitcnt lgkmcnt(4)
    v_perm_b32 v60, v37, v36, s52
    v_accvgpr_write_b32 a66, v60
    v_perm_b32 v61, v37, v36, s53
    v_accvgpr_write_b32 a74, v61
    v_perm_b32 v62, v39, v38, s52
    v_accvgpr_write_b32 a67, v62
    v_perm_b32 v63, v39, v38, s53
    v_accvgpr_write_b32 a75, v63
    s_waitcnt lgkmcnt(2)
    v_perm_b32 v60, v41, v40, s52
    v_accvgpr_write_b32 a68, v60
    v_perm_b32 v61, v41, v40, s53
    v_accvgpr_write_b32 a76, v61
    v_perm_b32 v62, v43, v42, s52
    v_accvgpr_write_b32 a69, v62
    v_perm_b32 v63, v43, v42, s53
    v_accvgpr_write_b32 a77, v63
    s_waitcnt lgkmcnt(0)
    v_perm_b32 v60, v45, v44, s52
    v_accvgpr_write_b32 a70, v60
    v_perm_b32 v61, v45, v44, s53
    v_accvgpr_write_b32 a78, v61
    v_perm_b32 v62, v47, v46, s52
    v_accvgpr_write_b32 a71, v62
    v_perm_b32 v63, v47, v46, s53
    v_accvgpr_write_b32 a79, v63
    s_waitcnt vmcnt(8)
    s_barrier
    s_mov_b32 s32, s12
    s_and_b32 s33, s13, 0xffff
    s_mov_b32 s34, 4194304
    s_mov_b32 s35, 0x20000
    s_lshl_b32 s48, s65, 8
    s_lshl_b32 s54, s44, 16
    s_add_u32 s48, s48, s54
    s_add_u32 m0, s47, 98304
    s_add_u32 s54, s48, 0
    buffer_load_dwordx4 v48, s[32:35], s54 offen lds
    s_add_u32 m0, s47, 99328
    s_add_u32 s54, s48, 32768
    buffer_load_dwordx4 v48, s[32:35], s54 offen lds
    s_add_u32 m0, s47, 100352
    s_add_u32 s54, s48, 262144
    buffer_load_dwordx4 v48, s[32:35], s54 offen lds
    s_add_u32 m0, s47, 101376
    s_add_u32 s54, s48, 294912
    buffer_load_dwordx4 v48, s[32:35], s54 offen lds
    ds_read2st64_b32 v[32:33], v50 offset0:64 offset1:65
    ds_read2st64_b32 v[34:35], v50 offset0:66 offset1:67
    ds_read2st64_b32 v[36:37], v50 offset0:68 offset1:69
    ds_read2st64_b32 v[38:39], v50 offset0:70 offset1:71
    ds_read2st64_b32 v[40:41], v50 offset0:72 offset1:73
    ds_read2st64_b32 v[42:43], v50 offset0:74 offset1:75
    ds_read2st64_b32 v[44:45], v50 offset0:76 offset1:77
    ds_read2st64_b32 v[46:47], v50 offset0:78 offset1:79
    s_waitcnt lgkmcnt(6)
    v_perm_b32 v60, v33, v32, s52
    v_accvgpr_write_b32 a80, v60
    v_perm_b32 v61, v33, v32, s53
    v_accvgpr_write_b32 a88, v61
    v_perm_b32 v62, v35, v34, s52
    v_accvgpr_write_b32 a81, v62
    v_perm_b32 v63, v35, v34, s53
    v_accvgpr_write_b32 a89, v63
    s_waitcnt lgkmcnt(4)
    v_perm_b32 v60, v37, v36, s52
    v_accvgpr_write_b32 a82, v60
    v_perm_b32 v61, v37, v36, s53
    v_accvgpr_write_b32 a90, v61
    v_perm_b32 v62, v39, v38, s52
    v_accvgpr_write_b32 a83, v62
    v_perm_b32 v63, v39, v38, s53
    v_accvgpr_write_b32 a91, v63
    s_waitcnt lgkmcnt(2)
    v_perm_b32 v60, v41, v40, s52
    v_accvgpr_write_b32 a84, v60
    v_perm_b32 v61, v41, v40, s53
    v_accvgpr_write_b32 a92, v61
    v_perm_b32 v62, v43, v42, s52
    v_accvgpr_write_b32 a85, v62
    v_perm_b32 v63, v43, v42, s53
    v_accvgpr_write_b32 a93, v63
    s_waitcnt lgkmcnt(0)
    v_perm_b32 v60, v45, v44, s52
    v_accvgpr_write_b32 a86, v60
    v_perm_b32 v61, v45, v44, s53
    v_accvgpr_write_b32 a94, v61
    v_perm_b32 v62, v47, v46, s52
    v_accvgpr_write_b32 a87, v62
    v_perm_b32 v63, v47, v46, s53
    v_accvgpr_write_b32 a95, v63
    s_waitcnt vmcnt(8)
    s_barrier
    s_add_u32 m0, s47, 114688
    s_add_u32 s54, s48, 524288
    buffer_load_dwordx4 v48, s[32:35], s54 offen lds
    s_add_u32 m0, s47, 115712
    s_add_u32 s54, s48, 557056
    buffer_load_dwordx4 v48, s[32:35], s54 offen lds
    s_add_u32 m0, s47, 116736
    s_add_u32 s54, s48, 786432
    buffer_load_dwordx4 v48, s[32:35], s54 offen lds
    s_add_u32 m0, s47, 117760
    s_add_u32 s54, s48, 819200
    buffer_load_dwordx4 v48, s[32:35], s54 offen lds
    ds_read2st64_b32 v[32:33], v50 offset0:128 offset1:129
    ds_read2st64_b32 v[34:35], v50 offset0:130 offset1:131
    ds_read2st64_b32 v[36:37], v50 offset0:132 offset1:133
    ds_read2st64_b32 v[38:39], v50 offset0:134 offset1:135
    ds_read2st64_b32 v[40:41], v50 offset0:136 offset1:137
    ds_read2st64_b32 v[42:43], v50 offset0:138 offset1:139
    ds_read2st64_b32 v[44:45], v50 offset0:140 offset1:141
    ds_read2st64_b32 v[46:47], v50 offset0:142 offset1:143
    s_waitcnt lgkmcnt(6)
    v_perm_b32 v60, v33, v32, s52
    v_accvgpr_write_b32 a96, v60
    v_perm_b32 v61, v33, v32, s53
    v_accvgpr_write_b32 a104, v61
    v_perm_b32 v62, v35, v34, s52
    v_accvgpr_write_b32 a97, v62
    v_perm_b32 v63, v35, v34, s53
    v_accvgpr_write_b32 a105, v63
    s_waitcnt lgkmcnt(4)
    v_perm_b32 v60, v37, v36, s52
    v_accvgpr_write_b32 a98, v60
    v_perm_b32 v61, v37, v36, s53
    v_accvgpr_write_b32 a106, v61
    v_perm_b32 v62, v39, v38, s52
    v_accvgpr_write_b32 a99, v62
    v_perm_b32 v63, v39, v38, s53
    v_accvgpr_write_b32 a107, v63
    s_waitcnt lgkmcnt(2)
    v_perm_b32 v60, v41, v40, s52
    v_accvgpr_write_b32 a100, v60
    v_perm_b32 v61, v41, v40, s53
    v_accvgpr_write_b32 a108, v61
    v_perm_b32 v62, v43, v42, s52
    v_accvgpr_write_b32 a101, v62
    v_perm_b32 v63, v43, v42, s53
    v_accvgpr_write_b32 a109, v63
    s_waitcnt lgkmcnt(0)
    v_perm_b32 v60, v45, v44, s52
    v_accvgpr_write_b32 a102, v60
    v_perm_b32 v61, v45, v44, s53
    v_accvgpr_write_b32 a110, v61
    v_perm_b32 v62, v47, v46, s52
    v_accvgpr_write_b32 a103, v62
    v_perm_b32 v63, v47, v46, s53
    v_accvgpr_write_b32 a111, v63
    s_waitcnt vmcnt(8)
    s_barrier
    s_add_u32 m0, s47, 131072
    s_add_u32 s54, s48, 1048576
    buffer_load_dwordx4 v48, s[32:35], s54 offen lds
    s_add_u32 m0, s47, 132096
    s_add_u32 s54, s48, 1081344
    buffer_load_dwordx4 v48, s[32:35], s54 offen lds
    s_add_u32 m0, s47, 133120
    s_add_u32 s54, s48, 1310720
    buffer_load_dwordx4 v48, s[32:35], s54 offen lds
    s_add_u32 m0, s47, 134144
    s_add_u32 s54, s48, 1343488
    buffer_load_dwordx4 v48, s[32:35], s54 offen lds
    ds_read2st64_b32 v[32:33], v50 offset0:192 offset1:193
    ds_read2st64_b32 v[34:35], v50 offset0:194 offset1:195
    ds_read2st64_b32 v[36:37], v50 offset0:196 offset1:197
    ds_read2st64_b32 v[38:39], v50 offset0:198 offset1:199
    ds_read2st64_b32 v[40:41], v50 offset0:200 offset1:201
    ds_read2st64_b32 v[42:43], v50 offset0:202 offset1:203
    ds_read2st64_b32 v[44:45], v50 offset0:204 offset1:205
    ds_read2st64_b32 v[46:47], v50 offset0:206 offset1:207
    s_waitcnt lgkmcnt(6)
    v_perm_b32 v60, v33, v32, s52
    v_accvgpr_write_b32 a112, v60
    v_perm_b32 v61, v33, v32, s53
    v_accvgpr_write_b32 a120, v61
    v_perm_b32 v62, v35, v34, s52
    v_accvgpr_write_b32 a113, v62
    v_perm_b32 v63, v35, v34, s53
    v_accvgpr_write_b32 a121, v63
    s_waitcnt lgkmcnt(4)
    v_perm_b32 v60, v37, v36, s52
    v_accvgpr_write_b32 a114, v60
    v_perm_b32 v61, v37, v36, s53
    v_accvgpr_write_b32 a122, v61
    v_perm_b32 v62, v39, v38, s52
    v_accvgpr_write_b32 a115, v62
    v_perm_b32 v63, v39, v38, s53
    v_accvgpr_write_b32 a123, v63
    s_waitcnt lgkmcnt(2)
    v_perm_b32 v60, v41, v40, s52
    v_accvgpr_write_b32 a116, v60
    v_perm_b32 v61, v41, v40, s53
    v_accvgpr_write_b32 a124, v61
    v_perm_b32 v62, v43, v42, s52
    v_accvgpr_write_b32 a117, v62
    v_perm_b32 v63, v43, v42, s53
    v_accvgpr_write_b32 a125, v63
    s_waitcnt lgkmcnt(0)
    v_perm_b32 v60, v45, v44, s52
    v_accvgpr_write_b32 a118, v60
    v_perm_b32 v61, v45, v44, s53
    v_accvgpr_write_b32 a126, v61
    v_perm_b32 v62, v47, v46, s52
    v_accvgpr_write_b32 a119, v62
    v_perm_b32 v63, v47, v46, s53
    v_accvgpr_write_b32 a127, v63
    s_waitcnt vmcnt(8)
    s_barrier
    s_add_u32 m0, s47, 147456
    s_add_u32 s54, s48, 1572864
    buffer_load_dwordx4 v48, s[32:35], s54 offen lds
    s_add_u32 m0, s47, 148480
    s_add_u32 s54, s48, 1605632
    buffer_load_dwordx4 v48, s[32:35], s54 offen lds
    s_add_u32 m0, s47, 149504
    s_add_u32 s54, s48, 1835008
    buffer_load_dwordx4 v48, s[32:35], s54 offen lds
    s_add_u32 m0, s47, 150528
    s_add_u32 s54, s48, 1867776
    buffer_load_dwordx4 v48, s[32:35], s54 offen lds
    ds_read2st64_b32 v[32:33], v50 offset0:0 offset1:1
    ds_read2st64_b32 v[34:35], v50 offset0:2 offset1:3
    ds_read2st64_b32 v[36:37], v50 offset0:4 offset1:5
    ds_read2st64_b32 v[38:39], v50 offset0:6 offset1:7
    ds_read2st64_b32 v[40:41], v50 offset0:8 offset1:9
    ds_read2st64_b32 v[42:43], v50 offset0:10 offset1:11
    ds_read2st64_b32 v[44:45], v50 offset0:12 offset1:13
    ds_read2st64_b32 v[46:47], v50 offset0:14 offset1:15
    s_waitcnt lgkmcnt(6)
    v_perm_b32 v60, v33, v32, s52
    v_accvgpr_write_b32 a128, v60
    v_perm_b32 v61, v33, v32, s53
    v_accvgpr_write_b32 a136, v61
    v_perm_b32 v62, v35, v34, s52
    v_accvgpr_write_b32 a129, v62
    v_perm_b32 v63, v35, v34, s53
    v_accvgpr_write_b32 a137, v63
    s_waitcnt lgkmcnt(4)
    v_perm_b32 v60, v37, v36, s52
    v_accvgpr_write_b32 a130, v60
    v_perm_b32 v61, v37, v36, s53
    v_accvgpr_write_b32 a138, v61
    v_perm_b32 v62, v39, v38, s52
    v_accvgpr_write_b32 a131, v62
    v_perm_b32 v63, v39, v38, s53
    v_accvgpr_write_b32 a139, v63
    s_waitcnt lgkmcnt(2)
    v_perm_b32 v60, v41, v40, s52
    v_accvgpr_write_b32 a132, v60
    v_perm_b32 v61, v41, v40, s53
    v_accvgpr_write_b32 a140, v61
    v_perm_b32 v62, v43, v42, s52
    v_accvgpr_write_b32 a133, v62
    v_perm_b32 v63, v43, v42, s53
    v_accvgpr_write_b32 a141, v63
    s_waitcnt lgkmcnt(0)
    v_perm_b32 v60, v45, v44, s52
    v_accvgpr_write_b32 a134, v60
    v_perm_b32 v61, v45, v44, s53
    v_accvgpr_write_b32 a142, v61
    v_perm_b32 v62, v47, v46, s52
    v_accvgpr_write_b32 a135, v62
    v_perm_b32 v63, v47, v46, s53
    v_accvgpr_write_b32 a143, v63
    s_waitcnt vmcnt(8)
    s_barrier
    s_add_u32 m0, s47, 98304
    s_add_u32 s54, s48, 2097152
    buffer_load_dwordx4 v48, s[32:35], s54 offen lds
    s_add_u32 m0, s47, 99328
    s_add_u32 s54, s48, 2129920
    buffer_load_dwordx4 v48, s[32:35], s54 offen lds
    s_add_u32 m0, s47, 100352
    s_add_u32 s54, s48, 2359296
    buffer_load_dwordx4 v48, s[32:35], s54 offen lds
    s_add_u32 m0, s47, 101376
    s_add_u32 s54, s48, 2392064
    buffer_load_dwordx4 v48, s[32:35], s54 offen lds
    ds_read2st64_b32 v[32:33], v50 offset0:64 offset1:65
    ds_read2st64_b32 v[34:35], v50 offset0:66 offset1:67
    ds_read2st64_b32 v[36:37], v50 offset0:68 offset1:69
    ds_read2st64_b32 v[38:39], v50 offset0:70 offset1:71
    ds_read2st64_b32 v[40:41], v50 offset0:72 offset1:73
    ds_read2st64_b32 v[42:43], v50 offset0:74 offset1:75
    ds_read2st64_b32 v[44:45], v50 offset0:76 offset1:77
    ds_read2st64_b32 v[46:47], v50 offset0:78 offset1:79
    s_waitcnt lgkmcnt(6)
    v_perm_b32 v60, v33, v32, s52
    v_accvgpr_write_b32 a144, v60
    v_perm_b32 v61, v33, v32, s53
    v_accvgpr_write_b32 a152, v61
    v_perm_b32 v62, v35, v34, s52
    v_accvgpr_write_b32 a145, v62
    v_perm_b32 v63, v35, v34, s53
    v_accvgpr_write_b32 a153, v63
    s_waitcnt lgkmcnt(4)
    v_perm_b32 v60, v37, v36, s52
    v_accvgpr_write_b32 a146, v60
    v_perm_b32 v61, v37, v36, s53
    v_accvgpr_write_b32 a154, v61
    v_perm_b32 v62, v39, v38, s52
    v_accvgpr_write_b32 a147, v62
    v_perm_b32 v63, v39, v38, s53
    v_accvgpr_write_b32 a155, v63
    s_waitcnt lgkmcnt(2)
    v_perm_b32 v60, v41, v40, s52
    v_accvgpr_write_b32 a148, v60
    v_perm_b32 v61, v41, v40, s53
    v_accvgpr_write_b32 a156, v61
    v_perm_b32 v62, v43, v42, s52
    v_accvgpr_write_b32 a149, v62
    v_perm_b32 v63, v43, v42, s53
    v_accvgpr_write_b32 a157, v63
    s_waitcnt lgkmcnt(0)
    v_perm_b32 v60, v45, v44, s52
    v_accvgpr_write_b32 a150, v60
    v_perm_b32 v61, v45, v44, s53
    v_accvgpr_write_b32 a158, v61
    v_perm_b32 v62, v47, v46, s52
    v_accvgpr_write_b32 a151, v62
    v_perm_b32 v63, v47, v46, s53
    v_accvgpr_write_b32 a159, v63
    s_waitcnt vmcnt(8)
    s_barrier
    s_add_u32 m0, s47, 114688
    s_add_u32 s54, s48, 2621440
    buffer_load_dwordx4 v48, s[32:35], s54 offen lds
    s_add_u32 m0, s47, 115712
    s_add_u32 s54, s48, 2654208
    buffer_load_dwordx4 v48, s[32:35], s54 offen lds
    s_add_u32 m0, s47, 116736
    s_add_u32 s54, s48, 2883584
    buffer_load_dwordx4 v48, s[32:35], s54 offen lds
    s_add_u32 m0, s47, 117760
    s_add_u32 s54, s48, 2916352
    buffer_load_dwordx4 v48, s[32:35], s54 offen lds
    s_lshl_b32 s54, s66, 2
    s_add_u32 s54, s54, s44
    s_lshl_b32 s54, s54, 10
    s_mov_b32 s36, s8
    s_and_b32 s37, s9, 0xffff
    s_mov_b32 s38, 4194304
    s_mov_b32 s39, 0x20000
    s_add_u32 s55, s54, 0
    v_add_u32 v3, s55, v0
    buffer_load_dwordx4 v[128:131], v3, s[36:39], 0 offen
    s_add_u32 s55, s54, 917504
    v_add_u32 v3, s55, v0
    buffer_load_dwordx4 v[132:135], v3, s[36:39], 0 offen
    s_add_u32 s55, s54, 1835008
    v_add_u32 v3, s55, v0
    buffer_load_dwordx4 v[136:139], v3, s[36:39], 0 offen
    s_add_u32 s55, s54, 2752512
    v_add_u32 v3, s55, v0
    buffer_load_dwordx4 v[140:143], v3, s[36:39], 0 offen
    s_add_u32 s55, s54, 3670016
    v_add_u32 v3, s55, v0
    buffer_load_dwordx4 v[144:147], v3, s[36:39], 0 offen
    ds_read2st64_b32 v[32:33], v50 offset0:128 offset1:129
    ds_read2st64_b32 v[34:35], v50 offset0:130 offset1:131
    ds_read2st64_b32 v[36:37], v50 offset0:132 offset1:133
    ds_read2st64_b32 v[38:39], v50 offset0:134 offset1:135
    ds_read2st64_b32 v[40:41], v50 offset0:136 offset1:137
    ds_read2st64_b32 v[42:43], v50 offset0:138 offset1:139
    ds_read2st64_b32 v[44:45], v50 offset0:140 offset1:141
    ds_read2st64_b32 v[46:47], v50 offset0:142 offset1:143
    s_waitcnt lgkmcnt(6)
    v_perm_b32 v60, v33, v32, s52
    v_accvgpr_write_b32 a160, v60
    v_perm_b32 v61, v33, v32, s53
    v_accvgpr_write_b32 a168, v61
    v_perm_b32 v62, v35, v34, s52
    v_accvgpr_write_b32 a161, v62
    v_perm_b32 v63, v35, v34, s53
    v_accvgpr_write_b32 a169, v63
    s_waitcnt lgkmcnt(4)
    v_perm_b32 v60, v37, v36, s52
    v_accvgpr_write_b32 a162, v60
    v_perm_b32 v61, v37, v36, s53
    v_accvgpr_write_b32 a170, v61
    v_perm_b32 v62, v39, v38, s52
    v_accvgpr_write_b32 a163, v62
    v_perm_b32 v63, v39, v38, s53
    v_accvgpr_write_b32 a171, v63
    s_waitcnt lgkmcnt(2)
    v_perm_b32 v60, v41, v40, s52
    v_accvgpr_write_b32 a164, v60
    v_perm_b32 v61, v41, v40, s53
    v_accvgpr_write_b32 a172, v61
    v_perm_b32 v62, v43, v42, s52
    v_accvgpr_write_b32 a165, v62
    v_perm_b32 v63, v43, v42, s53
    v_accvgpr_write_b32 a173, v63
    s_waitcnt lgkmcnt(0)
    v_perm_b32 v60, v45, v44, s52
    v_accvgpr_write_b32 a166, v60
    v_perm_b32 v61, v45, v44, s53
    v_accvgpr_write_b32 a174, v61
    v_perm_b32 v62, v47, v46, s52
    v_accvgpr_write_b32 a167, v62
    v_perm_b32 v63, v47, v46, s53
    v_accvgpr_write_b32 a175, v63
    s_waitcnt vmcnt(13)
    s_barrier
    s_add_u32 m0, s47, 131072
    s_add_u32 s54, s48, 3145728
    buffer_load_dwordx4 v48, s[32:35], s54 offen lds
    s_add_u32 m0, s47, 132096
    s_add_u32 s54, s48, 3178496
    buffer_load_dwordx4 v48, s[32:35], s54 offen lds
    s_add_u32 m0, s47, 133120
    s_add_u32 s54, s48, 3407872
    buffer_load_dwordx4 v48, s[32:35], s54 offen lds
    s_add_u32 m0, s47, 134144
    s_add_u32 s54, s48, 3440640
    buffer_load_dwordx4 v48, s[32:35], s54 offen lds
    ds_read2st64_b32 v[32:33], v50 offset0:192 offset1:193
    ds_read2st64_b32 v[34:35], v50 offset0:194 offset1:195
    ds_read2st64_b32 v[36:37], v50 offset0:196 offset1:197
    ds_read2st64_b32 v[38:39], v50 offset0:198 offset1:199
    ds_read2st64_b32 v[40:41], v50 offset0:200 offset1:201
    ds_read2st64_b32 v[42:43], v50 offset0:202 offset1:203
    ds_read2st64_b32 v[44:45], v50 offset0:204 offset1:205
    ds_read2st64_b32 v[46:47], v50 offset0:206 offset1:207
    s_waitcnt lgkmcnt(6)
    v_perm_b32 v60, v33, v32, s52
    v_accvgpr_write_b32 a176, v60
    v_perm_b32 v61, v33, v32, s53
    v_accvgpr_write_b32 a184, v61
    v_perm_b32 v62, v35, v34, s52
    v_accvgpr_write_b32 a177, v62
    v_perm_b32 v63, v35, v34, s53
    v_accvgpr_write_b32 a185, v63
    s_waitcnt lgkmcnt(4)
    v_perm_b32 v60, v37, v36, s52
    v_accvgpr_write_b32 a178, v60
    v_perm_b32 v61, v37, v36, s53
    v_accvgpr_write_b32 a186, v61
    v_perm_b32 v62, v39, v38, s52
    v_accvgpr_write_b32 a179, v62
    v_perm_b32 v63, v39, v38, s53
    v_accvgpr_write_b32 a187, v63
    s_waitcnt lgkmcnt(2)
    v_perm_b32 v60, v41, v40, s52
    v_accvgpr_write_b32 a180, v60
    v_perm_b32 v61, v41, v40, s53
    v_accvgpr_write_b32 a188, v61
    v_perm_b32 v62, v43, v42, s52
    v_accvgpr_write_b32 a181, v62
    v_perm_b32 v63, v43, v42, s53
    v_accvgpr_write_b32 a189, v63
    s_waitcnt lgkmcnt(0)
    v_perm_b32 v60, v45, v44, s52
    v_accvgpr_write_b32 a182, v60
    v_perm_b32 v61, v45, v44, s53
    v_accvgpr_write_b32 a190, v61
    v_perm_b32 v62, v47, v46, s52
    v_accvgpr_write_b32 a183, v62
    v_perm_b32 v63, v47, v46, s53
    v_accvgpr_write_b32 a191, v63
    s_waitcnt vmcnt(13)
    s_barrier
    s_add_u32 m0, s47, 147456
    s_add_u32 s54, s48, 3670016
    buffer_load_dwordx4 v48, s[32:35], s54 offen lds
    s_add_u32 m0, s47, 148480
    s_add_u32 s54, s48, 3702784
    buffer_load_dwordx4 v48, s[32:35], s54 offen lds
    s_add_u32 m0, s47, 149504
    s_add_u32 s54, s48, 3932160
    buffer_load_dwordx4 v48, s[32:35], s54 offen lds
    s_add_u32 m0, s47, 150528
    s_add_u32 s54, s48, 3964928
    buffer_load_dwordx4 v48, s[32:35], s54 offen lds
    ds_read2st64_b32 v[32:33], v50 offset0:0 offset1:1
    ds_read2st64_b32 v[34:35], v50 offset0:2 offset1:3
    ds_read2st64_b32 v[36:37], v50 offset0:4 offset1:5
    ds_read2st64_b32 v[38:39], v50 offset0:6 offset1:7
    ds_read2st64_b32 v[40:41], v50 offset0:8 offset1:9
    ds_read2st64_b32 v[42:43], v50 offset0:10 offset1:11
    ds_read2st64_b32 v[44:45], v50 offset0:12 offset1:13
    ds_read2st64_b32 v[46:47], v50 offset0:14 offset1:15
    s_waitcnt lgkmcnt(6)
    v_perm_b32 v60, v33, v32, s52
    v_accvgpr_write_b32 a192, v60
    v_perm_b32 v61, v33, v32, s53
    v_accvgpr_write_b32 a200, v61
    v_perm_b32 v62, v35, v34, s52
    v_accvgpr_write_b32 a193, v62
    v_perm_b32 v63, v35, v34, s53
    v_accvgpr_write_b32 a201, v63
    s_waitcnt lgkmcnt(4)
    v_perm_b32 v60, v37, v36, s52
    v_accvgpr_write_b32 a194, v60
    v_perm_b32 v61, v37, v36, s53
    v_accvgpr_write_b32 a202, v61
    v_perm_b32 v62, v39, v38, s52
    v_accvgpr_write_b32 a195, v62
    v_perm_b32 v63, v39, v38, s53
    v_accvgpr_write_b32 a203, v63
    s_waitcnt lgkmcnt(2)
    v_perm_b32 v60, v41, v40, s52
    v_accvgpr_write_b32 a196, v60
    v_perm_b32 v61, v41, v40, s53
    v_accvgpr_write_b32 a204, v61
    v_perm_b32 v62, v43, v42, s52
    v_accvgpr_write_b32 a197, v62
    v_perm_b32 v63, v43, v42, s53
    v_accvgpr_write_b32 a205, v63
    s_waitcnt lgkmcnt(0)
    v_perm_b32 v60, v45, v44, s52
    v_accvgpr_write_b32 a198, v60
    v_perm_b32 v61, v45, v44, s53
    v_accvgpr_write_b32 a206, v61
    v_perm_b32 v62, v47, v46, s52
    v_accvgpr_write_b32 a199, v62
    v_perm_b32 v63, v47, v46, s53
    v_accvgpr_write_b32 a207, v63
    s_waitcnt vmcnt(13)
    s_barrier
    ds_read2st64_b32 v[32:33], v50 offset0:64 offset1:65
    ds_read2st64_b32 v[34:35], v50 offset0:66 offset1:67
    ds_read2st64_b32 v[36:37], v50 offset0:68 offset1:69
    ds_read2st64_b32 v[38:39], v50 offset0:70 offset1:71
    ds_read2st64_b32 v[40:41], v50 offset0:72 offset1:73
    ds_read2st64_b32 v[42:43], v50 offset0:74 offset1:75
    ds_read2st64_b32 v[44:45], v50 offset0:76 offset1:77
    ds_read2st64_b32 v[46:47], v50 offset0:78 offset1:79
    s_waitcnt lgkmcnt(6)
    v_perm_b32 v60, v33, v32, s52
    v_accvgpr_write_b32 a208, v60
    v_perm_b32 v61, v33, v32, s53
    v_accvgpr_write_b32 a216, v61
    v_perm_b32 v62, v35, v34, s52
    v_accvgpr_write_b32 a209, v62
    v_perm_b32 v63, v35, v34, s53
    v_accvgpr_write_b32 a217, v63
    s_waitcnt lgkmcnt(4)
    v_perm_b32 v60, v37, v36, s52
    v_accvgpr_write_b32 a210, v60
    v_perm_b32 v61, v37, v36, s53
    v_accvgpr_write_b32 a218, v61
    v_perm_b32 v62, v39, v38, s52
    v_accvgpr_write_b32 a211, v62
    v_perm_b32 v63, v39, v38, s53
    v_accvgpr_write_b32 a219, v63
    s_waitcnt lgkmcnt(2)
    v_perm_b32 v60, v41, v40, s52
    v_accvgpr_write_b32 a212, v60
    v_perm_b32 v61, v41, v40, s53
    v_accvgpr_write_b32 a220, v61
    v_perm_b32 v62, v43, v42, s52
    v_accvgpr_write_b32 a213, v62
    v_perm_b32 v63, v43, v42, s53
    v_accvgpr_write_b32 a221, v63
    s_waitcnt lgkmcnt(0)
    v_perm_b32 v60, v45, v44, s52
    v_accvgpr_write_b32 a214, v60
    v_perm_b32 v61, v45, v44, s53
    v_accvgpr_write_b32 a222, v61
    v_perm_b32 v62, v47, v46, s52
    v_accvgpr_write_b32 a215, v62
    v_perm_b32 v63, v47, v46, s53
    v_accvgpr_write_b32 a223, v63
    s_waitcnt vmcnt(4)
    s_barrier
    ds_read2st64_b32 v[32:33], v50 offset0:128 offset1:129
    ds_read2st64_b32 v[34:35], v50 offset0:130 offset1:131
    ds_read2st64_b32 v[36:37], v50 offset0:132 offset1:133
    ds_read2st64_b32 v[38:39], v50 offset0:134 offset1:135
    ds_read2st64_b32 v[40:41], v50 offset0:136 offset1:137
    ds_read2st64_b32 v[42:43], v50 offset0:138 offset1:139
    ds_read2st64_b32 v[44:45], v50 offset0:140 offset1:141
    ds_read2st64_b32 v[46:47], v50 offset0:142 offset1:143
    s_waitcnt lgkmcnt(6)
    v_perm_b32 v60, v33, v32, s52
    v_accvgpr_write_b32 a224, v60
    v_perm_b32 v61, v33, v32, s53
    v_accvgpr_write_b32 a232, v61
    v_perm_b32 v62, v35, v34, s52
    v_accvgpr_write_b32 a225, v62
    v_perm_b32 v63, v35, v34, s53
    v_accvgpr_write_b32 a233, v63
    s_waitcnt lgkmcnt(4)
    v_perm_b32 v60, v37, v36, s52
    v_accvgpr_write_b32 a226, v60
    v_perm_b32 v61, v37, v36, s53
    v_accvgpr_write_b32 a234, v61
    v_perm_b32 v62, v39, v38, s52
    v_accvgpr_write_b32 a227, v62
    v_perm_b32 v63, v39, v38, s53
    v_accvgpr_write_b32 a235, v63
    s_waitcnt lgkmcnt(2)
    v_perm_b32 v60, v41, v40, s52
    v_accvgpr_write_b32 a228, v60
    v_perm_b32 v61, v41, v40, s53
    v_accvgpr_write_b32 a236, v61
    v_perm_b32 v62, v43, v42, s52
    v_accvgpr_write_b32 a229, v62
    v_perm_b32 v63, v43, v42, s53
    v_accvgpr_write_b32 a237, v63
    s_waitcnt lgkmcnt(0)
    v_perm_b32 v60, v45, v44, s52
    v_accvgpr_write_b32 a230, v60
    v_perm_b32 v61, v45, v44, s53
    v_accvgpr_write_b32 a238, v61
    v_perm_b32 v62, v47, v46, s52
    v_accvgpr_write_b32 a231, v62
    v_perm_b32 v63, v47, v46, s53
    v_accvgpr_write_b32 a239, v63
    s_waitcnt vmcnt(0)
    s_barrier
    ds_read2st64_b32 v[32:33], v50 offset0:192 offset1:193
    ds_read2st64_b32 v[34:35], v50 offset0:194 offset1:195
    ds_read2st64_b32 v[36:37], v50 offset0:196 offset1:197
    ds_read2st64_b32 v[38:39], v50 offset0:198 offset1:199
    ds_read2st64_b32 v[40:41], v50 offset0:200 offset1:201
    ds_read2st64_b32 v[42:43], v50 offset0:202 offset1:203
    ds_read2st64_b32 v[44:45], v50 offset0:204 offset1:205
    ds_read2st64_b32 v[46:47], v50 offset0:206 offset1:207
    s_waitcnt lgkmcnt(6)
    v_perm_b32 v60, v33, v32, s52
    v_accvgpr_write_b32 a240, v60
    v_perm_b32 v61, v33, v32, s53
    v_accvgpr_write_b32 a248, v61
    v_perm_b32 v62, v35, v34, s52
    v_accvgpr_write_b32 a241, v62
    v_perm_b32 v63, v35, v34, s53
    v_accvgpr_write_b32 a249, v63
    s_waitcnt lgkmcnt(4)
    v_perm_b32 v60, v37, v36, s52
    v_accvgpr_write_b32 a242, v60
    v_perm_b32 v61, v37, v36, s53
    v_accvgpr_write_b32 a250, v61
    v_perm_b32 v62, v39, v38, s52
    v_accvgpr_write_b32 a243, v62
    v_perm_b32 v63, v39, v38, s53
    v_accvgpr_write_b32 a251, v63
    s_waitcnt lgkmcnt(2)
    v_perm_b32 v60, v41, v40, s52
    v_accvgpr_write_b32 a244, v60
    v_perm_b32 v61, v41, v40, s53
    v_accvgpr_write_b32 a252, v61
    v_perm_b32 v62, v43, v42, s52
    v_accvgpr_write_b32 a245, v62
    v_perm_b32 v63, v43, v42, s53
    v_accvgpr_write_b32 a253, v63
    s_waitcnt lgkmcnt(0)
    v_perm_b32 v60, v45, v44, s52
    v_accvgpr_write_b32 a246, v60
    v_perm_b32 v61, v45, v44, s53
    v_accvgpr_write_b32 a254, v61
    v_perm_b32 v62, v47, v46, s52
    v_accvgpr_write_b32 a247, v62
    v_perm_b32 v63, v47, v46, s53
    v_accvgpr_write_b32 a255, v63
    s_mov_b32 s58, 0
    s_mov_b32 s55, 8192
L_pp_100:
    buffer_load_dwordx4 v[8:11], v0, s[28:31], s55 offen sc1
    s_waitcnt vmcnt(0)
    v_cmp_ne_u64 vcc, s[42:43], v[8:9]
    v_cmp_ne_u64 s[56:57], s[42:43], v[10:11]
    s_nop 0
    s_or_b64 vcc, vcc, s[56:57]
    s_cbranch_scc0 L_ppd_101
    s_sleep 2
    s_add_u32 s58, s58, 1
    s_cmp_lt_u32 s58, 1048576
    s_cbranch_scc1 L_pp_100
    s_branch L_abort
L_ppd_101:
    s_mov_b32 s71, 0
    v_mov_b32 v2, v0
    s_mov_b32 s77, s68
    s_mov_b32 s72, s68
    s_min_u32 s57, s72, 63
    s_lshl_b32 s54, s57, 15
    s_lshl_b32 s55, s44, 13
    s_add_u32 s54, s54, s55
    s_add_u32 s54, s54, 1048576
    s_add_u32 s55, s55, s71
    s_mov_b32 m0, s55
    s_nop 0
    buffer_load_dwordx4 v0, s[28:31], s54 offen offset:0 lds
    buffer_load_dwordx4 v0, s[28:31], s54 offen offset:1024 lds
    buffer_load_dwordx4 v0, s[28:31], s54 offen offset:2048 lds
    buffer_load_dwordx4 v0, s[28:31], s54 offen offset:3072 lds
    s_add_u32 s54, s54, 4096
    s_add_u32 s55, s55, 4096
    s_mov_b32 m0, s55
    s_nop 0
    buffer_load_dwordx4 v0, s[28:31], s54 offen offset:0 lds
    buffer_load_dwordx4 v0, s[28:31], s54 offen offset:1024 lds
    buffer_load_dwordx4 v0, s[28:31], s54 offen offset:2048 lds
    buffer_load_dwordx4 v0, s[28:31], s54 offen offset:3072 lds
    s_add_u32 s72, s72, s69
    s_add_u32 s71, s71, 0x8000
    s_and_b32 s71, s71, 0x18000
    s_min_u32 s57, s72, 63
    s_lshl_b32 s54, s57, 15
    s_lshl_b32 s55, s44, 13
    s_add_u32 s54, s54, s55
    s_add_u32 s54, s54, 1048576
    s_add_u32 s55, s55, s71
    s_mov_b32 m0, s55
    s_nop 0
    buffer_load_dwordx4 v0, s[28:31], s54 offen offset:0 lds
    buffer_load_dwordx4 v0, s[28:31], s54 offen offset:1024 lds
    buffer_load_dwordx4 v0, s[28:31], s54 offen offset:2048 lds
    buffer_load_dwordx4 v0, s[28:31], s54 offen offset:3072 lds
    s_add_u32 s54, s54, 4096
    s_add_u32 s55, s55, 4096
    s_mov_b32 m0, s55
    s_nop 0
    buffer_load_dwordx4 v0, s[28:31], s54 offen offset:0 lds
    buffer_load_dwordx4 v0, s[28:31], s54 offen offset:1024 lds
    buffer_load_dwordx4 v0, s[28:31], s54 offen offset:2048 lds
    buffer_load_dwordx4 v0, s[28:31], s54 offen offset:3072 lds
    s_add_u32 s72, s72, s69
    s_add_u32 s71, s71, 0x8000
    s_and_b32 s71, s71, 0x18000
    s_waitcnt vmcnt(8)
    s_barrier
L_kv_97:
    s_min_u32 s57, s72, 63
    s_lshl_b32 s54, s57, 15
    s_lshl_b32 s55, s44, 13
    s_add_u32 s54, s54, s55
    s_add_u32 s54, s54, 1048576
    s_add_u32 s55, s55, s71
    s_mov_b32 m0, s55
    s_nop 0
    buffer_load_dwordx4 v0, s[28:31], s54 offen offset:0 lds
    buffer_load_dwordx4 v0, s[28:31], s54 offen offset:1024 lds
    buffer_load_dwordx4 v0, s[28:31], s54 offen offset:2048 lds
    buffer_load_dwordx4 v0, s[28:31], s54 offen offset:3072 lds
    s_add_u32 s54, s54, 4096
    s_add_u32 s55, s55, 4096
    s_mov_b32 m0, s55
    s_nop 0
    buffer_load_dwordx4 v0, s[28:31], s54 offen offset:0 lds
    buffer_load_dwordx4 v0, s[28:31], s54 offen offset:1024 lds
    buffer_load_dwordx4 v0, s[28:31], s54 offen offset:2048 lds
    buffer_load_dwordx4 v0, s[28:31], s54 offen offset:3072 lds
    s_add_u32 s72, s72, s69
    s_add_u32 s71, s71, 0x8000
    s_and_b32 s71, s71, 0x18000
    ds_read_b128 v[32:35], v2 offset:0
    ds_read_b128 v[36:39], v2 offset:16384
    ds_read_b128 v[40:43], v2 offset:1024
    ds_read_b128 v[44:47], v2 offset:17408
    ds_read_b128 v[48:51], v2 offset:2048
    ds_read_b128 v[52:55], v2 offset:18432
    s_waitcnt lgkmcnt(5)
    v_mfma_f32_16x16x32_bf16 v[64:67], a[0:3], v[32:35], 0
    ds_read_b128 v[56:59], v2 offset:3072
    v_mfma_f32_16x16x32_bf16 v[68:71], a[8:11], v[32:35], 0
    v_mfma_f32_16x16x32_bf16 v[80:83], v[32:35], a[128:131], 0
    v_mfma_f32_16x16x32_bf16 v[84:87], v[32:35], a[136:139], 0
    s_waitcnt lgkmcnt(5)
    v_mfma_f32_16x16x32_bf16 v[72:75], a[0:3], v[36:39], 0
    ds_read_b128 v[60:63], v2 offset:19456
    v_mfma_f32_16x16x32_bf16 v[76:79], a[8:11], v[36:39], 0
    v_mfma_f32_16x16x32_bf16 v[88:91], v[36:39], a[128:131], 0
    v_mfma_f32_16x16x32_bf16 v[92:95], v[36:39], a[136:139], 0
    s_waitcnt lgkmcnt(5)
    v_mfma_f32_16x16x32_bf16 v[64:67], a[4:7], v[40:43], v[64:67]
    ds_read_b128 v[32:35], v2 offset:4096
    v_mfma_f32_16x16x32_bf16 v[68:71], a[12:15], v[40:43], v[68:71]
    v_mfma_f32_16x16x32_bf16 v[80:83], v[40:43], a[132:135], v[80:83]
    v_mfma_f32_16x16x32_bf16 v[84:87], v[40:43], a[140:143], v[84:87]
    s_waitcnt lgkmcnt(5)
    v_mfma_f32_16x16x32_bf16 v[72:75], a[4:7], v[44:47], v[72:75]
    ds_read_b128 v[36:39], v2 offset:20480
    v_mfma_f32_16x16x32_bf16 v[76:79], a[12:15], v[44:47], v[76:79]
    v_mfma_f32_16x16x32_bf16 v[88:91], v[44:47], a[132:135], v[88:91]
    v_mfma_f32_16x16x32_bf16 v[92:95], v[44:47], a[140:143], v[92:95]
    s_waitcnt lgkmcnt(5)
    v_mfma_f32_16x16x32_bf16 v[64:67], a[16:19], v[48:51], v[64:67]
    ds_read_b128 v[40:43], v2 offset:5120
    v_mfma_f32_16x16x32_bf16 v[68:71], a[24:27], v[48:51], v[68:71]
    v_mfma_f32_16x16x32_bf16 v[80:83], v[48:51], a[144:147], v[80:83]
    v_mfma_f32_16x16x32_bf16 v[84:87], v[48:51], a[152:155], v[84:87]
    s_waitcnt lgkmcnt(5)
    v_mfma_f32_16x16x32_bf16 v[72:75], a[16:19], v[52:55], v[72:75]
    ds_read_b128 v[44:47], v2 offset:21504
    v_mfma_f32_16x16x32_bf16 v[76:79], a[24:27], v[52:55], v[76:79]
    v_mfma_f32_16x16x32_bf16 v[88:91], v[52:55], a[144:147], v[88:91]
    v_mfma_f32_16x16x32_bf16 v[92:95], v[52:55], a[152:155], v[92:95]
    s_waitcnt lgkmcnt(5)
    v_mfma_f32_16x16x32_bf16 v[64:67], a[20:23], v[56:59], v[64:67]
    ds_read_b128 v[48:51], v2 offset:6144
    v_mfma_f32_16x16x32_bf16 v[68:71], a[28:31], v[56:59], v[68:71]
    v_mfma_f32_16x16x32_bf16 v[80:83], v[56:59], a[148:151], v[80:83]
    v_mfma_f32_16x16x32_bf16 v[84:87], v[56:59], a[156:159], v[84:87]
    s_waitcnt lgkmcnt(5)
    v_mfma_f32_16x16x32_bf16 v[72:75], a[20:23], v[60:63], v[72:75]
    ds_read_b128 v[52:55], v2 offset:22528
    v_mfma_f32_16x16x32_bf16 v[76:79], a[28:31], v[60:63], v[76:79]
    v_mfma_f32_16x16x32_bf16 v[88:91], v[60:63], a[148:151], v[88:91]
    v_mfma_f32_16x16x32_bf16 v[92:95], v[60:63], a[156:159], v[92:95]
    s_waitcnt lgkmcnt(5)
    v_mfma_f32_16x16x32_bf16 v[64:67], a[32:35], v[32:35], v[64:67]
    ds_read_b128 v[56:59], v2 offset:7168
    v_mfma_f32_16x16x32_bf16 v[68:71], a[40:43], v[32:35], v[68:71]
    v_mfma_f32_16x16x32_bf16 v[80:83], v[32:35], a[160:163], v[80:83]
    v_mfma_f32_16x16x32_bf16 v[84:87], v[32:35], a[168:171], v[84:87]
    s_waitcnt lgkmcnt(5)
    v_mfma_f32_16x16x32_bf16 v[72:75], a[32:35], v[36:39], v[72:75]
    ds_read_b128 v[60:63], v2 offset:23552
    v_mfma_f32_16x16x32_bf16 v[76:79], a[40:43], v[36:39], v[76:79]
    v_mfma_f32_16x16x32_bf16 v[88:91], v[36:39], a[160:163], v[88:91]
    v_mfma_f32_16x16x32_bf16 v[92:95], v[36:39], a[168:171], v[92:95]
    s_waitcnt lgkmcnt(5)
    v_mfma_f32_16x16x32_bf16 v[64:67], a[36:39], v[40:43], v[64:67]
    ds_read_b128 v[32:35], v2 offset:8192
    v_mfma_f32_16x16x32_bf16 v[68:71], a[44:47], v[40:43], v[68:71]
    v_mfma_f32_16x16x32_bf16 v[80:83], v[40:43], a[164:167], v[80:83]
    v_mfma_f32_16x16x32_bf16 v[84:87], v[40:43], a[172:175], v[84:87]
    s_waitcnt lgkmcnt(5)
    v_mfma_f32_16x16x32_bf16 v[72:75], a[36:39], v[44:47], v[72:75]
    ds_read_b128 v[36:39], v2 offset:24576
    v_mfma_f32_16x16x32_bf16 v[76:79], a[44:47], v[44:47], v[76:79]
    v_mfma_f32_16x16x32_bf16 v[88:91], v[44:47], a[164:167], v[88:91]
    v_mfma_f32_16x16x32_bf16 v[92:95], v[44:47], a[172:175], v[92:95]
    s_waitcnt lgkmcnt(5)
    v_mfma_f32_16x16x32_bf16 v[64:67], a[48:51], v[48:51], v[64:67]
    ds_read_b128 v[40:43], v2 offset:9216
    v_mfma_f32_16x16x32_bf16 v[68:71], a[56:59], v[48:51], v[68:71]
    v_mfma_f32_16x16x32_bf16 v[80:83], v[48:51], a[176:179], v[80:83]
    v_mfma_f32_16x16x32_bf16 v[84:87], v[48:51], a[184:187], v[84:87]
    s_waitcnt lgkmcnt(5)
    v_mfma_f32_16x16x32_bf16 v[72:75], a[48:51], v[52:55], v[72:75]
    ds_read_b128 v[44:47], v2 offset:25600
    v_mfma_f32_16x16x32_bf16 v[76:79], a[56:59], v[52:55], v[76:79]
    v_mfma_f32_16x16x32_bf16 v[88:91], v[52:55], a[176:179], v[88:91]
    v_mfma_f32_16x16x32_bf16 v[92:95], v[52:55], a[184:187], v[92:95]
    s_waitcnt lgkmcnt(5)
    v_mfma_f32_16x16x32_bf16 v[64:67], a[52:55], v[56:59], v[64:67]
    ds_read_b128 v[48:51], v2 offset:10240
    v_mfma_f32_16x16x32_bf16 v[68:71], a[60:63], v[56:59], v[68:71]
    v_mfma_f32_16x16x32_bf16 v[80:83], v[56:59], a[180:183], v[80:83]
    v_mfma_f32_16x16x32_bf16 v[84:87], v[56:59], a[188:191], v[84:87]
    s_waitcnt lgkmcnt(5)
    v_mfma_f32_16x16x32_bf16 v[72:75], a[52:55], v[60:63], v[72:75]
    ds_read_b128 v[52:55], v2 offset:26624
    v_mfma_f32_16x16x32_bf16 v[76:79], a[60:63], v[60:63], v[76:79]
    v_mfma_f32_16x16x32_bf16 v[88:91], v[60:63], a[180:183], v[88:91]
    v_mfma_f32_16x16x32_bf16 v[92:95], v[60:63], a[188:191], v[92:95]
    s_waitcnt lgkmcnt(5)
    v_mfma_f32_16x16x32_bf16 v[64:67], a[64:67], v[32:35], v[64:67]
    ds_read_b128 v[56:59], v2 offset:11264
    v_mfma_f32_16x16x32_bf16 v[68:71], a[72:75], v[32:35], v[68:71]
    v_mfma_f32_16x16x32_bf16 v[80:83], v[32:35], a[192:195], v[80:83]
    v_mfma_f32_16x16x32_bf16 v[84:87], v[32:35], a[200:203], v[84:87]
    s_waitcnt lgkmcnt(5)
    v_mfma_f32_16x16x32_bf16 v[72:75], a[64:67], v[36:39], v[72:75]
    ds_read_b128 v[60:63], v2 offset:27648
    v_mfma_f32_16x16x32_bf16 v[76:79], a[72:75], v[36:39], v[76:79]
    v_mfma_f32_16x16x32_bf16 v[88:91], v[36:39], a[192:195], v[88:91]
    v_mfma_f32_16x16x32_bf16 v[92:95], v[36:39], a[200:203], v[92:95]
    s_waitcnt lgkmcnt(5)
    v_mfma_f32_16x16x32_bf16 v[64:67], a[68:71], v[40:43], v[64:67]
    ds_read_b128 v[32:35], v2 offset:12288
    v_mfma_f32_16x16x32_bf16 v[68:71], a[76:79], v[40:43], v[68:71]
    v_mfma_f32_16x16x32_bf16 v[80:83], v[40:43], a[196:199], v[80:83]
    v_mfma_f32_16x16x32_bf16 v[84:87], v[40:43], a[204:207], v[84:87]
    s_waitcnt lgkmcnt(5)
    v_mfma_f32_16x16x32_bf16 v[72:75], a[68:71], v[44:47], v[72:75]
    ds_read_b128 v[36:39], v2 offset:28672
    v_mfma_f32_16x16x32_bf16 v[76:79], a[76:79], v[44:47], v[76:79]
    v_mfma_f32_16x16x32_bf16 v[88:91], v[44:47], a[196:199], v[88:91]
    v_mfma_f32_16x16x32_bf16 v[92:95], v[44:47], a[204:207], v[92:95]
    s_waitcnt lgkmcnt(5)
    v_mfma_f32_16x16x32_bf16 v[64:67], a[80:83], v[48:51], v[64:67]
    ds_read_b128 v[40:43], v2 offset:13312
    v_mfma_f32_16x16x32_bf16 v[68:71], a[88:91], v[48:51], v[68:71]
    v_mfma_f32_16x16x32_bf16 v[80:83], v[48:51], a[208:211], v[80:83]
    v_mfma_f32_16x16x32_bf16 v[84:87], v[48:51], a[216:219], v[84:87]
    s_waitcnt lgkmcnt(5)
    v_mfma_f32_16x16x32_bf16 v[72:75], a[80:83], v[52:55], v[72:75]
    ds_read_b128 v[44:47], v2 offset:29696
    v_mfma_f32_16x16x32_bf16 v[76:79], a[88:91], v[52:55], v[76:79]
    v_mfma_f32_16x16x32_bf16 v[88:91], v[52:55], a[208:211], v[88:91]
    v_mfma_f32_16x16x32_bf16 v[92:95], v[52:55], a[216:219], v[92:95]
    s_waitcnt lgkmcnt(5)
    v_mfma_f32_16x16x32_bf16 v[64:67], a[84:87], v[56:59], v[64:67]
    ds_read_b128 v[48:51], v2 offset:14336
    v_mfma_f32_16x16x32_bf16 v[68:71], a[92:95], v[56:59], v[68:71]
    v_mfma_f32_16x16x32_bf16 v[80:83], v[56:59], a[212:215], v[80:83]
    v_mfma_f32_16x16x32_bf16 v[84:87], v[56:59], a[220:223], v[84:87]
    s_waitcnt lgkmcnt(5)
    v_mfma_f32_16x16x32_bf16 v[72:75], a[84:87], v[60:63], v[72:75]
    ds_read_b128 v[52:55], v2 offset:30720
    v_mfma_f32_16x16x32_bf16 v[76:79], a[92:95], v[60:63], v[76:79]
    v_mfma_f32_16x16x32_bf16 v[88:91], v[60:63], a[212:215], v[88:91]
    v_mfma_f32_16x16x32_bf16 v[92:95], v[60:63], a[220:223], v[92:95]
    s_waitcnt lgkmcnt(5)
    v_mfma_f32_16x16x32_bf16 v[64:67], a[96:99], v[32:35], v[64:67]
    ds_read_b128 v[56:59], v2 offset:15360
    v_mfma_f32_16x16x32_bf16 v[68:71], a[104:107], v[32:35], v[68:71]
    v_mfma_f32_16x16x32_bf16 v[80:83], v[32:35], a[224:227], v[80:83]
    v_mfma_f32_16x16x32_bf16 v[84:87], v[32:35], a[232:235], v[84:87]
    s_waitcnt lgkmcnt(5)
    v_mfma_f32_16x16x32_bf16 v[72:75], a[96:99], v[36:39], v[72:75]
    ds_read_b128 v[60:63], v2 offset:31744
    v_mfma_f32_16x16x32_bf16 v[76:79], a[104:107], v[36:39], v[76:79]
    v_mfma_f32_16x16x32_bf16 v[88:91], v[36:39], a[224:227], v[88:91]
    v_mfma_f32_16x16x32_bf16 v[92:95], v[36:39], a[232:235], v[92:95]
    s_waitcnt lgkmcnt(5)
    v_mfma_f32_16x16x32_bf16 v[64:67], a[100:103], v[40:43], v[64:67]
    v_mfma_f32_16x16x32_bf16 v[68:71], a[108:111], v[40:43], v[68:71]
    v_mfma_f32_16x16x32_bf16 v[80:83], v[40:43], a[228:231], v[80:83]
    v_mfma_f32_16x16x32_bf16 v[84:87], v[40:43], a[236:239], v[84:87]
    s_waitcnt lgkmcnt(4)
    v_mfma_f32_16x16x32_bf16 v[72:75], a[100:103], v[44:47], v[72:75]
    v_mfma_f32_16x16x32_bf16 v[76:79], a[108:111], v[44:47], v[76:79]
    v_mfma_f32_16x16x32_bf16 v[88:91], v[44:47], a[228:231], v[88:91]
    v_mfma_f32_16x16x32_bf16 v[92:95], v[44:47], a[236:239], v[92:95]
    s_waitcnt lgkmcnt(3)
    v_mfma_f32_16x16x32_bf16 v[64:67], a[112:115], v[48:51], v[64:67]
    v_mfma_f32_16x16x32_bf16 v[68:71], a[120:123], v[48:51], v[68:71]
    v_mfma_f32_16x16x32_bf16 v[80:83], v[48:51], a[240:243], v[80:83]
    v_mfma_f32_16x16x32_bf16 v[84:87], v[48:51], a[248:251], v[84:87]
    s_waitcnt lgkmcnt(2)
    v_mfma_f32_16x16x32_bf16 v[72:75], a[112:115], v[52:55], v[72:75]
    v_mfma_f32_16x16x32_bf16 v[76:79], a[120:123], v[52:55], v[76:79]
    v_mfma_f32_16x16x32_bf16 v[88:91], v[52:55], a[240:243], v[88:91]
    v_mfma_f32_16x16x32_bf16 v[92:95], v[52:55], a[248:251], v[92:95]
    s_waitcnt lgkmcnt(1)
    v_mfma_f32_16x16x32_bf16 v[64:67], a[116:119], v[56:59], v[64:67]
    v_mfma_f32_16x16x32_bf16 v[68:71], a[124:127], v[56:59], v[68:71]
    v_mfma_f32_16x16x32_bf16 v[80:83], v[56:59], a[244:247], v[80:83]
    v_mfma_f32_16x16x32_bf16 v[84:87], v[56:59], a[252:255], v[84:87]
    s_waitcnt lgkmcnt(0)
    v_mfma_f32_16x16x32_bf16 v[72:75], a[116:119], v[60:63], v[72:75]
    v_mfma_f32_16x16x32_bf16 v[76:79], a[124:127], v[60:63], v[76:79]
    v_mfma_f32_16x16x32_bf16 v[88:91], v[60:63], a[244:247], v[88:91]
    v_mfma_f32_16x16x32_bf16 v[92:95], v[60:63], a[252:255], v[92:95]
    s_lshl_b32 s54, s68, 18
    s_lshl_b32 s55, s65, 13
    s_add_u32 s54, s54, s55
    s_lshl_b32 s55, s44, 10
    s_add_u32 s56, s54, s55
    s_add_u32 s57, s56, s55
    v_cvt_pk_bf16_f32 v112, v64, v68
    v_cvt_pk_bf16_f32 v113, v65, v69
    v_cvt_pk_bf16_f32 v114, v66, v70
    v_cvt_pk_bf16_f32 v115, v67, v71
    s_add_u32 s54, s56, 33554432
    buffer_store_dwordx4 v[112:115], v0, s[28:31], s54 offen sc1
    v_cvt_pk_bf16_f32 v116, v72, v76
    v_cvt_pk_bf16_f32 v117, v73, v77
    v_cvt_pk_bf16_f32 v118, v74, v78
    v_cvt_pk_bf16_f32 v119, v75, v79
    s_add_u32 s54, s56, 33558528
    buffer_store_dwordx4 v[116:119], v0, s[28:31], s54 offen sc1
    v_cvt_pk_bf16_f32 v120, v80, v81
    v_cvt_pk_bf16_f32 v121, v82, v83
    v_cvt_pk_bf16_f32 v122, v88, v89
    v_cvt_pk_bf16_f32 v123, v90, v91
    s_add_u32 s54, s57, 50331648
    buffer_store_dwordx4 v[120:123], v0, s[28:31], s54 offen sc1
    v_cvt_pk_bf16_f32 v124, v84, v85
    v_cvt_pk_bf16_f32 v125, v86, v87
    v_cvt_pk_bf16_f32 v126, v92, v93
    v_cvt_pk_bf16_f32 v127, v94, v95
    s_add_u32 s54, s57, 50332672
    buffer_store_dwordx4 v[124:127], v0, s[28:31], s54 offen sc1
    s_lshr_b32 s54, s57, 1
    s_add_u32 s54, s54, 4194304
    v_mov_b64 v[12:13], -1
    v_mov_b64 v[14:15], -1
    buffer_store_dwordx4 v[12:15], v0, s[28:31], s54 offen sc1
    s_cmp_lg_u32 s77, s68
    s_cbranch_scc1 L_lz_102
    s_waitcnt vmcnt(0)
L_lz_102:
    s_waitcnt vmcnt(13)
    s_barrier
    s_cmp_lg_u32 s44, 0
    s_cbranch_scc1 L_nf_103
    s_lshl_b32 s55, s77, 3
    s_add_u32 s55, s55, s73
    v_mov_b32 v8, s42
    v_mov_b32 v9, s43
    s_mov_b64 exec, 1
    buffer_store_dwordx2 v[8:9], off, s[28:31], s55 sc1
    s_mov_b64 exec, -1
L_nf_103:
    s_mov_b32 s77, s68
    v_add_u32 v2, 0x8000, v2
    v_and_b32 v2, 0x1ffff, v2
    s_add_u32 s68, s68, s69
    s_cmp_lt_u32 s68, s70
    s_cbranch_scc1 L_kv_97
    s_waitcnt vmcnt(0)
    s_barrier
    s_cmp_lg_u32 s44, 0
    s_cbranch_scc1 L_nf_104
    s_lshl_b32 s55, s77, 3
    s_add_u32 s55, s55, s73
    v_mov_b32 v8, s42
    v_mov_b32 v9, s43
    s_mov_b64 exec, 1
    buffer_store_dwordx2 v[8:9], off, s[28:31], s55 sc1
    s_mov_b64 exec, -1
L_nf_104:
    s_mov_b32 s68, s67
    s_mov_b32 s69, 7
    s_mov_b32 s70, 64
    s_lshl_b32 s73, s65, 9
    s_add_u32 s73, s73, 49152
    s_mov_b32 s71, 0
    v_mov_b32 v2, v0
    s_mov_b32 s77, s68
    s_mov_b32 s72, s68
    s_min_u32 s57, s72, 63
    s_lshl_b32 s54, s57, 15
    s_lshl_b32 s55, s44, 13
    s_add_u32 s54, s54, s55
    s_add_u32 s54, s54, 1048576
    s_add_u32 s55, s55, s71
    s_mov_b32 m0, s55
    s_nop 0
    buffer_load_dwordx4 v0, s[28:31], s54 offen offset:0 lds
    buffer_load_dwordx4 v0, s[28:31], s54 offen offset:1024 lds
    buffer_load_dwordx4 v0, s[28:31], s54 offen offset:2048 lds
    buffer_load_dwordx4 v0, s[28:31], s54 offen offset:3072 lds
    s_add_u32 s54, s54, 4096
    s_add_u32 s55, s55, 4096
    s_mov_b32 m0, s55
    s_nop 0
    buffer_load_dwordx4 v0, s[28:31], s54 offen offset:0 lds
    buffer_load_dwordx4 v0, s[28:31], s54 offen offset:1024 lds
    buffer_load_dwordx4 v0, s[28:31], s54 offen offset:2048 lds
    buffer_load_dwordx4 v0, s[28:31], s54 offen offset:3072 lds
    s_add_u32 s72, s72, s69
    s_add_u32 s71, s71, 0x8000
    s_and_b32 s71, s71, 0x18000
    s_min_u32 s57, s72, 63
    s_lshl_b32 s54, s57, 15
    s_lshl_b32 s55, s44, 13
    s_add_u32 s54, s54, s55
    s_add_u32 s54, s54, 1048576
    s_add_u32 s55, s55, s71
    s_mov_b32 m0, s55
    s_nop 0
    buffer_load_dwordx4 v0, s[28:31], s54 offen offset:0 lds
    buffer_load_dwordx4 v0, s[28:31], s54 offen offset:1024 lds
    buffer_load_dwordx4 v0, s[28:31], s54 offen offset:2048 lds
    buffer_load_dwordx4 v0, s[28:31], s54 offen offset:3072 lds
    s_add_u32 s54, s54, 4096
    s_add_u32 s55, s55, 4096
    s_mov_b32 m0, s55
    s_nop 0
    buffer_load_dwordx4 v0, s[28:31], s54 offen offset:0 lds
    buffer_load_dwordx4 v0, s[28:31], s54 offen offset:1024 lds
    buffer_load_dwordx4 v0, s[28:31], s54 offen offset:2048 lds
    buffer_load_dwordx4 v0, s[28:31], s54 offen offset:3072 lds
    s_add_u32 s72, s72, s69
    s_add_u32 s71, s71, 0x8000
    s_and_b32 s71, s71, 0x18000
    s_and_b32 s54, s44, 3
    s_lshl_b32 s47, s54, 12
    s_lshl_b32 s54, s54, 6
    v_xor_b32 v49, s54, v0
    v_lshrrev_b32 v48, 8, v0
    v_mul_u32_u24 v48, 7936, v48
    v_add_u32 v48, v48, v49
    s_mov_b32 s32, s8
    s_and_b32 s33, s9, 0xffff
    s_mov_b32 s34, 4194304
    s_mov_b32 s35, 0x20000
    s_lshl_b32 s48, s65, 8
    s_lshl_b32 s54, s44, 16
    s_add_u32 s48, s48, s54
    s_add_u32 m0, s47, 98304
    s_add_u32 s54, s48, 0
    buffer_load_dwordx4 v48, s[32:35], s54 offen lds
    s_add_u32 m0, s47, 99328
    s_add_u32 s54, s48, 32768
    buffer_load_dwordx4 v48, s[32:35], s54 offen lds
    s_add_u32 m0, s47, 100352
    s_add_u32 s54, s48, 262144
    buffer_load_dwordx4 v48, s[32:35], s54 offen lds
    s_add_u32 m0, s47, 101376
    s_add_u32 s54, s48, 294912
    buffer_load_dwordx4 v48, s[32:35], s54 offen lds
    s_add_u32 m0, s47, 114688
    s_add_u32 s54, s48, 524288
    buffer_load_dwordx4 v48, s[32:35], s54 offen lds
    s_add_u32 m0, s47, 115712
    s_add_u32 s54, s48, 557056
    buffer_load_dwordx4 v48, s[32:35], s54 offen lds
    s_add_u32 m0, s47, 116736
    s_add_u32 s54, s48, 786432
    buffer_load_dwordx4 v48, s[32:35], s54 offen lds
    s_add_u32 m0, s47, 117760
    s_add_u32 s54, s48, 819200
    buffer_load_dwordx4 v48, s[32:35], s54 offen lds
    s_add_u32 m0, s47, 131072
    s_add_u32 s54, s48, 1048576
    buffer_load_dwordx4 v48, s[32:35], s54 offen lds
    s_add_u32 m0, s47, 132096
    s_add_u32 s54, s48, 1081344
    buffer_load_dwordx4 v48, s[32:35], s54 offen lds
    s_add_u32 m0, s47, 133120
    s_add_u32 s54, s48, 1310720
    buffer_load_dwordx4 v48, s[32:35], s54 offen lds
    s_add_u32 m0, s47, 134144
    s_add_u32 s54, s48, 1343488
    buffer_load_dwordx4 v48, s[32:35], s54 offen lds
    v_lshrrev_b32 v32, 8, v0
    v_bfe_u32 v33, v0, 4, 4
    v_lshlrev_b32 v33, 2, v33
    v_lshl_add_u32 v33, v32, 12, v33
    v_add_u32 v33, 98304, v33
    v_xor_b32 v50, s44, v32
    v_lshl_add_u32 v50, v50, 6, v33
    v_add_u32 v51, 0x10000, v50
    s_waitcnt vmcnt(8)
    s_barrier
    s_add_u32 m0, s47, 147456
    s_add_u32 s54, s48, 1572864
    buffer_load_dwordx4 v48, s[32:35], s54 offen lds
    s_add_u32 m0, s47, 148480
    s_add_u32 s54, s48, 1605632
    buffer_load_dwordx4 v48, s[32:35], s54 offen lds
    s_add_u32 m0, s47, 149504
    s_add_u32 s54, s48, 1835008
    buffer_load_dwordx4 v48, s[32:35], s54 offen lds
    s_add_u32 m0, s47, 150528
    s_add_u32 s54, s48, 1867776
    buffer_load_dwordx4 v48, s[32:35], s54 offen lds
    ds_read2st64_b32 v[32:33], v50 offset0:0 offset1:1
    ds_read2st64_b32 v[34:35], v50 offset0:2 offset1:3
    ds_read2st64_b32 v[36:37], v50 offset0:4 offset1:5
    ds_read2st64_b32 v[38:39], v50 offset0:6 offset1:7
    ds_read2st64_b32 v[40:41], v50 offset0:8 offset1:9
    ds_read2st64_b32 v[42:43], v50 offset0:10 offset1:11
    ds_read2st64_b32 v[44:45], v50 offset0:12 offset1:13
    ds_read2st64_b32 v[46:47], v50 offset0:14 offset1:15
    s_waitcnt lgkmcnt(6)
    v_perm_b32 v128, v33, v32, s52
    v_perm_b32 v136, v33, v32, s53
    v_perm_b32 v129, v35, v34, s52
    v_perm_b32 v137, v35, v34, s53
    s_waitcnt lgkmcnt(4)
    v_perm_b32 v130, v37, v36, s52
    v_perm_b32 v138, v37, v36, s53
    v_perm_b32 v131, v39, v38, s52
    v_perm_b32 v139, v39, v38, s53
    s_waitcnt lgkmcnt(2)
    v_perm_b32 v132, v41, v40, s52
    v_perm_b32 v140, v41, v40, s53
    v_perm_b32 v133, v43, v42, s52
    v_perm_b32 v141, v43, v42, s53
    s_waitcnt lgkmcnt(0)
    v_perm_b32 v134, v45, v44, s52
    v_perm_b32 v142, v45, v44, s53
    v_perm_b32 v135, v47, v46, s52
    v_perm_b32 v143, v47, v46, s53
    s_waitcnt vmcnt(8)
    s_barrier
    s_add_u32 m0, s47, 98304
    s_add_u32 s54, s48, 2097152
    buffer_load_dwordx4 v48, s[32:35], s54 offen lds
    s_add_u32 m0, s47, 99328
    s_add_u32 s54, s48, 2129920
    buffer_load_dwordx4 v48, s[32:35], s54 offen lds
    s_add_u32 m0, s47, 100352
    s_add_u32 s54, s48, 2359296
    buffer_load_dwordx4 v48, s[32:35], s54 offen lds
    s_add_u32 m0, s47, 101376
    s_add_u32 s54, s48, 2392064
    buffer_load_dwordx4 v48, s[32:35], s54 offen lds
    ds_read2st64_b32 v[32:33], v50 offset0:64 offset1:65
    ds_read2st64_b32 v[34:35], v50 offset0:66 offset1:67
    ds_read2st64_b32 v[36:37], v50 offset0:68 offset1:69
    ds_read2st64_b32 v[38:39], v50 offset0:70 offset1:71
    ds_read2st64_b32 v[40:41], v50 offset0:72 offset1:73
    ds_read2st64_b32 v[42:43], v50 offset0:74 offset1:75
    ds_read2st64_b32 v[44:45], v50 offset0:76 offset1:77
    ds_read2st64_b32 v[46:47], v50 offset0:78 offset1:79
    s_waitcnt lgkmcnt(6)
    v_perm_b32 v144, v33, v32, s52
    v_perm_b32 v152, v33, v32, s53
    v_perm_b32 v145, v35, v34, s52
    v_perm_b32 v153, v35, v34, s53
    s_waitcnt lgkmcnt(4)
    v_perm_b32 v146, v37, v36, s52
    v_perm_b32 v154, v37, v36, s53
    v_perm_b32 v147, v39, v38, s52
    v_perm_b32 v155, v39, v38, s53
    s_waitcnt lgkmcnt(2)
    v_perm_b32 v148, v41, v40, s52
    v_perm_b32 v156, v41, v40, s53
    v_perm_b32 v149, v43, v42, s52
    v_perm_b32 v157, v43, v42, s53
    s_waitcnt lgkmcnt(0)
    v_perm_b32 v150, v45, v44, s52
    v_perm_b32 v158, v45, v44, s53
    v_perm_b32 v151, v47, v46, s52
    v_perm_b32 v159, v47, v46, s53
    s_waitcnt vmcnt(8)
    s_barrier
    s_add_u32 m0, s47, 114688
    s_add_u32 s54, s48, 2621440
    buffer_load_dwordx4 v48, s[32:35], s54 offen lds
    s_add_u32 m0, s47, 115712
    s_add_u32 s54, s48, 2654208
    buffer_load_dwordx4 v48, s[32:35], s54 offen lds
    s_add_u32 m0, s47, 116736
    s_add_u32 s54, s48, 2883584
    buffer_load_dwordx4 v48, s[32:35], s54 offen lds
    s_add_u32 m0, s47, 117760
    s_add_u32 s54, s48, 2916352
    buffer_load_dwordx4 v48, s[32:35], s54 offen lds
    ds_read2st64_b32 v[32:33], v50 offset0:128 offset1:129
    ds_read2st64_b32 v[34:35], v50 offset0:130 offset1:131
    ds_read2st64_b32 v[36:37], v50 offset0:132 offset1:133
    ds_read2st64_b32 v[38:39], v50 offset0:134 offset1:135
    ds_read2st64_b32 v[40:41], v50 offset0:136 offset1:137
    ds_read2st64_b32 v[42:43], v50 offset0:138 offset1:139
    ds_read2st64_b32 v[44:45], v50 offset0:140 offset1:141
    ds_read2st64_b32 v[46:47], v50 offset0:142 offset1:143
    s_waitcnt lgkmcnt(6)
    v_perm_b32 v160, v33, v32, s52
    v_perm_b32 v168, v33, v32, s53
    v_perm_b32 v161, v35, v34, s52
    v_perm_b32 v169, v35, v34, s53
    s_waitcnt lgkmcnt(4)
    v_perm_b32 v162, v37, v36, s52
    v_perm_b32 v170, v37, v36, s53
    v_perm_b32 v163, v39, v38, s52
    v_perm_b32 v171, v39, v38, s53
    s_waitcnt lgkmcnt(2)
    v_perm_b32 v164, v41, v40, s52
    v_perm_b32 v172, v41, v40, s53
    v_perm_b32 v165, v43, v42, s52
    v_perm_b32 v173, v43, v42, s53
    s_waitcnt lgkmcnt(0)
    v_perm_b32 v166, v45, v44, s52
    v_perm_b32 v174, v45, v44, s53
    v_perm_b32 v167, v47, v46, s52
    v_perm_b32 v175, v47, v46, s53
    s_waitcnt vmcnt(8)
    s_barrier
    s_add_u32 m0, s47, 131072
    s_add_u32 s54, s48, 3145728
    buffer_load_dwordx4 v48, s[32:35], s54 offen lds
    s_add_u32 m0, s47, 132096
    s_add_u32 s54, s48, 3178496
    buffer_load_dwordx4 v48, s[32:35], s54 offen lds
    s_add_u32 m0, s47, 133120
    s_add_u32 s54, s48, 3407872
    buffer_load_dwordx4 v48, s[32:35], s54 offen lds
    s_add_u32 m0, s47, 134144
    s_add_u32 s54, s48, 3440640
    buffer_load_dwordx4 v48, s[32:35], s54 offen lds
    ds_read2st64_b32 v[32:33], v50 offset0:192 offset1:193
    ds_read2st64_b32 v[34:35], v50 offset0:194 offset1:195
    ds_read2st64_b32 v[36:37], v50 offset0:196 offset1:197
    ds_read2st64_b32 v[38:39], v50 offset0:198 offset1:199
    ds_read2st64_b32 v[40:41], v50 offset0:200 offset1:201
    ds_read2st64_b32 v[42:43], v50 offset0:202 offset1:203
    ds_read2st64_b32 v[44:45], v50 offset0:204 offset1:205
    ds_read2st64_b32 v[46:47], v50 offset0:206 offset1:207
    s_waitcnt lgkmcnt(6)
    v_perm_b32 v176, v33, v32, s52
    v_perm_b32 v184, v33, v32, s53
    v_perm_b32 v177, v35, v34, s52
    v_perm_b32 v185, v35, v34, s53
    s_waitcnt lgkmcnt(4)
    v_perm_b32 v178, v37, v36, s52
    v_perm_b32 v186, v37, v36, s53
    v_perm_b32 v179, v39, v38, s52
    v_perm_b32 v187, v39, v38, s53
    s_waitcnt lgkmcnt(2)
    v_perm_b32 v180, v41, v40, s52
    v_perm_b32 v188, v41, v40, s53
    v_perm_b32 v181, v43, v42, s52
    v_perm_b32 v189, v43, v42, s53
    s_waitcnt lgkmcnt(0)
    v_perm_b32 v182, v45, v44, s52
    v_perm_b32 v190, v45, v44, s53
    v_perm_b32 v183, v47, v46, s52
    v_perm_b32 v191, v47, v46, s53
    s_waitcnt vmcnt(8)
    s_barrier
    s_add_u32 m0, s47, 147456
    s_add_u32 s54, s48, 3670016
    buffer_load_dwordx4 v48, s[32:35], s54 offen lds
    s_add_u32 m0, s47, 148480
    s_add_u32 s54, s48, 3702784
    buffer_load_dwordx4 v48, s[32:35], s54 offen lds
    s_add_u32 m0, s47, 149504
    s_add_u32 s54, s48, 3932160
    buffer_load_dwordx4 v48, s[32:35], s54 offen lds
    s_add_u32 m0, s47, 150528
    s_add_u32 s54, s48, 3964928
    buffer_load_dwordx4 v48, s[32:35], s54 offen lds
    s_lshl_b32 s54, s66, 2
    s_add_u32 s54, s54, s44
    s_lshl_b32 s54, s54, 10
    s_mov_b32 s36, s16
    s_and_b32 s37, s17, 0xffff
    s_mov_b32 s38, 1835008
    s_mov_b32 s39, 0x20000
    s_add_u32 s55, s54, 0
    v_add_u32 v3, s55, v0
    buffer_load_dwordx4 v[64:67], v3, s[36:39], 0 offen
    s_add_u32 s55, s54, 917504
    v_add_u32 v3, s55, v0
    buffer_load_dwordx4 v[68:71], v3, s[36:39], 0 offen
    s_mov_b32 s36, s18
    s_and_b32 s37, s19, 0xffff
    s_mov_b32 s38, 1835008
    s_mov_b32 s39, 0x20000
    s_add_u32 s55, s54, 0
    v_add_u32 v3, s55, v0
    buffer_load_dwordx4 v[72:75], v3, s[36:39], 0 offen
    s_add_u32 s55, s54, 917504
    v_add_u32 v3, s55, v0
    buffer_load_dwordx4 v[76:79], v3, s[36:39], 0 offen
    s_mov_b32 s36, s20
    s_and_b32 s37, s21, 0xffff
    s_mov_b32 s38, 1835008
    s_mov_b32 s39, 0x20000
    s_add_u32 s55, s54, 0
    v_add_u32 v3, s55, v0
    buffer_load_dwordx4 v[80:83], v3, s[36:39], 0 offen
    s_add_u32 s55, s54, 917504
    v_add_u32 v3, s55, v0
    buffer_load_dwordx4 v[84:87], v3, s[36:39], 0 offen
    ds_read2st64_b32 v[32:33], v50 offset0:0 offset1:1
    ds_read2st64_b32 v[34:35], v50 offset0:2 offset1:3
    ds_read2st64_b32 v[36:37], v50 offset0:4 offset1:5
    ds_read2st64_b32 v[38:39], v50 offset0:6 offset1:7
    ds_read2st64_b32 v[40:41], v50 offset0:8 offset1:9
    ds_read2st64_b32 v[42:43], v50 offset0:10 offset1:11
    ds_read2st64_b32 v[44:45], v50 offset0:12 offset1:13
    ds_read2st64_b32 v[46:47], v50 offset0:14 offset1:15
    s_waitcnt lgkmcnt(6)
    v_perm_b32 v192, v33, v32, s52
    v_perm_b32 v200, v33, v32, s53
    v_perm_b32 v193, v35, v34, s52
    v_perm_b32 v201, v35, v34, s53
    s_waitcnt lgkmcnt(4)
    v_perm_b32 v194, v37, v36, s52
    v_perm_b32 v202, v37, v36, s53
    v_perm_b32 v195, v39, v38, s52
    v_perm_b32 v203, v39, v38, s53
    s_waitcnt lgkmcnt(2)
    v_perm_b32 v196, v41, v40, s52
    v_perm_b32 v204, v41, v40, s53
    v_perm_b32 v197, v43, v42, s52
    v_perm_b32 v205, v43, v42, s53
    s_waitcnt lgkmcnt(0)
    v_perm_b32 v198, v45, v44, s52
    v_perm_b32 v206, v45, v44, s53
    v_perm_b32 v199, v47, v46, s52
    v_perm_b32 v207, v47, v46, s53
    s_waitcnt vmcnt(14)
    s_barrier
    ds_read2st64_b32 v[32:33], v50 offset0:64 offset1:65
    ds_read2st64_b32 v[34:35], v50 offset0:66 offset1:67
    ds_read2st64_b32 v[36:37], v50 offset0:68 offset1:69
    ds_read2st64_b32 v[38:39], v50 offset0:70 offset1:71
    ds_read2st64_b32 v[40:41], v50 offset0:72 offset1:73
    ds_read2st64_b32 v[42:43], v50 offset0:74 offset1:75
    ds_read2st64_b32 v[44:45], v50 offset0:76 offset1:77
    ds_read2st64_b32 v[46:47], v50 offset0:78 offset1:79
    s_waitcnt lgkmcnt(6)
    v_perm_b32 v208, v33, v32, s52
    v_perm_b32 v216, v33, v32, s53
    v_perm_b32 v209, v35, v34, s52
    v_perm_b32 v217, v35, v34, s53
    s_waitcnt lgkmcnt(4)
    v_perm_b32 v210, v37, v36, s52
    v_perm_b32 v218, v37, v36, s53
    v_perm_b32 v211, v39, v38, s52
    v_perm_b32 v219, v39, v38, s53
    s_waitcnt lgkmcnt(2)
    v_perm_b32 v212, v41, v40, s52
    v_perm_b32 v220, v41, v40, s53
    v_perm_b32 v213, v43, v42, s52
    v_perm_b32 v221, v43, v42, s53
    s_waitcnt lgkmcnt(0)
    v_perm_b32 v214, v45, v44, s52
    v_perm_b32 v222, v45, v44, s53
    v_perm_b32 v215, v47, v46, s52
    v_perm_b32 v223, v47, v46, s53
    s_waitcnt vmcnt(10)
    s_barrier
    ds_read2st64_b32 v[32:33], v50 offset0:128 offset1:129
    ds_read2st64_b32 v[34:35], v50 offset0:130 offset1:131
    ds_read2st64_b32 v[36:37], v50 offset0:132 offset1:133
    ds_read2st64_b32 v[38:39], v50 offset0:134 offset1:135
    ds_read2st64_b32 v[40:41], v50 offset0:136 offset1:137
    ds_read2st64_b32 v[42:43], v50 offset0:138 offset1:139
    ds_read2st64_b32 v[44:45], v50 offset0:140 offset1:141
    ds_read2st64_b32 v[46:47], v50 offset0:142 offset1:143
    s_waitcnt lgkmcnt(6)
    v_perm_b32 v224, v33, v32, s52
    v_perm_b32 v232, v33, v32, s53
    v_perm_b32 v225, v35, v34, s52
    v_perm_b32 v233, v35, v34, s53
    s_waitcnt lgkmcnt(4)
    v_perm_b32 v226, v37, v36, s52
    v_perm_b32 v234, v37, v36, s53
    v_perm_b32 v227, v39, v38, s52
    v_perm_b32 v235, v39, v38, s53
    s_waitcnt lgkmcnt(2)
    v_perm_b32 v228, v41, v40, s52
    v_perm_b32 v236, v41, v40, s53
    v_perm_b32 v229, v43, v42, s52
    v_perm_b32 v237, v43, v42, s53
    s_waitcnt lgkmcnt(0)
    v_perm_b32 v230, v45, v44, s52
    v_perm_b32 v238, v45, v44, s53
    v_perm_b32 v231, v47, v46, s52
    v_perm_b32 v239, v47, v46, s53
    s_waitcnt vmcnt(6)
    s_barrier
    ds_read2st64_b32 v[32:33], v50 offset0:192 offset1:193
    ds_read2st64_b32 v[34:35], v50 offset0:194 offset1:195
    ds_read2st64_b32 v[36:37], v50 offset0:196 offset1:197
    ds_read2st64_b32 v[38:39], v50 offset0:198 offset1:199
    ds_read2st64_b32 v[40:41], v50 offset0:200 offset1:201
    ds_read2st64_b32 v[42:43], v50 offset0:202 offset1:203
    ds_read2st64_b32 v[44:45], v50 offset0:204 offset1:205
    ds_read2st64_b32 v[46:47], v50 offset0:206 offset1:207
    s_waitcnt lgkmcnt(6)
    v_perm_b32 v240, v33, v32, s52
    v_perm_b32 v248, v33, v32, s53
    v_perm_b32 v241, v35, v34, s52
    v_perm_b32 v249, v35, v34, s53
    s_waitcnt lgkmcnt(4)
    v_perm_b32 v242, v37, v36, s52
    v_perm_b32 v250, v37, v36, s53
    v_perm_b32 v243, v39, v38, s52
    v_perm_b32 v251, v39, v38, s53
    s_waitcnt lgkmcnt(2)
    v_perm_b32 v244, v41, v40, s52
    v_perm_b32 v252, v41, v40, s53
    v_perm_b32 v245, v43, v42, s52
    v_perm_b32 v253, v43, v42, s53
    s_waitcnt lgkmcnt(0)
    v_perm_b32 v246, v45, v44, s52
    v_perm_b32 v254, v45, v44, s53
    v_perm_b32 v247, v47, v46, s52
    v_perm_b32 v255, v47, v46, s53
    s_waitcnt vmcnt(0)
    s_barrier
L_q_105:
    s_min_u32 s57, s72, 63
    s_lshl_b32 s54, s57, 15
    s_lshl_b32 s55, s44, 13
    s_add_u32 s54, s54, s55
    s_add_u32 s54, s54, 1048576
    s_add_u32 s55, s55, s71
    s_mov_b32 m0, s55
    s_nop 0
    buffer_load_dwordx4 v0, s[28:31], s54 offen offset:0 lds
    buffer_load_dwordx4 v0, s[28:31], s54 offen offset:1024 lds
    buffer_load_dwordx4 v0, s[28:31], s54 offen offset:2048 lds
    buffer_load_dwordx4 v0, s[28:31], s54 offen offset:3072 lds
    s_add_u32 s54, s54, 4096
    s_add_u32 s55, s55, 4096
    s_mov_b32 m0, s55
    s_nop 0
    buffer_load_dwordx4 v0, s[28:31], s54 offen offset:0 lds
    buffer_load_dwordx4 v0, s[28:31], s54 offen offset:1024 lds
    buffer_load_dwordx4 v0, s[28:31], s54 offen offset:2048 lds
    buffer_load_dwordx4 v0, s[28:31], s54 offen offset:3072 lds
    s_add_u32 s72, s72, s69
    s_add_u32 s71, s71, 0x8000
    s_and_b32 s71, s71, 0x18000
    ds_read_b128 v[32:35], v2 offset:0
    ds_read_b128 v[36:39], v2 offset:16384
    ds_read_b128 v[40:43], v2 offset:1024
    ds_read_b128 v[44:47], v2 offset:17408
    ds_read_b128 v[48:51], v2 offset:2048
    ds_read_b128 v[52:55], v2 offset:18432
    s_waitcnt lgkmcnt(5)
    v_mfma_f32_16x16x32_bf16 v[96:99], v[128:131], v[32:35], 0
    ds_read_b128 v[56:59], v2 offset:3072
    v_mfma_f32_16x16x32_bf16 v[100:103], v[136:139], v[32:35], 0
    s_waitcnt lgkmcnt(5)
    v_mfma_f32_16x16x32_bf16 v[104:107], v[128:131], v[36:39], 0
    ds_read_b128 v[60:63], v2 offset:19456
    v_mfma_f32_16x16x32_bf16 v[108:111], v[136:139], v[36:39], 0
    s_waitcnt lgkmcnt(5)
    v_mfma_f32_16x16x32_bf16 v[96:99], v[132:135], v[40:43], v[96:99]
    ds_read_b128 v[32:35], v2 offset:4096
    v_mfma_f32_16x16x32_bf16 v[100:103], v[140:143], v[40:43], v[100:103]
    s_waitcnt lgkmcnt(5)
    v_mfma_f32_16x16x32_bf16 v[104:107], v[132:135], v[44:47], v[104:107]
    ds_read_b128 v[36:39], v2 offset:20480
    v_mfma_f32_16x16x32_bf16 v[108:111], v[140:143], v[44:47], v[108:111]
    s_waitcnt lgkmcnt(5)
    v_mfma_f32_16x16x32_bf16 v[96:99], v[144:147], v[48:51], v[96:99]
    ds_read_b128 v[40:43], v2 offset:5120
    v_mfma_f32_16x16x32_bf16 v[100:103], v[152:155], v[48:51], v[100:103]
    s_waitcnt lgkmcnt(5)
    v_mfma_f32_16x16x32_bf16 v[104:107], v[144:147], v[52:55], v[104:107]
    ds_read_b128 v[44:47], v2 offset:21504
    v_mfma_f32_16x16x32_bf16 v[108:111], v[152:155], v[52:55], v[108:111]
    s_waitcnt lgkmcnt(5)
    v_mfma_f32_16x16x32_bf16 v[96:99], v[148:151], v[56:59], v[96:99]
    ds_read_b128 v[48:51], v2 offset:6144
    v_mfma_f32_16x16x32_bf16 v[100:103], v[156:159], v[56:59], v[100:103]
    s_waitcnt lgkmcnt(5)
    v_mfma_f32_16x16x32_bf16 v[104:107], v[148:151], v[60:63], v[104:107]
    ds_read_b128 v[52:55], v2 offset:22528
    v_mfma_f32_16x16x32_bf16 v[108:111], v[156:159], v[60:63], v[108:111]
    s_waitcnt lgkmcnt(5)
    v_mfma_f32_16x16x32_bf16 v[96:99], v[160:163], v[32:35], v[96:99]
    ds_read_b128 v[56:59], v2 offset:7168
    v_mfma_f32_16x16x32_bf16 v[100:103], v[168:171], v[32:35], v[100:103]
    s_waitcnt lgkmcnt(5)
    v_mfma_f32_16x16x32_bf16 v[104:107], v[160:163], v[36:39], v[104:107]
    ds_read_b128 v[60:63], v2 offset:23552
    v_mfma_f32_16x16x32_bf16 v[108:111], v[168:171], v[36:39], v[108:111]
    s_waitcnt lgkmcnt(5)
    v_mfma_f32_16x16x32_bf16 v[96:99], v[164:167], v[40:43], v[96:99]
    ds_read_b128 v[32:35], v2 offset:8192
    v_mfma_f32_16x16x32_bf16 v[100:103], v[172:175], v[40:43], v[100:103]
    s_waitcnt lgkmcnt(5)
    v_mfma_f32_16x16x32_bf16 v[104:107], v[164:167], v[44:47], v[104:107]
    ds_read_b128 v[36:39], v2 offset:24576
    v_mfma_f32_16x16x32_bf16 v[108:111], v[172:175], v[44:47], v[108:111]
    s_waitcnt lgkmcnt(5)
    v_mfma_f32_16x16x32_bf16 v[96:99], v[176:179], v[48:51], v[96:99]
    ds_read_b128 v[40:43], v2 offset:9216
    v_mfma_f32_16x16x32_bf16 v[100:103], v[184:187], v[48:51], v[100:103]
    s_waitcnt lgkmcnt(5)
    v_mfma_f32_16x16x32_bf16 v[104:107], v[176:179], v[52:55], v[104:107]
    ds_read_b128 v[44:47], v2 offset:25600
    v_mfma_f32_16x16x32_bf16 v[108:111], v[184:187], v[52:55], v[108:111]
    s_waitcnt lgkmcnt(5)
    v_mfma_f32_16x16x32_bf16 v[96:99], v[180:183], v[56:59], v[96:99]
    ds_read_b128 v[48:51], v2 offset:10240
    v_mfma_f32_16x16x32_bf16 v[100:103], v[188:191], v[56:59], v[100:103]
    s_waitcnt lgkmcnt(5)
    v_mfma_f32_16x16x32_bf16 v[104:107], v[180:183], v[60:63], v[104:107]
    ds_read_b128 v[52:55], v2 offset:26624
    v_mfma_f32_16x16x32_bf16 v[108:111], v[188:191], v[60:63], v[108:111]
    s_waitcnt lgkmcnt(5)
    v_mfma_f32_16x16x32_bf16 v[96:99], v[192:195], v[32:35], v[96:99]
    ds_read_b128 v[56:59], v2 offset:11264
    v_mfma_f32_16x16x32_bf16 v[100:103], v[200:203], v[32:35], v[100:103]
    s_waitcnt lgkmcnt(5)
    v_mfma_f32_16x16x32_bf16 v[104:107], v[192:195], v[36:39], v[104:107]
    ds_read_b128 v[60:63], v2 offset:27648
    v_mfma_f32_16x16x32_bf16 v[108:111], v[200:203], v[36:39], v[108:111]
    s_waitcnt lgkmcnt(5)
    v_mfma_f32_16x16x32_bf16 v[96:99], v[196:199], v[40:43], v[96:99]
    ds_read_b128 v[32:35], v2 offset:12288
    v_mfma_f32_16x16x32_bf16 v[100:103], v[204:207], v[40:43], v[100:103]
    s_waitcnt lgkmcnt(5)
    v_mfma_f32_16x16x32_bf16 v[104:107], v[196:199], v[44:47], v[104:107]
    ds_read_b128 v[36:39], v2 offset:28672
    v_mfma_f32_16x16x32_bf16 v[108:111], v[204:207], v[44:47], v[108:111]
    s_waitcnt lgkmcnt(5)
    v_mfma_f32_16x16x32_bf16 v[96:99], v[208:211], v[48:51], v[96:99]
    ds_read_b128 v[40:43], v2 offset:13312
    v_mfma_f32_16x16x32_bf16 v[100:103], v[216:219], v[48:51], v[100:103]
    s_waitcnt lgkmcnt(5)
    v_mfma_f32_16x16x32_bf16 v[104:107], v[208:211], v[52:55], v[104:107]
    ds_read_b128 v[44:47], v2 offset:29696
    v_mfma_f32_16x16x32_bf16 v[108:111], v[216:219], v[52:55], v[108:111]
    s_waitcnt lgkmcnt(5)
    v_mfma_f32_16x16x32_bf16 v[96:99], v[212:215], v[56:59], v[96:99]
    ds_read_b128 v[48:51], v2 offset:14336
    v_mfma_f32_16x16x32_bf16 v[100:103], v[220:223], v[56:59], v[100:103]
    s_waitcnt lgkmcnt(5)
    v_mfma_f32_16x16x32_bf16 v[104:107], v[212:215], v[60:63], v[104:107]
    ds_read_b128 v[52:55], v2 offset:30720
    v_mfma_f32_16x16x32_bf16 v[108:111], v[220:223], v[60:63], v[108:111]
    s_waitcnt lgkmcnt(5)
    v_mfma_f32_16x16x32_bf16 v[96:99], v[224:227], v[32:35], v[96:99]
    ds_read_b128 v[56:59], v2 offset:15360
    v_mfma_f32_16x16x32_bf16 v[100:103], v[232:235], v[32:35], v[100:103]
    s_waitcnt lgkmcnt(5)
    v_mfma_f32_16x16x32_bf16 v[104:107], v[224:227], v[36:39], v[104:107]
    ds_read_b128 v[60:63], v2 offset:31744
    v_mfma_f32_16x16x32_bf16 v[108:111], v[232:235], v[36:39], v[108:111]
    s_waitcnt lgkmcnt(5)
    v_mfma_f32_16x16x32_bf16 v[96:99], v[228:231], v[40:43], v[96:99]
    v_mfma_f32_16x16x32_bf16 v[100:103], v[236:239], v[40:43], v[100:103]
    s_waitcnt lgkmcnt(4)
    v_mfma_f32_16x16x32_bf16 v[104:107], v[228:231], v[44:47], v[104:107]
    v_mfma_f32_16x16x32_bf16 v[108:111], v[236:239], v[44:47], v[108:111]
    s_waitcnt lgkmcnt(3)
    v_mfma_f32_16x16x32_bf16 v[96:99], v[240:243], v[48:51], v[96:99]
    v_mfma_f32_16x16x32_bf16 v[100:103], v[248:251], v[48:51], v[100:103]
    s_waitcnt lgkmcnt(2)
    v_mfma_f32_16x16x32_bf16 v[104:107], v[240:243], v[52:55], v[104:107]
    v_mfma_f32_16x16x32_bf16 v[108:111], v[248:251], v[52:55], v[108:111]
    s_waitcnt lgkmcnt(1)
    v_mfma_f32_16x16x32_bf16 v[96:99], v[244:247], v[56:59], v[96:99]
    v_mfma_f32_16x16x32_bf16 v[100:103], v[252:255], v[56:59], v[100:103]
    s_waitcnt lgkmcnt(0)
    v_mfma_f32_16x16x32_bf16 v[104:107], v[244:247], v[60:63], v[104:107]
    v_mfma_f32_16x16x32_bf16 v[108:111], v[252:255], v[60:63], v[108:111]
    s_lshl_b32 s54, s68, 18
    s_lshl_b32 s55, s65, 13
    s_add_u32 s54, s54, s55
    s_lshl_b32 s55, s44, 10
    s_add_u32 s56, s54, s55
    s_add_u32 s57, s56, s55
    v_cvt_pk_bf16_f32 v112, v96, v100
    v_cvt_pk_bf16_f32 v113, v97, v101
    v_cvt_pk_bf16_f32 v114, v98, v102
    v_cvt_pk_bf16_f32 v115, v99, v103
    s_add_u32 s54, s56, 16777216
    buffer_store_dwordx4 v[112:115], v0, s[28:31], s54 offen sc1
    v_cvt_pk_bf16_f32 v116, v104, v108
    v_cvt_pk_bf16_f32 v117, v105, v109
    v_cvt_pk_bf16_f32 v118, v106, v110
    v_cvt_pk_bf16_f32 v119, v107, v111
    s_add_u32 s54, s56, 16781312
    buffer_store_dwordx4 v[116:119], v0, s[28:31], s54 offen sc1
    s_cmp_lg_u32 s77, s68
    s_cbranch_scc1 L_lz_108
    s_waitcnt vmcnt(0)
L_lz_108:
    s_waitcnt vmcnt(10)
    s_barrier
    s_cmp_lg_u32 s44, 0
    s_cbranch_scc1 L_nf_109
    s_lshl_b32 s55, s77, 3
    s_add_u32 s55, s55, s73
    v_mov_b32 v8, s42
    v_mov_b32 v9, s43
    s_mov_b64 exec, 1
    buffer_store_dwordx2 v[8:9], off, s[28:31], s55 sc1
    s_mov_b64 exec, -1
L_nf_109:
    s_mov_b32 s77, s68
    v_add_u32 v2, 0x8000, v2
    v_and_b32 v2, 0x1ffff, v2
    s_add_u32 s68, s68, s69
    s_cmp_lt_u32 s68, s70
    s_cbranch_scc1 L_q_105
    s_waitcnt vmcnt(0)
    s_barrier
    s_cmp_lg_u32 s44, 0
    s_cbranch_scc1 L_nf_110
    s_lshl_b32 s55, s77, 3
    s_add_u32 s55, s55, s73
    v_mov_b32 v8, s42
    v_mov_b32 v9, s43
    s_mov_b64 exec, 1
    buffer_store_dwordx2 v[8:9], off, s[28:31], s55 sc1
    s_mov_b64 exec, -1
L_nf_110:
    s_cmp_lg_u32 s44, 0
    s_cbranch_scc1 L_wr_111
    s_lshl_b32 s55, s45, 3
    s_add_u32 s55, s55, 4096
    s_add_u32 s56, s42, s46
    s_addc_u32 s57, s43, 0
    v_mov_b32 v8, s56
    v_mov_b32 v9, s57
    s_mov_b64 exec, 1
    buffer_store_dwordx2 v[8:9], off, s[28:31], s55 sc1
    s_mov_b64 exec, -1
L_wr_111:
    s_lshr_b32 s74, s66, 4
    s_and_b32 s75, s66, 15
    s_lshl_b32 s76, s74, 2
    s_add_u32 s76, s76, s44
    s_lshl_b32 s76, s76, 11
    s_lshl_b32 s68, s75, 2
    s_mov_b32 s69, 1
    s_add_u32 s70, s68, 4
    s_mov_b32 s71, 0
    v_mov_b32 v2, v0
    s_mov_b32 s77, s68
    s_mov_b32 s72, s68
    s_min_u32 s57, s72, 63
    s_lshl_b32 s54, s57, 15
    s_lshl_b32 s55, s44, 13
    s_add_u32 s54, s54, s55
    s_add_u32 s54, s54, 1048576
    s_add_u32 s55, s55, s71
    s_mov_b32 m0, s55
    s_nop 0
    buffer_load_dwordx4 v0, s[28:31], s54 offen offset:0 lds
    buffer_load_dwordx4 v0, s[28:31], s54 offen offset:1024 lds
    buffer_load_dwordx4 v0, s[28:31], s54 offen offset:2048 lds
    buffer_load_dwordx4 v0, s[28:31], s54 offen offset:3072 lds
    s_add_u32 s54, s54, 4096
    s_add_u32 s55, s55, 4096
    s_mov_b32 m0, s55
    s_nop 0
    buffer_load_dwordx4 v0, s[28:31], s54 offen offset:0 lds
    buffer_load_dwordx4 v0, s[28:31], s54 offen offset:1024 lds
    buffer_load_dwordx4 v0, s[28:31], s54 offen offset:2048 lds
    buffer_load_dwordx4 v0, s[28:31], s54 offen offset:3072 lds
    s_add_u32 s72, s72, s69
    s_add_u32 s71, s71, 0x8000
    s_and_b32 s71, s71, 0x18000
    s_min_u32 s57, s72, 63
    s_lshl_b32 s54, s57, 15
    s_lshl_b32 s55, s44, 13
    s_add_u32 s54, s54, s55
    s_add_u32 s54, s54, 1048576
    s_add_u32 s55, s55, s71
    s_mov_b32 m0, s55
    s_nop 0
    buffer_load_dwordx4 v0, s[28:31], s54 offen offset:0 lds
    buffer_load_dwordx4 v0, s[28:31], s54 offen offset:1024 lds
    buffer_load_dwordx4 v0, s[28:31], s54 offen offset:2048 lds
    buffer_load_dwordx4 v0, s[28:31], s54 offen offset:3072 lds
    s_add_u32 s54, s54, 4096
    s_add_u32 s55, s55, 4096
    s_mov_b32 m0, s55
    s_nop 0
    buffer_load_dwordx4 v0, s[28:31], s54 offen offset:0 lds
    buffer_load_dwordx4 v0, s[28:31], s54 offen offset:1024 lds
    buffer_load_dwordx4 v0, s[28:31], s54 offen offset:2048 lds
    buffer_load_dwordx4 v0, s[28:31], s54 offen offset:3072 lds
    s_add_u32 s72, s72, s69
    s_add_u32 s71, s71, 0x8000
    s_and_b32 s71, s71, 0x18000
    s_and_b32 s54, s44, 3
    s_lshl_b32 s47, s54, 12
    s_lshl_b32 s54, s54, 6
    v_xor_b32 v49, s54, v0
    v_lshrrev_b32 v48, 8, v0
    v_mul_u32_u24 v48, 3328, v48
    v_add_u32 v48, v48, v49
    s_mov_b32 s32, s16
    s_and_b32 s33, s17, 0xffff
    s_mov_b32 s34, 1835008
    s_mov_b32 s35, 0x20000
    s_lshl_b32 s48, s74, 8
    s_mul_i32 s54, s44, 28672
    s_add_u32 s48, s48, s54
    s_add_u32 m0, s47, 98304
    s_add_u32 s54, s48, 0
    buffer_load_dwordx4 v48, s[32:35], s54 offen lds
    s_add_u32 m0, s47, 99328
    s_add_u32 s54, s48, 14336
    buffer_load_dwordx4 v48, s[32:35], s54 offen lds
    s_add_u32 m0, s47, 100352
    s_add_u32 s54, s48, 114688
    buffer_load_dwordx4 v48, s[32:35], s54 offen lds
    s_add_u32 m0, s47, 101376
    s_add_u32 s54, s48, 129024
    buffer_load_dwordx4 v48, s[32:35], s54 offen lds
    s_add_u32 m0, s47, 114688
    s_add_u32 s54, s48, 229376
    buffer_load_dwordx4 v48, s[32:35], s54 offen lds
    s_add_u32 m0, s47, 115712
    s_add_u32 s54, s48, 243712
    buffer_load_dwordx4 v48, s[32:35], s54 offen lds
    s_add_u32 m0, s47, 116736
    s_add_u32 s54, s48, 344064
    buffer_load_dwordx4 v48, s[32:35], s54 offen lds
    s_add_u32 m0, s47, 117760
    s_add_u32 s54, s48, 358400
    buffer_load_dwordx4 v48, s[32:35], s54 offen lds
    s_add_u32 m0, s47, 131072
    s_add_u32 s54, s48, 458752
    buffer_load_dwordx4 v48, s[32:35], s54 offen lds
    s_add_u32 m0, s47, 132096
    s_add_u32 s54, s48, 473088
    buffer_load_dwordx4 v48, s[32:35], s54 offen lds
    s_add_u32 m0, s47, 133120
    s_add_u32 s54, s48, 573440
    buffer_load_dwordx4 v48, s[32:35], s54 offen lds
    s_add_u32 m0, s47, 134144
    s_add_u32 s54, s48, 587776
    buffer_load_dwordx4 v48, s[32:35], s54 offen lds
    v_lshrrev_b32 v32, 8, v0
    v_bfe_u32 v33, v0, 4, 4
    v_lshlrev_b32 v33, 2, v33
    v_lshl_add_u32 v33, v32, 12, v33
    v_add_u32 v33, 98304, v33
    v_xor_b32 v50, s44, v32
    v_lshl_add_u32 v50, v50, 6, v33
    v_add_u32 v51, 0x10000, v50
    s_waitcnt vmcnt(8)
    s_barrier
    s_add_u32 m0, s47, 147456
    s_add_u32 s54, s48, 688128
    buffer_load_dwordx4 v48, s[32:35], s54 offen lds
    s_add_u32 m0, s47, 148480
    s_add_u32 s54, s48, 702464
    buffer_load_dwordx4 v48, s[32:35], s54 offen lds
    s_add_u32 m0, s47, 149504
    s_add_u32 s54, s48, 802816
    buffer_load_dwordx4 v48, s[32:35], s54 offen lds
    s_add_u32 m0, s47, 150528
    s_add_u32 s54, s48, 817152
    buffer_load_dwordx4 v48, s[32:35], s54 offen lds
    ds_read2st64_b32 v[32:33], v50 offset0:0 offset1:1
    ds_read2st64_b32 v[34:35], v50 offset0:2 offset1:3
    ds_read2st64_b32 v[36:37], v50 offset0:4 offset1:5
    ds_read2st64_b32 v[38:39], v50 offset0:6 offset1:7
    ds_read2st64_b32 v[40:41], v50 offset0:8 offset1:9
    ds_read2st64_b32 v[42:43], v50 offset0:10 offset1:11
    ds_read2st64_b32 v[44:45], v50 offset0:12 offset1:13
    ds_read2st64_b32 v[46:47], v50 offset0:14 offset1:15
    s_waitcnt lgkmcnt(6)
    v_perm_b32 v60, v33, v32, s52
    v_accvgpr_write_b32 a0, v60
    v_perm_b32 v61, v33, v32, s53
    v_accvgpr_write_b32 a8, v61
    v_perm_b32 v62, v35, v34, s52
    v_accvgpr_write_b32 a1, v62
    v_perm_b32 v63, v35, v34, s53
    v_accvgpr_write_b32 a9, v63
    s_waitcnt lgkmcnt(4)
    v_perm_b32 v60, v37, v36, s52
    v_accvgpr_write_b32 a2, v60
    v_perm_b32 v61, v37, v36, s53
    v_accvgpr_write_b32 a10, v61
    v_perm_b32 v62, v39, v38, s52
    v_accvgpr_write_b32 a3, v62
    v_perm_b32 v63, v39, v38, s53
    v_accvgpr_write_b32 a11, v63
    s_waitcnt lgkmcnt(2)
    v_perm_b32 v60, v41, v40, s52
    v_accvgpr_write_b32 a4, v60
    v_perm_b32 v61, v41, v40, s53
    v_accvgpr_write_b32 a12, v61
    v_perm_b32 v62, v43, v42, s52
    v_accvgpr_write_b32 a5, v62
    v_perm_b32 v63, v43, v42, s53
    v_accvgpr_write_b32 a13, v63
    s_waitcnt lgkmcnt(0)
    v_perm_b32 v60, v45, v44, s52
    v_accvgpr_write_b32 a6, v60
    v_perm_b32 v61, v45, v44, s53
    v_accvgpr_write_b32 a14, v61
    v_perm_b32 v62, v47, v46, s52
    v_accvgpr_write_b32 a7, v62
    v_perm_b32 v63, v47, v46, s53
    v_accvgpr_write_b32 a15, v63
    s_waitcnt vmcnt(8)
    s_barrier
    s_add_u32 m0, s47, 98304
    s_add_u32 s54, s48, 917504
    buffer_load_dwordx4 v48, s[32:35], s54 offen lds
    s_add_u32 m0, s47, 99328
    s_add_u32 s54, s48, 931840
    buffer_load_dwordx4 v48, s[32:35], s54 offen lds
    s_add_u32 m0, s47, 100352
    s_add_u32 s54, s48, 1032192
    buffer_load_dwordx4 v48, s[32:35], s54 offen lds
    s_add_u32 m0, s47, 101376
    s_add_u32 s54, s48, 1046528
    buffer_load_dwordx4 v48, s[32:35], s54 offen lds
    ds_read2st64_b32 v[32:33], v50 offset0:64 offset1:65
    ds_read2st64_b32 v[34:35], v50 offset0:66 offset1:67
    ds_read2st64_b32 v[36:37], v50 offset0:68 offset1:69
    ds_read2st64_b32 v[38:39], v50 offset0:70 offset1:71
    ds_read2st64_b32 v[40:41], v50 offset0:72 offset1:73
    ds_read2st64_b32 v[42:43], v50 offset0:74 offset1:75
    ds_read2st64_b32 v[44:45], v50 offset0:76 offset1:77
    ds_read2st64_b32 v[46:47], v50 offset0:78 offset1:79
    s_waitcnt lgkmcnt(6)
    v_perm_b32 v60, v33, v32, s52
    v_accvgpr_write_b32 a16, v60
    v_perm_b32 v61, v33, v32, s53
    v_accvgpr_write_b32 a24, v61
    v_perm_b32 v62, v35, v34, s52
    v_accvgpr_write_b32 a17, v62
    v_perm_b32 v63, v35, v34, s53
    v_accvgpr_write_b32 a25, v63
    s_waitcnt lgkmcnt(4)
    v_perm_b32 v60, v37, v36, s52
    v_accvgpr_write_b32 a18, v60
    v_perm_b32 v61, v37, v36, s53
    v_accvgpr_write_b32 a26, v61
    v_perm_b32 v62, v39, v38, s52
    v_accvgpr_write_b32 a19, v62
    v_perm_b32 v63, v39, v38, s53
    v_accvgpr_write_b32 a27, v63
    s_waitcnt lgkmcnt(2)
    v_perm_b32 v60, v41, v40, s52
    v_accvgpr_write_b32 a20, v60
    v_perm_b32 v61, v41, v40, s53
    v_accvgpr_write_b32 a28, v61
    v_perm_b32 v62, v43, v42, s52
    v_accvgpr_write_b32 a21, v62
    v_perm_b32 v63, v43, v42, s53
    v_accvgpr_write_b32 a29, v63
    s_waitcnt lgkmcnt(0)
    v_perm_b32 v60, v45, v44, s52
    v_accvgpr_write_b32 a22, v60
    v_perm_b32 v61, v45, v44, s53
    v_accvgpr_write_b32 a30, v61
    v_perm_b32 v62, v47, v46, s52
    v_accvgpr_write_b32 a23, v62
    v_perm_b32 v63, v47, v46, s53
    v_accvgpr_write_b32 a31, v63
    s_waitcnt vmcnt(8)
    s_barrier
    s_add_u32 m0, s47, 114688
    s_add_u32 s54, s48, 1146880
    buffer_load_dwordx4 v48, s[32:35], s54 offen lds
    s_add_u32 m0, s47, 115712
    s_add_u32 s54, s48, 1161216
    buffer_load_dwordx4 v48, s[32:35], s54 offen lds
    s_add_u32 m0, s47, 116736
    s_add_u32 s54, s48, 1261568
    buffer_load_dwordx4 v48, s[32:35], s54 offen lds
    s_add_u32 m0, s47, 117760
    s_add_u32 s54, s48, 1275904
    buffer_load_dwordx4 v48, s[32:35], s54 offen lds
    ds_read2st64_b32 v[32:33], v50 offset0:128 offset1:129
    ds_read2st64_b32 v[34:35], v50 offset0:130 offset1:131
    ds_read2st64_b32 v[36:37], v50 offset0:132 offset1:133
    ds_read2st64_b32 v[38:39], v50 offset0:134 offset1:135
    ds_read2st64_b32 v[40:41], v50 offset0:136 offset1:137
    ds_read2st64_b32 v[42:43], v50 offset0:138 offset1:139
    ds_read2st64_b32 v[44:45], v50 offset0:140 offset1:141
    ds_read2st64_b32 v[46:47], v50 offset0:142 offset1:143
    s_waitcnt lgkmcnt(6)
    v_perm_b32 v60, v33, v32, s52
    v_accvgpr_write_b32 a32, v60
    v_perm_b32 v61, v33, v32, s53
    v_accvgpr_write_b32 a40, v61
    v_perm_b32 v62, v35, v34, s52
    v_accvgpr_write_b32 a33, v62
    v_perm_b32 v63, v35, v34, s53
    v_accvgpr_write_b32 a41, v63
    s_waitcnt lgkmcnt(4)
    v_perm_b32 v60, v37, v36, s52
    v_accvgpr_write_b32 a34, v60
    v_perm_b32 v61, v37, v36, s53
    v_accvgpr_write_b32 a42, v61
    v_perm_b32 v62, v39, v38, s52
    v_accvgpr_write_b32 a35, v62
    v_perm_b32 v63, v39, v38, s53
    v_accvgpr_write_b32 a43, v63
    s_waitcnt lgkmcnt(2)
    v_perm_b32 v60, v41, v40, s52
    v_accvgpr_write_b32 a36, v60
    v_perm_b32 v61, v41, v40, s53
    v_accvgpr_write_b32 a44, v61
    v_perm_b32 v62, v43, v42, s52
    v_accvgpr_write_b32 a37, v62
    v_perm_b32 v63, v43, v42, s53
    v_accvgpr_write_b32 a45, v63
    s_waitcnt lgkmcnt(0)
    v_perm_b32 v60, v45, v44, s52
    v_accvgpr_write_b32 a38, v60
    v_perm_b32 v61, v45, v44, s53
    v_accvgpr_write_b32 a46, v61
    v_perm_b32 v62, v47, v46, s52
    v_accvgpr_write_b32 a39, v62
    v_perm_b32 v63, v47, v46, s53
    v_accvgpr_write_b32 a47, v63
    s_waitcnt vmcnt(8)
    s_barrier
    s_add_u32 m0, s47, 131072
    s_add_u32 s54, s48, 1376256
    buffer_load_dwordx4 v48, s[32:35], s54 offen lds
    s_add_u32 m0, s47, 132096
    s_add_u32 s54, s48, 1390592
    buffer_load_dwordx4 v48, s[32:35], s54 offen lds
    s_add_u32 m0, s47, 133120
    s_add_u32 s54, s48, 1490944
    buffer_load_dwordx4 v48, s[32:35], s54 offen lds
    s_add_u32 m0, s47, 134144
    s_add_u32 s54, s48, 1505280
    buffer_load_dwordx4 v48, s[32:35], s54 offen lds
    ds_read2st64_b32 v[32:33], v50 offset0:192 offset1:193
    ds_read2st64_b32 v[34:35], v50 offset0:194 offset1:195
    ds_read2st64_b32 v[36:37], v50 offset0:196 offset1:197
    ds_read2st64_b32 v[38:39], v50 offset0:198 offset1:199
    ds_read2st64_b32 v[40:41], v50 offset0:200 offset1:201
    ds_read2st64_b32 v[42:43], v50 offset0:202 offset1:203
    ds_read2st64_b32 v[44:45], v50 offset0:204 offset1:205
    ds_read2st64_b32 v[46:47], v50 offset0:206 offset1:207
    s_waitcnt lgkmcnt(6)
    v_perm_b32 v60, v33, v32, s52
    v_accvgpr_write_b32 a48, v60
    v_perm_b32 v61, v33, v32, s53
    v_accvgpr_write_b32 a56, v61
    v_perm_b32 v62, v35, v34, s52
    v_accvgpr_write_b32 a49, v62
    v_perm_b32 v63, v35, v34, s53
    v_accvgpr_write_b32 a57, v63
    s_waitcnt lgkmcnt(4)
    v_perm_b32 v60, v37, v36, s52
    v_accvgpr_write_b32 a50, v60
    v_perm_b32 v61, v37, v36, s53
    v_accvgpr_write_b32 a58, v61
    v_perm_b32 v62, v39, v38, s52
    v_accvgpr_write_b32 a51, v62
    v_perm_b32 v63, v39, v38, s53
    v_accvgpr_write_b32 a59, v63
    s_waitcnt lgkmcnt(2)
    v_perm_b32 v60, v41, v40, s52
    v_accvgpr_write_b32 a52, v60
    v_perm_b32 v61, v41, v40, s53
    v_accvgpr_write_b32 a60, v61
    v_perm_b32 v62, v43, v42, s52
    v_accvgpr_write_b32 a53, v62
    v_perm_b32 v63, v43, v42, s53
    v_accvgpr_write_b32 a61, v63
    s_waitcnt lgkmcnt(0)
    v_perm_b32 v60, v45, v44, s52
    v_accvgpr_write_b32 a54, v60
    v_perm_b32 v61, v45, v44, s53
    v_accvgpr_write_b32 a62, v61
    v_perm_b32 v62, v47, v46, s52
    v_accvgpr_write_b32 a55, v62
    v_perm_b32 v63, v47, v46, s53
    v_accvgpr_write_b32 a63, v63
    s_waitcnt vmcnt(8)
    s_barrier
    s_add_u32 m0, s47, 147456
    s_add_u32 s54, s48, 1605632
    buffer_load_dwordx4 v48, s[32:35], s54 offen lds
    s_add_u32 m0, s47, 148480
    s_add_u32 s54, s48, 1619968
    buffer_load_dwordx4 v48, s[32:35], s54 offen lds
    s_add_u32 m0, s47, 149504
    s_add_u32 s54, s48, 1720320
    buffer_load_dwordx4 v48, s[32:35], s54 offen lds
    s_add_u32 m0, s47, 150528
    s_add_u32 s54, s48, 1734656
    buffer_load_dwordx4 v48, s[32:35], s54 offen lds
    ds_read2st64_b32 v[32:33], v50 offset0:0 offset1:1
    ds_read2st64_b32 v[34:35], v50 offset0:2 offset1:3
    ds_read2st64_b32 v[36:37], v50 offset0:4 offset1:5
    ds_read2st64_b32 v[38:39], v50 offset0:6 offset1:7
    ds_read2st64_b32 v[40:41], v50 offset0:8 offset1:9
    ds_read2st64_b32 v[42:43], v50 offset0:10 offset1:11
    ds_read2st64_b32 v[44:45], v50 offset0:12 offset1:13
    ds_read2st64_b32 v[46:47], v50 offset0:14 offset1:15
    s_waitcnt lgkmcnt(6)
    v_perm_b32 v60, v33, v32, s52
    v_accvgpr_write_b32 a64, v60
    v_perm_b32 v61, v33, v32, s53
    v_accvgpr_write_b32 a72, v61
    v_perm_b32 v62, v35, v34, s52
    v_accvgpr_write_b32 a65, v62
    v_perm_b32 v63, v35, v34, s53
    v_accvgpr_write_b32 a73, v63
    s_waitcnt lgkmcnt(4)
    v_perm_b32 v60, v37, v36, s52
    v_accvgpr_write_b32 a66, v60
    v_perm_b32 v61, v37, v36, s53
    v_accvgpr_write_b32 a74, v61
    v_perm_b32 v62, v39, v38, s52
    v_accvgpr_write_b32 a67, v62
    v_perm_b32 v63, v39, v38, s53
    v_accvgpr_write_b32 a75, v63
    s_waitcnt lgkmcnt(2)
    v_perm_b32 v60, v41, v40, s52
    v_accvgpr_write_b32 a68, v60
    v_perm_b32 v61, v41, v40, s53
    v_accvgpr_write_b32 a76, v61
    v_perm_b32 v62, v43, v42, s52
    v_accvgpr_write_b32 a69, v62
    v_perm_b32 v63, v43, v42, s53
    v_accvgpr_write_b32 a77, v63
    s_waitcnt lgkmcnt(0)
    v_perm_b32 v60, v45, v44, s52
    v_accvgpr_write_b32 a70, v60
    v_perm_b32 v61, v45, v44, s53
    v_accvgpr_write_b32 a78, v61
    v_perm_b32 v62, v47, v46, s52
    v_accvgpr_write_b32 a71, v62
    v_perm_b32 v63, v47, v46, s53
    v_accvgpr_write_b32 a79, v63
    s_waitcnt vmcnt(8)
    s_barrier
    s_mov_b32 s32, s18
    s_and_b32 s33, s19, 0xffff
    s_mov_b32 s34, 1835008
    s_mov_b32 s35, 0x20000
    s_lshl_b32 s48, s74, 8
    s_mul_i32 s54, s44, 28672
    s_add_u32 s48, s48, s54
    s_add_u32 m0, s47, 98304
    s_add_u32 s54, s48, 0
    buffer_load_dwordx4 v48, s[32:35], s54 offen lds
    s_add_u32 m0, s47, 99328
    s_add_u32 s54, s48, 14336
    buffer_load_dwordx4 v48, s[32:35], s54 offen lds
    s_add_u32 m0, s47, 100352
    s_add_u32 s54, s48, 114688
    buffer_load_dwordx4 v48, s[32:35], s54 offen lds
    s_add_u32 m0, s47, 101376
    s_add_u32 s54, s48, 129024
    buffer_load_dwordx4 v48, s[32:35], s54 offen lds
    ds_read2st64_b32 v[32:33], v50 offset0:64 offset1:65
    ds_read2st64_b32 v[34:35], v50 offset0:66 offset1:67
    ds_read2st64_b32 v[36:37], v50 offset0:68 offset1:69
    ds_read2st64_b32 v[38:39], v50 offset0:70 offset1:71
    ds_read2st64_b32 v[40:41], v50 offset0:72 offset1:73
    ds_read2st64_b32 v[42:43], v50 offset0:74 offset1:75
    ds_read2st64_b32 v[44:45], v50 offset0:76 offset1:77
    ds_read2st64_b32 v[46:47], v50 offset0:78 offset1:79
    s_waitcnt lgkmcnt(6)
    v_perm_b32 v60, v33, v32, s52
    v_accvgpr_write_b32 a80, v60
    v_perm_b32 v61, v33, v32, s53
    v_accvgpr_write_b32 a88, v61
    v_perm_b32 v62, v35, v34, s52
    v_accvgpr_write_b32 a81, v62
    v_perm_b32 v63, v35, v34, s53
    v_accvgpr_write_b32 a89, v63
    s_waitcnt lgkmcnt(4)
    v_perm_b32 v60, v37, v36, s52
    v_accvgpr_write_b32 a82, v60
    v_perm_b32 v61, v37, v36, s53
    v_accvgpr_write_b32 a90, v61
    v_perm_b32 v62, v39, v38, s52
    v_accvgpr_write_b32 a83, v62
    v_perm_b32 v63, v39, v38, s53
    v_accvgpr_write_b32 a91, v63
    s_waitcnt lgkmcnt(2)
    v_perm_b32 v60, v41, v40, s52
    v_accvgpr_write_b32 a84, v60
    v_perm_b32 v61, v41, v40, s53
    v_accvgpr_write_b32 a92, v61
    v_perm_b32 v62, v43, v42, s52
    v_accvgpr_write_b32 a85, v62
    v_perm_b32 v63, v43, v42, s53
    v_accvgpr_write_b32 a93, v63
    s_waitcnt lgkmcnt(0)
    v_perm_b32 v60, v45, v44, s52
    v_accvgpr_write_b32 a86, v60
    v_perm_b32 v61, v45, v44, s53
    v_accvgpr_write_b32 a94, v61
    v_perm_b32 v62, v47, v46, s52
    v_accvgpr_write_b32 a87, v62
    v_perm_b32 v63, v47, v46, s53
    v_accvgpr_write_b32 a95, v63
    s_waitcnt vmcnt(8)
    s_barrier
    s_add_u32 m0, s47, 114688
    s_add_u32 s54, s48, 229376
    buffer_load_dwordx4 v48, s[32:35], s54 offen lds
    s_add_u32 m0, s47, 115712
    s_add_u32 s54, s48, 243712
    buffer_load_dwordx4 v48, s[32:35], s54 offen lds
    s_add_u32 m0, s47, 116736
    s_add_u32 s54, s48, 344064
    buffer_load_dwordx4 v48, s[32:35], s54 offen lds
    s_add_u32 m0, s47, 117760
    s_add_u32 s54, s48, 358400
    buffer_load_dwordx4 v48, s[32:35], s54 offen lds
    ds_read2st64_b32 v[32:33], v50 offset0:128 offset1:129
    ds_read2st64_b32 v[34:35], v50 offset0:130 offset1:131
    ds_read2st64_b32 v[36:37], v50 offset0:132 offset1:133
    ds_read2st64_b32 v[38:39], v50 offset0:134 offset1:135
    ds_read2st64_b32 v[40:41], v50 offset0:136 offset1:137
    ds_read2st64_b32 v[42:43], v50 offset0:138 offset1:139
    ds_read2st64_b32 v[44:45], v50 offset0:140 offset1:141
    ds_read2st64_b32 v[46:47], v50 offset0:142 offset1:143
    s_waitcnt lgkmcnt(6)
    v_perm_b32 v60, v33, v32, s52
    v_accvgpr_write_b32 a96, v60
    v_perm_b32 v61, v33, v32, s53
    v_accvgpr_write_b32 a104, v61
    v_perm_b32 v62, v35, v34, s52
    v_accvgpr_write_b32 a97, v62
    v_perm_b32 v63, v35, v34, s53
    v_accvgpr_write_b32 a105, v63
    s_waitcnt lgkmcnt(4)
    v_perm_b32 v60, v37, v36, s52
    v_accvgpr_write_b32 a98, v60
    v_perm_b32 v61, v37, v36, s53
    v_accvgpr_write_b32 a106, v61
    v_perm_b32 v62, v39, v38, s52
    v_accvgpr_write_b32 a99, v62
    v_perm_b32 v63, v39, v38, s53
    v_accvgpr_write_b32 a107, v63
    s_waitcnt lgkmcnt(2)
    v_perm_b32 v60, v41, v40, s52
    v_accvgpr_write_b32 a100, v60
    v_perm_b32 v61, v41, v40, s53
    v_accvgpr_write_b32 a108, v61
    v_perm_b32 v62, v43, v42, s52
    v_accvgpr_write_b32 a101, v62
    v_perm_b32 v63, v43, v42, s53
    v_accvgpr_write_b32 a109, v63
    s_waitcnt lgkmcnt(0)
    v_perm_b32 v60, v45, v44, s52
    v_accvgpr_write_b32 a102, v60
    v_perm_b32 v61, v45, v44, s53
    v_accvgpr_write_b32 a110, v61
    v_perm_b32 v62, v47, v46, s52
    v_accvgpr_write_b32 a103, v62
    v_perm_b32 v63, v47, v46, s53
    v_accvgpr_write_b32 a111, v63
    s_waitcnt vmcnt(8)
    s_barrier
    s_add_u32 m0, s47, 131072
    s_add_u32 s54, s48, 458752
    buffer_load_dwordx4 v48, s[32:35], s54 offen lds
    s_add_u32 m0, s47, 132096
    s_add_u32 s54, s48, 473088
    buffer_load_dwordx4 v48, s[32:35], s54 offen lds
    s_add_u32 m0, s47, 133120
    s_add_u32 s54, s48, 573440
    buffer_load_dwordx4 v48, s[32:35], s54 offen lds
    s_add_u32 m0, s47, 134144
    s_add_u32 s54, s48, 587776
    buffer_load_dwordx4 v48, s[32:35], s54 offen lds
    ds_read2st64_b32 v[32:33], v50 offset0:192 offset1:193
    ds_read2st64_b32 v[34:35], v50 offset0:194 offset1:195
    ds_read2st64_b32 v[36:37], v50 offset0:196 offset1:197
    ds_read2st64_b32 v[38:39], v50 offset0:198 offset1:199
    ds_read2st64_b32 v[40:41], v50 offset0:200 offset1:201
    ds_read2st64_b32 v[42:43], v50 offset0:202 offset1:203
    ds_read2st64_b32 v[44:45], v50 offset0:204 offset1:205
    ds_read2st64_b32 v[46:47], v50 offset0:206 offset1:207
    s_waitcnt lgkmcnt(6)
    v_perm_b32 v60, v33, v32, s52
    v_accvgpr_write_b32 a112, v60
    v_perm_b32 v61, v33, v32, s53
    v_accvgpr_write_b32 a120, v61
    v_perm_b32 v62, v35, v34, s52
    v_accvgpr_write_b32 a113, v62
    v_perm_b32 v63, v35, v34, s53
    v_accvgpr_write_b32 a121, v63
    s_waitcnt lgkmcnt(4)
    v_perm_b32 v60, v37, v36, s52
    v_accvgpr_write_b32 a114, v60
    v_perm_b32 v61, v37, v36, s53
    v_accvgpr_write_b32 a122, v61
    v_perm_b32 v62, v39, v38, s52
    v_accvgpr_write_b32 a115, v62
    v_perm_b32 v63, v39, v38, s53
    v_accvgpr_write_b32 a123, v63
    s_waitcnt lgkmcnt(2)
    v_perm_b32 v60, v41, v40, s52
    v_accvgpr_write_b32 a116, v60
    v_perm_b32 v61, v41, v40, s53
    v_accvgpr_write_b32 a124, v61
    v_perm_b32 v62, v43, v42, s52
    v_accvgpr_write_b32 a117, v62
    v_perm_b32 v63, v43, v42, s53
    v_accvgpr_write_b32 a125, v63
    s_waitcnt lgkmcnt(0)
    v_perm_b32 v60, v45, v44, s52
    v_accvgpr_write_b32 a118, v60
    v_perm_b32 v61, v45, v44, s53
    v_accvgpr_write_b32 a126, v61
    v_perm_b32 v62, v47, v46, s52
    v_accvgpr_write_b32 a119, v62
    v_perm_b32 v63, v47, v46, s53
    v_accvgpr_write_b32 a127, v63
    s_waitcnt vmcnt(8)
    s_barrier
    s_add_u32 m0, s47, 147456
    s_add_u32 s54, s48, 688128
    buffer_load_dwordx4 v48, s[32:35], s54 offen lds
    s_add_u32 m0, s47, 148480
    s_add_u32 s54, s48, 702464
    buffer_load_dwordx4 v48, s[32:35], s54 offen lds
    s_add_u32 m0, s47, 149504
    s_add_u32 s54, s48, 802816
    buffer_load_dwordx4 v48, s[32:35], s54 offen lds
    s_add_u32 m0, s47, 150528
    s_add_u32 s54, s48, 817152
    buffer_load_dwordx4 v48, s[32:35], s54 offen lds
    ds_read2st64_b32 v[32:33], v50 offset0:0 offset1:1
    ds_read2st64_b32 v[34:35], v50 offset0:2 offset1:3
    ds_read2st64_b32 v[36:37], v50 offset0:4 offset1:5
    ds_read2st64_b32 v[38:39], v50 offset0:6 offset1:7
    ds_read2st64_b32 v[40:41], v50 offset0:8 offset1:9
    ds_read2st64_b32 v[42:43], v50 offset0:10 offset1:11
    ds_read2st64_b32 v[44:45], v50 offset0:12 offset1:13
    ds_read2st64_b32 v[46:47], v50 offset0:14 offset1:15
    s_waitcnt lgkmcnt(6)
    v_perm_b32 v60, v33, v32, s52
    v_accvgpr_write_b32 a128, v60
    v_perm_b32 v61, v33, v32, s53
    v_accvgpr_write_b32 a136, v61
    v_perm_b32 v62, v35, v34, s52
    v_accvgpr_write_b32 a129, v62
    v_perm_b32 v63, v35, v34, s53
    v_accvgpr_write_b32 a137, v63
    s_waitcnt lgkmcnt(4)
    v_perm_b32 v60, v37, v36, s52
    v_accvgpr_write_b32 a130, v60
    v_perm_b32 v61, v37, v36, s53
    v_accvgpr_write_b32 a138, v61
    v_perm_b32 v62, v39, v38, s52
    v_accvgpr_write_b32 a131, v62
    v_perm_b32 v63, v39, v38, s53
    v_accvgpr_write_b32 a139, v63
    s_waitcnt lgkmcnt(2)
    v_perm_b32 v60, v41, v40, s52
    v_accvgpr_write_b32 a132, v60
    v_perm_b32 v61, v41, v40, s53
    v_accvgpr_write_b32 a140, v61
    v_perm_b32 v62, v43, v42, s52
    v_accvgpr_write_b32 a133, v62
    v_perm_b32 v63, v43, v42, s53
    v_accvgpr_write_b32 a141, v63
    s_waitcnt lgkmcnt(0)
    v_perm_b32 v60, v45, v44, s52
    v_accvgpr_write_b32 a134, v60
    v_perm_b32 v61, v45, v44, s53
    v_accvgpr_write_b32 a142, v61
    v_perm_b32 v62, v47, v46, s52
    v_accvgpr_write_b32 a135, v62
    v_perm_b32 v63, v47, v46, s53
    v_accvgpr_write_b32 a143, v63
    s_waitcnt vmcnt(8)
    s_barrier
    s_add_u32 m0, s47, 98304
    s_add_u32 s54, s48, 917504
    buffer_load_dwordx4 v48, s[32:35], s54 offen lds
    s_add_u32 m0, s47, 99328
    s_add_u32 s54, s48, 931840
    buffer_load_dwordx4 v48, s[32:35], s54 offen lds
    s_add_u32 m0, s47, 100352
    s_add_u32 s54, s48, 1032192
    buffer_load_dwordx4 v48, s[32:35], s54 offen lds
    s_add_u32 m0, s47, 101376
    s_add_u32 s54, s48, 1046528
    buffer_load_dwordx4 v48, s[32:35], s54 offen lds
    ds_read2st64_b32 v[32:33], v50 offset0:64 offset1:65
    ds_read2st64_b32 v[34:35], v50 offset0:66 offset1:67
    ds_read2st64_b32 v[36:37], v50 offset0:68 offset1:69
    ds_read2st64_b32 v[38:39], v50 offset0:70 offset1:71
    ds_read2st64_b32 v[40:41], v50 offset0:72 offset1:73
    ds_read2st64_b32 v[42:43], v50 offset0:74 offset1:75
    ds_read2st64_b32 v[44:45], v50 offset0:76 offset1:77
    ds_read2st64_b32 v[46:47], v50 offset0:78 offset1:79
    s_waitcnt lgkmcnt(6)
    v_perm_b32 v60, v33, v32, s52
    v_accvgpr_write_b32 a144, v60
    v_perm_b32 v61, v33, v32, s53
    v_accvgpr_write_b32 a152, v61
    v_perm_b32 v62, v35, v34, s52
    v_accvgpr_write_b32 a145, v62
    v_perm_b32 v63, v35, v34, s53
    v_accvgpr_write_b32 a153, v63
    s_waitcnt lgkmcnt(4)
    v_perm_b32 v60, v37, v36, s52
    v_accvgpr_write_b32 a146, v60
    v_perm_b32 v61, v37, v36, s53
    v_accvgpr_write_b32 a154, v61
    v_perm_b32 v62, v39, v38, s52
    v_accvgpr_write_b32 a147, v62
    v_perm_b32 v63, v39, v38, s53
    v_accvgpr_write_b32 a155, v63
    s_waitcnt lgkmcnt(2)
    v_perm_b32 v60, v41, v40, s52
    v_accvgpr_write_b32 a148, v60
    v_perm_b32 v61, v41, v40, s53
    v_accvgpr_write_b32 a156, v61
    v_perm_b32 v62, v43, v42, s52
    v_accvgpr_write_b32 a149, v62
    v_perm_b32 v63, v43, v42, s53
    v_accvgpr_write_b32 a157, v63
    s_waitcnt lgkmcnt(0)
    v_perm_b32 v60, v45, v44, s52
    v_accvgpr_write_b32 a150, v60
    v_perm_b32 v61, v45, v44, s53
    v_accvgpr_write_b32 a158, v61
    v_perm_b32 v62, v47, v46, s52
    v_accvgpr_write_b32 a151, v62
    v_perm_b32 v63, v47, v46, s53
    v_accvgpr_write_b32 a159, v63
    s_waitcnt vmcnt(8)
    s_barrier
    s_add_u32 m0, s47, 114688
    s_add_u32 s54, s48, 1146880
    buffer_load_dwordx4 v48, s[32:35], s54 offen lds
    s_add_u32 m0, s47, 115712
    s_add_u32 s54, s48, 1161216
    buffer_load_dwordx4 v48, s[32:35], s54 offen lds
    s_add_u32 m0, s47, 116736
    s_add_u32 s54, s48, 1261568
    buffer_load_dwordx4 v48, s[32:35], s54 offen lds
    s_add_u32 m0, s47, 117760
    s_add_u32 s54, s48, 1275904
    buffer_load_dwordx4 v48, s[32:35], s54 offen lds
    ds_read2st64_b32 v[32:33], v50 offset0:128 offset1:129
    ds_read2st64_b32 v[34:35], v50 offset0:130 offset1:131
    ds_read2st64_b32 v[36:37], v50 offset0:132 offset1:133
    ds_read2st64_b32 v[38:39], v50 offset0:134 offset1:135
    ds_read2st64_b32 v[40:41], v50 offset0:136 offset1:137
    ds_read2st64_b32 v[42:43], v50 offset0:138 offset1:139
    ds_read2st64_b32 v[44:45], v50 offset0:140 offset1:141
    ds_read2st64_b32 v[46:47], v50 offset0:142 offset1:143
    s_waitcnt lgkmcnt(6)
    v_perm_b32 v60, v33, v32, s52
    v_accvgpr_write_b32 a160, v60
    v_perm_b32 v61, v33, v32, s53
    v_accvgpr_write_b32 a168, v61
    v_perm_b32 v62, v35, v34, s52
    v_accvgpr_write_b32 a161, v62
    v_perm_b32 v63, v35, v34, s53
    v_accvgpr_write_b32 a169, v63
    s_waitcnt lgkmcnt(4)
    v_perm_b32 v60, v37, v36, s52
    v_accvgpr_write_b32 a162, v60
    v_perm_b32 v61, v37, v36, s53
    v_accvgpr_write_b32 a170, v61
    v_perm_b32 v62, v39, v38, s52
    v_accvgpr_write_b32 a163, v62
    v_perm_b32 v63, v39, v38, s53
    v_accvgpr_write_b32 a171, v63
    s_waitcnt lgkmcnt(2)
    v_perm_b32 v60, v41, v40, s52
    v_accvgpr_write_b32 a164, v60
    v_perm_b32 v61, v41, v40, s53
    v_accvgpr_write_b32 a172, v61
    v_perm_b32 v62, v43, v42, s52
    v_accvgpr_write_b32 a165, v62
    v_perm_b32 v63, v43, v42, s53
    v_accvgpr_write_b32 a173, v63
    s_waitcnt lgkmcnt(0)
    v_perm_b32 v60, v45, v44, s52
    v_accvgpr_write_b32 a166, v60
    v_perm_b32 v61, v45, v44, s53
    v_accvgpr_write_b32 a174, v61
    v_perm_b32 v62, v47, v46, s52
    v_accvgpr_write_b32 a167, v62
    v_perm_b32 v63, v47, v46, s53
    v_accvgpr_write_b32 a175, v63
    s_waitcnt vmcnt(8)
    s_barrier
    s_add_u32 m0, s47, 131072
    s_add_u32 s54, s48, 1376256
    buffer_load_dwordx4 v48, s[32:35], s54 offen lds
    s_add_u32 m0, s47, 132096
    s_add_u32 s54, s48, 1390592
    buffer_load_dwordx4 v48, s[32:35], s54 offen lds
    s_add_u32 m0, s47, 133120
    s_add_u32 s54, s48, 1490944
    buffer_load_dwordx4 v48, s[32:35], s54 offen lds
    s_add_u32 m0, s47, 134144
    s_add_u32 s54, s48, 1505280
    buffer_load_dwordx4 v48, s[32:35], s54 offen lds
    ds_read2st64_b32 v[32:33], v50 offset0:192 offset1:193
    ds_read2st64_b32 v[34:35], v50 offset0:194 offset1:195
    ds_read2st64_b32 v[36:37], v50 offset0:196 offset1:197
    ds_read2st64_b32 v[38:39], v50 offset0:198 offset1:199
    ds_read2st64_b32 v[40:41], v50 offset0:200 offset1:201
    ds_read2st64_b32 v[42:43], v50 offset0:202 offset1:203
    ds_read2st64_b32 v[44:45], v50 offset0:204 offset1:205
    ds_read2st64_b32 v[46:47], v50 offset0:206 offset1:207
    s_waitcnt lgkmcnt(6)
    v_perm_b32 v60, v33, v32, s52
    v_accvgpr_write_b32 a176, v60
    v_perm_b32 v61, v33, v32, s53
    v_accvgpr_write_b32 a184, v61
    v_perm_b32 v62, v35, v34, s52
    v_accvgpr_write_b32 a177, v62
    v_perm_b32 v63, v35, v34, s53
    v_accvgpr_write_b32 a185, v63
    s_waitcnt lgkmcnt(4)
    v_perm_b32 v60, v37, v36, s52
    v_accvgpr_write_b32 a178, v60
    v_perm_b32 v61, v37, v36, s53
    v_accvgpr_write_b32 a186, v61
    v_perm_b32 v62, v39, v38, s52
    v_accvgpr_write_b32 a179, v62
    v_perm_b32 v63, v39, v38, s53
    v_accvgpr_write_b32 a187, v63
    s_waitcnt lgkmcnt(2)
    v_perm_b32 v60, v41, v40, s52
    v_accvgpr_write_b32 a180, v60
    v_perm_b32 v61, v41, v40, s53
    v_accvgpr_write_b32 a188, v61
    v_perm_b32 v62, v43, v42, s52
    v_accvgpr_write_b32 a181, v62
    v_perm_b32 v63, v43, v42, s53
    v_accvgpr_write_b32 a189, v63
    s_waitcnt lgkmcnt(0)
    v_perm_b32 v60, v45, v44, s52
    v_accvgpr_write_b32 a182, v60
    v_perm_b32 v61, v45, v44, s53
    v_accvgpr_write_b32 a190, v61
    v_perm_b32 v62, v47, v46, s52
    v_accvgpr_write_b32 a183, v62
    v_perm_b32 v63, v47, v46, s53
    v_accvgpr_write_b32 a191, v63
    s_waitcnt vmcnt(8)
    s_barrier
    s_add_u32 m0, s47, 147456
    s_add_u32 s54, s48, 1605632
    buffer_load_dwordx4 v48, s[32:35], s54 offen lds
    s_add_u32 m0, s47, 148480
    s_add_u32 s54, s48, 1619968
    buffer_load_dwordx4 v48, s[32:35], s54 offen lds
    s_add_u32 m0, s47, 149504
    s_add_u32 s54, s48, 1720320
    buffer_load_dwordx4 v48, s[32:35], s54 offen lds
    s_add_u32 m0, s47, 150528
    s_add_u32 s54, s48, 1734656
    buffer_load_dwordx4 v48, s[32:35], s54 offen lds
    ds_read2st64_b32 v[32:33], v50 offset0:0 offset1:1
    ds_read2st64_b32 v[34:35], v50 offset0:2 offset1:3
    ds_read2st64_b32 v[36:37], v50 offset0:4 offset1:5
    ds_read2st64_b32 v[38:39], v50 offset0:6 offset1:7
    ds_read2st64_b32 v[40:41], v50 offset0:8 offset1:9
    ds_read2st64_b32 v[42:43], v50 offset0:10 offset1:11
    ds_read2st64_b32 v[44:45], v50 offset0:12 offset1:13
    ds_read2st64_b32 v[46:47], v50 offset0:14 offset1:15
    s_waitcnt lgkmcnt(6)
    v_perm_b32 v60, v33, v32, s52
    v_accvgpr_write_b32 a192, v60
    v_perm_b32 v61, v33, v32, s53
    v_accvgpr_write_b32 a200, v61
    v_perm_b32 v62, v35, v34, s52
    v_accvgpr_write_b32 a193, v62
    v_perm_b32 v63, v35, v34, s53
    v_accvgpr_write_b32 a201, v63
    s_waitcnt lgkmcnt(4)
    v_perm_b32 v60, v37, v36, s52
    v_accvgpr_write_b32 a194, v60
    v_perm_b32 v61, v37, v36, s53
    v_accvgpr_write_b32 a202, v61
    v_perm_b32 v62, v39, v38, s52
    v_accvgpr_write_b32 a195, v62
    v_perm_b32 v63, v39, v38, s53
    v_accvgpr_write_b32 a203, v63
    s_waitcnt lgkmcnt(2)
    v_perm_b32 v60, v41, v40, s52
    v_accvgpr_write_b32 a196, v60
    v_perm_b32 v61, v41, v40, s53
    v_accvgpr_write_b32 a204, v61
    v_perm_b32 v62, v43, v42, s52
    v_accvgpr_write_b32 a197, v62
    v_perm_b32 v63, v43, v42, s53
    v_accvgpr_write_b32 a205, v63
    s_waitcnt lgkmcnt(0)
    v_perm_b32 v60, v45, v44, s52
    v_accvgpr_write_b32 a198, v60
    v_perm_b32 v61, v45, v44, s53
    v_accvgpr_write_b32 a206, v61
    v_perm_b32 v62, v47, v46, s52
    v_accvgpr_write_b32 a199, v62
    v_perm_b32 v63, v47, v46, s53
    v_accvgpr_write_b32 a207, v63
    s_waitcnt vmcnt(8)
    s_barrier
    ds_read2st64_b32 v[32:33], v50 offset0:64 offset1:65
    ds_read2st64_b32 v[34:35], v50 offset0:66 offset1:67
    ds_read2st64_b32 v[36:37], v50 offset0:68 offset1:69
    ds_read2st64_b32 v[38:39], v50 offset0:70 offset1:71
    ds_read2st64_b32 v[40:41], v50 offset0:72 offset1:73
    ds_read2st64_b32 v[42:43], v50 offset0:74 offset1:75
    ds_read2st64_b32 v[44:45], v50 offset0:76 offset1:77
    ds_read2st64_b32 v[46:47], v50 offset0:78 offset1:79
    s_waitcnt lgkmcnt(6)
    v_perm_b32 v60, v33, v32, s52
    v_accvgpr_write_b32 a208, v60
    v_perm_b32 v61, v33, v32, s53
    v_accvgpr_write_b32 a216, v61
    v_perm_b32 v62, v35, v34, s52
    v_accvgpr_write_b32 a209, v62
    v_perm_b32 v63, v35, v34, s53
    v_accvgpr_write_b32 a217, v63
    s_waitcnt lgkmcnt(4)
    v_perm_b32 v60, v37, v36, s52
    v_accvgpr_write_b32 a210, v60
    v_perm_b32 v61, v37, v36, s53
    v_accvgpr_write_b32 a218, v61
    v_perm_b32 v62, v39, v38, s52
    v_accvgpr_write_b32 a211, v62
    v_perm_b32 v63, v39, v38, s53
    v_accvgpr_write_b32 a219, v63
    s_waitcnt lgkmcnt(2)
    v_perm_b32 v60, v41, v40, s52
    v_accvgpr_write_b32 a212, v60
    v_perm_b32 v61, v41, v40, s53
    v_accvgpr_write_b32 a220, v61
    v_perm_b32 v62, v43, v42, s52
    v_accvgpr_write_b32 a213, v62
    v_perm_b32 v63, v43, v42, s53
    v_accvgpr_write_b32 a221, v63
    s_waitcnt lgkmcnt(0)
    v_perm_b32 v60, v45, v44, s52
    v_accvgpr_write_b32 a214, v60
    v_perm_b32 v61, v45, v44, s53
    v_accvgpr_write_b32 a222, v61
    v_perm_b32 v62, v47, v46, s52
    v_accvgpr_write_b32 a215, v62
    v_perm_b32 v63, v47, v46, s53
    v_accvgpr_write_b32 a223, v63
    s_waitcnt vmcnt(4)
    s_barrier
    ds_read2st64_b32 v[32:33], v50 offset0:128 offset1:129
    ds_read2st64_b32 v[34:35], v50 offset0:130 offset1:131
    ds_read2st64_b32 v[36:37], v50 offset0:132 offset1:133
    ds_read2st64_b32 v[38:39], v50 offset0:134 offset1:135
    ds_read2st64_b32 v[40:41], v50 offset0:136 offset1:137
    ds_read2st64_b32 v[42:43], v50 offset0:138 offset1:139
    ds_read2st64_b32 v[44:45], v50 offset0:140 offset1:141
    ds_read2st64_b32 v[46:47], v50 offset0:142 offset1:143
    s_waitcnt lgkmcnt(6)
    v_perm_b32 v60, v33, v32, s52
    v_accvgpr_write_b32 a224, v60
    v_perm_b32 v61, v33, v32, s53
    v_accvgpr_write_b32 a232, v61
    v_perm_b32 v62, v35, v34, s52
    v_accvgpr_write_b32 a225, v62
    v_perm_b32 v63, v35, v34, s53
    v_accvgpr_write_b32 a233, v63
    s_waitcnt lgkmcnt(4)
    v_perm_b32 v60, v37, v36, s52
    v_accvgpr_write_b32 a226, v60
    v_perm_b32 v61, v37, v36, s53
    v_accvgpr_write_b32 a234, v61
    v_perm_b32 v62, v39, v38, s52
    v_accvgpr_write_b32 a227, v62
    v_perm_b32 v63, v39, v38, s53
    v_accvgpr_write_b32 a235, v63
    s_waitcnt lgkmcnt(2)
    v_perm_b32 v60, v41, v40, s52
    v_accvgpr_write_b32 a228, v60
    v_perm_b32 v61, v41, v40, s53
    v_accvgpr_write_b32 a236, v61
    v_perm_b32 v62, v43, v42, s52
    v_accvgpr_write_b32 a229, v62
    v_perm_b32 v63, v43, v42, s53
    v_accvgpr_write_b32 a237, v63
    s_waitcnt lgkmcnt(0)
    v_perm_b32 v60, v45, v44, s52
    v_accvgpr_write_b32 a230, v60
    v_perm_b32 v61, v45, v44, s53
    v_accvgpr_write_b32 a238, v61
    v_perm_b32 v62, v47, v46, s52
    v_accvgpr_write_b32 a231, v62
    v_perm_b32 v63, v47, v46, s53
    v_accvgpr_write_b32 a239, v63
    s_waitcnt vmcnt(0)
    s_barrier
    ds_read2st64_b32 v[32:33], v50 offset0:192 offset1:193
    ds_read2st64_b32 v[34:35], v50 offset0:194 offset1:195
    ds_read2st64_b32 v[36:37], v50 offset0:196 offset1:197
    ds_read2st64_b32 v[38:39], v50 offset0:198 offset1:199
    ds_read2st64_b32 v[40:41], v50 offset0:200 offset1:201
    ds_read2st64_b32 v[42:43], v50 offset0:202 offset1:203
    ds_read2st64_b32 v[44:45], v50 offset0:204 offset1:205
    ds_read2st64_b32 v[46:47], v50 offset0:206 offset1:207
    s_waitcnt lgkmcnt(6)
    v_perm_b32 v60, v33, v32, s52
    v_accvgpr_write_b32 a240, v60
    v_perm_b32 v61, v33, v32, s53
    v_accvgpr_write_b32 a248, v61
    v_perm_b32 v62, v35, v34, s52
    v_accvgpr_write_b32 a241, v62
    v_perm_b32 v63, v35, v34, s53
    v_accvgpr_write_b32 a249, v63
    s_waitcnt lgkmcnt(4)
    v_perm_b32 v60, v37, v36, s52
    v_accvgpr_write_b32 a242, v60
    v_perm_b32 v61, v37, v36, s53
    v_accvgpr_write_b32 a250, v61
    v_perm_b32 v62, v39, v38, s52
    v_accvgpr_write_b32 a243, v62
    v_perm_b32 v63, v39, v38, s53
    v_accvgpr_write_b32 a251, v63
    s_waitcnt lgkmcnt(2)
    v_perm_b32 v60, v41, v40, s52
    v_accvgpr_write_b32 a244, v60
    v_perm_b32 v61, v41, v40, s53
    v_accvgpr_write_b32 a252, v61
    v_perm_b32 v62, v43, v42, s52
    v_accvgpr_write_b32 a245, v62
    v_perm_b32 v63, v43, v42, s53
    v_accvgpr_write_b32 a253, v63
    s_waitcnt lgkmcnt(0)
    v_perm_b32 v60, v45, v44, s52
    v_accvgpr_write_b32 a246, v60
    v_perm_b32 v61, v45, v44, s53
    v_accvgpr_write_b32 a254, v61
    v_perm_b32 v62, v47, v46, s52
    v_accvgpr_write_b32 a247, v62
    v_perm_b32 v63, v47, v46, s53
    v_accvgpr_write_b32 a255, v63
    s_barrier
L_ffn_112:
    s_min_u32 s57, s72, 63
    s_lshl_b32 s54, s57, 15
    s_lshl_b32 s55, s44, 13
    s_add_u32 s54, s54, s55
    s_add_u32 s54, s54, 1048576
    s_add_u32 s55, s55, s71
    s_mov_b32 m0, s55
    s_nop 0
    buffer_load_dwordx4 v0, s[28:31], s54 offen offset:0 lds
    buffer_load_dwordx4 v0, s[28:31], s54 offen offset:1024 lds
    buffer_load_dwordx4 v0, s[28:31], s54 offen offset:2048 lds
    buffer_load_dwordx4 v0, s[28:31], s54 offen offset:3072 lds
    s_add_u32 s54, s54, 4096
    s_add_u32 s55, s55, 4096
    s_mov_b32 m0, s55
    s_nop 0
    buffer_load_dwordx4 v0, s[28:31], s54 offen offset:0 lds
    buffer_load_dwordx4 v0, s[28:31], s54 offen offset:1024 lds
    buffer_load_dwordx4 v0, s[28:31], s54 offen offset:2048 lds
    buffer_load_dwordx4 v0, s[28:31], s54 offen offset:3072 lds
    s_add_u32 s72, s72, s69
    s_add_u32 s71, s71, 0x8000
    s_and_b32 s71, s71, 0x18000
    ds_read_b128 v[32:35], v2 offset:0
    ds_read_b128 v[36:39], v2 offset:16384
    ds_read_b128 v[40:43], v2 offset:1024
    ds_read_b128 v[44:47], v2 offset:17408
    ds_read_b128 v[48:51], v2 offset:2048
    ds_read_b128 v[52:55], v2 offset:18432
    s_waitcnt lgkmcnt(5)
    v_mfma_f32_16x16x32_bf16 v[64:67], a[0:3], v[32:35], 0
    ds_read_b128 v[56:59], v2 offset:3072
    v_mfma_f32_16x16x32_bf16 v[68:71], a[8:11], v[32:35], 0
    v_mfma_f32_16x16x32_bf16 v[80:83], a[128:131], v[32:35], 0
    v_mfma_f32_16x16x32_bf16 v[84:87], a[136:139], v[32:35], 0
    s_waitcnt lgkmcnt(5)
    v_mfma_f32_16x16x32_bf16 v[72:75], a[0:3], v[36:39], 0
    ds_read_b128 v[60:63], v2 offset:19456
    v_mfma_f32_16x16x32_bf16 v[76:79], a[8:11], v[36:39], 0
    v_mfma_f32_16x16x32_bf16 v[88:91], a[128:131], v[36:39], 0
    v_mfma_f32_16x16x32_bf16 v[92:95], a[136:139], v[36:39], 0
    s_waitcnt lgkmcnt(5)
    v_mfma_f32_16x16x32_bf16 v[64:67], a[4:7], v[40:43], v[64:67]
    ds_read_b128 v[32:35], v2 offset:4096
    v_mfma_f32_16x16x32_bf16 v[68:71], a[12:15], v[40:43], v[68:71]
    v_mfma_f32_16x16x32_bf16 v[80:83], a[132:135], v[40:43], v[80:83]
    v_mfma_f32_16x16x32_bf16 v[84:87], a[140:143], v[40:43], v[84:87]
    s_waitcnt lgkmcnt(5)
    v_mfma_f32_16x16x32_bf16 v[72:75], a[4:7], v[44:47], v[72:75]
    ds_read_b128 v[36:39], v2 offset:20480
    v_mfma_f32_16x16x32_bf16 v[76:79], a[12:15], v[44:47], v[76:79]
    v_mfma_f32_16x16x32_bf16 v[88:91], a[132:135], v[44:47], v[88:91]
    v_mfma_f32_16x16x32_bf16 v[92:95], a[140:143], v[44:47], v[92:95]
    s_waitcnt lgkmcnt(5)
    v_mfma_f32_16x16x32_bf16 v[64:67], a[16:19], v[48:51], v[64:67]
    ds_read_b128 v[40:43], v2 offset:5120
    v_mfma_f32_16x16x32_bf16 v[68:71], a[24:27], v[48:51], v[68:71]
    v_mfma_f32_16x16x32_bf16 v[80:83], a[144:147], v[48:51], v[80:83]
    v_mfma_f32_16x16x32_bf16 v[84:87], a[152:155], v[48:51], v[84:87]
    s_waitcnt lgkmcnt(5)
    v_mfma_f32_16x16x32_bf16 v[72:75], a[16:19], v[52:55], v[72:75]
    ds_read_b128 v[44:47], v2 offset:21504
    v_mfma_f32_16x16x32_bf16 v[76:79], a[24:27], v[52:55], v[76:79]
    v_mfma_f32_16x16x32_bf16 v[88:91], a[144:147], v[52:55], v[88:91]
    v_mfma_f32_16x16x32_bf16 v[92:95], a[152:155], v[52:55], v[92:95]
    s_waitcnt lgkmcnt(5)
    v_mfma_f32_16x16x32_bf16 v[64:67], a[20:23], v[56:59], v[64:67]
    ds_read_b128 v[48:51], v2 offset:6144
    v_mfma_f32_16x16x32_bf16 v[68:71], a[28:31], v[56:59], v[68:71]
    v_mfma_f32_16x16x32_bf16 v[80:83], a[148:151], v[56:59], v[80:83]
    v_mfma_f32_16x16x32_bf16 v[84:87], a[156:159], v[56:59], v[84:87]
    s_waitcnt lgkmcnt(5)
    v_mfma_f32_16x16x32_bf16 v[72:75], a[20:23], v[60:63], v[72:75]
    ds_read_b128 v[52:55], v2 offset:22528
    v_mfma_f32_16x16x32_bf16 v[76:79], a[28:31], v[60:63], v[76:79]
    v_mfma_f32_16x16x32_bf16 v[88:91], a[148:151], v[60:63], v[88:91]
    v_mfma_f32_16x16x32_bf16 v[92:95], a[156:159], v[60:63], v[92:95]
    s_waitcnt lgkmcnt(5)
    v_mfma_f32_16x16x32_bf16 v[64:67], a[32:35], v[32:35], v[64:67]
    ds_read_b128 v[56:59], v2 offset:7168
    v_mfma_f32_16x16x32_bf16 v[68:71], a[40:43], v[32:35], v[68:71]
    v_mfma_f32_16x16x32_bf16 v[80:83], a[160:163], v[32:35], v[80:83]
    v_mfma_f32_16x16x32_bf16 v[84:87], a[168:171], v[32:35], v[84:87]
    s_waitcnt lgkmcnt(5)
    v_mfma_f32_16x16x32_bf16 v[72:75], a[32:35], v[36:39], v[72:75]
    ds_read_b128 v[60:63], v2 offset:23552
    v_mfma_f32_16x16x32_bf16 v[76:79], a[40:43], v[36:39], v[76:79]
    v_mfma_f32_16x16x32_bf16 v[88:91], a[160:163], v[36:39], v[88:91]
    v_mfma_f32_16x16x32_bf16 v[92:95], a[168:171], v[36:39], v[92:95]
    s_waitcnt lgkmcnt(5)
    v_mfma_f32_16x16x32_bf16 v[64:67], a[36:39], v[40:43], v[64:67]
    ds_read_b128 v[32:35], v2 offset:8192
    v_mfma_f32_16x16x32_bf16 v[68:71], a[44:47], v[40:43], v[68:71]
    v_mfma_f32_16x16x32_bf16 v[80:83], a[164:167], v[40:43], v[80:83]
    v_mfma_f32_16x16x32_bf16 v[84:87], a[172:175], v[40:43], v[84:87]
    s_waitcnt lgkmcnt(5)
    v_mfma_f32_16x16x32_bf16 v[72:75], a[36:39], v[44:47], v[72:75]
    ds_read_b128 v[36:39], v2 offset:24576
    v_mfma_f32_16x16x32_bf16 v[76:79], a[44:47], v[44:47], v[76:79]
    v_mfma_f32_16x16x32_bf16 v[88:91], a[164:167], v[44:47], v[88:91]
    v_mfma_f32_16x16x32_bf16 v[92:95], a[172:175], v[44:47], v[92:95]
    s_waitcnt lgkmcnt(5)
    v_mfma_f32_16x16x32_bf16 v[64:67], a[48:51], v[48:51], v[64:67]
    ds_read_b128 v[40:43], v2 offset:9216
    v_mfma_f32_16x16x32_bf16 v[68:71], a[56:59], v[48:51], v[68:71]
    v_mfma_f32_16x16x32_bf16 v[80:83], a[176:179], v[48:51], v[80:83]
    v_mfma_f32_16x16x32_bf16 v[84:87], a[184:187], v[48:51], v[84:87]
    s_waitcnt lgkmcnt(5)
    v_mfma_f32_16x16x32_bf16 v[72:75], a[48:51], v[52:55], v[72:75]
    ds_read_b128 v[44:47], v2 offset:25600
    v_mfma_f32_16x16x32_bf16 v[76:79], a[56:59], v[52:55], v[76:79]
    v_mfma_f32_16x16x32_bf16 v[88:91], a[176:179], v[52:55], v[88:91]
    v_mfma_f32_16x16x32_bf16 v[92:95], a[184:187], v[52:55], v[92:95]
    s_waitcnt lgkmcnt(5)
    v_mfma_f32_16x16x32_bf16 v[64:67], a[52:55], v[56:59], v[64:67]
    ds_read_b128 v[48:51], v2 offset:10240
    v_mfma_f32_16x16x32_bf16 v[68:71], a[60:63], v[56:59], v[68:71]
    v_mfma_f32_16x16x32_bf16 v[80:83], a[180:183], v[56:59], v[80:83]
    v_mfma_f32_16x16x32_bf16 v[84:87], a[188:191], v[56:59], v[84:87]
    s_waitcnt lgkmcnt(5)
    v_mfma_f32_16x16x32_bf16 v[72:75], a[52:55], v[60:63], v[72:75]
    ds_read_b128 v[52:55], v2 offset:26624
    v_mfma_f32_16x16x32_bf16 v[76:79], a[60:63], v[60:63], v[76:79]
    v_mfma_f32_16x16x32_bf16 v[88:91], a[180:183], v[60:63], v[88:91]
    v_mfma_f32_16x16x32_bf16 v[92:95], a[188:191], v[60:63], v[92:95]
    s_waitcnt lgkmcnt(5)
    v_mfma_f32_16x16x32_bf16 v[64:67], a[64:67], v[32:35], v[64:67]
    ds_read_b128 v[56:59], v2 offset:11264
    v_mfma_f32_16x16x32_bf16 v[68:71], a[72:75], v[32:35], v[68:71]
    v_mfma_f32_16x16x32_bf16 v[80:83], a[192:195], v[32:35], v[80:83]
    v_mfma_f32_16x16x32_bf16 v[84:87], a[200:203], v[32:35], v[84:87]
    s_waitcnt lgkmcnt(5)
    v_mfma_f32_16x16x32_bf16 v[72:75], a[64:67], v[36:39], v[72:75]
    ds_read_b128 v[60:63], v2 offset:27648
    v_mfma_f32_16x16x32_bf16 v[76:79], a[72:75], v[36:39], v[76:79]
    v_mfma_f32_16x16x32_bf16 v[88:91], a[192:195], v[36:39], v[88:91]
    v_mfma_f32_16x16x32_bf16 v[92:95], a[200:203], v[36:39], v[92:95]
    s_waitcnt lgkmcnt(5)
    v_mfma_f32_16x16x32_bf16 v[64:67], a[68:71], v[40:43], v[64:67]
    ds_read_b128 v[32:35], v2 offset:12288
    v_mfma_f32_16x16x32_bf16 v[68:71], a[76:79], v[40:43], v[68:71]
    v_mfma_f32_16x16x32_bf16 v[80:83], a[196:199], v[40:43], v[80:83]
    v_mfma_f32_16x16x32_bf16 v[84:87], a[204:207], v[40:43], v[84:87]
    s_waitcnt lgkmcnt(5)
    v_mfma_f32_16x16x32_bf16 v[72:75], a[68:71], v[44:47], v[72:75]
    ds_read_b128 v[36:39], v2 offset:28672
    v_mfma_f32_16x16x32_bf16 v[76:79], a[76:79], v[44:47], v[76:79]
    v_mfma_f32_16x16x32_bf16 v[88:91], a[196:199], v[44:47], v[88:91]
    v_mfma_f32_16x16x32_bf16 v[92:95], a[204:207], v[44:47], v[92:95]
    s_waitcnt lgkmcnt(5)
    v_mfma_f32_16x16x32_bf16 v[64:67], a[80:83], v[48:51], v[64:67]
    ds_read_b128 v[40:43], v2 offset:13312
    v_mfma_f32_16x16x32_bf16 v[68:71], a[88:91], v[48:51], v[68:71]
    v_mfma_f32_16x16x32_bf16 v[80:83], a[208:211], v[48:51], v[80:83]
    v_mfma_f32_16x16x32_bf16 v[84:87], a[216:219], v[48:51], v[84:87]
    s_waitcnt lgkmcnt(5)
    v_mfma_f32_16x16x32_bf16 v[72:75], a[80:83], v[52:55], v[72:75]
    ds_read_b128 v[44:47], v2 offset:29696
    v_mfma_f32_16x16x32_bf16 v[76:79], a[88:91], v[52:55], v[76:79]
    v_mfma_f32_16x16x32_bf16 v[88:91], a[208:211], v[52:55], v[88:91]
    v_mfma_f32_16x16x32_bf16 v[92:95], a[216:219], v[52:55], v[92:95]
    s_waitcnt lgkmcnt(5)
    v_mfma_f32_16x16x32_bf16 v[64:67], a[84:87], v[56:59], v[64:67]
    ds_read_b128 v[48:51], v2 offset:14336
    v_mfma_f32_16x16x32_bf16 v[68:71], a[92:95], v[56:59], v[68:71]
    v_mfma_f32_16x16x32_bf16 v[80:83], a[212:215], v[56:59], v[80:83]
    v_mfma_f32_16x16x32_bf16 v[84:87], a[220:223], v[56:59], v[84:87]
    s_waitcnt lgkmcnt(5)
    v_mfma_f32_16x16x32_bf16 v[72:75], a[84:87], v[60:63], v[72:75]
    ds_read_b128 v[52:55], v2 offset:30720
    v_mfma_f32_16x16x32_bf16 v[76:79], a[92:95], v[60:63], v[76:79]
    v_mfma_f32_16x16x32_bf16 v[88:91], a[212:215], v[60:63], v[88:91]
    v_mfma_f32_16x16x32_bf16 v[92:95], a[220:223], v[60:63], v[92:95]
    s_waitcnt lgkmcnt(5)
    v_mfma_f32_16x16x32_bf16 v[64:67], a[96:99], v[32:35], v[64:67]
    ds_read_b128 v[56:59], v2 offset:15360
    v_mfma_f32_16x16x32_bf16 v[68:71], a[104:107], v[32:35], v[68:71]
    v_mfma_f32_16x16x32_bf16 v[80:83], a[224:227], v[32:35], v[80:83]
    v_mfma_f32_16x16x32_bf16 v[84:87], a[232:235], v[32:35], v[84:87]
    s_waitcnt lgkmcnt(5)
    v_mfma_f32_16x16x32_bf16 v[72:75], a[96:99], v[36:39], v[72:75]
    ds_read_b128 v[60:63], v2 offset:31744
    v_mfma_f32_16x16x32_bf16 v[76:79], a[104:107], v[36:39], v[76:79]
    v_mfma_f32_16x16x32_bf16 v[88:91], a[224:227], v[36:39], v[88:91]
    v_mfma_f32_16x16x32_bf16 v[92:95], a[232:235], v[36:39], v[92:95]
    s_waitcnt lgkmcnt(5)
    v_mfma_f32_16x16x32_bf16 v[64:67], a[100:103], v[40:43], v[64:67]
    v_mfma_f32_16x16x32_bf16 v[68:71], a[108:111], v[40:43], v[68:71]
    v_mfma_f32_16x16x32_bf16 v[80:83], a[228:231], v[40:43], v[80:83]
    v_mfma_f32_16x16x32_bf16 v[84:87], a[236:239], v[40:43], v[84:87]
    s_waitcnt lgkmcnt(4)
    v_mfma_f32_16x16x32_bf16 v[72:75], a[100:103], v[44:47], v[72:75]
    v_mfma_f32_16x16x32_bf16 v[76:79], a[108:111], v[44:47], v[76:79]
    v_mfma_f32_16x16x32_bf16 v[88:91], a[228:231], v[44:47], v[88:91]
    v_mfma_f32_16x16x32_bf16 v[92:95], a[236:239], v[44:47], v[92:95]
    s_waitcnt lgkmcnt(3)
    v_mfma_f32_16x16x32_bf16 v[64:67], a[112:115], v[48:51], v[64:67]
    v_mfma_f32_16x16x32_bf16 v[68:71], a[120:123], v[48:51], v[68:71]
    v_mfma_f32_16x16x32_bf16 v[80:83], a[240:243], v[48:51], v[80:83]
    v_mfma_f32_16x16x32_bf16 v[84:87], a[248:251], v[48:51], v[84:87]
    s_waitcnt lgkmcnt(2)
    v_mfma_f32_16x16x32_bf16 v[72:75], a[112:115], v[52:55], v[72:75]
    v_mfma_f32_16x16x32_bf16 v[76:79], a[120:123], v[52:55], v[76:79]
    v_mfma_f32_16x16x32_bf16 v[88:91], a[240:243], v[52:55], v[88:91]
    v_mfma_f32_16x16x32_bf16 v[92:95], a[248:251], v[52:55], v[92:95]
    s_waitcnt lgkmcnt(1)
    v_mfma_f32_16x16x32_bf16 v[64:67], a[116:119], v[56:59], v[64:67]
    v_mfma_f32_16x16x32_bf16 v[68:71], a[124:127], v[56:59], v[68:71]
    v_mfma_f32_16x16x32_bf16 v[80:83], a[244:247], v[56:59], v[80:83]
    v_mfma_f32_16x16x32_bf16 v[84:87], a[252:255], v[56:59], v[84:87]
    s_waitcnt lgkmcnt(0)
    v_mfma_f32_16x16x32_bf16 v[72:75], a[116:119], v[60:63], v[72:75]
    v_mfma_f32_16x16x32_bf16 v[76:79], a[124:127], v[60:63], v[76:79]
    v_mfma_f32_16x16x32_bf16 v[88:91], a[244:247], v[60:63], v[88:91]
    v_mfma_f32_16x16x32_bf16 v[92:95], a[252:255], v[60:63], v[92:95]
    s_mul_i32 s54, s68, 114688
    s_add_u32 s54, s54, s76
    s_add_u32 s54, s54, 83886080
    v_max_f32 v64, 0, v64
    v_mul_f32 v64, v64, v80
    v_max_f32 v65, 0, v65
    v_mul_f32 v65, v65, v81
    v_max_f32 v66, 0, v66
    v_mul_f32 v66, v66, v82
    v_max_f32 v67, 0, v67
    v_mul_f32 v67, v67, v83
    v_max_f32 v68, 0, v68
    v_mul_f32 v68, v68, v84
    v_max_f32 v69, 0, v69
    v_mul_f32 v69, v69, v85
    v_max_f32 v70, 0, v70
    v_mul_f32 v70, v70, v86
    v_max_f32 v71, 0, v71
    v_mul_f32 v71, v71, v87
    v_cvt_pk_bf16_f32 v112, v64, v68
    v_cvt_pk_bf16_f32 v113, v65, v69
    v_cvt_pk_bf16_f32 v114, v66, v70
    v_cvt_pk_bf16_f32 v115, v67, v71
    buffer_store_dwordx4 v[112:115], v0, s[28:31], s54 offen offset:0 sc1
    v_max_f32 v72, 0, v72
    v_mul_f32 v72, v72, v88
    v_max_f32 v73, 0, v73
    v_mul_f32 v73, v73, v89
    v_max_f32 v74, 0, v74
    v_mul_f32 v74, v74, v90
    v_max_f32 v75, 0, v75
    v_mul_f32 v75, v75, v91
    v_max_f32 v76, 0, v76
    v_mul_f32 v76, v76, v92
    v_max_f32 v77, 0, v77
    v_mul_f32 v77, v77, v93
    v_max_f32 v78, 0, v78
    v_mul_f32 v78, v78, v94
    v_max_f32 v79, 0, v79
    v_mul_f32 v79, v79, v95
    v_cvt_pk_bf16_f32 v116, v72, v76
    v_cvt_pk_bf16_f32 v117, v73, v77
    v_cvt_pk_bf16_f32 v118, v74, v78
    v_cvt_pk_bf16_f32 v119, v75, v79
    buffer_store_dwordx4 v[116:119], v0, s[28:31], s54 offen offset:1024 sc1
    s_waitcnt vmcnt(10)
    s_barrier
    v_add_u32 v2, 0x8000, v2
    v_and_b32 v2, 0x1ffff, v2
    s_add_u32 s68, s68, s69
    s_cmp_lt_u32 s68, s70
    s_cbranch_scc1 L_ffn_112
    s_waitcnt vmcnt(0)
    s_barrier
    s_cmp_lg_u32 s44, 0
    s_cbranch_scc1 L_nf_115
    s_lshl_b32 s55, s75, 7
    s_lshl_b32 s54, s74, 3
    s_add_u32 s55, s55, s54
    s_add_u32 s55, s55, 16384
    v_mov_b32 v8, s42
    v_mov_b32 v9, s43
    s_mov_b64 exec, 1
    buffer_store_dwordx2 v[8:9], off, s[28:31], s55 sc1
    s_mov_b64 exec, -1
L_nf_115:
    s_lshr_b32 s74, s66, 5
    s_and_b32 s75, s66, 15
    v_lshrrev_b32 v30, 8, v0
    s_mov_b32 s54, 8192
    v_mul_lo_u32 v30, v30, s54
    v_bfe_u32 v31, v0, 4, 4
    v_lshl_add_u32 v30, v31, 2, v30
    v_add_u32 v31, 1024, v30
    s_mov_b32 s48, 2048
    s_mov_b32 s49, 26624
    s_mov_b32 s50, 26624
    s_mov_b32 s51, 26624
    s_lshl_b32 s76, s44, 20
    s_lshl_b32 s54, s75, 6
    s_add_u32 s76, s76, s54
    s_mov_b32 s32, s14
    s_and_b32 s33, s15, 0xffff
    s_mov_b32 s34, 4194304
    s_mov_b32 s35, 0x20000
    s_mov_b32 s47, s76
    s_call_b64 s[40:41], L_ldA0
    s_add_u32 s76, s76, 524288
    s_mov_b32 s32, s14
    s_and_b32 s33, s15, 0xffff
    s_mov_b32 s34, 4194304
    s_mov_b32 s35, 0x20000
    s_mov_b32 s47, s76
    s_call_b64 s[40:41], L_ldA1
    s_mul_i32 s76, s44, 458752
    s_lshl_b32 s54, s75, 6
    s_add_u32 s76, s76, s54
    s_mov_b32 s32, s20
    s_and_b32 s33, s21, 0xffff
    s_mov_b32 s34, 1835008
    s_mov_b32 s35, 0x20000
    s_mov_b32 s47, s76
    s_call_b64 s[40:41], L_ldV
    s_and_b32 s86, s66, 31
    s_and_b32 s87, s44, 1
    s_lshr_b32 s90, s44, 1
    s_lshr_b32 s89, s86, 4
    v_bfe_u32 v6, v0, 4, 4
    v_lshrrev_b32 v7, 8, v0
    v_lshrrev_b32 v8, 2, v6
    v_lshlrev_b32 v8, 7, v8
    v_lshl_add_u32 v8, v7, 5, v8
    v_and_b32 v9, 1, v6
    v_lshl_add_u32 v3, v9, 2, v8
    v_and_b32 v2, 127, v1
    v_lshrrev_b32 v8, 2, v6
    v_and_b32 v4, 3, v6
    v_lshl_add_u32 v4, v8, 3, v4
    s_lshl_b32 s54, s87, 2
    v_add_u32 v4, s54, v4
    v_lshlrev_b32 v8, 3, v7
    v_sub_u32 v4, v4, v8
    v_lshrrev_b32 v8, 2, v6
    v_and_b32 v5, 3, v6
    v_lshl_add_u32 v5, v8, 3, v5
    s_lshl_b32 s54, s89, 2
    v_add_u32 v5, s54, v5
    v_lshlrev_b32 v5, 10, v5
    v_lshl_add_u32 v5, v7, 4, v5
    s_lshl_b32 s54, s75, 6
    v_add_u32 v5, s54, v5
    s_mov_b32 s68, s74
    s_mov_b32 s94, 0
    s_lshl_b32 s93, s74, 19
    s_add_u32 s93, s93, 67108864
    s_mov_b32 s58, 0
    s_mov_b32 s55, 16384
L_pp_116:
    buffer_load_dwordx4 v[8:11], v0, s[28:31], s55 offen sc1
    s_waitcnt vmcnt(0)
    v_cmp_ne_u64 vcc, s[42:43], v[8:9]
    v_cmp_ne_u64 s[56:57], s[42:43], v[10:11]
    s_nop 0
    s_or_b64 vcc, vcc, s[56:57]
    s_mov_b32 s56, 2139062143
    s_mov_b32 s57, 2139062143
    s_and_b64 vcc, vcc, s[56:57]
    s_cbranch_scc0 L_ppd_117
    s_sleep 2
    s_add_u32 s58, s58, 1
    s_cmp_lt_u32 s58, 1048576
    s_cbranch_scc1 L_pp_116
    s_branch L_abort
L_ppd_117:
    s_mov_b32 s58, 0
    s_mov_b32 s55, 17408
L_pp_118:
    buffer_load_dwordx4 v[8:11], v0, s[28:31], s55 offen sc1
    s_waitcnt vmcnt(0)
    v_cmp_ne_u64 vcc, s[42:43], v[8:9]
    v_cmp_ne_u64 s[56:57], s[42:43], v[10:11]
    s_nop 0
    s_or_b64 vcc, vcc, s[56:57]
    s_mov_b32 s56, 2139062143
    s_mov_b32 s57, 2139062143
    s_and_b64 vcc, vcc, s[56:57]
    s_cbranch_scc0 L_ppd_119
    s_sleep 2
    s_add_u32 s58, s58, 1
    s_cmp_lt_u32 s58, 1048576
    s_cbranch_scc1 L_pp_118
    s_branch L_abort
L_ppd_119:
    s_lshl_b32 s55, s86, 9
    s_add_u32 s55, s55, 49152
    s_mov_b32 s58, 0
    s_mov_b32 s62, 4294967295
    s_mov_b32 s63, 4294967295
L_pf_120:
    buffer_load_dwordx2 v[8:9], v1, s[28:31], s55 offen sc1
    s_waitcnt vmcnt(0)
    v_cmp_ne_u64 vcc, s[42:43], v[8:9]
    s_nop 0
    s_and_b64 vcc, vcc, s[62:63]
    s_cbranch_scc0 L_pfd_121
    s_sleep 2
    s_add_u32 s58, s58, 1
    s_cmp_lt_u32 s58, 1048576
    s_cbranch_scc1 L_pf_120
    s_branch L_abort
L_pfd_121:
    s_mov_b32 s58, 0
    v_and_b32 v11, 0xff, v1
    s_lshl_b32 s55, s74, 8
    s_add_u32 s55, s55, 4352
L_grp_122:
    buffer_load_dwordx2 v[8:9], v11, s[28:31], s55 offen sc1
    v_mov_b32 v10, s43
    s_waitcnt vmcnt(0)
    v_subrev_co_u32 v8, vcc, s42, v8
    s_nop 1
    v_subb_co_u32 v9, vcc, v9, v10, vcc
    v_lshrrev_b32 v10, 3, v8
    v_or_b32 v9, v9, v10
    v_cmp_ne_u32 vcc, 0, v9
    s_cbranch_vccz L_grd_123
    s_sleep 2
    s_add_u32 s58, s58, 1
    s_cmp_lt_u32 s58, 1048576
    s_cbranch_scc1 L_grp_122
    s_branch L_abort
L_grd_123:
    v_cmp_ne_u32 vcc, s46, v8
    s_nop 0
    s_cmp_lg_u64 vcc, 0
    s_cselect_b32 s92, 1, 0
L_p3_124:
    s_mov_b32 s36, s4
    s_and_b32 s37, s5, 0xffff
    s_mov_b32 s38, 2097152
    s_mov_b32 s39, 0x20000
    s_mul_i32 s57, s68, 114688
    s_mul_i32 s54, s44, 28672
    s_add_u32 s57, s57, s54
    s_lshl_b32 s54, s89, 10
    s_add_u32 s57, s57, s54
    s_add_u32 s57, s57, 83886080
    s_add_u32 s54, s57, 0
    buffer_load_dwordx4 v[80:83], v0, s[28:31], s54 offen offset:0
    buffer_load_dwordx4 v[84:87], v0, s[28:31], s54 offen offset:2048
    s_add_u32 s54, s57, 4096
    buffer_load_dwordx4 v[88:91], v0, s[28:31], s54 offen offset:0
    buffer_load_dwordx4 v[92:95], v0, s[28:31], s54 offen offset:2048
    s_add_u32 s54, s57, 8192
    buffer_load_dwordx4 v[96:99], v0, s[28:31], s54 offen offset:0
    buffer_load_dwordx4 v[100:103], v0, s[28:31], s54 offen offset:2048
    s_add_u32 s54, s57, 12288
    buffer_load_dwordx4 v[104:107], v0, s[28:31], s54 offen offset:0
    buffer_load_dwordx4 v[108:111], v0, s[28:31], s54 offen offset:2048
    s_add_u32 s54, s57, 16384
    buffer_load_dwordx4 v[120:123], v0, s[28:31], s54 offen offset:0
    buffer_load_dwordx4 v[124:127], v0, s[28:31], s54 offen offset:2048
    s_add_u32 s54, s57, 20480
    buffer_load_dwordx4 v[240:243], v0, s[28:31], s54 offen offset:0
    buffer_load_dwordx4 v[244:247], v0, s[28:31], s54 offen offset:2048
    s_add_u32 s54, s57, 24576
    buffer_load_dwordx4 v[248:251], v0, s[28:31], s54 offen offset:0
    buffer_load_dwordx4 v[252:255], v0, s[28:31], s54 offen offset:2048
    s_lshl_b32 s88, s68, 18
    s_lshl_b32 s54, s86, 13
    s_add_u32 s88, s88, s54
    s_lshl_b32 s55, s87, 12
    s_add_u32 s55, s55, s88
    s_add_u32 s54, s55, 16777216
    buffer_load_dwordx4 v[16:19], v0, s[28:31], s54 offen offset:0
    buffer_load_dwordx4 v[20:23], v0, s[28:31], s54 offen offset:1024
    buffer_load_dwordx4 v[24:27], v0, s[28:31], s54 offen offset:2048
    buffer_load_dwordx4 v[28:31], v0, s[28:31], s54 offen offset:3072
    s_add_u32 s54, s88, 33554432
    buffer_load_dwordx4 v[32:35], v0, s[28:31], s54 offen offset:0
    buffer_load_dwordx4 v[36:39], v0, s[28:31], s54 offen offset:1024
    buffer_load_dwordx4 v[40:43], v0, s[28:31], s54 offen offset:2048
    buffer_load_dwordx4 v[44:47], v0, s[28:31], s54 offen offset:3072
    s_add_u32 s54, s88, 33558528
    buffer_load_dwordx4 v[48:51], v0, s[28:31], s54 offen offset:0
    buffer_load_dwordx4 v[52:55], v0, s[28:31], s54 offen offset:1024
    buffer_load_dwordx4 v[56:59], v0, s[28:31], s54 offen offset:2048
    buffer_load_dwordx4 v[60:63], v0, s[28:31], s54 offen offset:3072
    s_lshl_b32 s54, s90, 12
    s_add_u32 s54, s54, s88
    s_add_u32 s54, s54, 50331648
    buffer_load_dwordx4 v[64:67], v0, s[28:31], s54 offen offset:0
    buffer_load_dwordx4 v[68:71], v0, s[28:31], s54 offen offset:1024
    buffer_load_dwordx4 v[72:75], v0, s[28:31], s54 offen offset:2048
    buffer_load_dwordx4 v[76:79], v0, s[28:31], s54 offen offset:3072
    s_lshl_b32 s54, s68, 15
    buffer_load_dwordx4 v[12:15], v5, s[36:39], s54 offen
    s_waitcnt vmcnt(30)
    v_mfma_f32_16x16x32_bf16 v[112:115], v[128:131], v[80:83], 0
    v_mfma_f32_16x16x32_bf16 v[116:119], v[136:139], v[80:83], 0
    s_waitcnt vmcnt(29)
    v_mfma_f32_16x16x32_bf16 v[112:115], v[132:135], v[84:87], v[112:115]
    v_mfma_f32_16x16x32_bf16 v[116:119], v[140:143], v[84:87], v[116:119]
    s_waitcnt vmcnt(28)
    v_mfma_f32_16x16x32_bf16 v[112:115], v[144:147], v[88:91], v[112:115]
    v_mfma_f32_16x16x32_bf16 v[116:119], v[152:155], v[88:91], v[116:119]
    s_waitcnt vmcnt(27)
    v_mfma_f32_16x16x32_bf16 v[112:115], v[148:151], v[92:95], v[112:115]
    v_mfma_f32_16x16x32_bf16 v[116:119], v[156:159], v[92:95], v[116:119]
    s_waitcnt vmcnt(26)
    v_mfma_f32_16x16x32_bf16 v[112:115], v[160:163], v[96:99], v[112:115]
    v_mfma_f32_16x16x32_bf16 v[116:119], v[168:171], v[96:99], v[116:119]
    s_waitcnt vmcnt(25)
    v_mfma_f32_16x16x32_bf16 v[112:115], v[164:167], v[100:103], v[112:115]
    v_mfma_f32_16x16x32_bf16 v[116:119], v[172:175], v[100:103], v[116:119]
    s_waitcnt vmcnt(24)
    v_mfma_f32_16x16x32_bf16 v[112:115], v[176:179], v[104:107], v[112:115]
    v_mfma_f32_16x16x32_bf16 v[116:119], v[184:187], v[104:107], v[116:119]
    s_waitcnt vmcnt(23)
    v_mfma_f32_16x16x32_bf16 v[112:115], v[180:183], v[108:111], v[112:115]
    v_mfma_f32_16x16x32_bf16 v[116:119], v[188:191], v[108:111], v[116:119]
    s_waitcnt vmcnt(22)
    v_mfma_f32_16x16x32_bf16 v[112:115], v[192:195], v[120:123], v[112:115]
    v_mfma_f32_16x16x32_bf16 v[116:119], v[200:203], v[120:123], v[116:119]
    s_waitcnt vmcnt(21)
    v_mfma_f32_16x16x32_bf16 v[112:115], v[196:199], v[124:127], v[112:115]
    v_mfma_f32_16x16x32_bf16 v[116:119], v[204:207], v[124:127], v[116:119]
    s_waitcnt vmcnt(20)
    v_mfma_f32_16x16x32_bf16 v[112:115], v[208:211], v[240:243], v[112:115]
    v_mfma_f32_16x16x32_bf16 v[116:119], v[216:219], v[240:243], v[116:119]
    s_waitcnt vmcnt(19)
    v_mfma_f32_16x16x32_bf16 v[112:115], v[212:215], v[244:247], v[112:115]
    v_mfma_f32_16x16x32_bf16 v[116:119], v[220:223], v[244:247], v[116:119]
    s_waitcnt vmcnt(18)
    v_mfma_f32_16x16x32_bf16 v[112:115], v[224:227], v[248:251], v[112:115]
    v_mfma_f32_16x16x32_bf16 v[116:119], v[232:235], v[248:251], v[116:119]
    s_waitcnt vmcnt(17)
    v_mfma_f32_16x16x32_bf16 v[112:115], v[228:231], v[252:255], v[112:115]
    v_mfma_f32_16x16x32_bf16 v[116:119], v[236:239], v[252:255], v[116:119]
    s_waitcnt vmcnt(5)
    v_mfma_f32_16x16x32_bf16 v[120:123], v[32:35], v[16:19], 0
    v_mfma_f32_16x16x32_bf16 v[124:127], v[48:51], v[16:19], 0
    v_mfma_f32_16x16x32_bf16 v[120:123], v[36:39], v[20:23], v[120:123]
    v_mfma_f32_16x16x32_bf16 v[124:127], v[52:55], v[20:23], v[124:127]
    v_mfma_f32_16x16x32_bf16 v[120:123], v[40:43], v[24:27], v[120:123]
    v_mfma_f32_16x16x32_bf16 v[124:127], v[56:59], v[24:27], v[124:127]
    v_mfma_f32_16x16x32_bf16 v[120:123], v[44:47], v[28:31], v[120:123]
    v_mfma_f32_16x16x32_bf16 v[124:127], v[60:63], v[28:31], v[124:127]
    v_mov_b32 v252, 0xff800000
    v_cmp_le_i32 vcc, 0, v4
    s_nop 1
    v_cndmask_b32 v120, v252, v120, vcc
    v_cmp_le_i32 vcc, 1, v4
    s_nop 1
    v_cndmask_b32 v121, v252, v121, vcc
    v_cmp_le_i32 vcc, 2, v4
    s_nop 1
    v_cndmask_b32 v122, v252, v122, vcc
    v_cmp_le_i32 vcc, 3, v4
    s_nop 1
    v_cndmask_b32 v123, v252, v123, vcc
    v_cmp_le_i32 vcc, 4, v4
    s_nop 1
    v_cndmask_b32 v124, v252, v124, vcc
    v_cmp_le_i32 vcc, 5, v4
    s_nop 1
    v_cndmask_b32 v125, v252, v125, vcc
    v_cmp_le_i32 vcc, 6, v4
    s_nop 1
    v_cndmask_b32 v126, v252, v126, vcc
    v_cmp_le_i32 vcc, 7, v4
    s_nop 1
    v_cndmask_b32 v127, v252, v127, vcc
    v_max3_f32 v252, v120, v121, v122
    v_max3_f32 v253, v123, v124, v125
    v_max3_f32 v252, v252, v126, v127
    v_max_f32 v252, v252, v253
    v_mov_b32 v249, 0
    v_mov_b32 v250, 0
    s_lshl_b32 s55, s86, 7
    s_add_u32 s55, s55, 12288
    s_mov_b32 s58, 0
    s_lshr_b32 s54, s88, 1
    s_add_u32 s54, s54, 4194304
    s_lshl_b32 s72, s90, 11
    s_add_u32 s72, s72, s54
    s_max_u32 s71, s68, 61
    s_sub_u32 s71, s71, 61
    s_lshl_b32 s71, s71, 17
    s_sub_u32 s71, s54, s71
    s_mov_b64 s[94:95], 0
    s_branch L_kq_126
L_km_125:
    s_add_u32 s58, s58, 4096
    s_cbranch_scc1 L_abort
    s_sleep 4
    buffer_load_dword v10, off, s[28:31], s71 sc1
    buffer_load_dwordx2 v[8:9], off, s[28:31], s55 sc1
    s_waitcnt vmcnt(0)
    v_cmp_eq_u64 s[94:95], s[42:43], v[8:9]
    v_cmp_ne_u32 vcc, -1, v10
    s_nop 0
    s_or_b64 vcc, vcc, s[94:95]
    s_cbranch_scc0 L_km_125
L_kq_126:
    buffer_load_dword v96, v3, s[28:31], s54 offen offset:0 sc1
    buffer_load_dword v97, v3, s[28:31], s54 offen offset:8 sc1
    buffer_load_dword v98, v3, s[28:31], s54 offen offset:16 sc1
    buffer_load_dword v99, v3, s[28:31], s54 offen offset:24 sc1
    buffer_load_dword v100, v3, s[28:31], s54 offen offset:1024 sc1
    buffer_load_dword v101, v3, s[28:31], s54 offen offset:1032 sc1
    buffer_load_dword v102, v3, s[28:31], s54 offen offset:1040 sc1
    buffer_load_dword v103, v3, s[28:31], s54 offen offset:1048 sc1
    buffer_load_dword v104, v3, s[28:31], s54 offen offset:2048 sc1
    buffer_load_dword v105, v3, s[28:31], s54 offen offset:2056 sc1
    buffer_load_dword v106, v3, s[28:31], s54 offen offset:2064 sc1
    buffer_load_dword v107, v3, s[28:31], s54 offen offset:2072 sc1
    buffer_load_dword v108, v3, s[28:31], s54 offen offset:3072 sc1
    buffer_load_dword v109, v3, s[28:31], s54 offen offset:3080 sc1
    buffer_load_dword v110, v3, s[28:31], s54 offen offset:3088 sc1
    buffer_load_dword v111, v3, s[28:31], s54 offen offset:3096 sc1
    buffer_load_dwordx2 v[80:81], v1, s[28:31], s72 offen offset:512 sc1
    buffer_load_dwordx2 v[82:83], v1, s[28:31], s72 offen offset:1536 sc1
    buffer_load_dword v6, off, s[28:31], s71 sc1
    buffer_load_dwordx2 v[8:9], off, s[28:31], s55 sc1
    s_waitcnt vmcnt(16)
    v_mfma_f32_16x16x32_bf16 v[240:243], v[96:99], v[16:19], 0
    v_max3_u32 v10, v96, v97, v98
    v_max_u32 v10, v10, v99
    s_waitcnt vmcnt(12)
    v_mfma_f32_16x16x32_bf16 v[240:243], v[100:103], v[20:23], v[240:243]
    v_max3_u32 v10, v10, v100, v101
    v_max3_u32 v10, v10, v102, v103
    s_waitcnt vmcnt(8)
    v_mfma_f32_16x16x32_bf16 v[240:243], v[104:107], v[24:27], v[240:243]
    v_max3_u32 v10, v10, v104, v105
    v_max3_u32 v10, v10, v106, v107
    s_waitcnt vmcnt(4)
    v_mfma_f32_16x16x32_bf16 v[240:243], v[108:111], v[28:31], v[240:243]
    v_max3_u32 v10, v10, v108, v109
    v_max3_u32 v10, v10, v110, v111
    s_waitcnt vmcnt(2)
    v_max3_u32 v10, v10, v80, v81
    v_max3_u32 v10, v10, v82, v83
    v_cmp_eq_u32 vcc, -1, v10
    s_cbranch_vccz L_kqd_127
    s_cmp_lg_u64 s[94:95], 0
    s_cbranch_scc1 L_kqd_127
    s_waitcnt vmcnt(0)
    v_cmp_eq_u64 s[94:95], s[42:43], v[8:9]
    v_cmp_ne_u32 vcc, -1, v6
    s_nop 0
    s_or_b64 vcc, vcc, s[94:95]
    s_cbranch_scc0 L_km_125
    s_add_u32 s58, s58, 4096
    s_cbranch_scc0 L_kq_126
    s_branch L_abort
L_kqd_127:
    s_nop 0
    v_max3_f32 v252, v252, v240, v241
    v_mov_b32 v253, v252
    s_nop 1
    v_permlane16_swap_b32 v252, v253
    v_max_f32 v252, v252, v253
    v_mov_b32 v253, v252
    s_nop 1
    v_permlane32_swap_b32 v252, v253
    v_max_f32 v252, v252, v253
    v_mul_f32 v252, s59, v252
    v_fma_f32 v120, v120, s59, -v252
    v_fma_f32 v121, v121, s59, -v252
    v_fma_f32 v122, v122, s59, -v252
    v_fma_f32 v123, v123, s59, -v252
    v_fma_f32 v124, v124, s59, -v252
    v_fma_f32 v125, v125, s59, -v252
    v_fma_f32 v126, v126, s59, -v252
    v_fma_f32 v127, v127, s59, -v252
    v_fma_f32 v240, v240, s59, -v252
    v_fma_f32 v241, v241, s59, -v252
    v_exp_f32 v120, v120
    v_exp_f32 v121, v121
    v_exp_f32 v122, v122
    v_exp_f32 v123, v123
    v_exp_f32 v124, v124
    v_exp_f32 v125, v125
    v_exp_f32 v126, v126
    v_exp_f32 v127, v127
    v_exp_f32 v240, v240
    v_exp_f32 v241, v241
    v_cvt_pk_bf16_f32 v244, v120, v121
    v_cvt_pk_bf16_f32 v245, v122, v123
    v_cvt_pk_bf16_f32 v246, v124, v125
    v_cvt_pk_bf16_f32 v247, v126, v127
    v_cvt_pk_bf16_f32 v248, v240, v241
    v_cvt_pk_bf16_f32 v251, v240, v241
    v_mfma_f32_16x16x32_bf16 v[32:35], v[64:67], v[244:247], 0
    v_add_f32 v120, v120, v121
    v_add_f32 v122, v122, v123
    v_mfma_f32_16x16x32_bf16 v[36:39], v[68:71], v[244:247], 0
    v_add_f32 v124, v124, v125
    v_add_f32 v126, v126, v127
    v_mfma_f32_16x16x32_bf16 v[40:43], v[72:75], v[244:247], 0
    v_add_f32 v240, v240, v241
    v_add_f32 v120, v120, v122
    v_mfma_f32_16x16x32_bf16 v[44:47], v[76:79], v[244:247], 0
    v_add_f32 v124, v124, v126
    v_add_f32 v120, v120, v240
    v_add_f32 v252, v120, v124
    v_mfma_f32_16x16x16_bf16 v[32:35], v[80:81], v[248:249], v[32:35]
    v_mfma_f32_16x16x16_bf16 v[36:39], v[80:81], v[250:251], v[36:39]
    v_mfma_f32_16x16x16_bf16 v[40:43], v[82:83], v[248:249], v[40:43]
    v_mfma_f32_16x16x16_bf16 v[44:47], v[82:83], v[250:251], v[44:47]
    v_mov_b32 v253, v252
    s_nop 1
    v_permlane16_swap_b32 v252, v253
    v_add_f32 v252, v252, v253
    v_mov_b32 v253, v252
    s_nop 1
    v_permlane32_swap_b32 v252, v253
    v_add_f32 v252, v252, v253
    v_rcp_f32 v252, v252
    s_lshl_b32 s55, s87, 12
    s_lshl_b32 s54, s86, 13
    s_add_u32 s55, s55, s54
    s_lshl_b32 s54, s90, 11
    s_add_u32 s54, s54, s55
    s_add_u32 s54, s54, s93
    s_lshl_b32 s55, s68, 11
    s_add_u32 s72, s55, 3145728
    s_lshr_b32 s56, s86, 3
    s_lshl_b32 s56, s56, 8
    s_add_u32 s55, s72, s56
    s_and_b32 s56, s86, 7
    s_lshl_b32 s56, s56, 4
    s_add_u32 s55, s55, s56
    s_lshl_b32 s56, s87, 10
    s_add_u32 s55, s55, s56
    s_lshl_b32 s56, s90, 3
    s_add_u32 s55, s55, s56
    v_mov_b32 v10, s42
    v_mov_b32 v11, s43
    v_pk_mul_f32 v[32:33], v[32:33], v[252:253] op_sel_hi:[1,0]
    v_pk_mul_f32 v[34:35], v[34:35], v[252:253] op_sel_hi:[1,0]
    v_pk_mul_f32 v[36:37], v[36:37], v[252:253] op_sel_hi:[1,0]
    v_pk_mul_f32 v[38:39], v[38:39], v[252:253] op_sel_hi:[1,0]
    v_cvt_pk_bf16_f32 v16, v32, v36
    v_cvt_pk_bf16_f32 v17, v33, v37
    v_cvt_pk_bf16_f32 v18, v34, v38
    v_cvt_pk_bf16_f32 v19, v35, v39
    v_pk_mul_f32 v[40:41], v[40:41], v[252:253] op_sel_hi:[1,0]
    v_pk_mul_f32 v[42:43], v[42:43], v[252:253] op_sel_hi:[1,0]
    v_pk_mul_f32 v[44:45], v[44:45], v[252:253] op_sel_hi:[1,0]
    v_pk_mul_f32 v[46:47], v[46:47], v[252:253] op_sel_hi:[1,0]
    v_cvt_pk_bf16_f32 v20, v40, v44
    v_cvt_pk_bf16_f32 v21, v41, v45
    v_cvt_pk_bf16_f32 v22, v42, v46
    v_cvt_pk_bf16_f32 v23, v43, v47
    s_cmp_lg_u32 s92, 0
    s_cbranch_scc1 L_far_128
    buffer_store_dwordx4 v[16:19], v0, s[28:31], s54 offen offset:0
    buffer_store_dwordx4 v[20:23], v0, s[28:31], s54 offen offset:1024
    s_waitcnt vmcnt(0)
    s_mov_b64 exec, 1
    buffer_store_dwordx2 v[10:11], off, s[28:31], s55
    s_mov_b64 exec, -1
    s_branch L_snt_129
L_far_128:
    buffer_store_dwordx4 v[16:19], v0, s[28:31], s54 offen offset:0 sc1
    buffer_store_dwordx4 v[20:23], v0, s[28:31], s54 offen offset:1024 sc1
    s_waitcnt vmcnt(0)
    s_mov_b64 exec, 1
    buffer_store_dwordx2 v[10:11], off, s[28:31], s55 sc1
    s_mov_b64 exec, -1
L_snt_129:
    s_lshl_b32 s55, s89, 10
    s_lshl_b32 s54, s44, 8
    s_add_u32 s55, s55, s54
    s_add_u32 s55, s55, s72
    s_lshl_b32 s57, s44, 16
    s_lshl_b32 s54, s89, 12
    s_add_u32 s57, s57, s54
    s_add_u32 s57, s57, s93
    s_xor_b32 s93, s93, 262144
    s_mov_b32 s58, 0
    s_mov_b32 s62, 65535
    s_mov_b32 s63, 0
L_pf_130:
    buffer_load_dwordx2 v[8:9], v2, s[28:31], s55 offen sc1
    s_waitcnt vmcnt(0)
    v_cmp_ne_u64 vcc, s[42:43], v[8:9]
    s_nop 0
    s_and_b64 vcc, vcc, s[62:63]
    s_cbranch_scc0 L_pfd_131
    s_sleep 1
    s_add_u32 s58, s58, 1
    s_cmp_lt_u32 s58, 1048576
    s_cbranch_scc1 L_pf_130
    s_branch L_abort
L_pfd_131:
    s_add_u32 s54, s57, 0
    buffer_load_dwordx4 v[16:19], v0, s[28:31], s54 offen offset:0 sc1
    buffer_load_dwordx4 v[20:23], v0, s[28:31], s54 offen offset:1024 sc1
    buffer_load_dwordx4 v[24:27], v0, s[28:31], s54 offen offset:2048 sc1
    buffer_load_dwordx4 v[28:31], v0, s[28:31], s54 offen offset:3072 sc1
    s_add_u32 s54, s57, 8192
    buffer_load_dwordx4 v[32:35], v0, s[28:31], s54 offen offset:0 sc1
    buffer_load_dwordx4 v[36:39], v0, s[28:31], s54 offen offset:1024 sc1
    buffer_load_dwordx4 v[40:43], v0, s[28:31], s54 offen offset:2048 sc1
    buffer_load_dwordx4 v[44:47], v0, s[28:31], s54 offen offset:3072 sc1
    s_add_u32 s54, s57, 16384
    buffer_load_dwordx4 v[48:51], v0, s[28:31], s54 offen offset:0 sc1
    buffer_load_dwordx4 v[52:55], v0, s[28:31], s54 offen offset:1024 sc1
    buffer_load_dwordx4 v[56:59], v0, s[28:31], s54 offen offset:2048 sc1
    buffer_load_dwordx4 v[60:63], v0, s[28:31], s54 offen offset:3072 sc1
    s_add_u32 s54, s57, 24576
    buffer_load_dwordx4 v[64:67], v0, s[28:31], s54 offen offset:0 sc1
    buffer_load_dwordx4 v[68:71], v0, s[28:31], s54 offen offset:1024 sc1
    buffer_load_dwordx4 v[72:75], v0, s[28:31], s54 offen offset:2048 sc1
    buffer_load_dwordx4 v[76:79], v0, s[28:31], s54 offen offset:3072 sc1
    s_add_u32 s54, s57, 32768
    buffer_load_dwordx4 v[80:83], v0, s[28:31], s54 offen offset:0 sc1
    buffer_load_dwordx4 v[84:87], v0, s[28:31], s54 offen offset:1024 sc1
    buffer_load_dwordx4 v[88:91], v0, s[28:31], s54 offen offset:2048 sc1
    buffer_load_dwordx4 v[92:95], v0, s[28:31], s54 offen offset:3072 sc1
    s_add_u32 s54, s57, 40960
    buffer_load_dwordx4 v[96:99], v0, s[28:31], s54 offen offset:0 sc1
    buffer_load_dwordx4 v[100:103], v0, s[28:31], s54 offen offset:1024 sc1
    buffer_load_dwordx4 v[104:107], v0, s[28:31], s54 offen offset:2048 sc1
    buffer_load_dwordx4 v[108:111], v0, s[28:31], s54 offen offset:3072 sc1
    s_waitcnt vmcnt(23)
    v_mfma_f32_16x16x32_bf16 v[112:115], a[0:3], v[16:19], v[112:115]
    v_mfma_f32_16x16x32_bf16 v[116:119], a[8:11], v[16:19], v[116:119]
    s_add_u32 s54, s57, 49152
    buffer_load_dwordx4 v[16:19], v0, s[28:31], s54 offen offset:0 sc1
    s_waitcnt vmcnt(23)
    v_mfma_f32_16x16x32_bf16 v[112:115], a[4:7], v[20:23], v[112:115]
    v_mfma_f32_16x16x32_bf16 v[116:119], a[12:15], v[20:23], v[116:119]
    buffer_load_dwordx4 v[20:23], v0, s[28:31], s54 offen offset:1024 sc1
    s_waitcnt vmcnt(23)
    v_mfma_f32_16x16x32_bf16 v[112:115], a[16:19], v[24:27], v[112:115]
    v_mfma_f32_16x16x32_bf16 v[116:119], a[24:27], v[24:27], v[116:119]
    buffer_load_dwordx4 v[24:27], v0, s[28:31], s54 offen offset:2048 sc1
    s_waitcnt vmcnt(23)
    v_mfma_f32_16x16x32_bf16 v[112:115], a[20:23], v[28:31], v[112:115]
    v_mfma_f32_16x16x32_bf16 v[116:119], a[28:31], v[28:31], v[116:119]
    buffer_load_dwordx4 v[28:31], v0, s[28:31], s54 offen offset:3072 sc1
    s_waitcnt vmcnt(23)
    v_mfma_f32_16x16x32_bf16 v[112:115], a[32:35], v[32:35], v[112:115]
    v_mfma_f32_16x16x32_bf16 v[116:119], a[40:43], v[32:35], v[116:119]
    s_add_u32 s54, s57, 57344
    buffer_load_dwordx4 v[32:35], v0, s[28:31], s54 offen offset:0 sc1
    s_waitcnt vmcnt(23)
    v_mfma_f32_16x16x32_bf16 v[112:115], a[36:39], v[36:39], v[112:115]
    v_mfma_f32_16x16x32_bf16 v[116:119], a[44:47], v[36:39], v[116:119]
    buffer_load_dwordx4 v[36:39], v0, s[28:31], s54 offen offset:1024 sc1
    s_waitcnt vmcnt(23)
    v_mfma_f32_16x16x32_bf16 v[112:115], a[48:51], v[40:43], v[112:115]
    v_mfma_f32_16x16x32_bf16 v[116:119], a[56:59], v[40:43], v[116:119]
    buffer_load_dwordx4 v[40:43], v0, s[28:31], s54 offen offset:2048 sc1
    s_waitcnt vmcnt(23)
    v_mfma_f32_16x16x32_bf16 v[112:115], a[52:55], v[44:47], v[112:115]
    v_mfma_f32_16x16x32_bf16 v[116:119], a[60:63], v[44:47], v[116:119]
    buffer_load_dwordx4 v[44:47], v0, s[28:31], s54 offen offset:3072 sc1
    s_waitcnt vmcnt(23)
    v_mfma_f32_16x16x32_bf16 v[112:115], a[64:67], v[48:51], v[112:115]
    v_mfma_f32_16x16x32_bf16 v[116:119], a[72:75], v[48:51], v[116:119]
    s_waitcnt vmcnt(22)
    v_mfma_f32_16x16x32_bf16 v[112:115], a[68:71], v[52:55], v[112:115]
    v_mfma_f32_16x16x32_bf16 v[116:119], a[76:79], v[52:55], v[116:119]
    s_waitcnt vmcnt(21)
    v_mfma_f32_16x16x32_bf16 v[112:115], a[80:83], v[56:59], v[112:115]
    v_mfma_f32_16x16x32_bf16 v[116:119], a[88:91], v[56:59], v[116:119]
    s_waitcnt vmcnt(20)
    v_mfma_f32_16x16x32_bf16 v[112:115], a[84:87], v[60:63], v[112:115]
    v_mfma_f32_16x16x32_bf16 v[116:119], a[92:95], v[60:63], v[116:119]
    s_waitcnt vmcnt(19)
    v_mfma_f32_16x16x32_bf16 v[112:115], a[96:99], v[64:67], v[112:115]
    v_mfma_f32_16x16x32_bf16 v[116:119], a[104:107], v[64:67], v[116:119]
    s_waitcnt vmcnt(18)
    v_mfma_f32_16x16x32_bf16 v[112:115], a[100:103], v[68:71], v[112:115]
    v_mfma_f32_16x16x32_bf16 v[116:119], a[108:111], v[68:71], v[116:119]
    s_waitcnt vmcnt(17)
    v_mfma_f32_16x16x32_bf16 v[112:115], a[112:115], v[72:75], v[112:115]
    v_mfma_f32_16x16x32_bf16 v[116:119], a[120:123], v[72:75], v[116:119]
    s_waitcnt vmcnt(16)
    v_mfma_f32_16x16x32_bf16 v[112:115], a[116:119], v[76:79], v[112:115]
    v_mfma_f32_16x16x32_bf16 v[116:119], a[124:127], v[76:79], v[116:119]
    s_waitcnt vmcnt(15)
    v_mfma_f32_16x16x32_bf16 v[112:115], a[128:131], v[80:83], v[112:115]
    v_mfma_f32_16x16x32_bf16 v[116:119], a[136:139], v[80:83], v[116:119]
    s_waitcnt vmcnt(14)
    v_mfma_f32_16x16x32_bf16 v[112:115], a[132:135], v[84:87], v[112:115]
    v_mfma_f32_16x16x32_bf16 v[116:119], a[140:143], v[84:87], v[116:119]
    s_waitcnt vmcnt(13)
    v_mfma_f32_16x16x32_bf16 v[112:115], a[144:147], v[88:91], v[112:115]
    v_mfma_f32_16x16x32_bf16 v[116:119], a[152:155], v[88:91], v[116:119]
    s_waitcnt vmcnt(12)
    v_mfma_f32_16x16x32_bf16 v[112:115], a[148:151], v[92:95], v[112:115]
    v_mfma_f32_16x16x32_bf16 v[116:119], a[156:159], v[92:95], v[116:119]
    s_waitcnt vmcnt(11)
    v_mfma_f32_16x16x32_bf16 v[112:115], a[160:163], v[96:99], v[112:115]
    v_mfma_f32_16x16x32_bf16 v[116:119], a[168:171], v[96:99], v[116:119]
    s_waitcnt vmcnt(10)
    v_mfma_f32_16x16x32_bf16 v[112:115], a[164:167], v[100:103], v[112:115]
    v_mfma_f32_16x16x32_bf16 v[116:119], a[172:175], v[100:103], v[116:119]
    s_waitcnt vmcnt(9)
    v_mfma_f32_16x16x32_bf16 v[112:115], a[176:179], v[104:107], v[112:115]
    v_mfma_f32_16x16x32_bf16 v[116:119], a[184:187], v[104:107], v[116:119]
    s_waitcnt vmcnt(8)
    v_mfma_f32_16x16x32_bf16 v[112:115], a[180:183], v[108:111], v[112:115]
    v_mfma_f32_16x16x32_bf16 v[116:119], a[188:191], v[108:111], v[116:119]
    s_waitcnt vmcnt(7)
    v_mfma_f32_16x16x32_bf16 v[112:115], a[192:195], v[16:19], v[112:115]
    v_mfma_f32_16x16x32_bf16 v[116:119], a[200:203], v[16:19], v[116:119]
    s_waitcnt vmcnt(6)
    v_mfma_f32_16x16x32_bf16 v[112:115], a[196:199], v[20:23], v[112:115]
    v_mfma_f32_16x16x32_bf16 v[116:119], a[204:207], v[20:23], v[116:119]
    s_waitcnt vmcnt(5)
    v_mfma_f32_16x16x32_bf16 v[112:115], a[208:211], v[24:27], v[112:115]
    v_mfma_f32_16x16x32_bf16 v[116:119], a[216:219], v[24:27], v[116:119]
    s_waitcnt vmcnt(4)
    v_mfma_f32_16x16x32_bf16 v[112:115], a[212:215], v[28:31], v[112:115]
    v_mfma_f32_16x16x32_bf16 v[116:119], a[220:223], v[28:31], v[116:119]
    s_waitcnt vmcnt(3)
    v_mfma_f32_16x16x32_bf16 v[112:115], a[224:227], v[32:35], v[112:115]
    v_mfma_f32_16x16x32_bf16 v[116:119], a[232:235], v[32:35], v[116:119]
    s_waitcnt vmcnt(2)
    v_mfma_f32_16x16x32_bf16 v[112:115], a[228:231], v[36:39], v[112:115]
    v_mfma_f32_16x16x32_bf16 v[116:119], a[236:239], v[36:39], v[116:119]
    s_waitcnt vmcnt(1)
    v_mfma_f32_16x16x32_bf16 v[112:115], a[240:243], v[40:43], v[112:115]
    v_mfma_f32_16x16x32_bf16 v[116:119], a[248:251], v[40:43], v[116:119]
    s_waitcnt vmcnt(0)
    v_mfma_f32_16x16x32_bf16 v[112:115], a[244:247], v[44:47], v[112:115]
    v_mfma_f32_16x16x32_bf16 v[116:119], a[252:255], v[44:47], v[116:119]
    s_lshl_b32 s54, s44, 11
    v_add_u32 v8, s54, v0
    v_lshlrev_b32 v64, 16, v12
    v_and_b32 v68, 0xffff0000, v12
    v_lshlrev_b32 v65, 16, v13
    v_and_b32 v69, 0xffff0000, v13
    v_lshlrev_b32 v66, 16, v14
    v_and_b32 v70, 0xffff0000, v14
    v_lshlrev_b32 v67, 16, v15
    v_and_b32 v71, 0xffff0000, v15
    s_mov_b32 s36, s22
    s_and_b32 s37, s23, 0xffff
    s_mov_b32 s38, 2097152
    s_mov_b32 s39, 0x20000
    ds_write_b128 v8, v[112:115] offset:0
    ds_write_b128 v8, v[116:119] offset:1024
    v_pk_add_f32 v[64:65], v[64:65], v[112:113]
    v_pk_add_f32 v[66:67], v[66:67], v[114:115]
    v_pk_add_f32 v[68:69], v[68:69], v[116:117]
    v_pk_add_f32 v[70:71], v[70:71], v[118:119]
    s_waitcnt lgkmcnt(0)
    s_barrier
    s_cmp_lg_u32 s44, 0
    s_cbranch_scc1 L_fin_132
    ds_read_b128 v[40:43], v0 offset:2048
    ds_read_b128 v[44:47], v0 offset:3072
    ds_read_b128 v[48:51], v0 offset:4096
    ds_read_b128 v[52:55], v0 offset:5120
    ds_read_b128 v[56:59], v0 offset:6144
    ds_read_b128 v[60:63], v0 offset:7168
    s_lshl_b32 s54, s68, 15
    s_waitcnt lgkmcnt(4)
    v_pk_add_f32 v[64:65], v[64:65], v[40:41]
    v_pk_add_f32 v[66:67], v[66:67], v[42:43]
    v_pk_add_f32 v[68:69], v[68:69], v[44:45]
    v_pk_add_f32 v[70:71], v[70:71], v[46:47]
    s_waitcnt lgkmcnt(2)
    v_pk_add_f32 v[64:65], v[64:65], v[48:49]
    v_pk_add_f32 v[66:67], v[66:67], v[50:51]
    v_pk_add_f32 v[68:69], v[68:69], v[52:53]
    v_pk_add_f32 v[70:71], v[70:71], v[54:55]
    s_waitcnt lgkmcnt(0)
    v_pk_add_f32 v[64:65], v[64:65], v[56:57]
    v_pk_add_f32 v[66:67], v[66:67], v[58:59]
    v_pk_add_f32 v[68:69], v[68:69], v[60:61]
    v_pk_add_f32 v[70:71], v[70:71], v[62:63]
    v_cvt_pk_bf16_f32 v72, v64, v68
    v_cvt_pk_bf16_f32 v73, v65, v69
    v_cvt_pk_bf16_f32 v74, v66, v70
    v_cvt_pk_bf16_f32 v75, v67, v71
    buffer_store_dwordx4 v[72:75], v5, s[36:39], s54 offen sc1
L_fin_132:
    s_barrier
    s_add_u32 s68, s68, 7
    s_cmp_lt_u32 s68, 64
    s_cbranch_scc1 L_p3_124
    s_endpgm
L_abort:
    s_endpgm
L_swap:
    s_waitcnt vmcnt(0) lgkmcnt(0)
    s_barrier
    s_cmp_lg_u32 s44, 0
    s_cbranch_scc1 L_tk_133
    v_mov_b32 v2, 0x10001
    s_mov_b64 exec, 1
    buffer_atomic_add v2, off, s[36:39], s51 sc0 sc1
    s_waitcnt vmcnt(0)
    s_mov_b64 exec, -1
    v_readfirstlane_b32 s57, v2
    s_nop 0
    s_lshr_b32 s57, s57, 16
    s_cmp_ge_u32 s57, 32
    s_cbranch_scc1 L_got_136
    s_lshl_b32 s56, s57, 1
    s_add_u32 s56, s56, 64
    s_add_u32 s56, s56, s51
    s_add_u32 s54, s45, 1
    v_mov_b32 v2, s54
    s_mov_b64 exec, 1
    buffer_store_short v2, off, s[36:39], s56 sc1
    s_mov_b64 exec, -1
    s_xor_b32 s56, s56, 128
    s_mov_b32 s58, 0
L_ovl_134:
    buffer_load_dword v2, off, s[36:39], 0 sc1
    buffer_load_dword v3, off, s[36:39], 0 offset:128 sc1
    buffer_load_ushort v4, off, s[36:39], s56 sc1
    s_waitcnt vmcnt(0)
    v_readfirstlane_b32 s66, v2
    v_readfirstlane_b32 s67, v3
    v_readfirstlane_b32 s68, v4
    s_nop 0
    s_cmp_lg_u32 s68, 0
    s_cbranch_scc1 L_ovs_135
    s_add_u32 s54, s66, s67
    s_and_b32 s54, s54, 0xffff
    s_min_u32 s55, s66, s67
    s_lshr_b32 s55, s55, 16
    s_cmp_lt_u32 s57, s55
    s_cselect_b32 s54, 0, s54
    s_cmp_ge_u32 s54, 256
    s_cbranch_scc1 L_got_136
    s_sleep 8
    s_add_u32 s58, s58, 1
    s_cmp_lt_u32 s58, 1048576
    s_cbranch_scc1 L_ovl_134
    s_mov_b32 s68, 0x1000
L_ovs_135:
    s_sub_u32 s45, s68, 1
L_got_136:
    v_mov_b32 v2, s45
    v_mov_b32 v3, 0x7c00
    ds_write_b32 v3, v2
    s_waitcnt lgkmcnt(0)
L_tk_133:
    s_barrier
    v_mov_b32 v3, 0x7c00
    ds_read_b32 v2, v3
    s_mov_b32 s51, -1
    s_waitcnt lgkmcnt(0)
    v_readfirstlane_b32 s45, v2
    s_sub_u32 s42, s42, 0x7F4A7C15
    s_subb_u32 s43, s43, 0x9E3779B9
    s_cmp_lt_u32 s45, 256
    s_cbranch_scc1 L_dispatch
    s_endpgm
L_ldA0:
    buffer_load_dword v64, v30, s[32:35], s47 offen
    buffer_load_dword v65, v31, s[32:35], s47 offen
    s_add_u32 s47, s47, s48
    buffer_load_dword v66, v30, s[32:35], s47 offen
    buffer_load_dword v67, v31, s[32:35], s47 offen
    s_add_u32 s47, s47, s48
    buffer_load_dword v68, v30, s[32:35], s47 offen
    buffer_load_dword v69, v31, s[32:35], s47 offen
    s_add_u32 s47, s47, s48
    buffer_load_dword v70, v30, s[32:35], s47 offen
    buffer_load_dword v71, v31, s[32:35], s47 offen
    s_add_u32 s47, s47, s49
    buffer_load_dword v72, v30, s[32:35], s47 offen
    buffer_load_dword v73, v31, s[32:35], s47 offen
    s_add_u32 s47, s47, s48
    buffer_load_dword v74, v30, s[32:35], s47 offen
    buffer_load_dword v75, v31, s[32:35], s47 offen
    s_add_u32 s47, s47, s48
    buffer_load_dword v76, v30, s[32:35], s47 offen
    buffer_load_dword v77, v31, s[32:35], s47 offen
    s_add_u32 s47, s47, s48
    buffer_load_dword v78, v30, s[32:35], s47 offen
    buffer_load_dword v79, v31, s[32:35], s47 offen
    s_add_u32 s47, s47, s50
    buffer_load_dword v80, v30, s[32:35], s47 offen
    buffer_load_dword v81, v31, s[32:35], s47 offen
    s_add_u32 s47, s47, s48
    buffer_load_dword v82, v30, s[32:35], s47 offen
    buffer_load_dword v83, v31, s[32:35], s47 offen
    s_add_u32 s47, s47, s48
    buffer_load_dword v84, v30, s[32:35], s47 offen
    buffer_load_dword v85, v31, s[32:35], s47 offen
    s_add_u32 s47, s47, s48
    buffer_load_dword v86, v30, s[32:35], s47 offen
    buffer_load_dword v87, v31, s[32:35], s47 offen
    s_add_u32 s47, s47, s49
    buffer_load_dword v88, v30, s[32:35], s47 offen
    buffer_load_dword v89, v31, s[32:35], s47 offen
    s_add_u32 s47, s47, s48
    buffer_load_dword v90, v30, s[32:35], s47 offen
    buffer_load_dword v91, v31, s[32:35], s47 offen
    s_add_u32 s47, s47, s48
    buffer_load_dword v92, v30, s[32:35], s47 offen
    buffer_load_dword v93, v31, s[32:35], s47 offen
    s_add_u32 s47, s47, s48
    buffer_load_dword v94, v30, s[32:35], s47 offen
    buffer_load_dword v95, v31, s[32:35], s47 offen
    s_add_u32 s47, s47, s51
    buffer_load_dword v96, v30, s[32:35], s47 offen
    buffer_load_dword v97, v31, s[32:35], s47 offen
    s_add_u32 s47, s47, s48
    buffer_load_dword v98, v30, s[32:35], s47 offen
    buffer_load_dword v99, v31, s[32:35], s47 offen
    s_add_u32 s47, s47, s48
    buffer_load_dword v100, v30, s[32:35], s47 offen
    buffer_load_dword v101, v31, s[32:35], s47 offen
    s_add_u32 s47, s47, s48
    buffer_load_dword v102, v30, s[32:35], s47 offen
    buffer_load_dword v103, v31, s[32:35], s47 offen
    s_add_u32 s47, s47, s49
    buffer_load_dword v104, v30, s[32:35], s47 offen
    buffer_load_dword v105, v31, s[32:35], s47 offen
    s_add_u32 s47, s47, s48
    buffer_load_dword v106, v30, s[32:35], s47 offen
    buffer_load_dword v107, v31, s[32:35], s47 offen
    s_add_u32 s47, s47, s48
    buffer_load_dword v108, v30, s[32:35], s47 offen
    buffer_load_dword v109, v31, s[32:35], s47 offen
    s_add_u32 s47, s47, s48
    buffer_load_dword v110, v30, s[32:35], s47 offen
    buffer_load_dword v111, v31, s[32:35], s47 offen
    s_add_u32 s47, s47, s50
    buffer_load_dword v112, v30, s[32:35], s47 offen
    buffer_load_dword v113, v31, s[32:35], s47 offen
    s_add_u32 s47, s47, s48
    buffer_load_dword v114, v30, s[32:35], s47 offen
    buffer_load_dword v115, v31, s[32:35], s47 offen
    s_add_u32 s47, s47, s48
    buffer_load_dword v116, v30, s[32:35], s47 offen
    buffer_load_dword v117, v31, s[32:35], s47 offen
    s_add_u32 s47, s47, s48
    buffer_load_dword v118, v30, s[32:35], s47 offen
    buffer_load_dword v119, v31, s[32:35], s47 offen
    s_add_u32 s47, s47, s49
    buffer_load_dword v120, v30, s[32:35], s47 offen
    buffer_load_dword v121, v31, s[32:35], s47 offen
    s_add_u32 s47, s47, s48
    buffer_load_dword v122, v30, s[32:35], s47 offen
    buffer_load_dword v123, v31, s[32:35], s47 offen
    s_add_u32 s47, s47, s48
    s_waitcnt vmcnt(58)
    v_perm_b32 v124, v65, v64, s52
    v_perm_b32 v125, v65, v64, s53
    v_accvgpr_write_b32 a0, v124
    v_accvgpr_write_b32 a8, v125
    buffer_load_dword v64, v30, s[32:35], s47 offen
    buffer_load_dword v65, v31, s[32:35], s47 offen
    s_add_u32 s47, s47, s48
    s_waitcnt vmcnt(58)
    v_perm_b32 v126, v67, v66, s52
    v_perm_b32 v127, v67, v66, s53
    v_accvgpr_write_b32 a1, v126
    v_accvgpr_write_b32 a9, v127
    buffer_load_dword v66, v30, s[32:35], s47 offen
    buffer_load_dword v67, v31, s[32:35], s47 offen
    s_add_u32 s47, s47, s51
    s_waitcnt vmcnt(58)
    v_perm_b32 v124, v69, v68, s52
    v_perm_b32 v125, v69, v68, s53
    v_accvgpr_write_b32 a2, v124
    v_accvgpr_write_b32 a10, v125
    buffer_load_dword v68, v30, s[32:35], s47 offen
    buffer_load_dword v69, v31, s[32:35], s47 offen
    s_add_u32 s47, s47, s48
    s_waitcnt vmcnt(58)
    v_perm_b32 v126, v71, v70, s52
    v_perm_b32 v127, v71, v70, s53
    v_accvgpr_write_b32 a3, v126
    v_accvgpr_write_b32 a11, v127
    buffer_load_dword v70, v30, s[32:35], s47 offen
    buffer_load_dword v71, v31, s[32:35], s47 offen
    s_add_u32 s47, s47, s48
    s_waitcnt vmcnt(58)
    v_perm_b32 v124, v73, v72, s52
    v_perm_b32 v125, v73, v72, s53
    v_accvgpr_write_b32 a4, v124
    v_accvgpr_write_b32 a12, v125
    buffer_load_dword v72, v30, s[32:35], s47 offen
    buffer_load_dword v73, v31, s[32:35], s47 offen
    s_add_u32 s47, s47, s48
    s_waitcnt vmcnt(58)
    v_perm_b32 v126, v75, v74, s52
    v_perm_b32 v127, v75, v74, s53
    v_accvgpr_write_b32 a5, v126
    v_accvgpr_write_b32 a13, v127
    buffer_load_dword v74, v30, s[32:35], s47 offen
    buffer_load_dword v75, v31, s[32:35], s47 offen
    s_add_u32 s47, s47, s49
    s_waitcnt vmcnt(58)
    v_perm_b32 v124, v77, v76, s52
    v_perm_b32 v125, v77, v76, s53
    v_accvgpr_write_b32 a6, v124
    v_accvgpr_write_b32 a14, v125
    buffer_load_dword v76, v30, s[32:35], s47 offen
    buffer_load_dword v77, v31, s[32:35], s47 offen
    s_add_u32 s47, s47, s48
    s_waitcnt vmcnt(58)
    v_perm_b32 v126, v79, v78, s52
    v_perm_b32 v127, v79, v78, s53
    v_accvgpr_write_b32 a7, v126
    v_accvgpr_write_b32 a15, v127
    buffer_load_dword v78, v30, s[32:35], s47 offen
    buffer_load_dword v79, v31, s[32:35], s47 offen
    s_add_u32 s47, s47, s48
    s_waitcnt vmcnt(58)
    v_perm_b32 v124, v81, v80, s52
    v_perm_b32 v125, v81, v80, s53
    v_accvgpr_write_b32 a16, v124
    v_accvgpr_write_b32 a24, v125
    buffer_load_dword v80, v30, s[32:35], s47 offen
    buffer_load_dword v81, v31, s[32:35], s47 offen
    s_add_u32 s47, s47, s48
    s_waitcnt vmcnt(58)
    v_perm_b32 v126, v83, v82, s52
    v_perm_b32 v127, v83, v82, s53
    v_accvgpr_write_b32 a17, v126
    v_accvgpr_write_b32 a25, v127
    buffer_load_dword v82, v30, s[32:35], s47 offen
    buffer_load_dword v83, v31, s[32:35], s47 offen
    s_add_u32 s47, s47, s50
    s_waitcnt vmcnt(58)
    v_perm_b32 v124, v85, v84, s52
    v_perm_b32 v125, v85, v84, s53
    v_accvgpr_write_b32 a18, v124
    v_accvgpr_write_b32 a26, v125
    buffer_load_dword v84, v30, s[32:35], s47 offen
    buffer_load_dword v85, v31, s[32:35], s47 offen
    s_add_u32 s47, s47, s48
    s_waitcnt vmcnt(58)
    v_perm_b32 v126, v87, v86, s52
    v_perm_b32 v127, v87, v86, s53
    v_accvgpr_write_b32 a19, v126
    v_accvgpr_write_b32 a27, v127
    buffer_load_dword v86, v30, s[32:35], s47 offen
    buffer_load_dword v87, v31, s[32:35], s47 offen
    s_add_u32 s47, s47, s48
    s_waitcnt vmcnt(58)
    v_perm_b32 v124, v89, v88, s52
    v_perm_b32 v125, v89, v88, s53
    v_accvgpr_write_b32 a20, v124
    v_accvgpr_write_b32 a28, v125
    buffer_load_dword v88, v30, s[32:35], s47 offen
    buffer_load_dword v89, v31, s[32:35], s47 offen
    s_add_u32 s47, s47, s48
    s_waitcnt vmcnt(58)
    v_perm_b32 v126, v91, v90, s52
    v_perm_b32 v127, v91, v90, s53
    v_accvgpr_write_b32 a21, v126
    v_accvgpr_write_b32 a29, v127
    buffer_load_dword v90, v30, s[32:35], s47 offen
    buffer_load_dword v91, v31, s[32:35], s47 offen
    s_add_u32 s47, s47, s49
    s_waitcnt vmcnt(58)
    v_perm_b32 v124, v93, v92, s52
    v_perm_b32 v125, v93, v92, s53
    v_accvgpr_write_b32 a22, v124
    v_accvgpr_write_b32 a30, v125
    buffer_load_dword v92, v30, s[32:35], s47 offen
    buffer_load_dword v93, v31, s[32:35], s47 offen
    s_add_u32 s47, s47, s48
    s_waitcnt vmcnt(58)
    v_perm_b32 v126, v95, v94, s52
    v_perm_b32 v127, v95, v94, s53
    v_accvgpr_write_b32 a23, v126
    v_accvgpr_write_b32 a31, v127
    buffer_load_dword v94, v30, s[32:35], s47 offen
    buffer_load_dword v95, v31, s[32:35], s47 offen
    s_add_u32 s47, s47, s48
    s_waitcnt vmcnt(58)
    v_perm_b32 v124, v97, v96, s52
    v_perm_b32 v125, v97, v96, s53
    v_accvgpr_write_b32 a32, v124
    v_accvgpr_write_b32 a40, v125
    buffer_load_dword v96, v30, s[32:35], s47 offen
    buffer_load_dword v97, v31, s[32:35], s47 offen
    s_add_u32 s47, s47, s48
    s_waitcnt vmcnt(58)
    v_perm_b32 v126, v99, v98, s52
    v_perm_b32 v127, v99, v98, s53
    v_accvgpr_write_b32 a33, v126
    v_accvgpr_write_b32 a41, v127
    buffer_load_dword v98, v30, s[32:35], s47 offen
    buffer_load_dword v99, v31, s[32:35], s47 offen
    s_add_u32 s47, s47, s51
    s_waitcnt vmcnt(58)
    v_perm_b32 v124, v101, v100, s52
    v_perm_b32 v125, v101, v100, s53
    v_accvgpr_write_b32 a34, v124
    v_accvgpr_write_b32 a42, v125
    buffer_load_dword v100, v30, s[32:35], s47 offen
    buffer_load_dword v101, v31, s[32:35], s47 offen
    s_add_u32 s47, s47, s48
    s_waitcnt vmcnt(58)
    v_perm_b32 v126, v103, v102, s52
    v_perm_b32 v127, v103, v102, s53
    v_accvgpr_write_b32 a35, v126
    v_accvgpr_write_b32 a43, v127
    buffer_load_dword v102, v30, s[32:35], s47 offen
    buffer_load_dword v103, v31, s[32:35], s47 offen
    s_add_u32 s47, s47, s48
    s_waitcnt vmcnt(58)
    v_perm_b32 v124, v105, v104, s52
    v_perm_b32 v125, v105, v104, s53
    v_accvgpr_write_b32 a36, v124
    v_accvgpr_write_b32 a44, v125
    buffer_load_dword v104, v30, s[32:35], s47 offen
    buffer_load_dword v105, v31, s[32:35], s47 offen
    s_add_u32 s47, s47, s48
    s_waitcnt vmcnt(58)
    v_perm_b32 v126, v107, v106, s52
    v_perm_b32 v127, v107, v106, s53
    v_accvgpr_write_b32 a37, v126
    v_accvgpr_write_b32 a45, v127
    buffer_load_dword v106, v30, s[32:35], s47 offen
    buffer_load_dword v107, v31, s[32:35], s47 offen
    s_add_u32 s47, s47, s49
    s_waitcnt vmcnt(58)
    v_perm_b32 v124, v109, v108, s52
    v_perm_b32 v125, v109, v108, s53
    v_accvgpr_write_b32 a38, v124
    v_accvgpr_write_b32 a46, v125
    buffer_load_dword v108, v30, s[32:35], s47 offen
    buffer_load_dword v109, v31, s[32:35], s47 offen
    s_add_u32 s47, s47, s48
    s_waitcnt vmcnt(58)
    v_perm_b32 v126, v111, v110, s52
    v_perm_b32 v127, v111, v110, s53
    v_accvgpr_write_b32 a39, v126
    v_accvgpr_write_b32 a47, v127
    buffer_load_dword v110, v30, s[32:35], s47 offen
    buffer_load_dword v111, v31, s[32:35], s47 offen
    s_add_u32 s47, s47, s48
    s_waitcnt vmcnt(58)
    v_perm_b32 v124, v113, v112, s52
    v_perm_b32 v125, v113, v112, s53
    v_accvgpr_write_b32 a48, v124
    v_accvgpr_write_b32 a56, v125
    buffer_load_dword v112, v30, s[32:35], s47 offen
    buffer_load_dword v113, v31, s[32:35], s47 offen
    s_add_u32 s47, s47, s48
    s_waitcnt vmcnt(58)
    v_perm_b32 v126, v115, v114, s52
    v_perm_b32 v127, v115, v114, s53
    v_accvgpr_write_b32 a49, v126
    v_accvgpr_write_b32 a57, v127
    buffer_load_dword v114, v30, s[32:35], s47 offen
    buffer_load_dword v115, v31, s[32:35], s47 offen
    s_add_u32 s47, s47, s50
    s_waitcnt vmcnt(58)
    v_perm_b32 v124, v117, v116, s52
    v_perm_b32 v125, v117, v116, s53
    v_accvgpr_write_b32 a50, v124
    v_accvgpr_write_b32 a58, v125
    buffer_load_dword v116, v30, s[32:35], s47 offen
    buffer_load_dword v117, v31, s[32:35], s47 offen
    s_add_u32 s47, s47, s48
    s_waitcnt vmcnt(58)
    v_perm_b32 v126, v119, v118, s52
    v_perm_b32 v127, v119, v118, s53
    v_accvgpr_write_b32 a51, v126
    v_accvgpr_write_b32 a59, v127
    buffer_load_dword v118, v30, s[32:35], s47 offen
    buffer_load_dword v119, v31, s[32:35], s47 offen
    s_add_u32 s47, s47, s48
    s_waitcnt vmcnt(58)
    v_perm_b32 v124, v121, v120, s52
    v_perm_b32 v125, v121, v120, s53
    v_accvgpr_write_b32 a52, v124
    v_accvgpr_write_b32 a60, v125
    buffer_load_dword v120, v30, s[32:35], s47 offen
    buffer_load_dword v121, v31, s[32:35], s47 offen
    s_add_u32 s47, s47, s48
    s_waitcnt vmcnt(58)
    v_perm_b32 v126, v123, v122, s52
    v_perm_b32 v127, v123, v122, s53
    v_accvgpr_write_b32 a53, v126
    v_accvgpr_write_b32 a61, v127
    buffer_load_dword v122, v30, s[32:35], s47 offen
    buffer_load_dword v123, v31, s[32:35], s47 offen
    s_add_u32 s47, s47, s49
    s_waitcnt vmcnt(58)
    v_perm_b32 v124, v65, v64, s52
    v_perm_b32 v125, v65, v64, s53
    v_accvgpr_write_b32 a54, v124
    v_accvgpr_write_b32 a62, v125
    buffer_load_dword v64, v30, s[32:35], s47 offen
    buffer_load_dword v65, v31, s[32:35], s47 offen
    s_add_u32 s47, s47, s48
    s_waitcnt vmcnt(58)
    v_perm_b32 v126, v67, v66, s52
    v_perm_b32 v127, v67, v66, s53
    v_accvgpr_write_b32 a55, v126
    v_accvgpr_write_b32 a63, v127
    buffer_load_dword v66, v30, s[32:35], s47 offen
    buffer_load_dword v67, v31, s[32:35], s47 offen
    s_add_u32 s47, s47, s48
    s_waitcnt vmcnt(58)
    v_perm_b32 v124, v69, v68, s52
    v_perm_b32 v125, v69, v68, s53
    v_accvgpr_write_b32 a64, v124
    v_accvgpr_write_b32 a72, v125
    buffer_load_dword v68, v30, s[32:35], s47 offen
    buffer_load_dword v69, v31, s[32:35], s47 offen
    s_add_u32 s47, s47, s48
    s_waitcnt vmcnt(58)
    v_perm_b32 v126, v71, v70, s52
    v_perm_b32 v127, v71, v70, s53
    v_accvgpr_write_b32 a65, v126
    v_accvgpr_write_b32 a73, v127
    buffer_load_dword v70, v30, s[32:35], s47 offen
    buffer_load_dword v71, v31, s[32:35], s47 offen
    s_add_u32 s47, s47, s51
    s_waitcnt vmcnt(58)
    v_perm_b32 v124, v73, v72, s52
    v_perm_b32 v125, v73, v72, s53
    v_accvgpr_write_b32 a66, v124
    v_accvgpr_write_b32 a74, v125
    s_waitcnt vmcnt(56)
    v_perm_b32 v126, v75, v74, s52
    v_perm_b32 v127, v75, v74, s53
    v_accvgpr_write_b32 a67, v126
    v_accvgpr_write_b32 a75, v127
    s_waitcnt vmcnt(54)
    v_perm_b32 v124, v77, v76, s52
    v_perm_b32 v125, v77, v76, s53
    v_accvgpr_write_b32 a68, v124
    v_accvgpr_write_b32 a76, v125
    s_waitcnt vmcnt(52)
    v_perm_b32 v126, v79, v78, s52
    v_perm_b32 v127, v79, v78, s53
    v_accvgpr_write_b32 a69, v126
    v_accvgpr_write_b32 a77, v127
    s_waitcnt vmcnt(50)
    v_perm_b32 v124, v81, v80, s52
    v_perm_b32 v125, v81, v80, s53
    v_accvgpr_write_b32 a70, v124
    v_accvgpr_write_b32 a78, v125
    s_waitcnt vmcnt(48)
    v_perm_b32 v126, v83, v82, s52
    v_perm_b32 v127, v83, v82, s53
    v_accvgpr_write_b32 a71, v126
    v_accvgpr_write_b32 a79, v127
    s_waitcnt vmcnt(46)
    v_perm_b32 v124, v85, v84, s52
    v_perm_b32 v125, v85, v84, s53
    v_accvgpr_write_b32 a80, v124
    v_accvgpr_write_b32 a88, v125
    s_waitcnt vmcnt(44)
    v_perm_b32 v126, v87, v86, s52
    v_perm_b32 v127, v87, v86, s53
    v_accvgpr_write_b32 a81, v126
    v_accvgpr_write_b32 a89, v127
    s_waitcnt vmcnt(42)
    v_perm_b32 v124, v89, v88, s52
    v_perm_b32 v125, v89, v88, s53
    v_accvgpr_write_b32 a82, v124
    v_accvgpr_write_b32 a90, v125
    s_waitcnt vmcnt(40)
    v_perm_b32 v126, v91, v90, s52
    v_perm_b32 v127, v91, v90, s53
    v_accvgpr_write_b32 a83, v126
    v_accvgpr_write_b32 a91, v127
    s_waitcnt vmcnt(38)
    v_perm_b32 v124, v93, v92, s52
    v_perm_b32 v125, v93, v92, s53
    v_accvgpr_write_b32 a84, v124
    v_accvgpr_write_b32 a92, v125
    s_waitcnt vmcnt(36)
    v_perm_b32 v126, v95, v94, s52
    v_perm_b32 v127, v95, v94, s53
    v_accvgpr_write_b32 a85, v126
    v_accvgpr_write_b32 a93, v127
    s_waitcnt vmcnt(34)
    v_perm_b32 v124, v97, v96, s52
    v_perm_b32 v125, v97, v96, s53
    v_accvgpr_write_b32 a86, v124
    v_accvgpr_write_b32 a94, v125
    s_waitcnt vmcnt(32)
    v_perm_b32 v126, v99, v98, s52
    v_perm_b32 v127, v99, v98, s53
    v_accvgpr_write_b32 a87, v126
    v_accvgpr_write_b32 a95, v127
    s_waitcnt vmcnt(30)
    v_perm_b32 v124, v101, v100, s52
    v_perm_b32 v125, v101, v100, s53
    v_accvgpr_write_b32 a96, v124
    v_accvgpr_write_b32 a104, v125
    s_waitcnt vmcnt(28)
    v_perm_b32 v126, v103, v102, s52
    v_perm_b32 v127, v103, v102, s53
    v_accvgpr_write_b32 a97, v126
    v_accvgpr_write_b32 a105, v127
    s_waitcnt vmcnt(26)
    v_perm_b32 v124, v105, v104, s52
    v_perm_b32 v125, v105, v104, s53
    v_accvgpr_write_b32 a98, v124
    v_accvgpr_write_b32 a106, v125
    s_waitcnt vmcnt(24)
    v_perm_b32 v126, v107, v106, s52
    v_perm_b32 v127, v107, v106, s53
    v_accvgpr_write_b32 a99, v126
    v_accvgpr_write_b32 a107, v127
    s_waitcnt vmcnt(22)
    v_perm_b32 v124, v109, v108, s52
    v_perm_b32 v125, v109, v108, s53
    v_accvgpr_write_b32 a100, v124
    v_accvgpr_write_b32 a108, v125
    s_waitcnt vmcnt(20)
    v_perm_b32 v126, v111, v110, s52
    v_perm_b32 v127, v111, v110, s53
    v_accvgpr_write_b32 a101, v126
    v_accvgpr_write_b32 a109, v127
    s_waitcnt vmcnt(18)
    v_perm_b32 v124, v113, v112, s52
    v_perm_b32 v125, v113, v112, s53
    v_accvgpr_write_b32 a102, v124
    v_accvgpr_write_b32 a110, v125
    s_waitcnt vmcnt(16)
    v_perm_b32 v126, v115, v114, s52
    v_perm_b32 v127, v115, v114, s53
    v_accvgpr_write_b32 a103, v126
    v_accvgpr_write_b32 a111, v127
    s_waitcnt vmcnt(14)
    v_perm_b32 v124, v117, v116, s52
    v_perm_b32 v125, v117, v116, s53
    v_accvgpr_write_b32 a112, v124
    v_accvgpr_write_b32 a120, v125
    s_waitcnt vmcnt(12)
    v_perm_b32 v126, v119, v118, s52
    v_perm_b32 v127, v119, v118, s53
    v_accvgpr_write_b32 a113, v126
    v_accvgpr_write_b32 a121, v127
    s_waitcnt vmcnt(10)
    v_perm_b32 v124, v121, v120, s52
    v_perm_b32 v125, v121, v120, s53
    v_accvgpr_write_b32 a114, v124
    v_accvgpr_write_b32 a122, v125
    s_waitcnt vmcnt(8)
    v_perm_b32 v126, v123, v122, s52
    v_perm_b32 v127, v123, v122, s53
    v_accvgpr_write_b32 a115, v126
    v_accvgpr_write_b32 a123, v127
    s_waitcnt vmcnt(6)
    v_perm_b32 v124, v65, v64, s52
    v_perm_b32 v125, v65, v64, s53
    v_accvgpr_write_b32 a116, v124
    v_accvgpr_write_b32 a124, v125
    s_waitcnt vmcnt(4)
    v_perm_b32 v126, v67, v66, s52
    v_perm_b32 v127, v67, v66, s53
    v_accvgpr_write_b32 a117, v126
    v_accvgpr_write_b32 a125, v127
    s_waitcnt vmcnt(2)
    v_perm_b32 v124, v69, v68, s52
    v_perm_b32 v125, v69, v68, s53
    v_accvgpr_write_b32 a118, v124
    v_accvgpr_write_b32 a126, v125
    s_waitcnt vmcnt(0)
    v_perm_b32 v126, v71, v70, s52
    v_perm_b32 v127, v71, v70, s53
    v_accvgpr_write_b32 a119, v126
    v_accvgpr_write_b32 a127, v127
    s_nop 4
    s_setpc_b64 s[40:41]
L_ldA1:
    buffer_load_dword v64, v30, s[32:35], s47 offen
    buffer_load_dword v65, v31, s[32:35], s47 offen
    s_add_u32 s47, s47, s48
    buffer_load_dword v66, v30, s[32:35], s47 offen
    buffer_load_dword v67, v31, s[32:35], s47 offen
    s_add_u32 s47, s47, s48
    buffer_load_dword v68, v30, s[32:35], s47 offen
    buffer_load_dword v69, v31, s[32:35], s47 offen
    s_add_u32 s47, s47, s48
    buffer_load_dword v70, v30, s[32:35], s47 offen
    buffer_load_dword v71, v31, s[32:35], s47 offen
    s_add_u32 s47, s47, s49
    buffer_load_dword v72, v30, s[32:35], s47 offen
    buffer_load_dword v73, v31, s[32:35], s47 offen
    s_add_u32 s47, s47, s48
    buffer_load_dword v74, v30, s[32:35], s47 offen
    buffer_load_dword v75, v31, s[32:35], s47 offen
    s_add_u32 s47, s47, s48
    buffer_load_dword v76, v30, s[32:35], s47 offen
    buffer_load_dword v77, v31, s[32:35], s47 offen
    s_add_u32 s47, s47, s48
    buffer_load_dword v78, v30, s[32:35], s47 offen
    buffer_load_dword v79, v31, s[32:35], s47 offen
    s_add_u32 s47, s47, s50
    buffer_load_dword v80, v30, s[32:35], s47 offen
    buffer_load_dword v81, v31, s[32:35], s47 offen
    s_add_u32 s47, s47, s48
    buffer_load_dword v82, v30, s[32:35], s47 offen
    buffer_load_dword v83, v31, s[32:35], s47 offen
    s_add_u32 s47, s47, s48
    buffer_load_dword v84, v30, s[32:35], s47 offen
    buffer_load_dword v85, v31, s[32:35], s47 offen
    s_add_u32 s47, s47, s48
    buffer_load_dword v86, v30, s[32:35], s47 offen
    buffer_load_dword v87, v31, s[32:35], s47 offen
    s_add_u32 s47, s47, s49
    buffer_load_dword v88, v30, s[32:35], s47 offen
    buffer_load_dword v89, v31, s[32:35], s47 offen
    s_add_u32 s47, s47, s48
    buffer_load_dword v90, v30, s[32:35], s47 offen
    buffer_load_dword v91, v31, s[32:35], s47 offen
    s_add_u32 s47, s47, s48
    buffer_load_dword v92, v30, s[32:35], s47 offen
    buffer_load_dword v93, v31, s[32:35], s47 offen
    s_add_u32 s47, s47, s48
    buffer_load_dword v94, v30, s[32:35], s47 offen
    buffer_load_dword v95, v31, s[32:35], s47 offen
    s_add_u32 s47, s47, s51
    buffer_load_dword v96, v30, s[32:35], s47 offen
    buffer_load_dword v97, v31, s[32:35], s47 offen
    s_add_u32 s47, s47, s48
    buffer_load_dword v98, v30, s[32:35], s47 offen
    buffer_load_dword v99, v31, s[32:35], s47 offen
    s_add_u32 s47, s47, s48
    buffer_load_dword v100, v30, s[32:35], s47 offen
    buffer_load_dword v101, v31, s[32:35], s47 offen
    s_add_u32 s47, s47, s48
    buffer_load_dword v102, v30, s[32:35], s47 offen
    buffer_load_dword v103, v31, s[32:35], s47 offen
    s_add_u32 s47, s47, s49
    buffer_load_dword v104, v30, s[32:35], s47 offen
    buffer_load_dword v105, v31, s[32:35], s47 offen
    s_add_u32 s47, s47, s48
    buffer_load_dword v106, v30, s[32:35], s47 offen
    buffer_load_dword v107, v31, s[32:35], s47 offen
    s_add_u32 s47, s47, s48
    buffer_load_dword v108, v30, s[32:35], s47 offen
    buffer_load_dword v109, v31, s[32:35], s47 offen
    s_add_u32 s47, s47, s48
    buffer_load_dword v110, v30, s[32:35], s47 offen
    buffer_load_dword v111, v31, s[32:35], s47 offen
    s_add_u32 s47, s47, s50
    buffer_load_dword v112, v30, s[32:35], s47 offen
    buffer_load_dword v113, v31, s[32:35], s47 offen
    s_add_u32 s47, s47, s48
    buffer_load_dword v114, v30, s[32:35], s47 offen
    buffer_load_dword v115, v31, s[32:35], s47 offen
    s_add_u32 s47, s47, s48
    buffer_load_dword v116, v30, s[32:35], s47 offen
    buffer_load_dword v117, v31, s[32:35], s47 offen
    s_add_u32 s47, s47, s48
    buffer_load_dword v118, v30, s[32:35], s47 offen
    buffer_load_dword v119, v31, s[32:35], s47 offen
    s_add_u32 s47, s47, s49
    buffer_load_dword v120, v30, s[32:35], s47 offen
    buffer_load_dword v121, v31, s[32:35], s47 offen
    s_add_u32 s47, s47, s48
    buffer_load_dword v122, v30, s[32:35], s47 offen
    buffer_load_dword v123, v31, s[32:35], s47 offen
    s_add_u32 s47, s47, s48
    s_waitcnt vmcnt(58)
    v_perm_b32 v124, v65, v64, s52
    v_perm_b32 v125, v65, v64, s53
    v_accvgpr_write_b32 a128, v124
    v_accvgpr_write_b32 a136, v125
    buffer_load_dword v64, v30, s[32:35], s47 offen
    buffer_load_dword v65, v31, s[32:35], s47 offen
    s_add_u32 s47, s47, s48
    s_waitcnt vmcnt(58)
    v_perm_b32 v126, v67, v66, s52
    v_perm_b32 v127, v67, v66, s53
    v_accvgpr_write_b32 a129, v126
    v_accvgpr_write_b32 a137, v127
    buffer_load_dword v66, v30, s[32:35], s47 offen
    buffer_load_dword v67, v31, s[32:35], s47 offen
    s_add_u32 s47, s47, s51
    s_waitcnt vmcnt(58)
    v_perm_b32 v124, v69, v68, s52
    v_perm_b32 v125, v69, v68, s53
    v_accvgpr_write_b32 a130, v124
    v_accvgpr_write_b32 a138, v125
    buffer_load_dword v68, v30, s[32:35], s47 offen
    buffer_load_dword v69, v31, s[32:35], s47 offen
    s_add_u32 s47, s47, s48
    s_waitcnt vmcnt(58)
    v_perm_b32 v126, v71, v70, s52
    v_perm_b32 v127, v71, v70, s53
    v_accvgpr_write_b32 a131, v126
    v_accvgpr_write_b32 a139, v127
    buffer_load_dword v70, v30, s[32:35], s47 offen
    buffer_load_dword v71, v31, s[32:35], s47 offen
    s_add_u32 s47, s47, s48
    s_waitcnt vmcnt(58)
    v_perm_b32 v124, v73, v72, s52
    v_perm_b32 v125, v73, v72, s53
    v_accvgpr_write_b32 a132, v124
    v_accvgpr_write_b32 a140, v125
    buffer_load_dword v72, v30, s[32:35], s47 offen
    buffer_load_dword v73, v31, s[32:35], s47 offen
    s_add_u32 s47, s47, s48
    s_waitcnt vmcnt(58)
    v_perm_b32 v126, v75, v74, s52
    v_perm_b32 v127, v75, v74, s53
    v_accvgpr_write_b32 a133, v126
    v_accvgpr_write_b32 a141, v127
    buffer_load_dword v74, v30, s[32:35], s47 offen
    buffer_load_dword v75, v31, s[32:35], s47 offen
    s_add_u32 s47, s47, s49
    s_waitcnt vmcnt(58)
    v_perm_b32 v124, v77, v76, s52
    v_perm_b32 v125, v77, v76, s53
    v_accvgpr_write_b32 a134, v124
    v_accvgpr_write_b32 a142, v125
    buffer_load_dword v76, v30, s[32:35], s47 offen
    buffer_load_dword v77, v31, s[32:35], s47 offen
    s_add_u32 s47, s47, s48
    s_waitcnt vmcnt(58)
    v_perm_b32 v126, v79, v78, s52
    v_perm_b32 v127, v79, v78, s53
    v_accvgpr_write_b32 a135, v126
    v_accvgpr_write_b32 a143, v127
    buffer_load_dword v78, v30, s[32:35], s47 offen
    buffer_load_dword v79, v31, s[32:35], s47 offen
    s_add_u32 s47, s47, s48
    s_waitcnt vmcnt(58)
    v_perm_b32 v124, v81, v80, s52
    v_perm_b32 v125, v81, v80, s53
    v_accvgpr_write_b32 a144, v124
    v_accvgpr_write_b32 a152, v125
    buffer_load_dword v80, v30, s[32:35], s47 offen
    buffer_load_dword v81, v31, s[32:35], s47 offen
    s_add_u32 s47, s47, s48
    s_waitcnt vmcnt(58)
    v_perm_b32 v126, v83, v82, s52
    v_perm_b32 v127, v83, v82, s53
    v_accvgpr_write_b32 a145, v126
    v_accvgpr_write_b32 a153, v127
    buffer_load_dword v82, v30, s[32:35], s47 offen
    buffer_load_dword v83, v31, s[32:35], s47 offen
    s_add_u32 s47, s47, s50
    s_waitcnt vmcnt(58)
    v_perm_b32 v124, v85, v84, s52
    v_perm_b32 v125, v85, v84, s53
    v_accvgpr_write_b32 a146, v124
    v_accvgpr_write_b32 a154, v125
    buffer_load_dword v84, v30, s[32:35], s47 offen
    buffer_load_dword v85, v31, s[32:35], s47 offen
    s_add_u32 s47, s47, s48
    s_waitcnt vmcnt(58)
    v_perm_b32 v126, v87, v86, s52
    v_perm_b32 v127, v87, v86, s53
    v_accvgpr_write_b32 a147, v126
    v_accvgpr_write_b32 a155, v127
    buffer_load_dword v86, v30, s[32:35], s47 offen
    buffer_load_dword v87, v31, s[32:35], s47 offen
    s_add_u32 s47, s47, s48
    s_waitcnt vmcnt(58)
    v_perm_b32 v124, v89, v88, s52
    v_perm_b32 v125, v89, v88, s53
    v_accvgpr_write_b32 a148, v124
    v_accvgpr_write_b32 a156, v125
    buffer_load_dword v88, v30, s[32:35], s47 offen
    buffer_load_dword v89, v31, s[32:35], s47 offen
    s_add_u32 s47, s47, s48
    s_waitcnt vmcnt(58)
    v_perm_b32 v126, v91, v90, s52
    v_perm_b32 v127, v91, v90, s53
    v_accvgpr_write_b32 a149, v126
    v_accvgpr_write_b32 a157, v127
    buffer_load_dword v90, v30, s[32:35], s47 offen
    buffer_load_dword v91, v31, s[32:35], s47 offen
    s_add_u32 s47, s47, s49
    s_waitcnt vmcnt(58)
    v_perm_b32 v124, v93, v92, s52
    v_perm_b32 v125, v93, v92, s53
    v_accvgpr_write_b32 a150, v124
    v_accvgpr_write_b32 a158, v125
    buffer_load_dword v92, v30, s[32:35], s47 offen
    buffer_load_dword v93, v31, s[32:35], s47 offen
    s_add_u32 s47, s47, s48
    s_waitcnt vmcnt(58)
    v_perm_b32 v126, v95, v94, s52
    v_perm_b32 v127, v95, v94, s53
    v_accvgpr_write_b32 a151, v126
    v_accvgpr_write_b32 a159, v127
    buffer_load_dword v94, v30, s[32:35], s47 offen
    buffer_load_dword v95, v31, s[32:35], s47 offen
    s_add_u32 s47, s47, s48
    s_waitcnt vmcnt(58)
    v_perm_b32 v124, v97, v96, s52
    v_perm_b32 v125, v97, v96, s53
    v_accvgpr_write_b32 a160, v124
    v_accvgpr_write_b32 a168, v125
    buffer_load_dword v96, v30, s[32:35], s47 offen
    buffer_load_dword v97, v31, s[32:35], s47 offen
    s_add_u32 s47, s47, s48
    s_waitcnt vmcnt(58)
    v_perm_b32 v126, v99, v98, s52
    v_perm_b32 v127, v99, v98, s53
    v_accvgpr_write_b32 a161, v126
    v_accvgpr_write_b32 a169, v127
    buffer_load_dword v98, v30, s[32:35], s47 offen
    buffer_load_dword v99, v31, s[32:35], s47 offen
    s_add_u32 s47, s47, s51
    s_waitcnt vmcnt(58)
    v_perm_b32 v124, v101, v100, s52
    v_perm_b32 v125, v101, v100, s53
    v_accvgpr_write_b32 a162, v124
    v_accvgpr_write_b32 a170, v125
    buffer_load_dword v100, v30, s[32:35], s47 offen
    buffer_load_dword v101, v31, s[32:35], s47 offen
    s_add_u32 s47, s47, s48
    s_waitcnt vmcnt(58)
    v_perm_b32 v126, v103, v102, s52
    v_perm_b32 v127, v103, v102, s53
    v_accvgpr_write_b32 a163, v126
    v_accvgpr_write_b32 a171, v127
    buffer_load_dword v102, v30, s[32:35], s47 offen
    buffer_load_dword v103, v31, s[32:35], s47 offen
    s_add_u32 s47, s47, s48
    s_waitcnt vmcnt(58)
    v_perm_b32 v124, v105, v104, s52
    v_perm_b32 v125, v105, v104, s53
    v_accvgpr_write_b32 a164, v124
    v_accvgpr_write_b32 a172, v125
    buffer_load_dword v104, v30, s[32:35], s47 offen
    buffer_load_dword v105, v31, s[32:35], s47 offen
    s_add_u32 s47, s47, s48
    s_waitcnt vmcnt(58)
    v_perm_b32 v126, v107, v106, s52
    v_perm_b32 v127, v107, v106, s53
    v_accvgpr_write_b32 a165, v126
    v_accvgpr_write_b32 a173, v127
    buffer_load_dword v106, v30, s[32:35], s47 offen
    buffer_load_dword v107, v31, s[32:35], s47 offen
    s_add_u32 s47, s47, s49
    s_waitcnt vmcnt(58)
    v_perm_b32 v124, v109, v108, s52
    v_perm_b32 v125, v109, v108, s53
    v_accvgpr_write_b32 a166, v124
    v_accvgpr_write_b32 a174, v125
    buffer_load_dword v108, v30, s[32:35], s47 offen
    buffer_load_dword v109, v31, s[32:35], s47 offen
    s_add_u32 s47, s47, s48
    s_waitcnt vmcnt(58)
    v_perm_b32 v126, v111, v110, s52
    v_perm_b32 v127, v111, v110, s53
    v_accvgpr_write_b32 a167, v126
    v_accvgpr_write_b32 a175, v127
    buffer_load_dword v110, v30, s[32:35], s47 offen
    buffer_load_dword v111, v31, s[32:35], s47 offen
    s_add_u32 s47, s47, s48
    s_waitcnt vmcnt(58)
    v_perm_b32 v124, v113, v112, s52
    v_perm_b32 v125, v113, v112, s53
    v_accvgpr_write_b32 a176, v124
    v_accvgpr_write_b32 a184, v125
    buffer_load_dword v112, v30, s[32:35], s47 offen
    buffer_load_dword v113, v31, s[32:35], s47 offen
    s_add_u32 s47, s47, s48
    s_waitcnt vmcnt(58)
    v_perm_b32 v126, v115, v114, s52
    v_perm_b32 v127, v115, v114, s53
    v_accvgpr_write_b32 a177, v126
    v_accvgpr_write_b32 a185, v127
    buffer_load_dword v114, v30, s[32:35], s47 offen
    buffer_load_dword v115, v31, s[32:35], s47 offen
    s_add_u32 s47, s47, s50
    s_waitcnt vmcnt(58)
    v_perm_b32 v124, v117, v116, s52
    v_perm_b32 v125, v117, v116, s53
    v_accvgpr_write_b32 a178, v124
    v_accvgpr_write_b32 a186, v125
    buffer_load_dword v116, v30, s[32:35], s47 offen
    buffer_load_dword v117, v31, s[32:35], s47 offen
    s_add_u32 s47, s47, s48
    s_waitcnt vmcnt(58)
    v_perm_b32 v126, v119, v118, s52
    v_perm_b32 v127, v119, v118, s53
    v_accvgpr_write_b32 a179, v126
    v_accvgpr_write_b32 a187, v127
    buffer_load_dword v118, v30, s[32:35], s47 offen
    buffer_load_dword v119, v31, s[32:35], s47 offen
    s_add_u32 s47, s47, s48
    s_waitcnt vmcnt(58)
    v_perm_b32 v124, v121, v120, s52
    v_perm_b32 v125, v121, v120, s53
    v_accvgpr_write_b32 a180, v124
    v_accvgpr_write_b32 a188, v125
    buffer_load_dword v120, v30, s[32:35], s47 offen
    buffer_load_dword v121, v31, s[32:35], s47 offen
    s_add_u32 s47, s47, s48
    s_waitcnt vmcnt(58)
    v_perm_b32 v126, v123, v122, s52
    v_perm_b32 v127, v123, v122, s53
    v_accvgpr_write_b32 a181, v126
    v_accvgpr_write_b32 a189, v127
    buffer_load_dword v122, v30, s[32:35], s47 offen
    buffer_load_dword v123, v31, s[32:35], s47 offen
    s_add_u32 s47, s47, s49
    s_waitcnt vmcnt(58)
    v_perm_b32 v124, v65, v64, s52
    v_perm_b32 v125, v65, v64, s53
    v_accvgpr_write_b32 a182, v124
    v_accvgpr_write_b32 a190, v125
    buffer_load_dword v64, v30, s[32:35], s47 offen
    buffer_load_dword v65, v31, s[32:35], s47 offen
    s_add_u32 s47, s47, s48
    s_waitcnt vmcnt(58)
    v_perm_b32 v126, v67, v66, s52
    v_perm_b32 v127, v67, v66, s53
    v_accvgpr_write_b32 a183, v126
    v_accvgpr_write_b32 a191, v127
    buffer_load_dword v66, v30, s[32:35], s47 offen
    buffer_load_dword v67, v31, s[32:35], s47 offen
    s_add_u32 s47, s47, s48
    s_waitcnt vmcnt(58)
    v_perm_b32 v124, v69, v68, s52
    v_perm_b32 v125, v69, v68, s53
    v_accvgpr_write_b32 a192, v124
    v_accvgpr_write_b32 a200, v125
    buffer_load_dword v68, v30, s[32:35], s47 offen
    buffer_load_dword v69, v31, s[32:35], s47 offen
    s_add_u32 s47, s47, s48
    s_waitcnt vmcnt(58)
    v_perm_b32 v126, v71, v70, s52
    v_perm_b32 v127, v71, v70, s53
    v_accvgpr_write_b32 a193, v126
    v_accvgpr_write_b32 a201, v127
    buffer_load_dword v70, v30, s[32:35], s47 offen
    buffer_load_dword v71, v31, s[32:35], s47 offen
    s_add_u32 s47, s47, s51
    s_waitcnt vmcnt(58)
    v_perm_b32 v124, v73, v72, s52
    v_perm_b32 v125, v73, v72, s53
    v_accvgpr_write_b32 a194, v124
    v_accvgpr_write_b32 a202, v125
    s_waitcnt vmcnt(56)
    v_perm_b32 v126, v75, v74, s52
    v_perm_b32 v127, v75, v74, s53
    v_accvgpr_write_b32 a195, v126
    v_accvgpr_write_b32 a203, v127
    s_waitcnt vmcnt(54)
    v_perm_b32 v124, v77, v76, s52
    v_perm_b32 v125, v77, v76, s53
    v_accvgpr_write_b32 a196, v124
    v_accvgpr_write_b32 a204, v125
    s_waitcnt vmcnt(52)
    v_perm_b32 v126, v79, v78, s52
    v_perm_b32 v127, v79, v78, s53
    v_accvgpr_write_b32 a197, v126
    v_accvgpr_write_b32 a205, v127
    s_waitcnt vmcnt(50)
    v_perm_b32 v124, v81, v80, s52
    v_perm_b32 v125, v81, v80, s53
    v_accvgpr_write_b32 a198, v124
    v_accvgpr_write_b32 a206, v125
    s_waitcnt vmcnt(48)
    v_perm_b32 v126, v83, v82, s52
    v_perm_b32 v127, v83, v82, s53
    v_accvgpr_write_b32 a199, v126
    v_accvgpr_write_b32 a207, v127
    s_waitcnt vmcnt(46)
    v_perm_b32 v124, v85, v84, s52
    v_perm_b32 v125, v85, v84, s53
    v_accvgpr_write_b32 a208, v124
    v_accvgpr_write_b32 a216, v125
    s_waitcnt vmcnt(44)
    v_perm_b32 v126, v87, v86, s52
    v_perm_b32 v127, v87, v86, s53
    v_accvgpr_write_b32 a209, v126
    v_accvgpr_write_b32 a217, v127
    s_waitcnt vmcnt(42)
    v_perm_b32 v124, v89, v88, s52
    v_perm_b32 v125, v89, v88, s53
    v_accvgpr_write_b32 a210, v124
    v_accvgpr_write_b32 a218, v125
    s_waitcnt vmcnt(40)
    v_perm_b32 v126, v91, v90, s52
    v_perm_b32 v127, v91, v90, s53
    v_accvgpr_write_b32 a211, v126
    v_accvgpr_write_b32 a219, v127
    s_waitcnt vmcnt(38)
    v_perm_b32 v124, v93, v92, s52
    v_perm_b32 v125, v93, v92, s53
    v_accvgpr_write_b32 a212, v124
    v_accvgpr_write_b32 a220, v125
    s_waitcnt vmcnt(36)
    v_perm_b32 v126, v95, v94, s52
    v_perm_b32 v127, v95, v94, s53
    v_accvgpr_write_b32 a213, v126
    v_accvgpr_write_b32 a221, v127
    s_waitcnt vmcnt(34)
    v_perm_b32 v124, v97, v96, s52
    v_perm_b32 v125, v97, v96, s53
    v_accvgpr_write_b32 a214, v124
    v_accvgpr_write_b32 a222, v125
    s_waitcnt vmcnt(32)
    v_perm_b32 v126, v99, v98, s52
    v_perm_b32 v127, v99, v98, s53
    v_accvgpr_write_b32 a215, v126
    v_accvgpr_write_b32 a223, v127
    s_waitcnt vmcnt(30)
    v_perm_b32 v124, v101, v100, s52
    v_perm_b32 v125, v101, v100, s53
    v_accvgpr_write_b32 a224, v124
    v_accvgpr_write_b32 a232, v125
    s_waitcnt vmcnt(28)
    v_perm_b32 v126, v103, v102, s52
    v_perm_b32 v127, v103, v102, s53
    v_accvgpr_write_b32 a225, v126
    v_accvgpr_write_b32 a233, v127
    s_waitcnt vmcnt(26)
    v_perm_b32 v124, v105, v104, s52
    v_perm_b32 v125, v105, v104, s53
    v_accvgpr_write_b32 a226, v124
    v_accvgpr_write_b32 a234, v125
    s_waitcnt vmcnt(24)
    v_perm_b32 v126, v107, v106, s52
    v_perm_b32 v127, v107, v106, s53
    v_accvgpr_write_b32 a227, v126
    v_accvgpr_write_b32 a235, v127
    s_waitcnt vmcnt(22)
    v_perm_b32 v124, v109, v108, s52
    v_perm_b32 v125, v109, v108, s53
    v_accvgpr_write_b32 a228, v124
    v_accvgpr_write_b32 a236, v125
    s_waitcnt vmcnt(20)
    v_perm_b32 v126, v111, v110, s52
    v_perm_b32 v127, v111, v110, s53
    v_accvgpr_write_b32 a229, v126
    v_accvgpr_write_b32 a237, v127
    s_waitcnt vmcnt(18)
    v_perm_b32 v124, v113, v112, s52
    v_perm_b32 v125, v113, v112, s53
    v_accvgpr_write_b32 a230, v124
    v_accvgpr_write_b32 a238, v125
    s_waitcnt vmcnt(16)
    v_perm_b32 v126, v115, v114, s52
    v_perm_b32 v127, v115, v114, s53
    v_accvgpr_write_b32 a231, v126
    v_accvgpr_write_b32 a239, v127
    s_waitcnt vmcnt(14)
    v_perm_b32 v124, v117, v116, s52
    v_perm_b32 v125, v117, v116, s53
    v_accvgpr_write_b32 a240, v124
    v_accvgpr_write_b32 a248, v125
    s_waitcnt vmcnt(12)
    v_perm_b32 v126, v119, v118, s52
    v_perm_b32 v127, v119, v118, s53
    v_accvgpr_write_b32 a241, v126
    v_accvgpr_write_b32 a249, v127
    s_waitcnt vmcnt(10)
    v_perm_b32 v124, v121, v120, s52
    v_perm_b32 v125, v121, v120, s53
    v_accvgpr_write_b32 a242, v124
    v_accvgpr_write_b32 a250, v125
    s_waitcnt vmcnt(8)
    v_perm_b32 v126, v123, v122, s52
    v_perm_b32 v127, v123, v122, s53
    v_accvgpr_write_b32 a243, v126
    v_accvgpr_write_b32 a251, v127
    s_waitcnt vmcnt(6)
    v_perm_b32 v124, v65, v64, s52
    v_perm_b32 v125, v65, v64, s53
    v_accvgpr_write_b32 a244, v124
    v_accvgpr_write_b32 a252, v125
    s_waitcnt vmcnt(4)
    v_perm_b32 v126, v67, v66, s52
    v_perm_b32 v127, v67, v66, s53
    v_accvgpr_write_b32 a245, v126
    v_accvgpr_write_b32 a253, v127
    s_waitcnt vmcnt(2)
    v_perm_b32 v124, v69, v68, s52
    v_perm_b32 v125, v69, v68, s53
    v_accvgpr_write_b32 a246, v124
    v_accvgpr_write_b32 a254, v125
    s_waitcnt vmcnt(0)
    v_perm_b32 v126, v71, v70, s52
    v_perm_b32 v127, v71, v70, s53
    v_accvgpr_write_b32 a247, v126
    v_accvgpr_write_b32 a255, v127
    s_nop 4
    s_setpc_b64 s[40:41]
L_ldV:
    buffer_load_dword v64, v30, s[32:35], s47 offen
    buffer_load_dword v65, v31, s[32:35], s47 offen
    s_add_u32 s47, s47, s48
    buffer_load_dword v66, v30, s[32:35], s47 offen
    buffer_load_dword v67, v31, s[32:35], s47 offen
    s_add_u32 s47, s47, s48
    buffer_load_dword v68, v30, s[32:35], s47 offen
    buffer_load_dword v69, v31, s[32:35], s47 offen
    s_add_u32 s47, s47, s48
    buffer_load_dword v70, v30, s[32:35], s47 offen
    buffer_load_dword v71, v31, s[32:35], s47 offen
    s_add_u32 s47, s47, s49
    buffer_load_dword v72, v30, s[32:35], s47 offen
    buffer_load_dword v73, v31, s[32:35], s47 offen
    s_add_u32 s47, s47, s48
    buffer_load_dword v74, v30, s[32:35], s47 offen
    buffer_load_dword v75, v31, s[32:35], s47 offen
    s_add_u32 s47, s47, s48
    buffer_load_dword v76, v30, s[32:35], s47 offen
    buffer_load_dword v77, v31, s[32:35], s47 offen
    s_add_u32 s47, s47, s48
    buffer_load_dword v78, v30, s[32:35], s47 offen
    buffer_load_dword v79, v31, s[32:35], s47 offen
    s_add_u32 s47, s47, s50
    buffer_load_dword v80, v30, s[32:35], s47 offen
    buffer_load_dword v81, v31, s[32:35], s47 offen
    s_add_u32 s47, s47, s48
    buffer_load_dword v82, v30, s[32:35], s47 offen
    buffer_load_dword v83, v31, s[32:35], s47 offen
    s_add_u32 s47, s47, s48
    buffer_load_dword v84, v30, s[32:35], s47 offen
    buffer_load_dword v85, v31, s[32:35], s47 offen
    s_add_u32 s47, s47, s48
    buffer_load_dword v86, v30, s[32:35], s47 offen
    buffer_load_dword v87, v31, s[32:35], s47 offen
    s_add_u32 s47, s47, s49
    buffer_load_dword v88, v30, s[32:35], s47 offen
    buffer_load_dword v89, v31, s[32:35], s47 offen
    s_add_u32 s47, s47, s48
    buffer_load_dword v90, v30, s[32:35], s47 offen
    buffer_load_dword v91, v31, s[32:35], s47 offen
    s_add_u32 s47, s47, s48
    buffer_load_dword v92, v30, s[32:35], s47 offen
    buffer_load_dword v93, v31, s[32:35], s47 offen
    s_add_u32 s47, s47, s48
    buffer_load_dword v94, v30, s[32:35], s47 offen
    buffer_load_dword v95, v31, s[32:35], s47 offen
    s_add_u32 s47, s47, s51
    buffer_load_dword v96, v30, s[32:35], s47 offen
    buffer_load_dword v97, v31, s[32:35], s47 offen
    s_add_u32 s47, s47, s48
    buffer_load_dword v98, v30, s[32:35], s47 offen
    buffer_load_dword v99, v31, s[32:35], s47 offen
    s_add_u32 s47, s47, s48
    buffer_load_dword v100, v30, s[32:35], s47 offen
    buffer_load_dword v101, v31, s[32:35], s47 offen
    s_add_u32 s47, s47, s48
    buffer_load_dword v102, v30, s[32:35], s47 offen
    buffer_load_dword v103, v31, s[32:35], s47 offen
    s_add_u32 s47, s47, s49
    buffer_load_dword v104, v30, s[32:35], s47 offen
    buffer_load_dword v105, v31, s[32:35], s47 offen
    s_add_u32 s47, s47, s48
    buffer_load_dword v106, v30, s[32:35], s47 offen
    buffer_load_dword v107, v31, s[32:35], s47 offen
    s_add_u32 s47, s47, s48
    buffer_load_dword v108, v30, s[32:35], s47 offen
    buffer_load_dword v109, v31, s[32:35], s47 offen
    s_add_u32 s47, s47, s48
    buffer_load_dword v110, v30, s[32:35], s47 offen
    buffer_load_dword v111, v31, s[32:35], s47 offen
    s_add_u32 s47, s47, s50
    buffer_load_dword v112, v30, s[32:35], s47 offen
    buffer_load_dword v113, v31, s[32:35], s47 offen
    s_add_u32 s47, s47, s48
    buffer_load_dword v114, v30, s[32:35], s47 offen
    buffer_load_dword v115, v31, s[32:35], s47 offen
    s_add_u32 s47, s47, s48
    buffer_load_dword v116, v30, s[32:35], s47 offen
    buffer_load_dword v117, v31, s[32:35], s47 offen
    s_add_u32 s47, s47, s48
    buffer_load_dword v118, v30, s[32:35], s47 offen
    buffer_load_dword v119, v31, s[32:35], s47 offen
    s_add_u32 s47, s47, s49
    buffer_load_dword v120, v30, s[32:35], s47 offen
    buffer_load_dword v121, v31, s[32:35], s47 offen
    s_add_u32 s47, s47, s48
    buffer_load_dword v122, v30, s[32:35], s47 offen
    buffer_load_dword v123, v31, s[32:35], s47 offen
    s_add_u32 s47, s47, s48
    s_waitcnt vmcnt(58)
    v_perm_b32 v128, v65, v64, s52
    v_perm_b32 v136, v65, v64, s53
    buffer_load_dword v64, v30, s[32:35], s47 offen
    buffer_load_dword v65, v31, s[32:35], s47 offen
    s_add_u32 s47, s47, s48
    s_waitcnt vmcnt(58)
    v_perm_b32 v129, v67, v66, s52
    v_perm_b32 v137, v67, v66, s53
    buffer_load_dword v66, v30, s[32:35], s47 offen
    buffer_load_dword v67, v31, s[32:35], s47 offen
    s_add_u32 s47, s47, s51
    s_waitcnt vmcnt(58)
    v_perm_b32 v130, v69, v68, s52
    v_perm_b32 v138, v69, v68, s53
    buffer_load_dword v68, v30, s[32:35], s47 offen
    buffer_load_dword v69, v31, s[32:35], s47 offen
    s_add_u32 s47, s47, s48
    s_waitcnt vmcnt(58)
    v_perm_b32 v131, v71, v70, s52
    v_perm_b32 v139, v71, v70, s53
    buffer_load_dword v70, v30, s[32:35], s47 offen
    buffer_load_dword v71, v31, s[32:35], s47 offen
    s_add_u32 s47, s47, s48
    s_waitcnt vmcnt(58)
    v_perm_b32 v132, v73, v72, s52
    v_perm_b32 v140, v73, v72, s53
    buffer_load_dword v72, v30, s[32:35], s47 offen
    buffer_load_dword v73, v31, s[32:35], s47 offen
    s_add_u32 s47, s47, s48
    s_waitcnt vmcnt(58)
    v_perm_b32 v133, v75, v74, s52
    v_perm_b32 v141, v75, v74, s53
    buffer_load_dword v74, v30, s[32:35], s47 offen
    buffer_load_dword v75, v31, s[32:35], s47 offen
    s_add_u32 s47, s47, s49
    s_waitcnt vmcnt(58)
    v_perm_b32 v134, v77, v76, s52
    v_perm_b32 v142, v77, v76, s53
    buffer_load_dword v76, v30, s[32:35], s47 offen
    buffer_load_dword v77, v31, s[32:35], s47 offen
    s_add_u32 s47, s47, s48
    s_waitcnt vmcnt(58)
    v_perm_b32 v135, v79, v78, s52
    v_perm_b32 v143, v79, v78, s53
    buffer_load_dword v78, v30, s[32:35], s47 offen
    buffer_load_dword v79, v31, s[32:35], s47 offen
    s_add_u32 s47, s47, s48
    s_waitcnt vmcnt(58)
    v_perm_b32 v144, v81, v80, s52
    v_perm_b32 v152, v81, v80, s53
    buffer_load_dword v80, v30, s[32:35], s47 offen
    buffer_load_dword v81, v31, s[32:35], s47 offen
    s_add_u32 s47, s47, s48
    s_waitcnt vmcnt(58)
    v_perm_b32 v145, v83, v82, s52
    v_perm_b32 v153, v83, v82, s53
    buffer_load_dword v82, v30, s[32:35], s47 offen
    buffer_load_dword v83, v31, s[32:35], s47 offen
    s_add_u32 s47, s47, s50
    s_waitcnt vmcnt(58)
    v_perm_b32 v146, v85, v84, s52
    v_perm_b32 v154, v85, v84, s53
    buffer_load_dword v84, v30, s[32:35], s47 offen
    buffer_load_dword v85, v31, s[32:35], s47 offen
    s_add_u32 s47, s47, s48
    s_waitcnt vmcnt(58)
    v_perm_b32 v147, v87, v86, s52
    v_perm_b32 v155, v87, v86, s53
    buffer_load_dword v86, v30, s[32:35], s47 offen
    buffer_load_dword v87, v31, s[32:35], s47 offen
    s_add_u32 s47, s47, s48
    s_waitcnt vmcnt(58)
    v_perm_b32 v148, v89, v88, s52
    v_perm_b32 v156, v89, v88, s53
    buffer_load_dword v88, v30, s[32:35], s47 offen
    buffer_load_dword v89, v31, s[32:35], s47 offen
    s_add_u32 s47, s47, s48
    s_waitcnt vmcnt(58)
    v_perm_b32 v149, v91, v90, s52
    v_perm_b32 v157, v91, v90, s53
    buffer_load_dword v90, v30, s[32:35], s47 offen
    buffer_load_dword v91, v31, s[32:35], s47 offen
    s_add_u32 s47, s47, s49
    s_waitcnt vmcnt(58)
    v_perm_b32 v150, v93, v92, s52
    v_perm_b32 v158, v93, v92, s53
    buffer_load_dword v92, v30, s[32:35], s47 offen
    buffer_load_dword v93, v31, s[32:35], s47 offen
    s_add_u32 s47, s47, s48
    s_waitcnt vmcnt(58)
    v_perm_b32 v151, v95, v94, s52
    v_perm_b32 v159, v95, v94, s53
    buffer_load_dword v94, v30, s[32:35], s47 offen
    buffer_load_dword v95, v31, s[32:35], s47 offen
    s_add_u32 s47, s47, s48
    s_waitcnt vmcnt(58)
    v_perm_b32 v160, v97, v96, s52
    v_perm_b32 v168, v97, v96, s53
    buffer_load_dword v96, v30, s[32:35], s47 offen
    buffer_load_dword v97, v31, s[32:35], s47 offen
    s_add_u32 s47, s47, s48
    s_waitcnt vmcnt(58)
    v_perm_b32 v161, v99, v98, s52
    v_perm_b32 v169, v99, v98, s53
    buffer_load_dword v98, v30, s[32:35], s47 offen
    buffer_load_dword v99, v31, s[32:35], s47 offen
    s_add_u32 s47, s47, s51
    s_waitcnt vmcnt(58)
    v_perm_b32 v162, v101, v100, s52
    v_perm_b32 v170, v101, v100, s53
    buffer_load_dword v100, v30, s[32:35], s47 offen
    buffer_load_dword v101, v31, s[32:35], s47 offen
    s_add_u32 s47, s47, s48
    s_waitcnt vmcnt(58)
    v_perm_b32 v163, v103, v102, s52
    v_perm_b32 v171, v103, v102, s53
    buffer_load_dword v102, v30, s[32:35], s47 offen
    buffer_load_dword v103, v31, s[32:35], s47 offen
    s_add_u32 s47, s47, s48
    s_waitcnt vmcnt(58)
    v_perm_b32 v164, v105, v104, s52
    v_perm_b32 v172, v105, v104, s53
    buffer_load_dword v104, v30, s[32:35], s47 offen
    buffer_load_dword v105, v31, s[32:35], s47 offen
    s_add_u32 s47, s47, s48
    s_waitcnt vmcnt(58)
    v_perm_b32 v165, v107, v106, s52
    v_perm_b32 v173, v107, v106, s53
    buffer_load_dword v106, v30, s[32:35], s47 offen
    buffer_load_dword v107, v31, s[32:35], s47 offen
    s_add_u32 s47, s47, s49
    s_waitcnt vmcnt(58)
    v_perm_b32 v166, v109, v108, s52
    v_perm_b32 v174, v109, v108, s53
    buffer_load_dword v108, v30, s[32:35], s47 offen
    buffer_load_dword v109, v31, s[32:35], s47 offen
    s_add_u32 s47, s47, s48
    s_waitcnt vmcnt(58)
    v_perm_b32 v167, v111, v110, s52
    v_perm_b32 v175, v111, v110, s53
    buffer_load_dword v110, v30, s[32:35], s47 offen
    buffer_load_dword v111, v31, s[32:35], s47 offen
    s_add_u32 s47, s47, s48
    s_waitcnt vmcnt(58)
    v_perm_b32 v176, v113, v112, s52
    v_perm_b32 v184, v113, v112, s53
    buffer_load_dword v112, v30, s[32:35], s47 offen
    buffer_load_dword v113, v31, s[32:35], s47 offen
    s_add_u32 s47, s47, s48
    s_waitcnt vmcnt(58)
    v_perm_b32 v177, v115, v114, s52
    v_perm_b32 v185, v115, v114, s53
    buffer_load_dword v114, v30, s[32:35], s47 offen
    buffer_load_dword v115, v31, s[32:35], s47 offen
    s_add_u32 s47, s47, s50
    s_waitcnt vmcnt(58)
    v_perm_b32 v178, v117, v116, s52
    v_perm_b32 v186, v117, v116, s53
    buffer_load_dword v116, v30, s[32:35], s47 offen
    buffer_load_dword v117, v31, s[32:35], s47 offen
    s_add_u32 s47, s47, s48
    s_waitcnt vmcnt(58)
    v_perm_b32 v179, v119, v118, s52
    v_perm_b32 v187, v119, v118, s53
    buffer_load_dword v118, v30, s[32:35], s47 offen
    buffer_load_dword v119, v31, s[32:35], s47 offen
    s_add_u32 s47, s47, s48
    s_waitcnt vmcnt(58)
    v_perm_b32 v180, v121, v120, s52
    v_perm_b32 v188, v121, v120, s53
    buffer_load_dword v120, v30, s[32:35], s47 offen
    buffer_load_dword v121, v31, s[32:35], s47 offen
    s_add_u32 s47, s47, s48
    s_waitcnt vmcnt(58)
    v_perm_b32 v181, v123, v122, s52
    v_perm_b32 v189, v123, v122, s53
    buffer_load_dword v122, v30, s[32:35], s47 offen
    buffer_load_dword v123, v31, s[32:35], s47 offen
    s_add_u32 s47, s47, s49
    s_waitcnt vmcnt(58)
    v_perm_b32 v182, v65, v64, s52
    v_perm_b32 v190, v65, v64, s53
    buffer_load_dword v64, v30, s[32:35], s47 offen
    buffer_load_dword v65, v31, s[32:35], s47 offen
    s_add_u32 s47, s47, s48
    s_waitcnt vmcnt(58)
    v_perm_b32 v183, v67, v66, s52
    v_perm_b32 v191, v67, v66, s53
    buffer_load_dword v66, v30, s[32:35], s47 offen
    buffer_load_dword v67, v31, s[32:35], s47 offen
    s_add_u32 s47, s47, s48
    s_waitcnt vmcnt(58)
    v_perm_b32 v192, v69, v68, s52
    v_perm_b32 v200, v69, v68, s53
    buffer_load_dword v68, v30, s[32:35], s47 offen
    buffer_load_dword v69, v31, s[32:35], s47 offen
    s_add_u32 s47, s47, s48
    s_waitcnt vmcnt(58)
    v_perm_b32 v193, v71, v70, s52
    v_perm_b32 v201, v71, v70, s53
    buffer_load_dword v70, v30, s[32:35], s47 offen
    buffer_load_dword v71, v31, s[32:35], s47 offen
    s_add_u32 s47, s47, s51
    s_waitcnt vmcnt(58)
    v_perm_b32 v194, v73, v72, s52
    v_perm_b32 v202, v73, v72, s53
    s_waitcnt vmcnt(56)
    v_perm_b32 v195, v75, v74, s52
    v_perm_b32 v203, v75, v74, s53
    s_waitcnt vmcnt(54)
    v_perm_b32 v196, v77, v76, s52
    v_perm_b32 v204, v77, v76, s53
    s_waitcnt vmcnt(52)
    v_perm_b32 v197, v79, v78, s52
    v_perm_b32 v205, v79, v78, s53
    s_waitcnt vmcnt(50)
    v_perm_b32 v198, v81, v80, s52
    v_perm_b32 v206, v81, v80, s53
    s_waitcnt vmcnt(48)
    v_perm_b32 v199, v83, v82, s52
    v_perm_b32 v207, v83, v82, s53
    s_waitcnt vmcnt(46)
    v_perm_b32 v208, v85, v84, s52
    v_perm_b32 v216, v85, v84, s53
    s_waitcnt vmcnt(44)
    v_perm_b32 v209, v87, v86, s52
    v_perm_b32 v217, v87, v86, s53
    s_waitcnt vmcnt(42)
    v_perm_b32 v210, v89, v88, s52
    v_perm_b32 v218, v89, v88, s53
    s_waitcnt vmcnt(40)
    v_perm_b32 v211, v91, v90, s52
    v_perm_b32 v219, v91, v90, s53
    s_waitcnt vmcnt(38)
    v_perm_b32 v212, v93, v92, s52
    v_perm_b32 v220, v93, v92, s53
    s_waitcnt vmcnt(36)
    v_perm_b32 v213, v95, v94, s52
    v_perm_b32 v221, v95, v94, s53
    s_waitcnt vmcnt(34)
    v_perm_b32 v214, v97, v96, s52
    v_perm_b32 v222, v97, v96, s53
    s_waitcnt vmcnt(32)
    v_perm_b32 v215, v99, v98, s52
    v_perm_b32 v223, v99, v98, s53
    s_waitcnt vmcnt(30)
    v_perm_b32 v224, v101, v100, s52
    v_perm_b32 v232, v101, v100, s53
    s_waitcnt vmcnt(28)
    v_perm_b32 v225, v103, v102, s52
    v_perm_b32 v233, v103, v102, s53
    s_waitcnt vmcnt(26)
    v_perm_b32 v226, v105, v104, s52
    v_perm_b32 v234, v105, v104, s53
    s_waitcnt vmcnt(24)
    v_perm_b32 v227, v107, v106, s52
    v_perm_b32 v235, v107, v106, s53
    s_waitcnt vmcnt(22)
    v_perm_b32 v228, v109, v108, s52
    v_perm_b32 v236, v109, v108, s53
    s_waitcnt vmcnt(20)
    v_perm_b32 v229, v111, v110, s52
    v_perm_b32 v237, v111, v110, s53
    s_waitcnt vmcnt(18)
    v_perm_b32 v230, v113, v112, s52
    v_perm_b32 v238, v113, v112, s53
    s_waitcnt vmcnt(16)
    v_perm_b32 v231, v115, v114, s52
    v_perm_b32 v239, v115, v114, s53
    s_waitcnt vmcnt(14)
    v_perm_b32 v240, v117, v116, s52
    v_perm_b32 v248, v117, v116, s53
    s_waitcnt vmcnt(12)
    v_perm_b32 v241, v119, v118, s52
    v_perm_b32 v249, v119, v118, s53
    s_waitcnt vmcnt(10)
    v_perm_b32 v242, v121, v120, s52
    v_perm_b32 v250, v121, v120, s53
    s_waitcnt vmcnt(8)
    v_perm_b32 v243, v123, v122, s52
    v_perm_b32 v251, v123, v122, s53
    s_waitcnt vmcnt(6)
    v_perm_b32 v244, v65, v64, s52
    v_perm_b32 v252, v65, v64, s53
    s_waitcnt vmcnt(4)
    v_perm_b32 v245, v67, v66, s52
    v_perm_b32 v253, v67, v66, s53
    s_waitcnt vmcnt(2)
    v_perm_b32 v246, v69, v68, s52
    v_perm_b32 v254, v69, v68, s53
    s_waitcnt vmcnt(0)
    v_perm_b32 v247, v71, v70, s52
    v_perm_b32 v255, v71, v70, s53
    s_nop 4
    s_setpc_b64 s[40:41]
.section .rodata,"a"
.p2align 6
.amdhsa_kernel parallel_sum__memory_aug_recurrent_mem_tr__glu_gated_reglu__prompt_kernel
  .amdhsa_next_free_vgpr 512
  .amdhsa_next_free_sgpr 102
  .amdhsa_accum_offset 256
  .amdhsa_group_segment_fixed_size 0
  .amdhsa_kernarg_size 112
  .amdhsa_user_sgpr_count 2
  .amdhsa_user_sgpr_kernarg_segment_ptr 1
  .amdhsa_system_sgpr_workgroup_id_x 1
.end_amdhsa_kernel
```
